```python
import torch

def _softmax(x, axis=-1):
    return torch.softmax(x, dim=axis)

def _gelu(x):
    return torch.nn.functional.gelu(x, approximate='tanh')

def _silu(x):
    return torch.nn.functional.silu(x)

def _sigmoid(x):
    return torch.sigmoid(x)

def _layernorm(x, axis=-1, eps=1e-05):
    m = x.mean(dim=axis, keepdim=True)
    v = x.var(dim=axis, keepdim=True, unbiased=False)
    return (x - m) / torch.sqrt(v + eps)

def _scatter_add(tgt, idx, src, axis=0):
    return tgt.clone().index_add_(axis, idx, src)

def _segment_sum(src, seg, n):
    out = torch.zeros((n,) + src.shape[1:], dtype=src.dtype)
    return out.index_add_(0, seg, src)

def _pad(x, pw):
    flat = tuple((v for pair in reversed(pw) for v in pair))
    return torch.nn.functional.pad(x, flat)
kernel_name = 'interleave_layers__memory_aug_recurrent_mem_tr__swiglu_ffn__prompt'

def setup_inputs():

    _w = lambda a: (lambda t: t.to(torch.bfloat16) if t.is_floating_point() else t)(torch.as_tensor(a))

    def _A_setup():
        B, S, Dm = (1, 2048, 448)
        H, Dh = (16, 256)
        M, seg = (8, 32)
        seg = min(seg, S)
        S = S // seg * seg
        return {'x': _w((lambda *s: torch.randn(*s, dtype=torch.bfloat16) * 0.05)(B, S, Dm)), 'mem0': _w((lambda *s: torch.randn(*s, dtype=torch.bfloat16) * 0.8)(B, M, Dm)), 'Wq': _w((lambda *s: torch.randn(*s, dtype=torch.bfloat16) * 1.6)(Dm, H, Dh) * Dm ** (-0.5)), 'Wk': _w((lambda *s: torch.randn(*s, dtype=torch.bfloat16) * 1.6)(Dm, H, Dh) * Dm ** (-0.5)), 'Wv': _w((lambda *s: torch.randn(*s, dtype=torch.bfloat16) * 0.8)(Dm, H, Dh) * Dm ** (-0.5)), 'Wo': _w((lambda *s: torch.randn(*s, dtype=torch.bfloat16) * 0.8)(H, Dh, Dm) * (H * Dh) ** (-0.5)), 'seg_len': seg}
    _A_in = _A_setup()

    def _B_setup():
        B, S, D, F = (1, 2048, 448, 1792)
        return {'x': _w((lambda *s: torch.randn(*s, dtype=torch.bfloat16) * 0.05)(B, S, D)), 'w_gate': _w((lambda *s: torch.randn(*s, dtype=torch.bfloat16) * 0.05)(D, F)), 'w_up': _w((lambda *s: torch.randn(*s, dtype=torch.bfloat16) * 0.05)(D, F)), 'w_down': _w((lambda *s: torch.randn(*s, dtype=torch.bfloat16) * 0.05)(F, D))}
    _B_in = _B_setup()
    return {'A_x': _A_in['x'], 'A_mem0': _A_in['mem0'], 'A_Wq': _A_in['Wq'], 'A_Wk': _A_in['Wk'], 'A_Wv': _A_in['Wv'], 'A_Wo': _A_in['Wo'], 'A_seg_len': _A_in['seg_len'], 'B_x': _B_in['x'], 'B_w_gate': _B_in['w_gate'], 'B_w_up': _B_in['w_up'], 'B_w_down': _B_in['w_down']}

def reference(A_x, A_mem0, A_Wq, A_Wk, A_Wv, A_Wo, A_seg_len, B_x, B_w_gate, B_w_up, B_w_down):

    def _A_ref(x, mem0, Wq, Wk, Wv, Wo, seg_len):
        B, S, Dm = x.shape
        H, Dh = (Wq.shape[1], Wq.shape[2])
        M = mem0.shape[1]
        scale = Dh ** (-0.5)
        n_seg = S // seg_len
        L = M + seg_len
        idx = torch.arange(L)
        mask = (idx[:, None] < M) | (idx[:, None] >= idx[None, :])
        mem = mem0
        outs = []
        for s in range(n_seg):
            xs = x[:, s * seg_len:(s + 1) * seg_len, :].clone()
            h = torch.concatenate([mem, xs], axis=1)
            q = torch.einsum('btd,dhe->bhte', h, Wq)
            k = torch.einsum('btd,dhe->bhte', h, Wk)
            v = torch.einsum('btd,dhe->bhte', h, Wv)
            scores = torch.einsum('bhqe,bhke->bhqk', q, k) * scale
            scores = torch.where(mask[None, None], scores, -1000000000.0)
            p = _softmax(scores, axis=-1)
            o = torch.einsum('bhqk,bhke->bhqe', p, v)
            o = torch.einsum('bhte,hed->btd', o, Wo)
            mem = o[:, :M, :].clone()
            outs.append(o[:, M:, :])
        return torch.concatenate(outs, axis=1)

    def _B_ref(x, w_gate, w_up, w_down):
        g = _silu(x @ w_gate)
        u = x @ w_up
        return g * u @ w_down
    x = A_x
    x = x + _A_ref(_layernorm(x, axis=-1), A_mem0, A_Wq, A_Wk, A_Wv, A_Wo, A_seg_len)
    x = x + _B_ref(_layernorm(x, axis=-1), B_w_gate, B_w_up, B_w_down)
    x = x + _A_ref(_layernorm(x, axis=-1), A_mem0, A_Wq, A_Wk, A_Wv, A_Wo, A_seg_len)
    x = x + _B_ref(_layernorm(x, axis=-1), B_w_gate, B_w_up, B_w_down)
    return x
```

```asm
; @launch grid=(256,1,1) block=(256,1,1) lds=163840
.amdgcn_target "amdgcn-amd-amdhsa--gfx950"
.text
.globl interleave_layers__memory_aug_recurrent_mem_tr__swiglu_ffn__prompt_kernel
.p2align 8
.type interleave_layers__memory_aug_recurrent_mem_tr__swiglu_ffn__prompt_kernel,@function
interleave_layers__memory_aug_recurrent_mem_tr__swiglu_ffn__prompt_kernel:
K_START:
s_load_dwordx2 s[4:5], s[0:1], 104
s_load_dwordx2 s[6:7], s[0:1], 96
v_lshrrev_b32 v2, 6, v0
v_and_b32 v1, 63, v0
v_readfirstlane_b32 s12, v2
s_waitcnt lgkmcnt(0)
s_mov_b32 s8, s4
s_and_b32 s9, s5, 0xffff
s_mov_b32 s10, 0x10000000
s_mov_b32 s11, 0x00020000
s_mov_b32 s16, 300000
s_mov_b32 s92, s6
s_and_b32 s93, s7, 0xffff
s_mov_b32 s94, 256
s_mov_b32 s95, 0x00020000
s_cmp_ge_u32 s2, 256
s_cbranch_scc1 M_EXIT
s_mov_b32 s52, 0x20202020
s_mov_b32 s53, 0x20202020
s_cmp_lg_u32 s12, 0
s_cbranch_scc1 M_WAITROLE
s_getreg_b32 s3, hwreg(HW_REG_XCC_ID, 0, 3)
s_lshl_b32 s3, s3, 2
s_lshr_b32 s3, 0x65742130, s3
s_and_b32 s3, s3, 7
s_mov_b64 exec, 1
v_mov_b32 v2, 1
s_lshl_b32 s17, s3, 5
buffer_atomic_add v2, off, s[92:95], s17 sc0 sc1
s_lshl_b32 s20, s3, 3
s_lshr_b64 s[54:55], s[52:53], s20
s_and_b32 s57, s54, 0xff
s_waitcnt vmcnt(0)
v_readfirstlane_b32 s13, v2
s_nop 0
s_and_b32 s13, s13, 0xffff
s_mov_b64 exec, -1
s_cmp_lt_u32 s13, s57
s_cbranch_scc1 M_GOTROLE
v_and_b32 v3, 7, v1
v_lshlrev_b32 v4, 3, v3
v_lshrrev_b64 v[4:5], v4, s[52:53]
v_and_b32 v4, 0xff, v4
v_lshlrev_b32 v3, 5, v3
s_mov_b32 s19, 60
M_SURP:
buffer_load_dword v5, v3, s[92:95], 0 offen sc1
s_waitcnt vmcnt(0)
v_and_b32 v5, 0xffff, v5
v_cmp_lt_u32 vcc, v5, v4
s_mov_b32 s3, 8
s_nop 2
s_cbranch_vccz M_GOTROLE
s_sleep 8
s_sub_u32 s19, s19, 1
s_cbranch_scc0 M_SURP
s_mov_b32 s19, 0
s_ff1_i32_b32 s3, vcc_lo
s_mov_b64 exec, 1
v_mov_b32 v2, 0x10001
s_lshl_b32 s17, s3, 5
buffer_atomic_add v2, off, s[92:95], s17 sc0 sc1
s_lshl_b32 s20, s3, 3
s_lshr_b64 s[54:55], s[52:53], s20
s_and_b32 s57, s54, 0xff
s_waitcnt vmcnt(0)
v_readfirstlane_b32 s13, v2
s_nop 0
s_and_b32 s13, s13, 0xffff
s_mov_b64 exec, -1
s_cmp_lt_u32 s13, s57
s_cbranch_scc0 M_SURP
M_GOTROLE:
s_lshl_b32 s17, s3, 16
s_or_b32 s17, s17, s13
v_mov_b32 v2, s17
v_mov_b32 v3, 0
ds_write_b32 v3, v2
s_waitcnt lgkmcnt(0)
M_WAITROLE:
s_barrier
v_mov_b32 v3, 0
ds_read_b32 v2, v3
s_waitcnt lgkmcnt(0)
v_readfirstlane_b32 s17, v2
s_barrier
s_lshr_b32 s3, s17, 16
s_and_b32 s13, s17, 0xffff
s_cmp_ge_u32 s3, 8
s_cbranch_scc1 M_EXIT
s_mov_b32 s101, s17
s_lshl_b32 s20, s3, 3
s_lshr_b64 s[54:55], s[52:53], s20
s_and_b32 s57, s54, 0xff
s_lshl_b32 s56, s3, 5
s_and_b32 s14, s3, 1
s_mov_b32 s91, s13
s_getpc_b64 s[54:55]
WCODE_1:
s_sub_u32 s54, s54, WCODE_1-K_START
s_subb_u32 s55, s55, 0
v_mbcnt_lo_u32_b32 v2, -1, 0
v_mbcnt_hi_u32_b32 v2, -1, v2
v_lshl_add_u32 v2, v2, 5, s91
v_lshlrev_b32 v2, 6, v2
v_min_u32 v2, K_END-K_START-4, v2
global_load_dword a254, v2, s[54:55]
s_cmp_eq_u32 s3, 0
s_cbranch_scc1 M_MISC
s_lshl_b32 s17, s3, 2
s_lshr_b32 s21, 0x3200f1f0, s17
s_lshr_b32 s18, 0xca, s3
s_and_b32 s18, s18, 1
s_cbranch_scc0 M_WARM
s_lshr_b32 s21, 0x32001000, s17
s_and_b32 s21, s21, 3
s_lshl_b32 s21, s21, 5
s_add_u32 s21, s21, s13
s_load_dwordx8 s[24:31], s[0:1], 16
s_lshr_b32 s22, s21, 2
s_and_b32 s36, s22, 15
s_lshr_b32 s37, s22, 4
s_and_b32 s23, s21, 3
s_lshl_b32 s23, s23, 2
s_add_u32 s23, s23, s12
s_min_u32 s38, s23, 13
v_mov_b32 v3, 0
v_mov_b32 v15, 1
v_lshrrev_b32 v18, 5, v1
v_and_b32 v19, 31, v1
v_xor_b32 v2, v19, v18
v_lshlrev_b32 v2, 4, v2
v_lshl_add_u32 v2, v18, 13, v2
s_cmp_eq_u32 s37, 0
s_waitcnt lgkmcnt(0)
s_cselect_b32 s40, s24, s28
s_cselect_b32 s41, s25, s29
s_cselect_b32 s44, s26, s30
s_cselect_b32 s45, s27, s31
s_and_b32 s41, s41, 0xffff
s_and_b32 s45, s45, 0xffff
s_mov_b32 s42, 3670016
s_mov_b32 s43, 0x00020000
s_mov_b32 s46, 3670016
s_mov_b32 s47, 0x00020000
s_lshr_b32 s17, s12, 1
s_lshl_b32 s48, s17, 5
s_and_b32 s18, s12, 1
s_lshl_b32 s19, s18, 3
s_add_u32 s48, s48, s19
s_lshl_b32 s48, s48, 13
s_lshl_b32 s19, s36, 9
s_add_u32 s48, s48, s19
s_lshl_b32 s49, s12, 13
s_lshl_b32 s50, s12, 14
s_cmp_eq_u32 s37, 1
s_cbranch_scc1 P_RB_2
s_lshl_b32 s51, s38, 18
s_add_u32 s51, s51, s19
v_xor_b32 v23, 0, v2
s_add_u32 s18, s51, 0
s_add_u32 m0, s50, 0
s_nop 0
buffer_load_dwordx4 v23, s[44:47], s18 offen lds
v_xor_b32 v23, 32, v2
s_add_u32 s18, s51, 16384
s_add_u32 m0, s50, 1024
s_nop 0
buffer_load_dwordx4 v23, s[44:47], s18 offen lds
v_xor_b32 v23, 64, v2
s_add_u32 s18, s51, 32768
s_add_u32 m0, s50, 2048
s_nop 0
buffer_load_dwordx4 v23, s[44:47], s18 offen lds
v_xor_b32 v23, 96, v2
s_add_u32 s18, s51, 49152
s_add_u32 m0, s50, 3072
s_nop 0
buffer_load_dwordx4 v23, s[44:47], s18 offen lds
v_xor_b32 v23, 128, v2
s_add_u32 s18, s51, 65536
s_add_u32 m0, s50, 4096
s_nop 0
buffer_load_dwordx4 v23, s[44:47], s18 offen lds
v_xor_b32 v23, 160, v2
s_add_u32 s18, s51, 81920
s_add_u32 m0, s50, 5120
s_nop 0
buffer_load_dwordx4 v23, s[44:47], s18 offen lds
v_xor_b32 v23, 192, v2
s_add_u32 s18, s51, 98304
s_add_u32 m0, s50, 6144
s_nop 0
buffer_load_dwordx4 v23, s[44:47], s18 offen lds
v_xor_b32 v23, 224, v2
s_add_u32 s18, s51, 114688
s_add_u32 m0, s50, 7168
s_nop 0
buffer_load_dwordx4 v23, s[44:47], s18 offen lds
v_xor_b32 v23, 0, v2
s_add_u32 s18, s51, 131072
s_add_u32 m0, s50, 8192
s_nop 0
buffer_load_dwordx4 v23, s[44:47], s18 offen lds
v_xor_b32 v23, 32, v2
s_add_u32 s18, s51, 147456
s_add_u32 m0, s50, 9216
s_nop 0
buffer_load_dwordx4 v23, s[44:47], s18 offen lds
v_xor_b32 v23, 64, v2
s_add_u32 s18, s51, 163840
s_add_u32 m0, s50, 10240
s_nop 0
buffer_load_dwordx4 v23, s[44:47], s18 offen lds
v_xor_b32 v23, 96, v2
s_add_u32 s18, s51, 180224
s_add_u32 m0, s50, 11264
s_nop 0
buffer_load_dwordx4 v23, s[44:47], s18 offen lds
v_xor_b32 v23, 128, v2
s_add_u32 s18, s51, 196608
s_add_u32 m0, s50, 12288
s_nop 0
buffer_load_dwordx4 v23, s[44:47], s18 offen lds
v_xor_b32 v23, 160, v2
s_add_u32 s18, s51, 212992
s_add_u32 m0, s50, 13312
s_nop 0
buffer_load_dwordx4 v23, s[44:47], s18 offen lds
v_xor_b32 v23, 192, v2
s_add_u32 s18, s51, 229376
s_add_u32 m0, s50, 14336
s_nop 0
buffer_load_dwordx4 v23, s[44:47], s18 offen lds
v_xor_b32 v23, 224, v2
s_add_u32 s18, s51, 245760
s_add_u32 m0, s50, 15360
s_nop 0
buffer_load_dwordx4 v23, s[44:47], s18 offen lds
s_branch P_RDONE_3
P_RB_2:
v_lshrrev_b32 v23, 2, v1
v_mul_u32_u24 v23, 896, v23
v_and_b32 v20, 3, v1
v_lshl_add_u32 v23, v20, 4, v23
s_mul_i32 s51, s36, 229376
s_lshl_b32 s20, s38, 6
s_add_u32 s51, s51, s20
s_add_u32 m0, s50, 0
s_nop 0
buffer_load_dwordx4 v23, s[44:47], s51 offen lds
s_add_u32 s51, s51, 14336
s_add_u32 m0, s50, 1024
s_nop 0
buffer_load_dwordx4 v23, s[44:47], s51 offen lds
s_add_u32 s51, s51, 14336
s_add_u32 m0, s50, 2048
s_nop 0
buffer_load_dwordx4 v23, s[44:47], s51 offen lds
s_add_u32 s51, s51, 14336
s_add_u32 m0, s50, 3072
s_nop 0
buffer_load_dwordx4 v23, s[44:47], s51 offen lds
s_add_u32 s51, s51, 14336
s_add_u32 m0, s50, 4096
s_nop 0
buffer_load_dwordx4 v23, s[44:47], s51 offen lds
s_add_u32 s51, s51, 14336
s_add_u32 m0, s50, 5120
s_nop 0
buffer_load_dwordx4 v23, s[44:47], s51 offen lds
s_add_u32 s51, s51, 14336
s_add_u32 m0, s50, 6144
s_nop 0
buffer_load_dwordx4 v23, s[44:47], s51 offen lds
s_add_u32 s51, s51, 14336
s_add_u32 m0, s50, 7168
s_nop 0
buffer_load_dwordx4 v23, s[44:47], s51 offen lds
s_add_u32 s51, s51, 14336
s_add_u32 m0, s50, 8192
s_nop 0
buffer_load_dwordx4 v23, s[44:47], s51 offen lds
s_add_u32 s51, s51, 14336
s_add_u32 m0, s50, 9216
s_nop 0
buffer_load_dwordx4 v23, s[44:47], s51 offen lds
s_add_u32 s51, s51, 14336
s_add_u32 m0, s50, 10240
s_nop 0
buffer_load_dwordx4 v23, s[44:47], s51 offen lds
s_add_u32 s51, s51, 14336
s_add_u32 m0, s50, 11264
s_nop 0
buffer_load_dwordx4 v23, s[44:47], s51 offen lds
s_add_u32 s51, s51, 14336
s_add_u32 m0, s50, 12288
s_nop 0
buffer_load_dwordx4 v23, s[44:47], s51 offen lds
s_add_u32 s51, s51, 14336
s_add_u32 m0, s50, 13312
s_nop 0
buffer_load_dwordx4 v23, s[44:47], s51 offen lds
s_add_u32 s51, s51, 14336
s_add_u32 m0, s50, 14336
s_nop 0
buffer_load_dwordx4 v23, s[44:47], s51 offen lds
s_add_u32 s51, s51, 14336
s_add_u32 m0, s50, 15360
s_nop 0
buffer_load_dwordx4 v23, s[44:47], s51 offen lds
s_add_u32 s51, s51, 14336
P_RDONE_3:
s_add_u32 s55, s49, 65536
v_xor_b32 v23, 0, v2
s_add_u32 s18, s48, 0
s_add_u32 m0, s55, 0
s_nop 0
buffer_load_dwordx4 v23, s[40:43], s18 offen lds
v_xor_b32 v23, 32, v2
s_add_u32 s18, s48, 16384
s_add_u32 m0, s55, 1024
s_nop 0
buffer_load_dwordx4 v23, s[40:43], s18 offen lds
v_xor_b32 v23, 64, v2
s_add_u32 s18, s48, 131072
s_add_u32 m0, s55, 2048
s_nop 0
buffer_load_dwordx4 v23, s[40:43], s18 offen lds
v_xor_b32 v23, 96, v2
s_add_u32 s18, s48, 147456
s_add_u32 m0, s55, 3072
s_nop 0
buffer_load_dwordx4 v23, s[40:43], s18 offen lds
v_xor_b32 v23, 128, v2
s_add_u32 s18, s48, 32768
s_add_u32 m0, s55, 4096
s_nop 0
buffer_load_dwordx4 v23, s[40:43], s18 offen lds
v_xor_b32 v23, 160, v2
s_add_u32 s18, s48, 49152
s_add_u32 m0, s55, 5120
s_nop 0
buffer_load_dwordx4 v23, s[40:43], s18 offen lds
v_xor_b32 v23, 192, v2
s_add_u32 s18, s48, 163840
s_add_u32 m0, s55, 6144
s_nop 0
buffer_load_dwordx4 v23, s[40:43], s18 offen lds
v_xor_b32 v23, 224, v2
s_add_u32 s18, s48, 180224
s_add_u32 m0, s55, 7168
s_nop 0
buffer_load_dwordx4 v23, s[40:43], s18 offen lds
s_add_u32 s48, s48, 524288
v_and_b32 v20, 15, v1
v_xor_b32 v20, v20, v18
v_lshlrev_b32 v20, 4, v20
v_lshl_add_u32 v20, v19, 9, v20
v_xor_b32 v4, 0, v20
v_xor_b32 v5, 32, v20
v_xor_b32 v6, 64, v20
v_xor_b32 v7, 96, v20
v_xor_b32 v8, 128, v20
v_xor_b32 v9, 160, v20
v_xor_b32 v10, 192, v20
v_xor_b32 v11, 224, v20
v_add_u32 v120, 65536, v4
v_add_u32 v121, 65536, v5
v_add_u32 v122, 65536, v6
v_add_u32 v123, 65536, v7
v_add_u32 v124, 65536, v8
v_add_u32 v125, 65536, v9
v_add_u32 v126, 65536, v10
v_add_u32 v127, 65536, v11
v_add_u32 v128, 131072, v4
v_add_u32 v129, 131072, v5
v_add_u32 v130, 131072, v6
v_add_u32 v131, 131072, v7
v_add_u32 v132, 131072, v8
v_add_u32 v133, 131072, v9
v_add_u32 v134, 131072, v10
v_add_u32 v135, 131072, v11
s_mul_i32 s39, s37, 14336
s_lshl_b32 s20, s36, 7
s_add_u32 s39, s39, s20
s_lshl_b32 s20, s23, 2
s_add_u32 s39, s39, s20
s_add_u32 s39, s39, 38797312
s_cmp_eq_u32 s37, 1
s_cbranch_scc1 P_OB_4
s_lshl_b32 s20, s38, 5
v_add_u32 v20, s20, v19
v_lshrrev_b32 v14, 4, v20
v_mul_u32_u24 v14, 14336, v14
v_and_b32 v21, 15, v20
v_lshl_add_u32 v14, v21, 4, v14
v_lshl_add_u32 v12, v18, 9, v14
v_add_u32 v13, 256, v12
s_mul_i32 s52, s36, 401408
s_add_u32 s52, s52, 0
s_mov_b32 s54, 1024
v_mov_b32 v16, 0x3db8aa3b
s_nop 0
s_branch P_ODONE_5
P_OB_4:
v_lshlrev_b32 v12, 4, v19
v_lshl_add_u32 v12, v18, 10, v12
v_add_u32 v13, 512, v12
s_mul_i32 s52, s36, 14
s_add_u32 s52, s52, s38
s_mul_i32 s52, s52, 28672
s_add_u32 s52, s52, 7340032
s_mov_b32 s54, 2048
v_mov_b32 v16, 1.0
P_ODONE_5:
s_cmp_ge_u32 s23, 14
s_cselect_b32 s52, 0x10000000, s52
s_waitcnt vmcnt(8)
s_cmp_eq_u32 s37, 1
s_cbranch_scc1 P_FB_6
v_add_u32 v20, s50, v4
ds_read_b128 v[24:27], v20
ds_read_b128 v[56:59], v20 offset:256
v_add_u32 v20, s50, v5
ds_read_b128 v[28:31], v20
ds_read_b128 v[60:63], v20 offset:256
v_add_u32 v20, s50, v6
ds_read_b128 v[32:35], v20
ds_read_b128 v[64:67], v20 offset:256
v_add_u32 v20, s50, v7
ds_read_b128 v[36:39], v20
ds_read_b128 v[68:71], v20 offset:256
v_add_u32 v20, s50, v8
ds_read_b128 v[40:43], v20
ds_read_b128 v[72:75], v20 offset:256
v_add_u32 v20, s50, v9
ds_read_b128 v[44:47], v20
ds_read_b128 v[76:79], v20 offset:256
v_add_u32 v20, s50, v10
ds_read_b128 v[48:51], v20
ds_read_b128 v[80:83], v20 offset:256
v_add_u32 v20, s50, v11
ds_read_b128 v[52:55], v20
ds_read_b128 v[84:87], v20 offset:256
s_branch P_FDONE_7
P_FB_6:
v_bfe_u32 v20, v1, 2, 2
v_lshl_add_u32 v20, v18, 3, v20
v_lshlrev_b32 v20, 6, v20
v_bfe_u32 v21, v1, 4, 1
v_lshl_add_u32 v20, v21, 5, v20
v_and_b32 v21, 3, v1
v_lshl_add_u32 v20, v21, 3, v20
v_add_u32 v20, s50, v20
ds_read_b64_tr_b16 v[24:25], v20 offset:0
ds_read_b64_tr_b16 v[26:27], v20 offset:256
ds_read_b64_tr_b16 v[28:29], v20 offset:1024
ds_read_b64_tr_b16 v[30:31], v20 offset:1280
ds_read_b64_tr_b16 v[32:33], v20 offset:2048
ds_read_b64_tr_b16 v[34:35], v20 offset:2304
ds_read_b64_tr_b16 v[36:37], v20 offset:3072
ds_read_b64_tr_b16 v[38:39], v20 offset:3328
ds_read_b64_tr_b16 v[40:41], v20 offset:4096
ds_read_b64_tr_b16 v[42:43], v20 offset:4352
ds_read_b64_tr_b16 v[44:45], v20 offset:5120
ds_read_b64_tr_b16 v[46:47], v20 offset:5376
ds_read_b64_tr_b16 v[48:49], v20 offset:6144
ds_read_b64_tr_b16 v[50:51], v20 offset:6400
ds_read_b64_tr_b16 v[52:53], v20 offset:7168
ds_read_b64_tr_b16 v[54:55], v20 offset:7424
ds_read_b64_tr_b16 v[56:57], v20 offset:8192
ds_read_b64_tr_b16 v[58:59], v20 offset:8448
ds_read_b64_tr_b16 v[60:61], v20 offset:9216
ds_read_b64_tr_b16 v[62:63], v20 offset:9472
ds_read_b64_tr_b16 v[64:65], v20 offset:10240
ds_read_b64_tr_b16 v[66:67], v20 offset:10496
ds_read_b64_tr_b16 v[68:69], v20 offset:11264
ds_read_b64_tr_b16 v[70:71], v20 offset:11520
ds_read_b64_tr_b16 v[72:73], v20 offset:12288
ds_read_b64_tr_b16 v[74:75], v20 offset:12544
ds_read_b64_tr_b16 v[76:77], v20 offset:13312
ds_read_b64_tr_b16 v[78:79], v20 offset:13568
ds_read_b64_tr_b16 v[80:81], v20 offset:14336
ds_read_b64_tr_b16 v[82:83], v20 offset:14592
ds_read_b64_tr_b16 v[84:85], v20 offset:15360
ds_read_b64_tr_b16 v[86:87], v20 offset:15616
v_and_b32 v20, 15, v1
v_lshlrev_b32 v20, 3, v20
v_bfe_u32 v21, v1, 4, 1
v_lshl_add_u32 v20, v21, 2, v20
v_lshl_add_u32 v20, v18, 7, v20
s_waitcnt lgkmcnt(0)
ds_bpermute_b32 v24, v20, v24
ds_bpermute_b32 v25, v20, v25
ds_bpermute_b32 v26, v20, v26
ds_bpermute_b32 v27, v20, v27
ds_bpermute_b32 v28, v20, v28
ds_bpermute_b32 v29, v20, v29
ds_bpermute_b32 v30, v20, v30
ds_bpermute_b32 v31, v20, v31
ds_bpermute_b32 v32, v20, v32
ds_bpermute_b32 v33, v20, v33
ds_bpermute_b32 v34, v20, v34
ds_bpermute_b32 v35, v20, v35
ds_bpermute_b32 v36, v20, v36
ds_bpermute_b32 v37, v20, v37
ds_bpermute_b32 v38, v20, v38
ds_bpermute_b32 v39, v20, v39
ds_bpermute_b32 v40, v20, v40
ds_bpermute_b32 v41, v20, v41
ds_bpermute_b32 v42, v20, v42
ds_bpermute_b32 v43, v20, v43
ds_bpermute_b32 v44, v20, v44
ds_bpermute_b32 v45, v20, v45
ds_bpermute_b32 v46, v20, v46
ds_bpermute_b32 v47, v20, v47
ds_bpermute_b32 v48, v20, v48
ds_bpermute_b32 v49, v20, v49
ds_bpermute_b32 v50, v20, v50
ds_bpermute_b32 v51, v20, v51
ds_bpermute_b32 v52, v20, v52
ds_bpermute_b32 v53, v20, v53
ds_bpermute_b32 v54, v20, v54
ds_bpermute_b32 v55, v20, v55
ds_bpermute_b32 v56, v20, v56
ds_bpermute_b32 v57, v20, v57
ds_bpermute_b32 v58, v20, v58
ds_bpermute_b32 v59, v20, v59
ds_bpermute_b32 v60, v20, v60
ds_bpermute_b32 v61, v20, v61
ds_bpermute_b32 v62, v20, v62
ds_bpermute_b32 v63, v20, v63
ds_bpermute_b32 v64, v20, v64
ds_bpermute_b32 v65, v20, v65
ds_bpermute_b32 v66, v20, v66
ds_bpermute_b32 v67, v20, v67
ds_bpermute_b32 v68, v20, v68
ds_bpermute_b32 v69, v20, v69
ds_bpermute_b32 v70, v20, v70
ds_bpermute_b32 v71, v20, v71
ds_bpermute_b32 v72, v20, v72
ds_bpermute_b32 v73, v20, v73
ds_bpermute_b32 v74, v20, v74
ds_bpermute_b32 v75, v20, v75
ds_bpermute_b32 v76, v20, v76
ds_bpermute_b32 v77, v20, v77
ds_bpermute_b32 v78, v20, v78
ds_bpermute_b32 v79, v20, v79
ds_bpermute_b32 v80, v20, v80
ds_bpermute_b32 v81, v20, v81
ds_bpermute_b32 v82, v20, v82
ds_bpermute_b32 v83, v20, v83
ds_bpermute_b32 v84, v20, v84
ds_bpermute_b32 v85, v20, v85
ds_bpermute_b32 v86, v20, v86
ds_bpermute_b32 v87, v20, v87
P_FDONE_7:
s_add_u32 s55, s49, 98304
v_xor_b32 v23, 0, v2
s_add_u32 s18, s48, 0
s_add_u32 m0, s55, 0
s_nop 0
buffer_load_dwordx4 v23, s[40:43], s18 offen lds
v_xor_b32 v23, 32, v2
s_add_u32 s18, s48, 16384
s_add_u32 m0, s55, 1024
s_nop 0
buffer_load_dwordx4 v23, s[40:43], s18 offen lds
v_xor_b32 v23, 64, v2
s_add_u32 s18, s48, 131072
s_add_u32 m0, s55, 2048
s_nop 0
buffer_load_dwordx4 v23, s[40:43], s18 offen lds
v_xor_b32 v23, 96, v2
s_add_u32 s18, s48, 147456
s_add_u32 m0, s55, 3072
s_nop 0
buffer_load_dwordx4 v23, s[40:43], s18 offen lds
v_xor_b32 v23, 128, v2
s_add_u32 s18, s48, 32768
s_add_u32 m0, s55, 4096
s_nop 0
buffer_load_dwordx4 v23, s[40:43], s18 offen lds
v_xor_b32 v23, 160, v2
s_add_u32 s18, s48, 49152
s_add_u32 m0, s55, 5120
s_nop 0
buffer_load_dwordx4 v23, s[40:43], s18 offen lds
v_xor_b32 v23, 192, v2
s_add_u32 s18, s48, 163840
s_add_u32 m0, s55, 6144
s_nop 0
buffer_load_dwordx4 v23, s[40:43], s18 offen lds
v_xor_b32 v23, 224, v2
s_add_u32 s18, s48, 180224
s_add_u32 m0, s55, 7168
s_nop 0
buffer_load_dwordx4 v23, s[40:43], s18 offen lds
s_add_u32 s48, s48, 524288
s_waitcnt lgkmcnt(0)
s_waitcnt vmcnt(8)
s_barrier
buffer_load_dword v22, off, s[92:95], 0 offset:176 sc1
s_add_u32 s55, s49, 131072
v_xor_b32 v23, 0, v2
s_add_u32 s18, s48, 0
s_add_u32 m0, s55, 0
s_nop 0
buffer_load_dwordx4 v23, s[40:43], s18 offen lds
v_xor_b32 v23, 32, v2
s_add_u32 s18, s48, 16384
s_add_u32 m0, s55, 1024
s_nop 0
buffer_load_dwordx4 v23, s[40:43], s18 offen lds
v_xor_b32 v23, 64, v2
s_add_u32 s18, s48, 131072
s_add_u32 m0, s55, 2048
s_nop 0
buffer_load_dwordx4 v23, s[40:43], s18 offen lds
v_xor_b32 v23, 96, v2
s_add_u32 s18, s48, 147456
s_add_u32 m0, s55, 3072
s_nop 0
buffer_load_dwordx4 v23, s[40:43], s18 offen lds
v_xor_b32 v23, 128, v2
s_add_u32 s18, s48, 32768
s_add_u32 m0, s55, 4096
s_nop 0
buffer_load_dwordx4 v23, s[40:43], s18 offen lds
v_xor_b32 v23, 160, v2
s_add_u32 s18, s48, 49152
s_add_u32 m0, s55, 5120
s_nop 0
buffer_load_dwordx4 v23, s[40:43], s18 offen lds
v_xor_b32 v23, 192, v2
s_add_u32 s18, s48, 163840
s_add_u32 m0, s55, 6144
s_nop 0
buffer_load_dwordx4 v23, s[40:43], s18 offen lds
v_xor_b32 v23, 224, v2
s_add_u32 s18, s48, 180224
s_add_u32 m0, s55, 7168
s_nop 0
buffer_load_dwordx4 v23, s[40:43], s18 offen lds
s_add_u32 s48, s48, 524288
ds_read_b128 v[88:91], v120 offset:0
ds_read_b128 v[92:95], v120 offset:16384
ds_read_b128 v[96:99], v121 offset:0
ds_read_b128 v[100:103], v121 offset:16384
ds_read_b128 v[104:107], v122 offset:0
ds_read_b128 v[108:111], v122 offset:16384
s_waitcnt lgkmcnt(5)
v_mfma_f32_32x32x16_bf16 v[144:159], v[88:91], v[24:27], 0
ds_read_b128 v[112:115], v123 offset:0
s_waitcnt lgkmcnt(5)
v_mfma_f32_32x32x16_bf16 v[160:175], v[92:95], v[24:27], 0
ds_read_b128 v[116:119], v123 offset:16384
s_waitcnt lgkmcnt(5)
v_mfma_f32_32x32x16_bf16 v[144:159], v[96:99], v[28:31], v[144:159]
ds_read_b128 v[88:91], v124 offset:0
s_waitcnt lgkmcnt(5)
v_mfma_f32_32x32x16_bf16 v[160:175], v[100:103], v[28:31], v[160:175]
ds_read_b128 v[92:95], v124 offset:16384
s_waitcnt lgkmcnt(5)
v_mfma_f32_32x32x16_bf16 v[144:159], v[104:107], v[32:35], v[144:159]
ds_read_b128 v[96:99], v125 offset:0
s_waitcnt lgkmcnt(5)
v_mfma_f32_32x32x16_bf16 v[160:175], v[108:111], v[32:35], v[160:175]
ds_read_b128 v[100:103], v125 offset:16384
s_waitcnt lgkmcnt(5)
v_mfma_f32_32x32x16_bf16 v[144:159], v[112:115], v[36:39], v[144:159]
ds_read_b128 v[104:107], v126 offset:0
s_waitcnt lgkmcnt(5)
v_mfma_f32_32x32x16_bf16 v[160:175], v[116:119], v[36:39], v[160:175]
ds_read_b128 v[108:111], v126 offset:16384
s_waitcnt lgkmcnt(5)
v_mfma_f32_32x32x16_bf16 v[144:159], v[88:91], v[40:43], v[144:159]
ds_read_b128 v[112:115], v127 offset:0
s_waitcnt lgkmcnt(5)
v_mfma_f32_32x32x16_bf16 v[160:175], v[92:95], v[40:43], v[160:175]
ds_read_b128 v[116:119], v127 offset:16384
s_waitcnt lgkmcnt(5)
v_mfma_f32_32x32x16_bf16 v[144:159], v[96:99], v[44:47], v[144:159]
ds_read_b128 v[88:91], v120 offset:256
s_waitcnt lgkmcnt(5)
v_mfma_f32_32x32x16_bf16 v[160:175], v[100:103], v[44:47], v[160:175]
ds_read_b128 v[92:95], v120 offset:16640
s_waitcnt lgkmcnt(5)
v_mfma_f32_32x32x16_bf16 v[144:159], v[104:107], v[48:51], v[144:159]
ds_read_b128 v[96:99], v121 offset:256
s_waitcnt lgkmcnt(5)
v_mfma_f32_32x32x16_bf16 v[160:175], v[108:111], v[48:51], v[160:175]
ds_read_b128 v[100:103], v121 offset:16640
s_waitcnt lgkmcnt(5)
v_mfma_f32_32x32x16_bf16 v[144:159], v[112:115], v[52:55], v[144:159]
ds_read_b128 v[104:107], v122 offset:256
s_waitcnt lgkmcnt(5)
v_mfma_f32_32x32x16_bf16 v[160:175], v[116:119], v[52:55], v[160:175]
ds_read_b128 v[108:111], v122 offset:16640
s_waitcnt lgkmcnt(5)
v_mfma_f32_32x32x16_bf16 v[144:159], v[88:91], v[56:59], v[144:159]
ds_read_b128 v[112:115], v123 offset:256
s_waitcnt lgkmcnt(5)
v_mfma_f32_32x32x16_bf16 v[160:175], v[92:95], v[56:59], v[160:175]
ds_read_b128 v[116:119], v123 offset:16640
s_waitcnt lgkmcnt(5)
v_mfma_f32_32x32x16_bf16 v[144:159], v[96:99], v[60:63], v[144:159]
ds_read_b128 v[88:91], v124 offset:256
s_waitcnt lgkmcnt(5)
v_mfma_f32_32x32x16_bf16 v[160:175], v[100:103], v[60:63], v[160:175]
ds_read_b128 v[92:95], v124 offset:16640
s_waitcnt lgkmcnt(5)
v_mfma_f32_32x32x16_bf16 v[144:159], v[104:107], v[64:67], v[144:159]
ds_read_b128 v[96:99], v125 offset:256
s_waitcnt lgkmcnt(5)
v_mfma_f32_32x32x16_bf16 v[160:175], v[108:111], v[64:67], v[160:175]
ds_read_b128 v[100:103], v125 offset:16640
s_waitcnt lgkmcnt(5)
v_mfma_f32_32x32x16_bf16 v[144:159], v[112:115], v[68:71], v[144:159]
ds_read_b128 v[104:107], v126 offset:256
s_waitcnt lgkmcnt(5)
v_mfma_f32_32x32x16_bf16 v[160:175], v[116:119], v[68:71], v[160:175]
ds_read_b128 v[108:111], v126 offset:16640
s_waitcnt lgkmcnt(5)
v_mfma_f32_32x32x16_bf16 v[144:159], v[88:91], v[72:75], v[144:159]
ds_read_b128 v[112:115], v127 offset:256
s_waitcnt lgkmcnt(5)
v_mfma_f32_32x32x16_bf16 v[160:175], v[92:95], v[72:75], v[160:175]
ds_read_b128 v[116:119], v127 offset:16640
s_waitcnt lgkmcnt(5)
v_mfma_f32_32x32x16_bf16 v[144:159], v[96:99], v[76:79], v[144:159]
s_waitcnt lgkmcnt(4)
v_mfma_f32_32x32x16_bf16 v[160:175], v[100:103], v[76:79], v[160:175]
s_waitcnt lgkmcnt(3)
v_mfma_f32_32x32x16_bf16 v[144:159], v[104:107], v[80:83], v[144:159]
s_waitcnt lgkmcnt(2)
v_mfma_f32_32x32x16_bf16 v[160:175], v[108:111], v[80:83], v[160:175]
s_waitcnt lgkmcnt(1)
v_mfma_f32_32x32x16_bf16 v[144:159], v[112:115], v[84:87], v[144:159]
s_waitcnt lgkmcnt(0)
v_mfma_f32_32x32x16_bf16 v[160:175], v[116:119], v[84:87], v[160:175]
s_waitcnt vmcnt(9)
s_barrier
s_add_u32 s55, s49, 0
v_xor_b32 v23, 0, v2
s_add_u32 s18, s48, 0
s_add_u32 m0, s55, 0
s_nop 0
buffer_load_dwordx4 v23, s[40:43], s18 offen lds
v_xor_b32 v23, 32, v2
s_add_u32 s18, s48, 16384
s_add_u32 m0, s55, 1024
s_nop 0
buffer_load_dwordx4 v23, s[40:43], s18 offen lds
v_xor_b32 v23, 64, v2
s_add_u32 s18, s48, 131072
s_add_u32 m0, s55, 2048
s_nop 0
buffer_load_dwordx4 v23, s[40:43], s18 offen lds
v_xor_b32 v23, 96, v2
s_add_u32 s18, s48, 147456
s_add_u32 m0, s55, 3072
s_nop 0
buffer_load_dwordx4 v23, s[40:43], s18 offen lds
v_xor_b32 v23, 128, v2
s_add_u32 s18, s48, 32768
s_add_u32 m0, s55, 4096
s_nop 0
buffer_load_dwordx4 v23, s[40:43], s18 offen lds
v_xor_b32 v23, 160, v2
s_add_u32 s18, s48, 49152
s_add_u32 m0, s55, 5120
s_nop 0
buffer_load_dwordx4 v23, s[40:43], s18 offen lds
v_xor_b32 v23, 192, v2
s_add_u32 s18, s48, 163840
s_add_u32 m0, s55, 6144
s_nop 0
buffer_load_dwordx4 v23, s[40:43], s18 offen lds
v_xor_b32 v23, 224, v2
s_add_u32 s18, s48, 180224
s_add_u32 m0, s55, 7168
s_nop 0
buffer_load_dwordx4 v23, s[40:43], s18 offen lds
s_add_u32 s48, s48, 524288
s_add_u32 s55, s49, 32768
v_xor_b32 v23, 0, v2
s_add_u32 s18, s48, 0
s_add_u32 m0, s55, 0
s_nop 0
buffer_load_dwordx4 v23, s[40:43], s18 offen lds
v_xor_b32 v23, 32, v2
s_add_u32 s18, s48, 16384
s_add_u32 m0, s55, 1024
s_nop 0
buffer_load_dwordx4 v23, s[40:43], s18 offen lds
v_xor_b32 v23, 64, v2
s_add_u32 s18, s48, 131072
s_add_u32 m0, s55, 2048
s_nop 0
buffer_load_dwordx4 v23, s[40:43], s18 offen lds
v_xor_b32 v23, 96, v2
s_add_u32 s18, s48, 147456
s_add_u32 m0, s55, 3072
s_nop 0
buffer_load_dwordx4 v23, s[40:43], s18 offen lds
v_xor_b32 v23, 128, v2
s_add_u32 s18, s48, 32768
s_add_u32 m0, s55, 4096
s_nop 0
buffer_load_dwordx4 v23, s[40:43], s18 offen lds
v_xor_b32 v23, 160, v2
s_add_u32 s18, s48, 49152
s_add_u32 m0, s55, 5120
s_nop 0
buffer_load_dwordx4 v23, s[40:43], s18 offen lds
v_xor_b32 v23, 192, v2
s_add_u32 s18, s48, 163840
s_add_u32 m0, s55, 6144
s_nop 0
buffer_load_dwordx4 v23, s[40:43], s18 offen lds
v_xor_b32 v23, 224, v2
s_add_u32 s18, s48, 180224
s_add_u32 m0, s55, 7168
s_nop 0
buffer_load_dwordx4 v23, s[40:43], s18 offen lds
s_add_u32 s48, s48, 524288
ds_read_b128 v[88:91], v120 offset:32768
ds_read_b128 v[92:95], v120 offset:49152
ds_read_b128 v[96:99], v121 offset:32768
ds_read_b128 v[100:103], v121 offset:49152
ds_read_b128 v[104:107], v122 offset:32768
ds_read_b128 v[108:111], v122 offset:49152
s_waitcnt lgkmcnt(5)
v_mfma_f32_32x32x16_bf16 v[176:191], v[88:91], v[24:27], 0
ds_read_b128 v[112:115], v123 offset:32768
s_waitcnt lgkmcnt(5)
v_mfma_f32_32x32x16_bf16 v[192:207], v[92:95], v[24:27], 0
ds_read_b128 v[116:119], v123 offset:49152
s_waitcnt lgkmcnt(5)
v_mfma_f32_32x32x16_bf16 v[176:191], v[96:99], v[28:31], v[176:191]
ds_read_b128 v[88:91], v124 offset:32768
v_mul_f32 v144, v144, v16
v_mul_f32 v145, v145, v16
v_mul_f32 v146, v146, v16
v_mul_f32 v147, v147, v16
s_waitcnt lgkmcnt(5)
v_mfma_f32_32x32x16_bf16 v[192:207], v[100:103], v[28:31], v[192:207]
ds_read_b128 v[92:95], v124 offset:49152
v_mul_f32 v148, v148, v16
v_mul_f32 v149, v149, v16
v_mul_f32 v150, v150, v16
v_mul_f32 v151, v151, v16
s_waitcnt lgkmcnt(5)
v_mfma_f32_32x32x16_bf16 v[176:191], v[104:107], v[32:35], v[176:191]
ds_read_b128 v[96:99], v125 offset:32768
v_mul_f32 v152, v152, v16
v_mul_f32 v153, v153, v16
v_mul_f32 v154, v154, v16
v_mul_f32 v155, v155, v16
s_waitcnt lgkmcnt(5)
v_mfma_f32_32x32x16_bf16 v[192:207], v[108:111], v[32:35], v[192:207]
ds_read_b128 v[100:103], v125 offset:49152
v_mul_f32 v156, v156, v16
v_mul_f32 v157, v157, v16
v_mul_f32 v158, v158, v16
v_mul_f32 v159, v159, v16
s_waitcnt lgkmcnt(5)
v_mfma_f32_32x32x16_bf16 v[176:191], v[112:115], v[36:39], v[176:191]
ds_read_b128 v[104:107], v126 offset:32768
v_cvt_pk_bf16_f32 v208, v144, v145
v_cvt_pk_bf16_f32 v209, v146, v147
v_cvt_pk_bf16_f32 v210, v148, v149
v_cvt_pk_bf16_f32 v211, v150, v151
s_waitcnt lgkmcnt(5)
v_mfma_f32_32x32x16_bf16 v[192:207], v[116:119], v[36:39], v[192:207]
ds_read_b128 v[108:111], v126 offset:49152
v_cvt_pk_bf16_f32 v212, v152, v153
v_cvt_pk_bf16_f32 v213, v154, v155
v_cvt_pk_bf16_f32 v214, v156, v157
v_cvt_pk_bf16_f32 v215, v158, v159
s_waitcnt lgkmcnt(5)
v_mfma_f32_32x32x16_bf16 v[176:191], v[88:91], v[40:43], v[176:191]
ds_read_b128 v[112:115], v127 offset:32768
buffer_store_dwordx4 v[208:211], v12, s[8:11], s52 offen sc1
buffer_store_dwordx4 v[212:215], v13, s[8:11], s52 offen sc1
s_add_u32 s52, s52, s54
v_mul_f32 v160, v160, v16
s_waitcnt lgkmcnt(5)
v_mfma_f32_32x32x16_bf16 v[192:207], v[92:95], v[40:43], v[192:207]
ds_read_b128 v[116:119], v127 offset:49152
v_mul_f32 v161, v161, v16
v_mul_f32 v162, v162, v16
v_mul_f32 v163, v163, v16
v_mul_f32 v164, v164, v16
s_waitcnt lgkmcnt(5)
v_mfma_f32_32x32x16_bf16 v[176:191], v[96:99], v[44:47], v[176:191]
ds_read_b128 v[88:91], v120 offset:33024
v_mul_f32 v165, v165, v16
v_mul_f32 v166, v166, v16
v_mul_f32 v167, v167, v16
v_mul_f32 v168, v168, v16
s_waitcnt lgkmcnt(5)
v_mfma_f32_32x32x16_bf16 v[192:207], v[100:103], v[44:47], v[192:207]
ds_read_b128 v[92:95], v120 offset:49408
v_mul_f32 v169, v169, v16
v_mul_f32 v170, v170, v16
v_mul_f32 v171, v171, v16
v_mul_f32 v172, v172, v16
s_waitcnt lgkmcnt(5)
v_mfma_f32_32x32x16_bf16 v[176:191], v[104:107], v[48:51], v[176:191]
ds_read_b128 v[96:99], v121 offset:33024
v_mul_f32 v173, v173, v16
v_mul_f32 v174, v174, v16
v_mul_f32 v175, v175, v16
v_cvt_pk_bf16_f32 v224, v160, v161
s_waitcnt lgkmcnt(5)
v_mfma_f32_32x32x16_bf16 v[192:207], v[108:111], v[48:51], v[192:207]
ds_read_b128 v[100:103], v121 offset:49408
v_cvt_pk_bf16_f32 v225, v162, v163
v_cvt_pk_bf16_f32 v226, v164, v165
v_cvt_pk_bf16_f32 v227, v166, v167
v_cvt_pk_bf16_f32 v228, v168, v169
s_waitcnt lgkmcnt(5)
v_mfma_f32_32x32x16_bf16 v[176:191], v[112:115], v[52:55], v[176:191]
ds_read_b128 v[104:107], v122 offset:33024
v_cvt_pk_bf16_f32 v229, v170, v171
v_cvt_pk_bf16_f32 v230, v172, v173
v_cvt_pk_bf16_f32 v231, v174, v175
buffer_store_dwordx4 v[224:227], v12, s[8:11], s52 offen sc1
s_waitcnt lgkmcnt(5)
v_mfma_f32_32x32x16_bf16 v[192:207], v[116:119], v[52:55], v[192:207]
ds_read_b128 v[108:111], v122 offset:49408
buffer_store_dwordx4 v[228:231], v13, s[8:11], s52 offen sc1
s_add_u32 s52, s52, s54
s_waitcnt lgkmcnt(5)
v_mfma_f32_32x32x16_bf16 v[176:191], v[88:91], v[56:59], v[176:191]
ds_read_b128 v[112:115], v123 offset:33024
s_waitcnt lgkmcnt(5)
v_mfma_f32_32x32x16_bf16 v[192:207], v[92:95], v[56:59], v[192:207]
ds_read_b128 v[116:119], v123 offset:49408
s_waitcnt lgkmcnt(5)
v_mfma_f32_32x32x16_bf16 v[176:191], v[96:99], v[60:63], v[176:191]
ds_read_b128 v[88:91], v124 offset:33024
s_waitcnt lgkmcnt(5)
v_mfma_f32_32x32x16_bf16 v[192:207], v[100:103], v[60:63], v[192:207]
ds_read_b128 v[92:95], v124 offset:49408
s_waitcnt lgkmcnt(5)
v_mfma_f32_32x32x16_bf16 v[176:191], v[104:107], v[64:67], v[176:191]
ds_read_b128 v[96:99], v125 offset:33024
s_waitcnt lgkmcnt(5)
v_mfma_f32_32x32x16_bf16 v[192:207], v[108:111], v[64:67], v[192:207]
ds_read_b128 v[100:103], v125 offset:49408
s_waitcnt lgkmcnt(5)
v_mfma_f32_32x32x16_bf16 v[176:191], v[112:115], v[68:71], v[176:191]
ds_read_b128 v[104:107], v126 offset:33024
s_waitcnt lgkmcnt(5)
v_mfma_f32_32x32x16_bf16 v[192:207], v[116:119], v[68:71], v[192:207]
ds_read_b128 v[108:111], v126 offset:49408
s_waitcnt lgkmcnt(5)
v_mfma_f32_32x32x16_bf16 v[176:191], v[88:91], v[72:75], v[176:191]
ds_read_b128 v[112:115], v127 offset:33024
s_waitcnt lgkmcnt(5)
v_mfma_f32_32x32x16_bf16 v[192:207], v[92:95], v[72:75], v[192:207]
ds_read_b128 v[116:119], v127 offset:49408
s_waitcnt lgkmcnt(5)
v_mfma_f32_32x32x16_bf16 v[176:191], v[96:99], v[76:79], v[176:191]
s_waitcnt lgkmcnt(4)
v_mfma_f32_32x32x16_bf16 v[192:207], v[100:103], v[76:79], v[192:207]
s_waitcnt lgkmcnt(3)
v_mfma_f32_32x32x16_bf16 v[176:191], v[104:107], v[80:83], v[176:191]
s_waitcnt lgkmcnt(2)
v_mfma_f32_32x32x16_bf16 v[192:207], v[108:111], v[80:83], v[192:207]
s_waitcnt lgkmcnt(1)
v_mfma_f32_32x32x16_bf16 v[176:191], v[112:115], v[84:87], v[176:191]
s_waitcnt lgkmcnt(0)
v_mfma_f32_32x32x16_bf16 v[192:207], v[116:119], v[84:87], v[192:207]
s_mov_b32 s33, 1
s_cmp_eq_u32 s33, 0
s_cbranch_scc1 OPT_9
s_getreg_b32 s20, hwreg(HW_REG_IB_STS)
s_and_b32 s20, s20, 0xc0000f
s_cmp_gt_u32 s20, 0
s_cbranch_scc1 OPT_9
s_waitcnt vmcnt(0)
GI_10:
v_cmp_gt_u32 vcc, 4, v22
s_cbranch_vccnz GI_10_p
GI_10_ok:
s_mov_b64 exec, 1
buffer_store_dword v15, v3, s[8:11], s39 offen sc1
s_mov_b64 exec, -1
s_add_u32 s39, s39, 2048
s_mov_b32 s33, 0
OPT_9:
s_waitcnt vmcnt(20)
s_barrier
s_add_u32 s55, s49, 65536
v_xor_b32 v23, 0, v2
s_add_u32 s18, s48, 0
s_add_u32 m0, s55, 0
s_nop 0
buffer_load_dwordx4 v23, s[40:43], s18 offen lds
v_xor_b32 v23, 32, v2
s_add_u32 s18, s48, 16384
s_add_u32 m0, s55, 1024
s_nop 0
buffer_load_dwordx4 v23, s[40:43], s18 offen lds
v_xor_b32 v23, 64, v2
s_add_u32 s18, s48, 131072
s_add_u32 m0, s55, 2048
s_nop 0
buffer_load_dwordx4 v23, s[40:43], s18 offen lds
v_xor_b32 v23, 96, v2
s_add_u32 s18, s48, 147456
s_add_u32 m0, s55, 3072
s_nop 0
buffer_load_dwordx4 v23, s[40:43], s18 offen lds
v_xor_b32 v23, 128, v2
s_add_u32 s18, s48, 32768
s_add_u32 m0, s55, 4096
s_nop 0
buffer_load_dwordx4 v23, s[40:43], s18 offen lds
v_xor_b32 v23, 160, v2
s_add_u32 s18, s48, 49152
s_add_u32 m0, s55, 5120
s_nop 0
buffer_load_dwordx4 v23, s[40:43], s18 offen lds
v_xor_b32 v23, 192, v2
s_add_u32 s18, s48, 163840
s_add_u32 m0, s55, 6144
s_nop 0
buffer_load_dwordx4 v23, s[40:43], s18 offen lds
v_xor_b32 v23, 224, v2
s_add_u32 s18, s48, 180224
s_add_u32 m0, s55, 7168
s_nop 0
buffer_load_dwordx4 v23, s[40:43], s18 offen lds
s_add_u32 s48, s48, 524288
s_add_u32 s55, s49, 98304
v_xor_b32 v23, 0, v2
s_add_u32 s18, s48, 0
s_add_u32 m0, s55, 0
s_nop 0
buffer_load_dwordx4 v23, s[40:43], s18 offen lds
v_xor_b32 v23, 32, v2
s_add_u32 s18, s48, 16384
s_add_u32 m0, s55, 1024
s_nop 0
buffer_load_dwordx4 v23, s[40:43], s18 offen lds
v_xor_b32 v23, 64, v2
s_add_u32 s18, s48, 131072
s_add_u32 m0, s55, 2048
s_nop 0
buffer_load_dwordx4 v23, s[40:43], s18 offen lds
v_xor_b32 v23, 96, v2
s_add_u32 s18, s48, 147456
s_add_u32 m0, s55, 3072
s_nop 0
buffer_load_dwordx4 v23, s[40:43], s18 offen lds
v_xor_b32 v23, 128, v2
s_add_u32 s18, s48, 32768
s_add_u32 m0, s55, 4096
s_nop 0
buffer_load_dwordx4 v23, s[40:43], s18 offen lds
v_xor_b32 v23, 160, v2
s_add_u32 s18, s48, 49152
s_add_u32 m0, s55, 5120
s_nop 0
buffer_load_dwordx4 v23, s[40:43], s18 offen lds
v_xor_b32 v23, 192, v2
s_add_u32 s18, s48, 163840
s_add_u32 m0, s55, 6144
s_nop 0
buffer_load_dwordx4 v23, s[40:43], s18 offen lds
v_xor_b32 v23, 224, v2
s_add_u32 s18, s48, 180224
s_add_u32 m0, s55, 7168
s_nop 0
buffer_load_dwordx4 v23, s[40:43], s18 offen lds
s_add_u32 s48, s48, 524288
ds_read_b128 v[88:91], v128 offset:0
ds_read_b128 v[92:95], v128 offset:16384
ds_read_b128 v[96:99], v129 offset:0
ds_read_b128 v[100:103], v129 offset:16384
ds_read_b128 v[104:107], v130 offset:0
ds_read_b128 v[108:111], v130 offset:16384
s_waitcnt lgkmcnt(5)
v_mfma_f32_32x32x16_bf16 v[144:159], v[88:91], v[24:27], 0
s_cmp_eq_u32 s33, 0
s_cbranch_scc1 OPT_12
s_getreg_b32 s20, hwreg(HW_REG_IB_STS)
s_and_b32 s20, s20, 0xc0000f
s_cmp_gt_u32 s20, 4194304
s_cbranch_scc1 OPT_12
s_waitcnt vmcnt(16)
GI_13:
v_cmp_gt_u32 vcc, 4, v22
s_cbranch_vccnz GI_13_p
GI_13_ok:
s_mov_b64 exec, 1
buffer_store_dword v15, v3, s[8:11], s39 offen sc1
s_mov_b64 exec, -1
s_add_u32 s39, s39, 2048
s_mov_b32 s33, 0
OPT_12:
ds_read_b128 v[112:115], v131 offset:0
s_waitcnt lgkmcnt(5)
v_mfma_f32_32x32x16_bf16 v[160:175], v[92:95], v[24:27], 0
ds_read_b128 v[116:119], v131 offset:16384
s_waitcnt lgkmcnt(5)
v_mfma_f32_32x32x16_bf16 v[144:159], v[96:99], v[28:31], v[144:159]
ds_read_b128 v[88:91], v132 offset:0
v_mul_f32 v176, v176, v16
v_mul_f32 v177, v177, v16
v_mul_f32 v178, v178, v16
v_mul_f32 v179, v179, v16
s_waitcnt lgkmcnt(5)
v_mfma_f32_32x32x16_bf16 v[160:175], v[100:103], v[28:31], v[160:175]
ds_read_b128 v[92:95], v132 offset:16384
v_mul_f32 v180, v180, v16
v_mul_f32 v181, v181, v16
v_mul_f32 v182, v182, v16
v_mul_f32 v183, v183, v16
s_waitcnt lgkmcnt(5)
v_mfma_f32_32x32x16_bf16 v[144:159], v[104:107], v[32:35], v[144:159]
ds_read_b128 v[96:99], v133 offset:0
v_mul_f32 v184, v184, v16
v_mul_f32 v185, v185, v16
v_mul_f32 v186, v186, v16
v_mul_f32 v187, v187, v16
s_waitcnt lgkmcnt(5)
v_mfma_f32_32x32x16_bf16 v[160:175], v[108:111], v[32:35], v[160:175]
ds_read_b128 v[100:103], v133 offset:16384
v_mul_f32 v188, v188, v16
v_mul_f32 v189, v189, v16
v_mul_f32 v190, v190, v16
v_mul_f32 v191, v191, v16
s_waitcnt lgkmcnt(5)
v_mfma_f32_32x32x16_bf16 v[144:159], v[112:115], v[36:39], v[144:159]
s_cmp_eq_u32 s33, 0
s_cbranch_scc1 OPT_15
s_getreg_b32 s20, hwreg(HW_REG_IB_STS)
s_and_b32 s20, s20, 0xc0000f
s_cmp_gt_u32 s20, 4194304
s_cbranch_scc1 OPT_15
s_waitcnt vmcnt(16)
GI_16:
v_cmp_gt_u32 vcc, 4, v22
s_cbranch_vccnz GI_16_p
GI_16_ok:
s_mov_b64 exec, 1
buffer_store_dword v15, v3, s[8:11], s39 offen sc1
s_mov_b64 exec, -1
s_add_u32 s39, s39, 2048
s_mov_b32 s33, 0
OPT_15:
ds_read_b128 v[104:107], v134 offset:0
s_waitcnt lgkmcnt(5)
v_mfma_f32_32x32x16_bf16 v[160:175], v[116:119], v[36:39], v[160:175]
ds_read_b128 v[108:111], v134 offset:16384
v_cvt_pk_bf16_f32 v208, v176, v177
v_cvt_pk_bf16_f32 v209, v178, v179
v_cvt_pk_bf16_f32 v210, v180, v181
v_cvt_pk_bf16_f32 v211, v182, v183
s_waitcnt lgkmcnt(5)
v_mfma_f32_32x32x16_bf16 v[144:159], v[88:91], v[40:43], v[144:159]
ds_read_b128 v[112:115], v135 offset:0
v_cvt_pk_bf16_f32 v212, v184, v185
v_cvt_pk_bf16_f32 v213, v186, v187
v_cvt_pk_bf16_f32 v214, v188, v189
v_cvt_pk_bf16_f32 v215, v190, v191
s_waitcnt lgkmcnt(5)
v_mfma_f32_32x32x16_bf16 v[160:175], v[92:95], v[40:43], v[160:175]
ds_read_b128 v[116:119], v135 offset:16384
buffer_store_dwordx4 v[208:211], v12, s[8:11], s52 offen sc1
buffer_store_dwordx4 v[212:215], v13, s[8:11], s52 offen sc1
s_add_u32 s52, s52, s54
v_mul_f32 v192, v192, v16
s_waitcnt lgkmcnt(5)
v_mfma_f32_32x32x16_bf16 v[144:159], v[96:99], v[44:47], v[144:159]
ds_read_b128 v[88:91], v128 offset:256
v_mul_f32 v193, v193, v16
v_mul_f32 v194, v194, v16
v_mul_f32 v195, v195, v16
v_mul_f32 v196, v196, v16
s_waitcnt lgkmcnt(5)
v_mfma_f32_32x32x16_bf16 v[160:175], v[100:103], v[44:47], v[160:175]
ds_read_b128 v[92:95], v128 offset:16640
v_mul_f32 v197, v197, v16
v_mul_f32 v198, v198, v16
v_mul_f32 v199, v199, v16
v_mul_f32 v200, v200, v16
s_waitcnt lgkmcnt(5)
v_mfma_f32_32x32x16_bf16 v[144:159], v[104:107], v[48:51], v[144:159]
s_cmp_eq_u32 s33, 0
s_cbranch_scc1 OPT_18
s_waitcnt vmcnt(18)
GI_19:
v_cmp_gt_u32 vcc, 4, v22
s_cbranch_vccnz GI_19_p
GI_19_ok:
s_mov_b64 exec, 1
buffer_store_dword v15, v3, s[8:11], s39 offen sc1
s_mov_b64 exec, -1
s_add_u32 s39, s39, 2048
s_mov_b32 s33, 0
OPT_18:
ds_read_b128 v[96:99], v129 offset:256
s_waitcnt lgkmcnt(5)
v_mfma_f32_32x32x16_bf16 v[160:175], v[108:111], v[48:51], v[160:175]
ds_read_b128 v[100:103], v129 offset:16640
v_mul_f32 v201, v201, v16
v_mul_f32 v202, v202, v16
v_mul_f32 v203, v203, v16
v_mul_f32 v204, v204, v16
s_waitcnt lgkmcnt(5)
v_mfma_f32_32x32x16_bf16 v[144:159], v[112:115], v[52:55], v[144:159]
ds_read_b128 v[104:107], v130 offset:256
v_mul_f32 v205, v205, v16
v_mul_f32 v206, v206, v16
v_mul_f32 v207, v207, v16
v_cvt_pk_bf16_f32 v224, v192, v193
s_waitcnt lgkmcnt(5)
v_mfma_f32_32x32x16_bf16 v[160:175], v[116:119], v[52:55], v[160:175]
ds_read_b128 v[108:111], v130 offset:16640
v_cvt_pk_bf16_f32 v225, v194, v195
v_cvt_pk_bf16_f32 v226, v196, v197
v_cvt_pk_bf16_f32 v227, v198, v199
v_cvt_pk_bf16_f32 v228, v200, v201
s_waitcnt lgkmcnt(5)
v_mfma_f32_32x32x16_bf16 v[144:159], v[88:91], v[56:59], v[144:159]
ds_read_b128 v[112:115], v131 offset:256
v_cvt_pk_bf16_f32 v229, v202, v203
v_cvt_pk_bf16_f32 v230, v204, v205
v_cvt_pk_bf16_f32 v231, v206, v207
buffer_store_dwordx4 v[224:227], v12, s[8:11], s52 offen sc1
s_waitcnt lgkmcnt(5)
v_mfma_f32_32x32x16_bf16 v[160:175], v[92:95], v[56:59], v[160:175]
ds_read_b128 v[116:119], v131 offset:16640
buffer_store_dwordx4 v[228:231], v13, s[8:11], s52 offen sc1
s_add_u32 s52, s52, s54
s_waitcnt lgkmcnt(5)
v_mfma_f32_32x32x16_bf16 v[144:159], v[96:99], v[60:63], v[144:159]
ds_read_b128 v[88:91], v132 offset:256
s_waitcnt lgkmcnt(5)
v_mfma_f32_32x32x16_bf16 v[160:175], v[100:103], v[60:63], v[160:175]
ds_read_b128 v[92:95], v132 offset:16640
s_waitcnt lgkmcnt(5)
v_mfma_f32_32x32x16_bf16 v[144:159], v[104:107], v[64:67], v[144:159]
ds_read_b128 v[96:99], v133 offset:256
s_waitcnt lgkmcnt(5)
v_mfma_f32_32x32x16_bf16 v[160:175], v[108:111], v[64:67], v[160:175]
ds_read_b128 v[100:103], v133 offset:16640
s_waitcnt lgkmcnt(5)
v_mfma_f32_32x32x16_bf16 v[144:159], v[112:115], v[68:71], v[144:159]
ds_read_b128 v[104:107], v134 offset:256
s_waitcnt lgkmcnt(5)
v_mfma_f32_32x32x16_bf16 v[160:175], v[116:119], v[68:71], v[160:175]
ds_read_b128 v[108:111], v134 offset:16640
s_waitcnt lgkmcnt(5)
v_mfma_f32_32x32x16_bf16 v[144:159], v[88:91], v[72:75], v[144:159]
ds_read_b128 v[112:115], v135 offset:256
s_waitcnt lgkmcnt(5)
v_mfma_f32_32x32x16_bf16 v[160:175], v[92:95], v[72:75], v[160:175]
ds_read_b128 v[116:119], v135 offset:16640
s_waitcnt lgkmcnt(5)
v_mfma_f32_32x32x16_bf16 v[144:159], v[96:99], v[76:79], v[144:159]
s_waitcnt lgkmcnt(4)
v_mfma_f32_32x32x16_bf16 v[160:175], v[100:103], v[76:79], v[160:175]
s_waitcnt lgkmcnt(3)
v_mfma_f32_32x32x16_bf16 v[144:159], v[104:107], v[80:83], v[144:159]
s_waitcnt lgkmcnt(2)
v_mfma_f32_32x32x16_bf16 v[160:175], v[108:111], v[80:83], v[160:175]
s_waitcnt lgkmcnt(1)
v_mfma_f32_32x32x16_bf16 v[144:159], v[112:115], v[84:87], v[144:159]
s_waitcnt lgkmcnt(0)
v_mfma_f32_32x32x16_bf16 v[160:175], v[116:119], v[84:87], v[160:175]
s_mov_b32 s33, 1
s_cmp_eq_u32 s33, 0
s_cbranch_scc1 OPT_21
s_getreg_b32 s20, hwreg(HW_REG_IB_STS)
s_and_b32 s20, s20, 0xc0000f
s_cmp_gt_u32 s20, 0
s_cbranch_scc1 OPT_21
s_waitcnt vmcnt(0)
s_mov_b64 exec, 1
buffer_store_dword v15, v3, s[8:11], s39 offen sc1
s_mov_b64 exec, -1
s_add_u32 s39, s39, 2048
s_mov_b32 s33, 0
OPT_21:
s_waitcnt vmcnt(32)
s_barrier
ds_read_b128 v[88:91], v4 offset:0
ds_read_b128 v[92:95], v4 offset:16384
ds_read_b128 v[96:99], v5 offset:0
ds_read_b128 v[100:103], v5 offset:16384
ds_read_b128 v[104:107], v6 offset:0
ds_read_b128 v[108:111], v6 offset:16384
s_waitcnt lgkmcnt(5)
v_mfma_f32_32x32x16_bf16 v[176:191], v[88:91], v[24:27], 0
s_cmp_eq_u32 s33, 0
s_cbranch_scc1 OPT_23
s_getreg_b32 s20, hwreg(HW_REG_IB_STS)
s_and_b32 s20, s20, 0xc0000f
s_cmp_gt_u32 s20, 0
s_cbranch_scc1 OPT_23
s_waitcnt vmcnt(0)
s_mov_b64 exec, 1
buffer_store_dword v15, v3, s[8:11], s39 offen sc1
s_mov_b64 exec, -1
s_add_u32 s39, s39, 2048
s_mov_b32 s33, 0
OPT_23:
ds_read_b128 v[112:115], v7 offset:0
s_waitcnt lgkmcnt(5)
v_mfma_f32_32x32x16_bf16 v[192:207], v[92:95], v[24:27], 0
ds_read_b128 v[116:119], v7 offset:16384
s_waitcnt lgkmcnt(5)
v_mfma_f32_32x32x16_bf16 v[176:191], v[96:99], v[28:31], v[176:191]
ds_read_b128 v[88:91], v8 offset:0
v_mul_f32 v144, v144, v16
v_mul_f32 v145, v145, v16
v_mul_f32 v146, v146, v16
v_mul_f32 v147, v147, v16
s_waitcnt lgkmcnt(5)
v_mfma_f32_32x32x16_bf16 v[192:207], v[100:103], v[28:31], v[192:207]
ds_read_b128 v[92:95], v8 offset:16384
v_mul_f32 v148, v148, v16
v_mul_f32 v149, v149, v16
v_mul_f32 v150, v150, v16
v_mul_f32 v151, v151, v16
s_waitcnt lgkmcnt(5)
v_mfma_f32_32x32x16_bf16 v[176:191], v[104:107], v[32:35], v[176:191]
ds_read_b128 v[96:99], v9 offset:0
v_mul_f32 v152, v152, v16
v_mul_f32 v153, v153, v16
v_mul_f32 v154, v154, v16
v_mul_f32 v155, v155, v16
s_waitcnt lgkmcnt(5)
v_mfma_f32_32x32x16_bf16 v[192:207], v[108:111], v[32:35], v[192:207]
ds_read_b128 v[100:103], v9 offset:16384
v_mul_f32 v156, v156, v16
v_mul_f32 v157, v157, v16
v_mul_f32 v158, v158, v16
v_mul_f32 v159, v159, v16
s_waitcnt lgkmcnt(5)
v_mfma_f32_32x32x16_bf16 v[176:191], v[112:115], v[36:39], v[176:191]
s_cmp_eq_u32 s33, 0
s_cbranch_scc1 OPT_25
s_getreg_b32 s20, hwreg(HW_REG_IB_STS)
s_and_b32 s20, s20, 0xc0000f
s_cmp_gt_u32 s20, 0
s_cbranch_scc1 OPT_25
s_waitcnt vmcnt(0)
s_mov_b64 exec, 1
buffer_store_dword v15, v3, s[8:11], s39 offen sc1
s_mov_b64 exec, -1
s_add_u32 s39, s39, 2048
s_mov_b32 s33, 0
OPT_25:
ds_read_b128 v[104:107], v10 offset:0
s_waitcnt lgkmcnt(5)
v_mfma_f32_32x32x16_bf16 v[192:207], v[116:119], v[36:39], v[192:207]
ds_read_b128 v[108:111], v10 offset:16384
v_cvt_pk_bf16_f32 v208, v144, v145
v_cvt_pk_bf16_f32 v209, v146, v147
v_cvt_pk_bf16_f32 v210, v148, v149
v_cvt_pk_bf16_f32 v211, v150, v151
s_waitcnt lgkmcnt(5)
v_mfma_f32_32x32x16_bf16 v[176:191], v[88:91], v[40:43], v[176:191]
ds_read_b128 v[112:115], v11 offset:0
v_cvt_pk_bf16_f32 v212, v152, v153
v_cvt_pk_bf16_f32 v213, v154, v155
v_cvt_pk_bf16_f32 v214, v156, v157
v_cvt_pk_bf16_f32 v215, v158, v159
s_waitcnt lgkmcnt(5)
v_mfma_f32_32x32x16_bf16 v[192:207], v[92:95], v[40:43], v[192:207]
ds_read_b128 v[116:119], v11 offset:16384
buffer_store_dwordx4 v[208:211], v12, s[8:11], s52 offen sc1
buffer_store_dwordx4 v[212:215], v13, s[8:11], s52 offen sc1
s_add_u32 s52, s52, s54
v_mul_f32 v160, v160, v16
s_waitcnt lgkmcnt(5)
v_mfma_f32_32x32x16_bf16 v[176:191], v[96:99], v[44:47], v[176:191]
ds_read_b128 v[88:91], v4 offset:256
v_mul_f32 v161, v161, v16
v_mul_f32 v162, v162, v16
v_mul_f32 v163, v163, v16
v_mul_f32 v164, v164, v16
s_waitcnt lgkmcnt(5)
v_mfma_f32_32x32x16_bf16 v[192:207], v[100:103], v[44:47], v[192:207]
ds_read_b128 v[92:95], v4 offset:16640
v_mul_f32 v165, v165, v16
v_mul_f32 v166, v166, v16
v_mul_f32 v167, v167, v16
v_mul_f32 v168, v168, v16
s_waitcnt lgkmcnt(5)
v_mfma_f32_32x32x16_bf16 v[176:191], v[104:107], v[48:51], v[176:191]
s_cmp_eq_u32 s33, 0
s_cbranch_scc1 OPT_27
s_waitcnt vmcnt(2)
s_mov_b64 exec, 1
buffer_store_dword v15, v3, s[8:11], s39 offen sc1
s_mov_b64 exec, -1
s_add_u32 s39, s39, 2048
s_mov_b32 s33, 0
OPT_27:
ds_read_b128 v[96:99], v5 offset:256
s_waitcnt lgkmcnt(5)
v_mfma_f32_32x32x16_bf16 v[192:207], v[108:111], v[48:51], v[192:207]
ds_read_b128 v[100:103], v5 offset:16640
v_mul_f32 v169, v169, v16
v_mul_f32 v170, v170, v16
v_mul_f32 v171, v171, v16
v_mul_f32 v172, v172, v16
s_waitcnt lgkmcnt(5)
v_mfma_f32_32x32x16_bf16 v[176:191], v[112:115], v[52:55], v[176:191]
ds_read_b128 v[104:107], v6 offset:256
v_mul_f32 v173, v173, v16
v_mul_f32 v174, v174, v16
v_mul_f32 v175, v175, v16
v_cvt_pk_bf16_f32 v224, v160, v161
s_waitcnt lgkmcnt(5)
v_mfma_f32_32x32x16_bf16 v[192:207], v[116:119], v[52:55], v[192:207]
ds_read_b128 v[108:111], v6 offset:16640
v_cvt_pk_bf16_f32 v225, v162, v163
v_cvt_pk_bf16_f32 v226, v164, v165
v_cvt_pk_bf16_f32 v227, v166, v167
v_cvt_pk_bf16_f32 v228, v168, v169
s_waitcnt lgkmcnt(5)
v_mfma_f32_32x32x16_bf16 v[176:191], v[88:91], v[56:59], v[176:191]
ds_read_b128 v[112:115], v7 offset:256
v_cvt_pk_bf16_f32 v229, v170, v171
v_cvt_pk_bf16_f32 v230, v172, v173
v_cvt_pk_bf16_f32 v231, v174, v175
buffer_store_dwordx4 v[224:227], v12, s[8:11], s52 offen sc1
s_waitcnt lgkmcnt(5)
v_mfma_f32_32x32x16_bf16 v[192:207], v[92:95], v[56:59], v[192:207]
ds_read_b128 v[116:119], v7 offset:16640
buffer_store_dwordx4 v[228:231], v13, s[8:11], s52 offen sc1
s_add_u32 s52, s52, s54
s_waitcnt lgkmcnt(5)
v_mfma_f32_32x32x16_bf16 v[176:191], v[96:99], v[60:63], v[176:191]
ds_read_b128 v[88:91], v8 offset:256
s_waitcnt lgkmcnt(5)
v_mfma_f32_32x32x16_bf16 v[192:207], v[100:103], v[60:63], v[192:207]
ds_read_b128 v[92:95], v8 offset:16640
s_waitcnt lgkmcnt(5)
v_mfma_f32_32x32x16_bf16 v[176:191], v[104:107], v[64:67], v[176:191]
ds_read_b128 v[96:99], v9 offset:256
s_waitcnt lgkmcnt(5)
v_mfma_f32_32x32x16_bf16 v[192:207], v[108:111], v[64:67], v[192:207]
ds_read_b128 v[100:103], v9 offset:16640
s_waitcnt lgkmcnt(5)
v_mfma_f32_32x32x16_bf16 v[176:191], v[112:115], v[68:71], v[176:191]
ds_read_b128 v[104:107], v10 offset:256
s_waitcnt lgkmcnt(5)
v_mfma_f32_32x32x16_bf16 v[192:207], v[116:119], v[68:71], v[192:207]
ds_read_b128 v[108:111], v10 offset:16640
s_waitcnt lgkmcnt(5)
v_mfma_f32_32x32x16_bf16 v[176:191], v[88:91], v[72:75], v[176:191]
ds_read_b128 v[112:115], v11 offset:256
s_waitcnt lgkmcnt(5)
v_mfma_f32_32x32x16_bf16 v[192:207], v[92:95], v[72:75], v[192:207]
ds_read_b128 v[116:119], v11 offset:16640
s_waitcnt lgkmcnt(5)
v_mfma_f32_32x32x16_bf16 v[176:191], v[96:99], v[76:79], v[176:191]
s_waitcnt lgkmcnt(4)
v_mfma_f32_32x32x16_bf16 v[192:207], v[100:103], v[76:79], v[192:207]
s_waitcnt lgkmcnt(3)
v_mfma_f32_32x32x16_bf16 v[176:191], v[104:107], v[80:83], v[176:191]
s_waitcnt lgkmcnt(2)
v_mfma_f32_32x32x16_bf16 v[192:207], v[108:111], v[80:83], v[192:207]
s_waitcnt lgkmcnt(1)
v_mfma_f32_32x32x16_bf16 v[176:191], v[112:115], v[84:87], v[176:191]
s_waitcnt lgkmcnt(0)
v_mfma_f32_32x32x16_bf16 v[192:207], v[116:119], v[84:87], v[192:207]
s_mov_b32 s33, 1
s_cmp_eq_u32 s33, 0
s_cbranch_scc1 OPT_29
s_getreg_b32 s20, hwreg(HW_REG_IB_STS)
s_and_b32 s20, s20, 0xc0000f
s_cmp_gt_u32 s20, 0
s_cbranch_scc1 OPT_29
s_waitcnt vmcnt(0)
s_mov_b64 exec, 1
buffer_store_dword v15, v3, s[8:11], s39 offen sc1
s_mov_b64 exec, -1
s_add_u32 s39, s39, 2048
s_mov_b32 s33, 0
OPT_29:
s_waitcnt vmcnt(28)
s_barrier
ds_read_b128 v[88:91], v4 offset:32768
ds_read_b128 v[92:95], v4 offset:49152
ds_read_b128 v[96:99], v5 offset:32768
ds_read_b128 v[100:103], v5 offset:49152
ds_read_b128 v[104:107], v6 offset:32768
ds_read_b128 v[108:111], v6 offset:49152
s_waitcnt lgkmcnt(5)
v_mfma_f32_32x32x16_bf16 v[144:159], v[88:91], v[24:27], 0
s_cmp_eq_u32 s33, 0
s_cbranch_scc1 OPT_31
s_getreg_b32 s20, hwreg(HW_REG_IB_STS)
s_and_b32 s20, s20, 0xc0000f
s_cmp_gt_u32 s20, 0
s_cbranch_scc1 OPT_31
s_waitcnt vmcnt(0)
s_mov_b64 exec, 1
buffer_store_dword v15, v3, s[8:11], s39 offen sc1
s_mov_b64 exec, -1
s_add_u32 s39, s39, 2048
s_mov_b32 s33, 0
OPT_31:
ds_read_b128 v[112:115], v7 offset:32768
s_waitcnt lgkmcnt(5)
v_mfma_f32_32x32x16_bf16 v[160:175], v[92:95], v[24:27], 0
ds_read_b128 v[116:119], v7 offset:49152
s_waitcnt lgkmcnt(5)
v_mfma_f32_32x32x16_bf16 v[144:159], v[96:99], v[28:31], v[144:159]
ds_read_b128 v[88:91], v8 offset:32768
v_mul_f32 v176, v176, v16
v_mul_f32 v177, v177, v16
v_mul_f32 v178, v178, v16
v_mul_f32 v179, v179, v16
s_waitcnt lgkmcnt(5)
v_mfma_f32_32x32x16_bf16 v[160:175], v[100:103], v[28:31], v[160:175]
ds_read_b128 v[92:95], v8 offset:49152
v_mul_f32 v180, v180, v16
v_mul_f32 v181, v181, v16
v_mul_f32 v182, v182, v16
v_mul_f32 v183, v183, v16
s_waitcnt lgkmcnt(5)
v_mfma_f32_32x32x16_bf16 v[144:159], v[104:107], v[32:35], v[144:159]
ds_read_b128 v[96:99], v9 offset:32768
v_mul_f32 v184, v184, v16
v_mul_f32 v185, v185, v16
v_mul_f32 v186, v186, v16
v_mul_f32 v187, v187, v16
s_waitcnt lgkmcnt(5)
v_mfma_f32_32x32x16_bf16 v[160:175], v[108:111], v[32:35], v[160:175]
ds_read_b128 v[100:103], v9 offset:49152
v_mul_f32 v188, v188, v16
v_mul_f32 v189, v189, v16
v_mul_f32 v190, v190, v16
v_mul_f32 v191, v191, v16
s_waitcnt lgkmcnt(5)
v_mfma_f32_32x32x16_bf16 v[144:159], v[112:115], v[36:39], v[144:159]
s_cmp_eq_u32 s33, 0
s_cbranch_scc1 OPT_33
s_getreg_b32 s20, hwreg(HW_REG_IB_STS)
s_and_b32 s20, s20, 0xc0000f
s_cmp_gt_u32 s20, 0
s_cbranch_scc1 OPT_33
s_waitcnt vmcnt(0)
s_mov_b64 exec, 1
buffer_store_dword v15, v3, s[8:11], s39 offen sc1
s_mov_b64 exec, -1
s_add_u32 s39, s39, 2048
s_mov_b32 s33, 0
OPT_33:
ds_read_b128 v[104:107], v10 offset:32768
s_waitcnt lgkmcnt(5)
v_mfma_f32_32x32x16_bf16 v[160:175], v[116:119], v[36:39], v[160:175]
ds_read_b128 v[108:111], v10 offset:49152
v_cvt_pk_bf16_f32 v208, v176, v177
v_cvt_pk_bf16_f32 v209, v178, v179
v_cvt_pk_bf16_f32 v210, v180, v181
v_cvt_pk_bf16_f32 v211, v182, v183
s_waitcnt lgkmcnt(5)
v_mfma_f32_32x32x16_bf16 v[144:159], v[88:91], v[40:43], v[144:159]
ds_read_b128 v[112:115], v11 offset:32768
v_cvt_pk_bf16_f32 v212, v184, v185
v_cvt_pk_bf16_f32 v213, v186, v187
v_cvt_pk_bf16_f32 v214, v188, v189
v_cvt_pk_bf16_f32 v215, v190, v191
s_waitcnt lgkmcnt(5)
v_mfma_f32_32x32x16_bf16 v[160:175], v[92:95], v[40:43], v[160:175]
ds_read_b128 v[116:119], v11 offset:49152
buffer_store_dwordx4 v[208:211], v12, s[8:11], s52 offen sc1
buffer_store_dwordx4 v[212:215], v13, s[8:11], s52 offen sc1
s_add_u32 s52, s52, s54
v_mul_f32 v192, v192, v16
s_waitcnt lgkmcnt(5)
v_mfma_f32_32x32x16_bf16 v[144:159], v[96:99], v[44:47], v[144:159]
ds_read_b128 v[88:91], v4 offset:33024
v_mul_f32 v193, v193, v16
v_mul_f32 v194, v194, v16
v_mul_f32 v195, v195, v16
v_mul_f32 v196, v196, v16
s_waitcnt lgkmcnt(5)
v_mfma_f32_32x32x16_bf16 v[160:175], v[100:103], v[44:47], v[160:175]
ds_read_b128 v[92:95], v4 offset:49408
v_mul_f32 v197, v197, v16
v_mul_f32 v198, v198, v16
v_mul_f32 v199, v199, v16
v_mul_f32 v200, v200, v16
s_waitcnt lgkmcnt(5)
v_mfma_f32_32x32x16_bf16 v[144:159], v[104:107], v[48:51], v[144:159]
s_cmp_eq_u32 s33, 0
s_cbranch_scc1 OPT_35
s_waitcnt vmcnt(2)
s_mov_b64 exec, 1
buffer_store_dword v15, v3, s[8:11], s39 offen sc1
s_mov_b64 exec, -1
s_add_u32 s39, s39, 2048
s_mov_b32 s33, 0
OPT_35:
ds_read_b128 v[96:99], v5 offset:33024
s_waitcnt lgkmcnt(5)
v_mfma_f32_32x32x16_bf16 v[160:175], v[108:111], v[48:51], v[160:175]
ds_read_b128 v[100:103], v5 offset:49408
v_mul_f32 v201, v201, v16
v_mul_f32 v202, v202, v16
v_mul_f32 v203, v203, v16
v_mul_f32 v204, v204, v16
s_waitcnt lgkmcnt(5)
v_mfma_f32_32x32x16_bf16 v[144:159], v[112:115], v[52:55], v[144:159]
ds_read_b128 v[104:107], v6 offset:33024
v_mul_f32 v205, v205, v16
v_mul_f32 v206, v206, v16
v_mul_f32 v207, v207, v16
v_cvt_pk_bf16_f32 v224, v192, v193
s_waitcnt lgkmcnt(5)
v_mfma_f32_32x32x16_bf16 v[160:175], v[116:119], v[52:55], v[160:175]
ds_read_b128 v[108:111], v6 offset:49408
v_cvt_pk_bf16_f32 v225, v194, v195
v_cvt_pk_bf16_f32 v226, v196, v197
v_cvt_pk_bf16_f32 v227, v198, v199
v_cvt_pk_bf16_f32 v228, v200, v201
s_waitcnt lgkmcnt(5)
v_mfma_f32_32x32x16_bf16 v[144:159], v[88:91], v[56:59], v[144:159]
ds_read_b128 v[112:115], v7 offset:33024
v_cvt_pk_bf16_f32 v229, v202, v203
v_cvt_pk_bf16_f32 v230, v204, v205
v_cvt_pk_bf16_f32 v231, v206, v207
buffer_store_dwordx4 v[224:227], v12, s[8:11], s52 offen sc1
s_waitcnt lgkmcnt(5)
v_mfma_f32_32x32x16_bf16 v[160:175], v[92:95], v[56:59], v[160:175]
ds_read_b128 v[116:119], v7 offset:49408
buffer_store_dwordx4 v[228:231], v13, s[8:11], s52 offen sc1
s_add_u32 s52, s52, s54
s_waitcnt lgkmcnt(5)
v_mfma_f32_32x32x16_bf16 v[144:159], v[96:99], v[60:63], v[144:159]
ds_read_b128 v[88:91], v8 offset:33024
s_waitcnt lgkmcnt(5)
v_mfma_f32_32x32x16_bf16 v[160:175], v[100:103], v[60:63], v[160:175]
ds_read_b128 v[92:95], v8 offset:49408
s_waitcnt lgkmcnt(5)
v_mfma_f32_32x32x16_bf16 v[144:159], v[104:107], v[64:67], v[144:159]
ds_read_b128 v[96:99], v9 offset:33024
s_waitcnt lgkmcnt(5)
v_mfma_f32_32x32x16_bf16 v[160:175], v[108:111], v[64:67], v[160:175]
ds_read_b128 v[100:103], v9 offset:49408
s_waitcnt lgkmcnt(5)
v_mfma_f32_32x32x16_bf16 v[144:159], v[112:115], v[68:71], v[144:159]
ds_read_b128 v[104:107], v10 offset:33024
s_waitcnt lgkmcnt(5)
v_mfma_f32_32x32x16_bf16 v[160:175], v[116:119], v[68:71], v[160:175]
ds_read_b128 v[108:111], v10 offset:49408
s_waitcnt lgkmcnt(5)
v_mfma_f32_32x32x16_bf16 v[144:159], v[88:91], v[72:75], v[144:159]
ds_read_b128 v[112:115], v11 offset:33024
s_waitcnt lgkmcnt(5)
v_mfma_f32_32x32x16_bf16 v[160:175], v[92:95], v[72:75], v[160:175]
ds_read_b128 v[116:119], v11 offset:49408
s_waitcnt lgkmcnt(5)
v_mfma_f32_32x32x16_bf16 v[144:159], v[96:99], v[76:79], v[144:159]
s_waitcnt lgkmcnt(4)
v_mfma_f32_32x32x16_bf16 v[160:175], v[100:103], v[76:79], v[160:175]
s_waitcnt lgkmcnt(3)
v_mfma_f32_32x32x16_bf16 v[144:159], v[104:107], v[80:83], v[144:159]
s_waitcnt lgkmcnt(2)
v_mfma_f32_32x32x16_bf16 v[160:175], v[108:111], v[80:83], v[160:175]
s_waitcnt lgkmcnt(1)
v_mfma_f32_32x32x16_bf16 v[144:159], v[112:115], v[84:87], v[144:159]
s_waitcnt lgkmcnt(0)
v_mfma_f32_32x32x16_bf16 v[160:175], v[116:119], v[84:87], v[160:175]
s_mov_b32 s33, 1
s_cmp_eq_u32 s33, 0
s_cbranch_scc1 OPT_37
s_getreg_b32 s20, hwreg(HW_REG_IB_STS)
s_and_b32 s20, s20, 0xc0000f
s_cmp_gt_u32 s20, 0
s_cbranch_scc1 OPT_37
s_waitcnt vmcnt(0)
s_mov_b64 exec, 1
buffer_store_dword v15, v3, s[8:11], s39 offen sc1
s_mov_b64 exec, -1
s_add_u32 s39, s39, 2048
s_mov_b32 s33, 0
OPT_37:
s_waitcnt vmcnt(20)
s_barrier
ds_read_b128 v[88:91], v120 offset:0
ds_read_b128 v[92:95], v120 offset:16384
ds_read_b128 v[96:99], v121 offset:0
ds_read_b128 v[100:103], v121 offset:16384
ds_read_b128 v[104:107], v122 offset:0
ds_read_b128 v[108:111], v122 offset:16384
s_waitcnt lgkmcnt(5)
v_mfma_f32_32x32x16_bf16 v[176:191], v[88:91], v[24:27], 0
s_cmp_eq_u32 s33, 0
s_cbranch_scc1 OPT_39
s_getreg_b32 s20, hwreg(HW_REG_IB_STS)
s_and_b32 s20, s20, 0xc0000f
s_cmp_gt_u32 s20, 0
s_cbranch_scc1 OPT_39
s_waitcnt vmcnt(0)
s_mov_b64 exec, 1
buffer_store_dword v15, v3, s[8:11], s39 offen sc1
s_mov_b64 exec, -1
s_add_u32 s39, s39, 2048
s_mov_b32 s33, 0
OPT_39:
ds_read_b128 v[112:115], v123 offset:0
s_waitcnt lgkmcnt(5)
v_mfma_f32_32x32x16_bf16 v[192:207], v[92:95], v[24:27], 0
ds_read_b128 v[116:119], v123 offset:16384
s_waitcnt lgkmcnt(5)
v_mfma_f32_32x32x16_bf16 v[176:191], v[96:99], v[28:31], v[176:191]
ds_read_b128 v[88:91], v124 offset:0
v_mul_f32 v144, v144, v16
v_mul_f32 v145, v145, v16
v_mul_f32 v146, v146, v16
v_mul_f32 v147, v147, v16
s_waitcnt lgkmcnt(5)
v_mfma_f32_32x32x16_bf16 v[192:207], v[100:103], v[28:31], v[192:207]
ds_read_b128 v[92:95], v124 offset:16384
v_mul_f32 v148, v148, v16
v_mul_f32 v149, v149, v16
v_mul_f32 v150, v150, v16
v_mul_f32 v151, v151, v16
s_waitcnt lgkmcnt(5)
v_mfma_f32_32x32x16_bf16 v[176:191], v[104:107], v[32:35], v[176:191]
ds_read_b128 v[96:99], v125 offset:0
v_mul_f32 v152, v152, v16
v_mul_f32 v153, v153, v16
v_mul_f32 v154, v154, v16
v_mul_f32 v155, v155, v16
s_waitcnt lgkmcnt(5)
v_mfma_f32_32x32x16_bf16 v[192:207], v[108:111], v[32:35], v[192:207]
ds_read_b128 v[100:103], v125 offset:16384
v_mul_f32 v156, v156, v16
v_mul_f32 v157, v157, v16
v_mul_f32 v158, v158, v16
v_mul_f32 v159, v159, v16
s_waitcnt lgkmcnt(5)
v_mfma_f32_32x32x16_bf16 v[176:191], v[112:115], v[36:39], v[176:191]
s_cmp_eq_u32 s33, 0
s_cbranch_scc1 OPT_41
s_getreg_b32 s20, hwreg(HW_REG_IB_STS)
s_and_b32 s20, s20, 0xc0000f
s_cmp_gt_u32 s20, 0
s_cbranch_scc1 OPT_41
s_waitcnt vmcnt(0)
s_mov_b64 exec, 1
buffer_store_dword v15, v3, s[8:11], s39 offen sc1
s_mov_b64 exec, -1
s_add_u32 s39, s39, 2048
s_mov_b32 s33, 0
OPT_41:
ds_read_b128 v[104:107], v126 offset:0
s_waitcnt lgkmcnt(5)
v_mfma_f32_32x32x16_bf16 v[192:207], v[116:119], v[36:39], v[192:207]
ds_read_b128 v[108:111], v126 offset:16384
v_cvt_pk_bf16_f32 v208, v144, v145
v_cvt_pk_bf16_f32 v209, v146, v147
v_cvt_pk_bf16_f32 v210, v148, v149
v_cvt_pk_bf16_f32 v211, v150, v151
s_waitcnt lgkmcnt(5)
v_mfma_f32_32x32x16_bf16 v[176:191], v[88:91], v[40:43], v[176:191]
ds_read_b128 v[112:115], v127 offset:0
v_cvt_pk_bf16_f32 v212, v152, v153
v_cvt_pk_bf16_f32 v213, v154, v155
v_cvt_pk_bf16_f32 v214, v156, v157
v_cvt_pk_bf16_f32 v215, v158, v159
s_waitcnt lgkmcnt(5)
v_mfma_f32_32x32x16_bf16 v[192:207], v[92:95], v[40:43], v[192:207]
ds_read_b128 v[116:119], v127 offset:16384
buffer_store_dwordx4 v[208:211], v12, s[8:11], s52 offen sc1
buffer_store_dwordx4 v[212:215], v13, s[8:11], s52 offen sc1
s_add_u32 s52, s52, s54
v_mul_f32 v160, v160, v16
s_waitcnt lgkmcnt(5)
v_mfma_f32_32x32x16_bf16 v[176:191], v[96:99], v[44:47], v[176:191]
ds_read_b128 v[88:91], v120 offset:256
v_mul_f32 v161, v161, v16
v_mul_f32 v162, v162, v16
v_mul_f32 v163, v163, v16
v_mul_f32 v164, v164, v16
s_waitcnt lgkmcnt(5)
v_mfma_f32_32x32x16_bf16 v[192:207], v[100:103], v[44:47], v[192:207]
ds_read_b128 v[92:95], v120 offset:16640
v_mul_f32 v165, v165, v16
v_mul_f32 v166, v166, v16
v_mul_f32 v167, v167, v16
v_mul_f32 v168, v168, v16
s_waitcnt lgkmcnt(5)
v_mfma_f32_32x32x16_bf16 v[176:191], v[104:107], v[48:51], v[176:191]
s_cmp_eq_u32 s33, 0
s_cbranch_scc1 OPT_43
s_waitcnt vmcnt(2)
s_mov_b64 exec, 1
buffer_store_dword v15, v3, s[8:11], s39 offen sc1
s_mov_b64 exec, -1
s_add_u32 s39, s39, 2048
s_mov_b32 s33, 0
OPT_43:
ds_read_b128 v[96:99], v121 offset:256
s_waitcnt lgkmcnt(5)
v_mfma_f32_32x32x16_bf16 v[192:207], v[108:111], v[48:51], v[192:207]
ds_read_b128 v[100:103], v121 offset:16640
v_mul_f32 v169, v169, v16
v_mul_f32 v170, v170, v16
v_mul_f32 v171, v171, v16
v_mul_f32 v172, v172, v16
s_waitcnt lgkmcnt(5)
v_mfma_f32_32x32x16_bf16 v[176:191], v[112:115], v[52:55], v[176:191]
ds_read_b128 v[104:107], v122 offset:256
v_mul_f32 v173, v173, v16
v_mul_f32 v174, v174, v16
v_mul_f32 v175, v175, v16
v_cvt_pk_bf16_f32 v224, v160, v161
s_waitcnt lgkmcnt(5)
v_mfma_f32_32x32x16_bf16 v[192:207], v[116:119], v[52:55], v[192:207]
ds_read_b128 v[108:111], v122 offset:16640
v_cvt_pk_bf16_f32 v225, v162, v163
v_cvt_pk_bf16_f32 v226, v164, v165
v_cvt_pk_bf16_f32 v227, v166, v167
v_cvt_pk_bf16_f32 v228, v168, v169
s_waitcnt lgkmcnt(5)
v_mfma_f32_32x32x16_bf16 v[176:191], v[88:91], v[56:59], v[176:191]
ds_read_b128 v[112:115], v123 offset:256
v_cvt_pk_bf16_f32 v229, v170, v171
v_cvt_pk_bf16_f32 v230, v172, v173
v_cvt_pk_bf16_f32 v231, v174, v175
buffer_store_dwordx4 v[224:227], v12, s[8:11], s52 offen sc1
s_waitcnt lgkmcnt(5)
v_mfma_f32_32x32x16_bf16 v[192:207], v[92:95], v[56:59], v[192:207]
ds_read_b128 v[116:119], v123 offset:16640
buffer_store_dwordx4 v[228:231], v13, s[8:11], s52 offen sc1
s_add_u32 s52, s52, s54
s_waitcnt lgkmcnt(5)
v_mfma_f32_32x32x16_bf16 v[176:191], v[96:99], v[60:63], v[176:191]
ds_read_b128 v[88:91], v124 offset:256
s_waitcnt lgkmcnt(5)
v_mfma_f32_32x32x16_bf16 v[192:207], v[100:103], v[60:63], v[192:207]
ds_read_b128 v[92:95], v124 offset:16640
s_waitcnt lgkmcnt(5)
v_mfma_f32_32x32x16_bf16 v[176:191], v[104:107], v[64:67], v[176:191]
ds_read_b128 v[96:99], v125 offset:256
s_waitcnt lgkmcnt(5)
v_mfma_f32_32x32x16_bf16 v[192:207], v[108:111], v[64:67], v[192:207]
ds_read_b128 v[100:103], v125 offset:16640
s_waitcnt lgkmcnt(5)
v_mfma_f32_32x32x16_bf16 v[176:191], v[112:115], v[68:71], v[176:191]
ds_read_b128 v[104:107], v126 offset:256
s_waitcnt lgkmcnt(5)
v_mfma_f32_32x32x16_bf16 v[192:207], v[116:119], v[68:71], v[192:207]
ds_read_b128 v[108:111], v126 offset:16640
s_waitcnt lgkmcnt(5)
v_mfma_f32_32x32x16_bf16 v[176:191], v[88:91], v[72:75], v[176:191]
ds_read_b128 v[112:115], v127 offset:256
s_waitcnt lgkmcnt(5)
v_mfma_f32_32x32x16_bf16 v[192:207], v[92:95], v[72:75], v[192:207]
ds_read_b128 v[116:119], v127 offset:16640
s_waitcnt lgkmcnt(5)
v_mfma_f32_32x32x16_bf16 v[176:191], v[96:99], v[76:79], v[176:191]
s_waitcnt lgkmcnt(4)
v_mfma_f32_32x32x16_bf16 v[192:207], v[100:103], v[76:79], v[192:207]
s_waitcnt lgkmcnt(3)
v_mfma_f32_32x32x16_bf16 v[176:191], v[104:107], v[80:83], v[176:191]
s_waitcnt lgkmcnt(2)
v_mfma_f32_32x32x16_bf16 v[192:207], v[108:111], v[80:83], v[192:207]
s_waitcnt lgkmcnt(1)
v_mfma_f32_32x32x16_bf16 v[176:191], v[112:115], v[84:87], v[176:191]
s_waitcnt lgkmcnt(0)
v_mfma_f32_32x32x16_bf16 v[192:207], v[116:119], v[84:87], v[192:207]
s_mov_b32 s33, 1
s_cmp_eq_u32 s33, 0
s_cbranch_scc1 OPT_45
s_getreg_b32 s20, hwreg(HW_REG_IB_STS)
s_and_b32 s20, s20, 0xc0000f
s_cmp_gt_u32 s20, 0
s_cbranch_scc1 OPT_45
s_waitcnt vmcnt(0)
s_mov_b64 exec, 1
buffer_store_dword v15, v3, s[8:11], s39 offen sc1
s_mov_b64 exec, -1
s_add_u32 s39, s39, 2048
s_mov_b32 s33, 0
OPT_45:
s_waitcnt vmcnt(16)
s_barrier
ds_read_b128 v[88:91], v120 offset:32768
ds_read_b128 v[92:95], v120 offset:49152
ds_read_b128 v[96:99], v121 offset:32768
ds_read_b128 v[100:103], v121 offset:49152
ds_read_b128 v[104:107], v122 offset:32768
ds_read_b128 v[108:111], v122 offset:49152
s_waitcnt lgkmcnt(5)
v_mfma_f32_32x32x16_bf16 v[144:159], v[88:91], v[24:27], 0
s_cmp_eq_u32 s33, 0
s_cbranch_scc1 OPT_47
s_getreg_b32 s20, hwreg(HW_REG_IB_STS)
s_and_b32 s20, s20, 0xc0000f
s_cmp_gt_u32 s20, 0
s_cbranch_scc1 OPT_47
s_waitcnt vmcnt(0)
s_mov_b64 exec, 1
buffer_store_dword v15, v3, s[8:11], s39 offen sc1
s_mov_b64 exec, -1
s_add_u32 s39, s39, 2048
s_mov_b32 s33, 0
OPT_47:
ds_read_b128 v[112:115], v123 offset:32768
s_waitcnt lgkmcnt(5)
v_mfma_f32_32x32x16_bf16 v[160:175], v[92:95], v[24:27], 0
ds_read_b128 v[116:119], v123 offset:49152
s_waitcnt lgkmcnt(5)
v_mfma_f32_32x32x16_bf16 v[144:159], v[96:99], v[28:31], v[144:159]
ds_read_b128 v[88:91], v124 offset:32768
v_mul_f32 v176, v176, v16
v_mul_f32 v177, v177, v16
v_mul_f32 v178, v178, v16
v_mul_f32 v179, v179, v16
s_waitcnt lgkmcnt(5)
v_mfma_f32_32x32x16_bf16 v[160:175], v[100:103], v[28:31], v[160:175]
ds_read_b128 v[92:95], v124 offset:49152
v_mul_f32 v180, v180, v16
v_mul_f32 v181, v181, v16
v_mul_f32 v182, v182, v16
v_mul_f32 v183, v183, v16
s_waitcnt lgkmcnt(5)
v_mfma_f32_32x32x16_bf16 v[144:159], v[104:107], v[32:35], v[144:159]
ds_read_b128 v[96:99], v125 offset:32768
v_mul_f32 v184, v184, v16
v_mul_f32 v185, v185, v16
v_mul_f32 v186, v186, v16
v_mul_f32 v187, v187, v16
s_waitcnt lgkmcnt(5)
v_mfma_f32_32x32x16_bf16 v[160:175], v[108:111], v[32:35], v[160:175]
ds_read_b128 v[100:103], v125 offset:49152
v_mul_f32 v188, v188, v16
v_mul_f32 v189, v189, v16
v_mul_f32 v190, v190, v16
v_mul_f32 v191, v191, v16
s_waitcnt lgkmcnt(5)
v_mfma_f32_32x32x16_bf16 v[144:159], v[112:115], v[36:39], v[144:159]
s_cmp_eq_u32 s33, 0
s_cbranch_scc1 OPT_49
s_getreg_b32 s20, hwreg(HW_REG_IB_STS)
s_and_b32 s20, s20, 0xc0000f
s_cmp_gt_u32 s20, 0
s_cbranch_scc1 OPT_49
s_waitcnt vmcnt(0)
s_mov_b64 exec, 1
buffer_store_dword v15, v3, s[8:11], s39 offen sc1
s_mov_b64 exec, -1
s_add_u32 s39, s39, 2048
s_mov_b32 s33, 0
OPT_49:
ds_read_b128 v[104:107], v126 offset:32768
s_waitcnt lgkmcnt(5)
v_mfma_f32_32x32x16_bf16 v[160:175], v[116:119], v[36:39], v[160:175]
ds_read_b128 v[108:111], v126 offset:49152
v_cvt_pk_bf16_f32 v208, v176, v177
v_cvt_pk_bf16_f32 v209, v178, v179
v_cvt_pk_bf16_f32 v210, v180, v181
v_cvt_pk_bf16_f32 v211, v182, v183
s_waitcnt lgkmcnt(5)
v_mfma_f32_32x32x16_bf16 v[144:159], v[88:91], v[40:43], v[144:159]
ds_read_b128 v[112:115], v127 offset:32768
v_cvt_pk_bf16_f32 v212, v184, v185
v_cvt_pk_bf16_f32 v213, v186, v187
v_cvt_pk_bf16_f32 v214, v188, v189
v_cvt_pk_bf16_f32 v215, v190, v191
s_waitcnt lgkmcnt(5)
v_mfma_f32_32x32x16_bf16 v[160:175], v[92:95], v[40:43], v[160:175]
ds_read_b128 v[116:119], v127 offset:49152
buffer_store_dwordx4 v[208:211], v12, s[8:11], s52 offen sc1
buffer_store_dwordx4 v[212:215], v13, s[8:11], s52 offen sc1
s_add_u32 s52, s52, s54
v_mul_f32 v192, v192, v16
s_waitcnt lgkmcnt(5)
v_mfma_f32_32x32x16_bf16 v[144:159], v[96:99], v[44:47], v[144:159]
ds_read_b128 v[88:91], v120 offset:33024
v_mul_f32 v193, v193, v16
v_mul_f32 v194, v194, v16
v_mul_f32 v195, v195, v16
v_mul_f32 v196, v196, v16
s_waitcnt lgkmcnt(5)
v_mfma_f32_32x32x16_bf16 v[160:175], v[100:103], v[44:47], v[160:175]
ds_read_b128 v[92:95], v120 offset:49408
v_mul_f32 v197, v197, v16
v_mul_f32 v198, v198, v16
v_mul_f32 v199, v199, v16
v_mul_f32 v200, v200, v16
s_waitcnt lgkmcnt(5)
v_mfma_f32_32x32x16_bf16 v[144:159], v[104:107], v[48:51], v[144:159]
s_cmp_eq_u32 s33, 0
s_cbranch_scc1 OPT_51
s_waitcnt vmcnt(2)
s_mov_b64 exec, 1
buffer_store_dword v15, v3, s[8:11], s39 offen sc1
s_mov_b64 exec, -1
s_add_u32 s39, s39, 2048
s_mov_b32 s33, 0
OPT_51:
ds_read_b128 v[96:99], v121 offset:33024
s_waitcnt lgkmcnt(5)
v_mfma_f32_32x32x16_bf16 v[160:175], v[108:111], v[48:51], v[160:175]
ds_read_b128 v[100:103], v121 offset:49408
v_mul_f32 v201, v201, v16
v_mul_f32 v202, v202, v16
v_mul_f32 v203, v203, v16
v_mul_f32 v204, v204, v16
s_waitcnt lgkmcnt(5)
v_mfma_f32_32x32x16_bf16 v[144:159], v[112:115], v[52:55], v[144:159]
ds_read_b128 v[104:107], v122 offset:33024
v_mul_f32 v205, v205, v16
v_mul_f32 v206, v206, v16
v_mul_f32 v207, v207, v16
v_cvt_pk_bf16_f32 v224, v192, v193
s_waitcnt lgkmcnt(5)
v_mfma_f32_32x32x16_bf16 v[160:175], v[116:119], v[52:55], v[160:175]
ds_read_b128 v[108:111], v122 offset:49408
v_cvt_pk_bf16_f32 v225, v194, v195
v_cvt_pk_bf16_f32 v226, v196, v197
v_cvt_pk_bf16_f32 v227, v198, v199
v_cvt_pk_bf16_f32 v228, v200, v201
s_waitcnt lgkmcnt(5)
v_mfma_f32_32x32x16_bf16 v[144:159], v[88:91], v[56:59], v[144:159]
ds_read_b128 v[112:115], v123 offset:33024
v_cvt_pk_bf16_f32 v229, v202, v203
v_cvt_pk_bf16_f32 v230, v204, v205
v_cvt_pk_bf16_f32 v231, v206, v207
buffer_store_dwordx4 v[224:227], v12, s[8:11], s52 offen sc1
s_waitcnt lgkmcnt(5)
v_mfma_f32_32x32x16_bf16 v[160:175], v[92:95], v[56:59], v[160:175]
ds_read_b128 v[116:119], v123 offset:49408
buffer_store_dwordx4 v[228:231], v13, s[8:11], s52 offen sc1
s_add_u32 s52, s52, s54
s_waitcnt lgkmcnt(5)
v_mfma_f32_32x32x16_bf16 v[144:159], v[96:99], v[60:63], v[144:159]
ds_read_b128 v[88:91], v124 offset:33024
s_waitcnt lgkmcnt(5)
v_mfma_f32_32x32x16_bf16 v[160:175], v[100:103], v[60:63], v[160:175]
ds_read_b128 v[92:95], v124 offset:49408
s_waitcnt lgkmcnt(5)
v_mfma_f32_32x32x16_bf16 v[144:159], v[104:107], v[64:67], v[144:159]
ds_read_b128 v[96:99], v125 offset:33024
s_waitcnt lgkmcnt(5)
v_mfma_f32_32x32x16_bf16 v[160:175], v[108:111], v[64:67], v[160:175]
ds_read_b128 v[100:103], v125 offset:49408
s_waitcnt lgkmcnt(5)
v_mfma_f32_32x32x16_bf16 v[144:159], v[112:115], v[68:71], v[144:159]
ds_read_b128 v[104:107], v126 offset:33024
s_waitcnt lgkmcnt(5)
v_mfma_f32_32x32x16_bf16 v[160:175], v[116:119], v[68:71], v[160:175]
ds_read_b128 v[108:111], v126 offset:49408
s_waitcnt lgkmcnt(5)
v_mfma_f32_32x32x16_bf16 v[144:159], v[88:91], v[72:75], v[144:159]
ds_read_b128 v[112:115], v127 offset:33024
s_waitcnt lgkmcnt(5)
v_mfma_f32_32x32x16_bf16 v[160:175], v[92:95], v[72:75], v[160:175]
ds_read_b128 v[116:119], v127 offset:49408
s_waitcnt lgkmcnt(5)
v_mfma_f32_32x32x16_bf16 v[144:159], v[96:99], v[76:79], v[144:159]
s_waitcnt lgkmcnt(4)
v_mfma_f32_32x32x16_bf16 v[160:175], v[100:103], v[76:79], v[160:175]
s_waitcnt lgkmcnt(3)
v_mfma_f32_32x32x16_bf16 v[144:159], v[104:107], v[80:83], v[144:159]
s_waitcnt lgkmcnt(2)
v_mfma_f32_32x32x16_bf16 v[160:175], v[108:111], v[80:83], v[160:175]
s_waitcnt lgkmcnt(1)
v_mfma_f32_32x32x16_bf16 v[144:159], v[112:115], v[84:87], v[144:159]
s_waitcnt lgkmcnt(0)
v_mfma_f32_32x32x16_bf16 v[160:175], v[116:119], v[84:87], v[160:175]
s_mov_b32 s33, 1
s_cmp_eq_u32 s33, 0
s_cbranch_scc1 OPT_53
s_getreg_b32 s20, hwreg(HW_REG_IB_STS)
s_and_b32 s20, s20, 0xc0000f
s_cmp_gt_u32 s20, 0
s_cbranch_scc1 OPT_53
s_waitcnt vmcnt(0)
s_mov_b64 exec, 1
buffer_store_dword v15, v3, s[8:11], s39 offen sc1
s_mov_b64 exec, -1
s_add_u32 s39, s39, 2048
s_mov_b32 s33, 0
OPT_53:
s_nop 6
v_mul_f32 v144, v144, v16
v_mul_f32 v145, v145, v16
v_mul_f32 v146, v146, v16
v_mul_f32 v147, v147, v16
v_mul_f32 v148, v148, v16
v_mul_f32 v149, v149, v16
v_mul_f32 v150, v150, v16
v_mul_f32 v151, v151, v16
v_mul_f32 v152, v152, v16
v_mul_f32 v153, v153, v16
v_mul_f32 v154, v154, v16
v_mul_f32 v155, v155, v16
v_mul_f32 v156, v156, v16
v_mul_f32 v157, v157, v16
v_mul_f32 v158, v158, v16
v_mul_f32 v159, v159, v16
v_cvt_pk_bf16_f32 v208, v144, v145
v_cvt_pk_bf16_f32 v209, v146, v147
v_cvt_pk_bf16_f32 v210, v148, v149
v_cvt_pk_bf16_f32 v211, v150, v151
v_cvt_pk_bf16_f32 v212, v152, v153
v_cvt_pk_bf16_f32 v213, v154, v155
v_cvt_pk_bf16_f32 v214, v156, v157
v_cvt_pk_bf16_f32 v215, v158, v159
buffer_store_dwordx4 v[208:211], v12, s[8:11], s52 offen sc1
buffer_store_dwordx4 v[212:215], v13, s[8:11], s52 offen sc1
s_add_u32 s52, s52, s54
v_mul_f32 v160, v160, v16
v_mul_f32 v161, v161, v16
v_mul_f32 v162, v162, v16
v_mul_f32 v163, v163, v16
v_mul_f32 v164, v164, v16
v_mul_f32 v165, v165, v16
v_mul_f32 v166, v166, v16
v_mul_f32 v167, v167, v16
v_mul_f32 v168, v168, v16
v_mul_f32 v169, v169, v16
v_mul_f32 v170, v170, v16
v_mul_f32 v171, v171, v16
v_mul_f32 v172, v172, v16
v_mul_f32 v173, v173, v16
v_mul_f32 v174, v174, v16
v_mul_f32 v175, v175, v16
v_cvt_pk_bf16_f32 v224, v160, v161
v_cvt_pk_bf16_f32 v225, v162, v163
v_cvt_pk_bf16_f32 v226, v164, v165
v_cvt_pk_bf16_f32 v227, v166, v167
v_cvt_pk_bf16_f32 v228, v168, v169
v_cvt_pk_bf16_f32 v229, v170, v171
v_cvt_pk_bf16_f32 v230, v172, v173
v_cvt_pk_bf16_f32 v231, v174, v175
buffer_store_dwordx4 v[224:227], v12, s[8:11], s52 offen sc1
buffer_store_dwordx4 v[228:231], v13, s[8:11], s52 offen sc1
s_add_u32 s52, s52, s54
s_cmp_eq_u32 s33, 0
s_cbranch_scc1 OPT_55
s_waitcnt vmcnt(4)
s_mov_b64 exec, 1
buffer_store_dword v15, v3, s[8:11], s39 offen sc1
s_mov_b64 exec, -1
s_add_u32 s39, s39, 2048
s_mov_b32 s33, 0
OPT_55:
s_waitcnt vmcnt(0)
s_mov_b64 exec, 1
buffer_store_dword v15, v3, s[8:11], s39 offen sc1
s_mov_b64 exec, -1
s_add_u32 s39, s39, 2048
s_barrier
s_branch M_NOPREP2
M_WARM:
s_lshr_b32 s21, 0x00210000, s17
s_and_b32 s21, s21, 3
s_lshl_b32 s21, s21, 5
s_add_u32 s21, s21, s13
s_cmp_ge_u32 s21, 32
s_cbranch_scc1 M_X0
s_load_dwordx8 s[24:31], s[0:1], 16
s_lshl_b32 s22, s21, 2
s_add_u32 s22, s22, s12
s_mul_i32 s22, s22, 9600
v_lshlrev_b32 v6, 7, v1
v_min_u32 v7, 15, v1
v_lshlrev_b32 v7, 7, v7
v_add_u32 v7, 8192, v7
s_mov_b32 s46, 3670016
s_mov_b32 s47, 0x00020000
s_waitcnt lgkmcnt(0)
s_mov_b32 s44, s26
s_and_b32 s45, s27, 0xffff
buffer_load_dword a255, v6, s[44:47], s22 offen
buffer_load_dword a255, v7, s[44:47], s22 offen
s_mov_b32 s44, s30
s_and_b32 s45, s31, 0xffff
buffer_load_dword a255, v6, s[44:47], s22 offen
buffer_load_dword a255, v7, s[44:47], s22 offen
s_mov_b32 s44, s24
s_and_b32 s45, s25, 0xffff
buffer_load_dword a255, v6, s[44:47], s22 offen
buffer_load_dword a255, v7, s[44:47], s22 offen
s_mov_b32 s44, s28
s_and_b32 s45, s29, 0xffff
buffer_load_dword a255, v6, s[44:47], s22 offen
buffer_load_dword a255, v7, s[44:47], s22 offen
s_load_dwordx4 s[24:27], s[0:1], 64
s_load_dwordx2 s[28:29], s[0:1], 80
s_lshl_b32 s22, s13, 2
s_add_u32 s22, s22, s12
s_mul_i32 s22, s22, 12544
v_min_u32 v6, 48, v1
v_lshlrev_b32 v6, 7, v6
v_add_u32 v7, 6272, v6
s_mov_b32 s46, 1605632
s_mov_b32 s47, 0x00020000
s_waitcnt lgkmcnt(0)
s_mov_b32 s44, s24
s_and_b32 s45, s25, 0xffff
buffer_load_dword a255, v6, s[44:47], s22 offen
buffer_load_dword a255, v7, s[44:47], s22 offen
s_mov_b32 s44, s26
s_and_b32 s45, s27, 0xffff
buffer_load_dword a255, v6, s[44:47], s22 offen
buffer_load_dword a255, v7, s[44:47], s22 offen
s_mov_b32 s44, s28
s_and_b32 s45, s29, 0xffff
buffer_load_dword a255, v6, s[44:47], s22 offen
buffer_load_dword a255, v7, s[44:47], s22 offen
s_branch M_NOPREP
M_X0:
s_sub_u32 s21, s21, 32
s_load_dwordx2 s[32:33], s[0:1], 0
v_lshrrev_b32 v18, 3, v0
v_and_b32 v19, 7, v0
v_mul_u32_u24 v2, 896, v18
v_lshl_add_u32 v2, v19, 4, v2
v_lshlrev_b32 v3, 9, v19
v_lshl_add_u32 v3, v18, 4, v3
v_lshlrev_b32 v4, 4, v18
s_mul_i32 s22, s21, 28672
s_waitcnt lgkmcnt(0)
s_mov_b32 s40, s32
s_and_b32 s41, s33, 0xffff
s_mov_b32 s42, 1835008
s_mov_b32 s43, 0x00020000
buffer_load_dwordx4 v[24:27], v2, s[40:43], s22 offen offset:0
buffer_load_dwordx4 v[28:31], v2, s[40:43], s22 offen offset:128
buffer_load_dwordx4 v[32:35], v2, s[40:43], s22 offen offset:256
buffer_load_dwordx4 v[36:39], v2, s[40:43], s22 offen offset:384
buffer_load_dwordx4 v[40:43], v2, s[40:43], s22 offen offset:512
buffer_load_dwordx4 v[44:47], v2, s[40:43], s22 offen offset:640
buffer_load_dwordx4 v[48:51], v2, s[40:43], s22 offen offset:768
s_add_u32 s21, s21, 32
s_load_dwordx8 s[24:31], s[0:1], 16
s_lshl_b32 s22, s21, 2
s_add_u32 s22, s22, s12
s_mul_i32 s22, s22, 9600
v_lshlrev_b32 v6, 7, v1
v_min_u32 v7, 15, v1
v_lshlrev_b32 v7, 7, v7
v_add_u32 v7, 8192, v7
s_mov_b32 s46, 3670016
s_mov_b32 s47, 0x00020000
s_waitcnt lgkmcnt(0)
s_mov_b32 s44, s26
s_and_b32 s45, s27, 0xffff
buffer_load_dword a255, v6, s[44:47], s22 offen
buffer_load_dword a255, v7, s[44:47], s22 offen
s_mov_b32 s44, s30
s_and_b32 s45, s31, 0xffff
buffer_load_dword a255, v6, s[44:47], s22 offen
buffer_load_dword a255, v7, s[44:47], s22 offen
s_mov_b32 s44, s24
s_and_b32 s45, s25, 0xffff
buffer_load_dword a255, v6, s[44:47], s22 offen
buffer_load_dword a255, v7, s[44:47], s22 offen
s_mov_b32 s44, s28
s_and_b32 s45, s29, 0xffff
buffer_load_dword a255, v6, s[44:47], s22 offen
buffer_load_dword a255, v7, s[44:47], s22 offen
s_sub_u32 s21, s21, 32
s_mul_i32 s22, s21, 28672
s_add_u32 s22, s22, 44040192
s_lshl_b32 s23, s21, 11
s_add_u32 s23, s23, 39321600
s_mov_b32 s36, 0x01010101
s_mov_b32 s37, 0x01010101
v_mov_b64 v[118:119], 0
s_waitcnt vmcnt(8)
buffer_store_dwordx4 v[24:27], v3, s[8:11], s22 offen sc1
s_add_u32 s22, s22, 4096
v_lshlrev_b32 v88, 16, v24
v_and_b32 v89, 0xffff0000, v24
v_lshlrev_b32 v90, 16, v25
v_and_b32 v91, 0xffff0000, v25
v_lshlrev_b32 v92, 16, v26
v_and_b32 v93, 0xffff0000, v26
v_lshlrev_b32 v94, 16, v27
v_and_b32 v95, 0xffff0000, v27
v_pk_add_f32 v[96:97], v[88:89], v[90:91]
v_pk_mul_f32 v[98:99], v[88:89], v[88:89]
v_pk_add_f32 v[100:101], v[92:93], v[94:95]
v_pk_fma_f32 v[98:99], v[90:91], v[90:91], v[98:99]
v_pk_fma_f32 v[98:99], v[92:93], v[92:93], v[98:99]
v_pk_fma_f32 v[98:99], v[94:95], v[94:95], v[98:99]
v_pk_add_f32 v[96:97], v[96:97], v[100:101]
v_add_f32 v104, v96, v97
v_add_f32 v105, v98, v99
s_nop 0
v_add_f32_dpp v104, v104, v104 quad_perm:[1,0,3,2] row_mask:0xf bank_mask:0xf
v_add_f32_dpp v105, v105, v105 quad_perm:[1,0,3,2] row_mask:0xf bank_mask:0xf
s_nop 0
v_add_f32_dpp v104, v104, v104 quad_perm:[2,3,0,1] row_mask:0xf bank_mask:0xf
v_add_f32_dpp v105, v105, v105 quad_perm:[2,3,0,1] row_mask:0xf bank_mask:0xf
s_nop 0
v_add_f32_dpp v104, v104, v104 row_half_mirror row_mask:0xf bank_mask:0xf
v_add_f32_dpp v105, v105, v105 row_half_mirror row_mask:0xf bank_mask:0xf
buffer_store_dwordx4 v[28:31], v3, s[8:11], s22 offen sc1
s_add_u32 s22, s22, 4096
v_lshlrev_b32 v88, 16, v28
v_and_b32 v89, 0xffff0000, v28
v_lshlrev_b32 v90, 16, v29
v_and_b32 v91, 0xffff0000, v29
v_lshlrev_b32 v92, 16, v30
v_and_b32 v93, 0xffff0000, v30
v_lshlrev_b32 v94, 16, v31
v_and_b32 v95, 0xffff0000, v31
v_pk_add_f32 v[96:97], v[88:89], v[90:91]
v_pk_mul_f32 v[98:99], v[88:89], v[88:89]
v_pk_add_f32 v[100:101], v[92:93], v[94:95]
v_pk_fma_f32 v[98:99], v[90:91], v[90:91], v[98:99]
v_pk_fma_f32 v[98:99], v[92:93], v[92:93], v[98:99]
v_pk_fma_f32 v[98:99], v[94:95], v[94:95], v[98:99]
v_pk_add_f32 v[96:97], v[96:97], v[100:101]
v_add_f32 v106, v96, v97
v_add_f32 v107, v98, v99
s_nop 0
v_add_f32_dpp v106, v106, v106 quad_perm:[1,0,3,2] row_mask:0xf bank_mask:0xf
v_add_f32_dpp v107, v107, v107 quad_perm:[1,0,3,2] row_mask:0xf bank_mask:0xf
s_nop 0
v_add_f32_dpp v106, v106, v106 quad_perm:[2,3,0,1] row_mask:0xf bank_mask:0xf
v_add_f32_dpp v107, v107, v107 quad_perm:[2,3,0,1] row_mask:0xf bank_mask:0xf
s_nop 0
v_add_f32_dpp v106, v106, v106 row_half_mirror row_mask:0xf bank_mask:0xf
v_add_f32_dpp v107, v107, v107 row_half_mirror row_mask:0xf bank_mask:0xf
buffer_store_dwordx4 v[32:35], v3, s[8:11], s22 offen sc1
s_add_u32 s22, s22, 4096
v_lshlrev_b32 v88, 16, v32
v_and_b32 v89, 0xffff0000, v32
v_lshlrev_b32 v90, 16, v33
v_and_b32 v91, 0xffff0000, v33
v_lshlrev_b32 v92, 16, v34
v_and_b32 v93, 0xffff0000, v34
v_lshlrev_b32 v94, 16, v35
v_and_b32 v95, 0xffff0000, v35
v_pk_add_f32 v[96:97], v[88:89], v[90:91]
v_pk_mul_f32 v[98:99], v[88:89], v[88:89]
v_pk_add_f32 v[100:101], v[92:93], v[94:95]
v_pk_fma_f32 v[98:99], v[90:91], v[90:91], v[98:99]
v_pk_fma_f32 v[98:99], v[92:93], v[92:93], v[98:99]
v_pk_fma_f32 v[98:99], v[94:95], v[94:95], v[98:99]
v_pk_add_f32 v[96:97], v[96:97], v[100:101]
v_add_f32 v108, v96, v97
v_add_f32 v109, v98, v99
s_nop 0
v_add_f32_dpp v108, v108, v108 quad_perm:[1,0,3,2] row_mask:0xf bank_mask:0xf
v_add_f32_dpp v109, v109, v109 quad_perm:[1,0,3,2] row_mask:0xf bank_mask:0xf
s_nop 0
v_add_f32_dpp v108, v108, v108 quad_perm:[2,3,0,1] row_mask:0xf bank_mask:0xf
v_add_f32_dpp v109, v109, v109 quad_perm:[2,3,0,1] row_mask:0xf bank_mask:0xf
s_nop 0
v_add_f32_dpp v108, v108, v108 row_half_mirror row_mask:0xf bank_mask:0xf
v_add_f32_dpp v109, v109, v109 row_half_mirror row_mask:0xf bank_mask:0xf
buffer_store_dwordx4 v[36:39], v3, s[8:11], s22 offen sc1
s_add_u32 s22, s22, 4096
v_lshlrev_b32 v88, 16, v36
v_and_b32 v89, 0xffff0000, v36
v_lshlrev_b32 v90, 16, v37
v_and_b32 v91, 0xffff0000, v37
v_lshlrev_b32 v92, 16, v38
v_and_b32 v93, 0xffff0000, v38
v_lshlrev_b32 v94, 16, v39
v_and_b32 v95, 0xffff0000, v39
v_pk_add_f32 v[96:97], v[88:89], v[90:91]
v_pk_mul_f32 v[98:99], v[88:89], v[88:89]
v_pk_add_f32 v[100:101], v[92:93], v[94:95]
v_pk_fma_f32 v[98:99], v[90:91], v[90:91], v[98:99]
v_pk_fma_f32 v[98:99], v[92:93], v[92:93], v[98:99]
v_pk_fma_f32 v[98:99], v[94:95], v[94:95], v[98:99]
v_pk_add_f32 v[96:97], v[96:97], v[100:101]
v_add_f32 v110, v96, v97
v_add_f32 v111, v98, v99
s_nop 0
v_add_f32_dpp v110, v110, v110 quad_perm:[1,0,3,2] row_mask:0xf bank_mask:0xf
v_add_f32_dpp v111, v111, v111 quad_perm:[1,0,3,2] row_mask:0xf bank_mask:0xf
s_nop 0
v_add_f32_dpp v110, v110, v110 quad_perm:[2,3,0,1] row_mask:0xf bank_mask:0xf
v_add_f32_dpp v111, v111, v111 quad_perm:[2,3,0,1] row_mask:0xf bank_mask:0xf
s_nop 0
v_add_f32_dpp v110, v110, v110 row_half_mirror row_mask:0xf bank_mask:0xf
v_add_f32_dpp v111, v111, v111 row_half_mirror row_mask:0xf bank_mask:0xf
buffer_store_dwordx4 v[40:43], v3, s[8:11], s22 offen sc1
s_add_u32 s22, s22, 4096
v_lshlrev_b32 v88, 16, v40
v_and_b32 v89, 0xffff0000, v40
v_lshlrev_b32 v90, 16, v41
v_and_b32 v91, 0xffff0000, v41
v_lshlrev_b32 v92, 16, v42
v_and_b32 v93, 0xffff0000, v42
v_lshlrev_b32 v94, 16, v43
v_and_b32 v95, 0xffff0000, v43
v_pk_add_f32 v[96:97], v[88:89], v[90:91]
v_pk_mul_f32 v[98:99], v[88:89], v[88:89]
v_pk_add_f32 v[100:101], v[92:93], v[94:95]
v_pk_fma_f32 v[98:99], v[90:91], v[90:91], v[98:99]
v_pk_fma_f32 v[98:99], v[92:93], v[92:93], v[98:99]
v_pk_fma_f32 v[98:99], v[94:95], v[94:95], v[98:99]
v_pk_add_f32 v[96:97], v[96:97], v[100:101]
v_add_f32 v112, v96, v97
v_add_f32 v113, v98, v99
s_nop 0
v_add_f32_dpp v112, v112, v112 quad_perm:[1,0,3,2] row_mask:0xf bank_mask:0xf
v_add_f32_dpp v113, v113, v113 quad_perm:[1,0,3,2] row_mask:0xf bank_mask:0xf
s_nop 0
v_add_f32_dpp v112, v112, v112 quad_perm:[2,3,0,1] row_mask:0xf bank_mask:0xf
v_add_f32_dpp v113, v113, v113 quad_perm:[2,3,0,1] row_mask:0xf bank_mask:0xf
s_nop 0
v_add_f32_dpp v112, v112, v112 row_half_mirror row_mask:0xf bank_mask:0xf
v_add_f32_dpp v113, v113, v113 row_half_mirror row_mask:0xf bank_mask:0xf
buffer_store_dwordx4 v[44:47], v3, s[8:11], s22 offen sc1
s_add_u32 s22, s22, 4096
v_lshlrev_b32 v88, 16, v44
v_and_b32 v89, 0xffff0000, v44
v_lshlrev_b32 v90, 16, v45
v_and_b32 v91, 0xffff0000, v45
v_lshlrev_b32 v92, 16, v46
v_and_b32 v93, 0xffff0000, v46
v_lshlrev_b32 v94, 16, v47
v_and_b32 v95, 0xffff0000, v47
v_pk_add_f32 v[96:97], v[88:89], v[90:91]
v_pk_mul_f32 v[98:99], v[88:89], v[88:89]
v_pk_add_f32 v[100:101], v[92:93], v[94:95]
v_pk_fma_f32 v[98:99], v[90:91], v[90:91], v[98:99]
v_pk_fma_f32 v[98:99], v[92:93], v[92:93], v[98:99]
v_pk_fma_f32 v[98:99], v[94:95], v[94:95], v[98:99]
v_pk_add_f32 v[96:97], v[96:97], v[100:101]
v_add_f32 v114, v96, v97
v_add_f32 v115, v98, v99
s_nop 0
v_add_f32_dpp v114, v114, v114 quad_perm:[1,0,3,2] row_mask:0xf bank_mask:0xf
v_add_f32_dpp v115, v115, v115 quad_perm:[1,0,3,2] row_mask:0xf bank_mask:0xf
s_nop 0
v_add_f32_dpp v114, v114, v114 quad_perm:[2,3,0,1] row_mask:0xf bank_mask:0xf
v_add_f32_dpp v115, v115, v115 quad_perm:[2,3,0,1] row_mask:0xf bank_mask:0xf
s_nop 0
v_add_f32_dpp v114, v114, v114 row_half_mirror row_mask:0xf bank_mask:0xf
v_add_f32_dpp v115, v115, v115 row_half_mirror row_mask:0xf bank_mask:0xf
buffer_store_dwordx4 v[48:51], v3, s[8:11], s22 offen sc1
s_add_u32 s22, s22, 4096
v_lshlrev_b32 v88, 16, v48
v_and_b32 v89, 0xffff0000, v48
v_lshlrev_b32 v90, 16, v49
v_and_b32 v91, 0xffff0000, v49
v_lshlrev_b32 v92, 16, v50
v_and_b32 v93, 0xffff0000, v50
v_lshlrev_b32 v94, 16, v51
v_and_b32 v95, 0xffff0000, v51
v_pk_add_f32 v[96:97], v[88:89], v[90:91]
v_pk_mul_f32 v[98:99], v[88:89], v[88:89]
v_pk_add_f32 v[100:101], v[92:93], v[94:95]
v_pk_fma_f32 v[98:99], v[90:91], v[90:91], v[98:99]
v_pk_fma_f32 v[98:99], v[92:93], v[92:93], v[98:99]
v_pk_fma_f32 v[98:99], v[94:95], v[94:95], v[98:99]
v_pk_add_f32 v[96:97], v[96:97], v[100:101]
v_add_f32 v116, v96, v97
v_add_f32 v117, v98, v99
s_nop 0
v_add_f32_dpp v116, v116, v116 quad_perm:[1,0,3,2] row_mask:0xf bank_mask:0xf
v_add_f32_dpp v117, v117, v117 quad_perm:[1,0,3,2] row_mask:0xf bank_mask:0xf
s_nop 0
v_add_f32_dpp v116, v116, v116 quad_perm:[2,3,0,1] row_mask:0xf bank_mask:0xf
v_add_f32_dpp v117, v117, v117 quad_perm:[2,3,0,1] row_mask:0xf bank_mask:0xf
s_nop 0
v_add_f32_dpp v116, v116, v116 row_half_mirror row_mask:0xf bank_mask:0xf
v_add_f32_dpp v117, v117, v117 row_half_mirror row_mask:0xf bank_mask:0xf
s_mov_b64 exec, s[36:37]
buffer_store_dwordx4 v[104:107], v4, s[8:11], s23 offen offset:0 sc1
buffer_store_dwordx4 v[108:111], v4, s[8:11], s23 offen offset:512 sc1
buffer_store_dwordx4 v[112:115], v4, s[8:11], s23 offen offset:1024 sc1
buffer_store_dwordx4 v[116:119], v4, s[8:11], s23 offen offset:1536 sc1
s_mov_b64 exec, -1
s_waitcnt vmcnt(0)
s_barrier
s_cmp_lg_u32 s12, 0
s_cbranch_scc1 ARR_56
s_mov_b64 exec, 1
v_mov_b32 v16, 1
buffer_atomic_add v16, off, s[92:95], 0 offset:144 sc1
s_mov_b64 exec, -1
ARR_56:
s_branch M_NOPREP
M_MISC:
s_load_dwordx4 s[32:35], s[0:1], 0
v_lshrrev_b32 v18, 3, v0
v_and_b32 v19, 7, v0
v_mul_u32_u24 v2, 896, v18
v_lshl_add_u32 v2, v19, 4, v2
v_lshlrev_b32 v3, 9, v19
v_lshl_add_u32 v3, v18, 4, v3
v_lshlrev_b32 v4, 4, v18
s_mul_i32 s22, s13, 57344
s_add_u32 s23, s22, 28672
v_lshlrev_b32 v5, 4, v0
v_mov_b32 v8, -1
v_mov_b32 v9, -1
v_mov_b32 v10, -1
v_mov_b32 v11, -1
v_mov_b64 v[12:13], 0
v_mov_b64 v[14:15], 0
s_cmp_lt_u32 s13, 28
s_cbranch_scc1 P_NOFW_57
s_lshl_b32 s48, s13, 13
s_add_u32 s48, s48, 38567936
buffer_store_dwordx4 v[12:15], v5, s[8:11], s48 offen sc1
s_add_u32 s48, s48, 4096
buffer_store_dwordx4 v[12:15], v5, s[8:11], s48 offen sc1
s_add_u32 s48, s48, 4096
s_waitcnt vmcnt(0)
s_barrier
s_cmp_lg_u32 s12, 0
s_cbranch_scc1 ARR_58
s_mov_b64 exec, 1
v_mov_b32 v16, 1
buffer_atomic_add v16, off, s[92:95], 0 offset:176 sc1
s_mov_b64 exec, -1
ARR_58:
P_NOFW_57:
s_mul_i32 s48, s13, 32768
s_add_u32 s48, s48, 37748736
buffer_store_dwordx4 v[12:15], v5, s[8:11], s48 offen sc1
s_add_u32 s48, s48, 4096
buffer_store_dwordx4 v[12:15], v5, s[8:11], s48 offen sc1
s_add_u32 s48, s48, 4096
buffer_store_dwordx4 v[12:15], v5, s[8:11], s48 offen sc1
s_add_u32 s48, s48, 4096
buffer_store_dwordx4 v[12:15], v5, s[8:11], s48 offen sc1
s_add_u32 s48, s48, 4096
buffer_store_dwordx4 v[12:15], v5, s[8:11], s48 offen sc1
s_add_u32 s48, s48, 4096
buffer_store_dwordx4 v[12:15], v5, s[8:11], s48 offen sc1
s_add_u32 s48, s48, 4096
buffer_store_dwordx4 v[12:15], v5, s[8:11], s48 offen sc1
s_add_u32 s48, s48, 4096
buffer_store_dwordx4 v[12:15], v5, s[8:11], s48 offen sc1
s_add_u32 s48, s48, 4096
s_mul_i32 s48, s13, 32768
s_add_u32 s48, s48, 35717120
buffer_store_dwordx4 v[8:11], v5, s[8:11], s48 offen sc1
s_add_u32 s48, s48, 4096
buffer_store_dwordx4 v[8:11], v5, s[8:11], s48 offen sc1
s_add_u32 s48, s48, 4096
buffer_store_dwordx4 v[8:11], v5, s[8:11], s48 offen sc1
s_add_u32 s48, s48, 4096
buffer_store_dwordx4 v[8:11], v5, s[8:11], s48 offen sc1
s_add_u32 s48, s48, 4096
buffer_store_dwordx4 v[8:11], v5, s[8:11], s48 offen sc1
s_add_u32 s48, s48, 4096
buffer_store_dwordx4 v[8:11], v5, s[8:11], s48 offen sc1
s_add_u32 s48, s48, 4096
buffer_store_dwordx4 v[8:11], v5, s[8:11], s48 offen sc1
s_add_u32 s48, s48, 4096
buffer_store_dwordx4 v[8:11], v5, s[8:11], s48 offen sc1
s_add_u32 s48, s48, 4096
s_mul_i32 s48, s13, 12288
s_add_u32 s48, s48, 54525952
buffer_store_dwordx4 v[8:11], v5, s[8:11], s48 offen sc1
s_add_u32 s48, s48, 4096
buffer_store_dwordx4 v[8:11], v5, s[8:11], s48 offen sc1
s_add_u32 s48, s48, 4096
buffer_store_dwordx4 v[8:11], v5, s[8:11], s48 offen sc1
s_add_u32 s48, s48, 4096
s_mul_i32 s48, s13, 12288
s_add_u32 s48, s48, 39452672
buffer_store_dwordx4 v[12:15], v5, s[8:11], s48 offen sc1
s_add_u32 s48, s48, 4096
buffer_store_dwordx4 v[12:15], v5, s[8:11], s48 offen sc1
s_add_u32 s48, s48, 4096
buffer_store_dwordx4 v[12:15], v5, s[8:11], s48 offen sc1
s_add_u32 s48, s48, 4096
s_waitcnt lgkmcnt(0)
s_mov_b32 s40, s32
s_and_b32 s41, s33, 0xffff
s_mov_b32 s42, 1835008
s_mov_b32 s43, 0x00020000
s_mov_b32 s44, s34
s_and_b32 s45, s35, 0xffff
s_mov_b32 s46, 7168
s_mov_b32 s47, 0x00020000
s_cmp_ge_u32 s13, 2
s_cbranch_scc1 P_NOMEM_59
s_mul_i32 s48, s13, 28672
s_add_u32 s48, s48, 35651584
v_bfe_u32 v6, v0, 2, 2
v_and_b32 v7, 1, v0
v_lshl_add_u32 v6, v6, 1, v7
v_mul_u32_u24 v6, 896, v6
v_lshrrev_b32 v7, 4, v0
v_lshl_add_u32 v6, v7, 5, v6
v_bfe_u32 v7, v0, 1, 1
v_lshl_add_u32 v6, v7, 2, v6
buffer_load_dword v88, v6, s[44:47], 0 offen
buffer_load_dword v89, v6, s[44:47], 0 offen offset:8
buffer_load_dword v90, v6, s[44:47], 0 offen offset:16
buffer_load_dword v91, v6, s[44:47], 0 offen offset:24
buffer_load_dword v92, v6, s[44:47], 0 offen offset:512
buffer_load_dword v93, v6, s[44:47], 0 offen offset:520
buffer_load_dword v94, v6, s[44:47], 0 offen offset:528
buffer_load_dword v95, v6, s[44:47], 0 offen offset:536
s_add_u32 s49, s48, 7168
buffer_store_dwordx4 v[8:11], v5, s[8:11], s49 offen sc1
s_add_u32 s49, s49, 4096
buffer_store_dwordx4 v[8:11], v5, s[8:11], s49 offen sc1
s_add_u32 s49, s49, 4096
buffer_store_dwordx4 v[8:11], v5, s[8:11], s49 offen sc1
s_add_u32 s49, s49, 4096
buffer_store_dwordx4 v[8:11], v5, s[8:11], s49 offen sc1
s_add_u32 s49, s49, 4096
buffer_store_dwordx4 v[8:11], v5, s[8:11], s49 offen sc1
s_add_u32 s49, s49, 4096
s_cmp_lg_u32 s12, 0
s_cbranch_scc1 P_M1_60
buffer_store_dwordx4 v[8:11], v5, s[8:11], s49 offen sc1
P_M1_60:
s_waitcnt vmcnt(0)
v_min_u32 v88, -2, v88
v_min_u32 v89, -2, v89
v_min_u32 v90, -2, v90
v_min_u32 v91, -2, v91
v_min_u32 v92, -2, v92
v_min_u32 v93, -2, v93
v_min_u32 v94, -2, v94
v_min_u32 v95, -2, v95
buffer_store_dwordx4 v[88:91], v5, s[8:11], s48 offen sc1
s_add_u32 s48, s48, 4096
s_cmp_eq_u32 s12, 3
s_cbranch_scc1 P_NOMEM_59
buffer_store_dwordx4 v[92:95], v5, s[8:11], s48 offen sc1
P_NOMEM_59:
s_waitcnt vmcnt(0)
s_barrier
s_cmp_lg_u32 s12, 0
s_cbranch_scc1 ARR_62
s_mov_b64 exec, 1
v_mov_b32 v16, 1
buffer_atomic_add v16, off, s[92:95], 0 offset:16 sc1
s_mov_b64 exec, -1
ARR_62:
M_NOPREP:
s_cmp_lg_u32 s12, 0
s_cbranch_scc1 WC_63_d
s_branch WC_63_in
WC_63:
s_sleep 16
WC_63_in:
buffer_load_dword v2, off, s[92:95], 0 offset:176 sc1
s_sub_u32 s16, s16, 1
s_cbranch_scc1 WC_63_ab
s_waitcnt vmcnt(0)
v_cmp_gt_u32 vcc, 4, v2
s_cbranch_vccnz WC_63
WC_63_d:
s_barrier
s_cmp_ge_u32 s3, 4
s_cselect_b32 s17, 28, 30
s_cmp_eq_u32 s3, 2
s_cselect_b32 s17, 32, s17
s_cmp_lt_u32 s13, s17
s_cbranch_scc1 M_PREPD
M_NOPREP2:
s_cmp_lg_u32 s12, 0
s_cbranch_scc1 WC_64_d
s_branch WC_64_in
WC_64:
s_sleep 16
WC_64_in:
buffer_load_dword v2, off, s[92:95], 0 offset:16 sc1
s_sub_u32 s16, s16, 1
s_cbranch_scc1 WC_64_ab
s_waitcnt vmcnt(0)
v_cmp_gt_u32 vcc, 32, v2
s_cbranch_vccnz WC_64
WC_64_d:
s_barrier
M_PREPD:
s_lshr_b32 s17, 0x8a, s3
s_and_b32 s17, s17, 1
s_cbranch_scc0 M_NOHOLD
s_lshl_b32 s17, s3, 2
s_lshr_b32 s21, 0x20001000, s17
s_and_b32 s21, s21, 3
s_lshl_b32 s21, s21, 5
s_add_u32 s21, s21, s13
v_lshlrev_b32 v5, 4, v0
v_mov_b32 v8, -1
v_mov_b32 v9, -1
v_mov_b32 v10, -1
v_mov_b32 v11, -1
s_mul_i32 s48, s21, 53248
s_add_u32 s48, s48, 54853632
buffer_store_dwordx4 v[8:11], v5, s[8:11], s48 offen sc1
s_add_u32 s48, s48, 4096
buffer_store_dwordx4 v[8:11], v5, s[8:11], s48 offen sc1
s_add_u32 s48, s48, 4096
buffer_store_dwordx4 v[8:11], v5, s[8:11], s48 offen sc1
s_add_u32 s48, s48, 4096
buffer_store_dwordx4 v[8:11], v5, s[8:11], s48 offen sc1
s_add_u32 s48, s48, 4096
buffer_store_dwordx4 v[8:11], v5, s[8:11], s48 offen sc1
s_add_u32 s48, s48, 4096
buffer_store_dwordx4 v[8:11], v5, s[8:11], s48 offen sc1
s_add_u32 s48, s48, 4096
buffer_store_dwordx4 v[8:11], v5, s[8:11], s48 offen sc1
s_add_u32 s48, s48, 4096
buffer_store_dwordx4 v[8:11], v5, s[8:11], s48 offen sc1
s_add_u32 s48, s48, 4096
buffer_store_dwordx4 v[8:11], v5, s[8:11], s48 offen sc1
s_add_u32 s48, s48, 4096
buffer_store_dwordx4 v[8:11], v5, s[8:11], s48 offen sc1
s_add_u32 s48, s48, 4096
buffer_store_dwordx4 v[8:11], v5, s[8:11], s48 offen sc1
s_add_u32 s48, s48, 4096
buffer_store_dwordx4 v[8:11], v5, s[8:11], s48 offen sc1
s_add_u32 s48, s48, 4096
buffer_store_dwordx4 v[8:11], v5, s[8:11], s48 offen sc1
s_add_u32 s48, s48, 4096
s_waitcnt vmcnt(0)
s_barrier
s_cmp_lg_u32 s12, 0
s_cbranch_scc1 ARR_65
s_mov_b64 exec, 1
v_mov_b32 v16, 1
s_mov_b32 s58, 38207488
buffer_atomic_add v16, off, s[8:11], s58 sc1
s_mov_b64 exec, -1
ARR_65:
s_mov_b32 s18, 35815424
M_HOLD:
s_sleep 8
buffer_load_dword v2, off, s[8:11], s18 sc1
s_sub_u32 s16, s16, 1
s_cbranch_scc1 M_HOLDAB
s_waitcnt vmcnt(0)
v_cmp_eq_u32 vcc, -1, v2
s_nop 3
s_cbranch_vccnz M_HOLD
v_and_b32 v6, 7, v1
v_lshlrev_b32 v6, 5, v6
buffer_load_dword v7, v6, s[92:95], 0 offen sc1
v_lshlrev_b32 v6, 7, v1
s_lshl_b32 s22, s13, 2
s_add_u32 s22, s22, s12
s_lshl_b32 s22, s22, 13
s_lshr_b32 s23, s21, 5
s_cmp_eq_u32 s23, 1
s_mov_b32 s24, 77594624
s_mov_b32 s26, 39845888
s_cselect_b32 s24, 45875200, s24
s_cselect_b32 s26, 84934656, s26
s_cselect_b32 s25, 6, 7
s_cselect_b32 s27, 7, 4
s_add_u32 s24, s24, s22
s_waitcnt vmcnt(0)
v_cmp_ne_u32 vcc, 32, v7
s_nop 3
s_cbranch_vccnz WW_END_66
s_cmp_eq_u32 s23, 0
s_cbranch_scc1 WW_END_66
WW_67:
buffer_load_dword a255, v6, s[8:11], s24 offen
s_add_u32 s24, s24, 1048576
s_sub_u32 s25, s25, 1
s_cmp_lg_u32 s25, 0
s_cbranch_scc1 WW_67
s_cmp_eq_u32 s27, 0
s_cbranch_scc1 WW_END_66
s_add_u32 s24, s22, s26
s_mov_b32 s25, s27
s_mov_b32 s27, 0
s_branch WW_67
WW_END_66:
s_branch M_NOHOLD
M_HOLDAB:
s_mov_b32 s16, 0
M_NOHOLD:
s_lshl_b32 s59, s14, 20
s_lshr_b32 s3, s3, 1
s_cmp_eq_u32 s3, 1
s_cbranch_scc1 M_T
s_cmp_eq_u32 s3, 2
s_cbranch_scc1 M_U
s_cmp_eq_u32 s3, 3
s_cbranch_scc1 M_PFF
s_mov_b32 s21, s12
s_cmp_eq_u32 s13, 31
s_cbranch_scc1 M_HT
s_add_u32 s21, s12, 3
s_cmp_eq_u32 s13, 30
s_cbranch_scc1 M_HP
s_cmp_ge_u32 s13, 16
s_cbranch_scc1 M_CB
s_cmp_eq_u32 s12, 0
s_cbranch_scc1 CA_W0_68
s_mul_i32 s19, s13, 401408
s_mul_i32 s17, s12, 14336
s_add_u32 s26, s19, s17
s_add_u32 s26, s26, 0
v_lshlrev_b32 v61, 4, v1
v_min_u32 v56, 13, v1
v_lshlrev_b32 v56, 2, v56
s_lshl_b32 s18, s13, 7
v_add_u32 v56, s18, v56
s_mov_b32 s58, 38797312
s_branch WF_69_in
WF_69:
s_sleep 12
WF_69_in:
buffer_load_dword v57, v56, s[8:11], s58 offen sc1
s_sub_u32 s16, s16, 1
s_cbranch_scc1 WFD_70_abort
s_waitcnt vmcnt(0)
v_cmp_eq_u32 vcc, 0, v57
s_cbranch_vccnz WF_69
WFD_70:
s_add_u32 s58, s58, 2048
buffer_load_dword v57, v56, s[8:11], s58 offen sc1
s_add_u32 s20, s26, 0
buffer_load_dwordx4 a[0:3], v61, s[8:11], s20 offen offset:0 sc1
buffer_load_dwordx4 a[4:7], v61, s[8:11], s20 offen offset:1024 sc1
s_add_u32 s20, s26, 57344
buffer_load_dwordx4 a[56:59], v61, s[8:11], s20 offen offset:0 sc1
buffer_load_dwordx4 a[60:63], v61, s[8:11], s20 offen offset:1024 sc1
s_add_u32 s20, s26, 114688
buffer_load_dwordx4 a[112:115], v61, s[8:11], s20 offen offset:0 sc1
buffer_load_dwordx4 a[116:119], v61, s[8:11], s20 offen offset:1024 sc1
s_add_u32 s20, s26, 172032
buffer_load_dwordx4 a[168:171], v61, s[8:11], s20 offen offset:0 sc1
buffer_load_dwordx4 a[172:175], v61, s[8:11], s20 offen offset:1024 sc1
s_add_u32 s20, s26, 215040
buffer_load_dwordx4 a[224:227], v61, s[8:11], s20 offen offset:0 sc1
buffer_load_dwordx4 a[228:231], v61, s[8:11], s20 offen offset:1024 sc1
s_add_u32 s20, s26, 258048
buffer_load_dwordx4 v[88:91], v61, s[8:11], s20 offen offset:0 sc1
buffer_load_dwordx4 v[92:95], v61, s[8:11], s20 offen offset:1024 sc1
s_add_u32 s20, s26, 301056
buffer_load_dwordx4 v[144:147], v61, s[8:11], s20 offen offset:0 sc1
buffer_load_dwordx4 v[148:151], v61, s[8:11], s20 offen offset:1024 sc1
s_add_u32 s20, s26, 344064
buffer_load_dwordx4 v[200:203], v61, s[8:11], s20 offen offset:0 sc1
buffer_load_dwordx4 v[204:207], v61, s[8:11], s20 offen offset:1024 sc1
s_waitcnt vmcnt(16)
v_cmp_eq_u32 vcc, 0, v57
s_cbranch_vccz OPT_71
s_nop 2
s_branch WF_72_in
WF_72:
s_sleep 12
WF_72_in:
buffer_load_dword v57, v56, s[8:11], s58 offen sc1
s_sub_u32 s16, s16, 1
s_cbranch_scc1 WFD_73_abort
s_waitcnt vmcnt(0)
v_cmp_eq_u32 vcc, 0, v57
s_cbranch_vccnz WF_72
WFD_73:
OPT_71:
s_add_u32 s58, s58, 2048
buffer_load_dword v57, v56, s[8:11], s58 offen sc1
s_add_u32 s20, s26, 2048
buffer_load_dwordx4 a[8:11], v61, s[8:11], s20 offen offset:0 sc1
buffer_load_dwordx4 a[12:15], v61, s[8:11], s20 offen offset:1024 sc1
s_add_u32 s20, s26, 59392
buffer_load_dwordx4 a[64:67], v61, s[8:11], s20 offen offset:0 sc1
buffer_load_dwordx4 a[68:71], v61, s[8:11], s20 offen offset:1024 sc1
s_add_u32 s20, s26, 116736
buffer_load_dwordx4 a[120:123], v61, s[8:11], s20 offen offset:0 sc1
buffer_load_dwordx4 a[124:127], v61, s[8:11], s20 offen offset:1024 sc1
s_add_u32 s20, s26, 174080
buffer_load_dwordx4 a[176:179], v61, s[8:11], s20 offen offset:0 sc1
buffer_load_dwordx4 a[180:183], v61, s[8:11], s20 offen offset:1024 sc1
s_add_u32 s20, s26, 217088
buffer_load_dwordx4 a[232:235], v61, s[8:11], s20 offen offset:0 sc1
buffer_load_dwordx4 a[236:239], v61, s[8:11], s20 offen offset:1024 sc1
s_add_u32 s20, s26, 260096
buffer_load_dwordx4 v[96:99], v61, s[8:11], s20 offen offset:0 sc1
buffer_load_dwordx4 v[100:103], v61, s[8:11], s20 offen offset:1024 sc1
s_add_u32 s20, s26, 303104
buffer_load_dwordx4 v[152:155], v61, s[8:11], s20 offen offset:0 sc1
buffer_load_dwordx4 v[156:159], v61, s[8:11], s20 offen offset:1024 sc1
s_add_u32 s20, s26, 346112
buffer_load_dwordx4 v[208:211], v61, s[8:11], s20 offen offset:0 sc1
buffer_load_dwordx4 v[212:215], v61, s[8:11], s20 offen offset:1024 sc1
s_waitcnt vmcnt(16)
v_cmp_eq_u32 vcc, 0, v57
s_cbranch_vccz OPT_74
s_nop 2
s_branch WF_75_in
WF_75:
s_sleep 12
WF_75_in:
buffer_load_dword v57, v56, s[8:11], s58 offen sc1
s_sub_u32 s16, s16, 1
s_cbranch_scc1 WFD_76_abort
s_waitcnt vmcnt(0)
v_cmp_eq_u32 vcc, 0, v57
s_cbranch_vccnz WF_75
WFD_76:
OPT_74:
s_add_u32 s58, s58, 2048
buffer_load_dword v57, v56, s[8:11], s58 offen sc1
s_add_u32 s20, s26, 4096
buffer_load_dwordx4 a[16:19], v61, s[8:11], s20 offen offset:0 sc1
buffer_load_dwordx4 a[20:23], v61, s[8:11], s20 offen offset:1024 sc1
s_add_u32 s20, s26, 61440
buffer_load_dwordx4 a[72:75], v61, s[8:11], s20 offen offset:0 sc1
buffer_load_dwordx4 a[76:79], v61, s[8:11], s20 offen offset:1024 sc1
s_add_u32 s20, s26, 118784
buffer_load_dwordx4 a[128:131], v61, s[8:11], s20 offen offset:0 sc1
buffer_load_dwordx4 a[132:135], v61, s[8:11], s20 offen offset:1024 sc1
s_add_u32 s20, s26, 176128
buffer_load_dwordx4 a[184:187], v61, s[8:11], s20 offen offset:0 sc1
buffer_load_dwordx4 a[188:191], v61, s[8:11], s20 offen offset:1024 sc1
s_add_u32 s20, s26, 219136
buffer_load_dwordx4 a[240:243], v61, s[8:11], s20 offen offset:0 sc1
buffer_load_dwordx4 a[244:247], v61, s[8:11], s20 offen offset:1024 sc1
s_add_u32 s20, s26, 262144
buffer_load_dwordx4 v[104:107], v61, s[8:11], s20 offen offset:0 sc1
buffer_load_dwordx4 v[108:111], v61, s[8:11], s20 offen offset:1024 sc1
s_add_u32 s20, s26, 305152
buffer_load_dwordx4 v[160:163], v61, s[8:11], s20 offen offset:0 sc1
buffer_load_dwordx4 v[164:167], v61, s[8:11], s20 offen offset:1024 sc1
s_add_u32 s20, s26, 348160
buffer_load_dwordx4 v[216:219], v61, s[8:11], s20 offen offset:0 sc1
buffer_load_dwordx4 v[220:223], v61, s[8:11], s20 offen offset:1024 sc1
s_waitcnt vmcnt(16)
v_cmp_eq_u32 vcc, 0, v57
s_cbranch_vccz OPT_77
s_nop 2
s_branch WF_78_in
WF_78:
s_sleep 12
WF_78_in:
buffer_load_dword v57, v56, s[8:11], s58 offen sc1
s_sub_u32 s16, s16, 1
s_cbranch_scc1 WFD_79_abort
s_waitcnt vmcnt(0)
v_cmp_eq_u32 vcc, 0, v57
s_cbranch_vccnz WF_78
WFD_79:
OPT_77:
s_add_u32 s58, s58, 2048
buffer_load_dword v57, v56, s[8:11], s58 offen sc1
s_add_u32 s20, s26, 6144
buffer_load_dwordx4 a[24:27], v61, s[8:11], s20 offen offset:0 sc1
buffer_load_dwordx4 a[28:31], v61, s[8:11], s20 offen offset:1024 sc1
s_add_u32 s20, s26, 63488
buffer_load_dwordx4 a[80:83], v61, s[8:11], s20 offen offset:0 sc1
buffer_load_dwordx4 a[84:87], v61, s[8:11], s20 offen offset:1024 sc1
s_add_u32 s20, s26, 120832
buffer_load_dwordx4 a[136:139], v61, s[8:11], s20 offen offset:0 sc1
buffer_load_dwordx4 a[140:143], v61, s[8:11], s20 offen offset:1024 sc1
s_add_u32 s20, s26, 178176
buffer_load_dwordx4 a[192:195], v61, s[8:11], s20 offen offset:0 sc1
buffer_load_dwordx4 a[196:199], v61, s[8:11], s20 offen offset:1024 sc1
s_add_u32 s20, s26, 221184
buffer_load_dwordx4 a[248:251], v61, s[8:11], s20 offen offset:0 sc1
buffer_load_dwordx4 a[252:255], v61, s[8:11], s20 offen offset:1024 sc1
s_add_u32 s20, s26, 264192
buffer_load_dwordx4 v[112:115], v61, s[8:11], s20 offen offset:0 sc1
buffer_load_dwordx4 v[116:119], v61, s[8:11], s20 offen offset:1024 sc1
s_add_u32 s20, s26, 307200
buffer_load_dwordx4 v[168:171], v61, s[8:11], s20 offen offset:0 sc1
buffer_load_dwordx4 v[172:175], v61, s[8:11], s20 offen offset:1024 sc1
s_add_u32 s20, s26, 350208
buffer_load_dwordx4 v[224:227], v61, s[8:11], s20 offen offset:0 sc1
buffer_load_dwordx4 v[228:231], v61, s[8:11], s20 offen offset:1024 sc1
s_waitcnt vmcnt(16)
v_cmp_eq_u32 vcc, 0, v57
s_cbranch_vccz OPT_80
s_nop 2
s_branch WF_81_in
WF_81:
s_sleep 12
WF_81_in:
buffer_load_dword v57, v56, s[8:11], s58 offen sc1
s_sub_u32 s16, s16, 1
s_cbranch_scc1 WFD_82_abort
s_waitcnt vmcnt(0)
v_cmp_eq_u32 vcc, 0, v57
s_cbranch_vccnz WF_81
WFD_82:
OPT_80:
s_add_u32 s58, s58, 2048
buffer_load_dword v57, v56, s[8:11], s58 offen sc1
s_add_u32 s20, s26, 8192
buffer_load_dwordx4 a[32:35], v61, s[8:11], s20 offen offset:0 sc1
buffer_load_dwordx4 a[36:39], v61, s[8:11], s20 offen offset:1024 sc1
s_add_u32 s20, s26, 65536
buffer_load_dwordx4 a[88:91], v61, s[8:11], s20 offen offset:0 sc1
buffer_load_dwordx4 a[92:95], v61, s[8:11], s20 offen offset:1024 sc1
s_add_u32 s20, s26, 122880
buffer_load_dwordx4 a[144:147], v61, s[8:11], s20 offen offset:0 sc1
buffer_load_dwordx4 a[148:151], v61, s[8:11], s20 offen offset:1024 sc1
s_add_u32 s20, s26, 180224
buffer_load_dwordx4 a[200:203], v61, s[8:11], s20 offen offset:0 sc1
buffer_load_dwordx4 a[204:207], v61, s[8:11], s20 offen offset:1024 sc1
s_add_u32 s20, s26, 223232
buffer_load_dwordx4 v[64:67], v61, s[8:11], s20 offen offset:0 sc1
buffer_load_dwordx4 v[68:71], v61, s[8:11], s20 offen offset:1024 sc1
s_add_u32 s20, s26, 266240
buffer_load_dwordx4 v[120:123], v61, s[8:11], s20 offen offset:0 sc1
buffer_load_dwordx4 v[124:127], v61, s[8:11], s20 offen offset:1024 sc1
s_add_u32 s20, s26, 309248
buffer_load_dwordx4 v[176:179], v61, s[8:11], s20 offen offset:0 sc1
buffer_load_dwordx4 v[180:183], v61, s[8:11], s20 offen offset:1024 sc1
s_add_u32 s20, s26, 352256
buffer_load_dwordx4 v[232:235], v61, s[8:11], s20 offen offset:0 sc1
buffer_load_dwordx4 v[236:239], v61, s[8:11], s20 offen offset:1024 sc1
s_waitcnt vmcnt(16)
v_cmp_eq_u32 vcc, 0, v57
s_cbranch_vccz OPT_83
s_nop 2
s_branch WF_84_in
WF_84:
s_sleep 12
WF_84_in:
buffer_load_dword v57, v56, s[8:11], s58 offen sc1
s_sub_u32 s16, s16, 1
s_cbranch_scc1 WFD_85_abort
s_waitcnt vmcnt(0)
v_cmp_eq_u32 vcc, 0, v57
s_cbranch_vccnz WF_84
WFD_85:
OPT_83:
s_getpc_b64 s[54:55]
WCODE_86:
s_sub_u32 s54, s54, WCODE_86-K_START
s_subb_u32 s55, s55, 0
v_mbcnt_lo_u32_b32 v57, -1, 0
v_mbcnt_hi_u32_b32 v57, -1, v57
v_lshl_add_u32 v57, v57, 5, s91
v_lshlrev_b32 v57, 6, v57
v_min_u32 v57, K_END-K_START-4, v57
global_load_dword v57, v57, s[54:55]
s_add_u32 s58, s58, 2048
buffer_load_dword v57, v56, s[8:11], s58 offen sc1
s_add_u32 s20, s26, 10240
buffer_load_dwordx4 a[40:43], v61, s[8:11], s20 offen offset:0 sc1
buffer_load_dwordx4 a[44:47], v61, s[8:11], s20 offen offset:1024 sc1
s_add_u32 s20, s26, 67584
buffer_load_dwordx4 a[96:99], v61, s[8:11], s20 offen offset:0 sc1
buffer_load_dwordx4 a[100:103], v61, s[8:11], s20 offen offset:1024 sc1
s_add_u32 s20, s26, 124928
buffer_load_dwordx4 a[152:155], v61, s[8:11], s20 offen offset:0 sc1
buffer_load_dwordx4 a[156:159], v61, s[8:11], s20 offen offset:1024 sc1
s_add_u32 s20, s26, 182272
buffer_load_dwordx4 a[208:211], v61, s[8:11], s20 offen offset:0 sc1
buffer_load_dwordx4 a[212:215], v61, s[8:11], s20 offen offset:1024 sc1
s_add_u32 s20, s26, 225280
buffer_load_dwordx4 v[72:75], v61, s[8:11], s20 offen offset:0 sc1
buffer_load_dwordx4 v[76:79], v61, s[8:11], s20 offen offset:1024 sc1
s_add_u32 s20, s26, 268288
buffer_load_dwordx4 v[128:131], v61, s[8:11], s20 offen offset:0 sc1
buffer_load_dwordx4 v[132:135], v61, s[8:11], s20 offen offset:1024 sc1
s_add_u32 s20, s26, 311296
buffer_load_dwordx4 v[184:187], v61, s[8:11], s20 offen offset:0 sc1
buffer_load_dwordx4 v[188:191], v61, s[8:11], s20 offen offset:1024 sc1
s_add_u32 s20, s26, 354304
buffer_load_dwordx4 v[240:243], v61, s[8:11], s20 offen offset:0 sc1
buffer_load_dwordx4 v[244:247], v61, s[8:11], s20 offen offset:1024 sc1
s_waitcnt vmcnt(16)
v_cmp_eq_u32 vcc, 0, v57
s_cbranch_vccz OPT_87
s_nop 2
s_branch WF_88_in
WF_88:
s_sleep 12
WF_88_in:
buffer_load_dword v57, v56, s[8:11], s58 offen sc1
s_sub_u32 s16, s16, 1
s_cbranch_scc1 WFD_89_abort
s_waitcnt vmcnt(0)
v_cmp_eq_u32 vcc, 0, v57
s_cbranch_vccnz WF_88
WFD_89:
OPT_87:
buffer_load_dword v56, off, s[92:95], 0 offset:16 sc1
s_add_u32 s20, s26, 12288
buffer_load_dwordx4 a[48:51], v61, s[8:11], s20 offen offset:0 sc1
buffer_load_dwordx4 a[52:55], v61, s[8:11], s20 offen offset:1024 sc1
s_add_u32 s20, s26, 69632
buffer_load_dwordx4 a[104:107], v61, s[8:11], s20 offen offset:0 sc1
buffer_load_dwordx4 a[108:111], v61, s[8:11], s20 offen offset:1024 sc1
s_add_u32 s20, s26, 126976
buffer_load_dwordx4 a[160:163], v61, s[8:11], s20 offen offset:0 sc1
buffer_load_dwordx4 a[164:167], v61, s[8:11], s20 offen offset:1024 sc1
s_add_u32 s20, s26, 184320
buffer_load_dwordx4 a[216:219], v61, s[8:11], s20 offen offset:0 sc1
buffer_load_dwordx4 a[220:223], v61, s[8:11], s20 offen offset:1024 sc1
s_add_u32 s20, s26, 227328
buffer_load_dwordx4 v[80:83], v61, s[8:11], s20 offen offset:0 sc1
buffer_load_dwordx4 v[84:87], v61, s[8:11], s20 offen offset:1024 sc1
s_add_u32 s20, s26, 270336
buffer_load_dwordx4 v[136:139], v61, s[8:11], s20 offen offset:0 sc1
buffer_load_dwordx4 v[140:143], v61, s[8:11], s20 offen offset:1024 sc1
s_add_u32 s20, s26, 313344
buffer_load_dwordx4 v[192:195], v61, s[8:11], s20 offen offset:0 sc1
buffer_load_dwordx4 v[196:199], v61, s[8:11], s20 offen offset:1024 sc1
s_add_u32 s20, s26, 356352
buffer_load_dwordx4 v[248:251], v61, s[8:11], s20 offen offset:0 sc1
buffer_load_dwordx4 v[252:255], v61, s[8:11], s20 offen offset:1024 sc1
s_waitcnt vmcnt(16)
PL_I_90:
v_cmp_gt_u32 vcc, 32, v56
s_cbranch_vccnz PL_I_90_p
PL_I_90_ok:
s_lshl_b32 s17, s12, 10
s_cmp_eq_u32 s12, 3
s_cselect_b32 s33, 3, 4
s_lshl_b32 s33, s33, 10
v_lshlrev_b32 v56, 4, v1
v_add_u32 v56, s17, v56
v_lshrrev_b32 v2, 4, v1
v_and_b32 v3, 15, v1
v_and_b32 v57, 2, v1
v_cmp_eq_u32 vcc, 2, v57
v_mov_b32 v57, 0x44444444
v_mov_b32 v58, 0xeeeeeeee
v_cndmask_b32 v57, v57, v58, vcc
v_and_b32 v58, 2, v1
v_lshlrev_b32 v58, 6, v58
v_lshl_add_u32 v58, v2, 8, v58
v_bfe_u32 v4, v1, 2, 2
v_lshl_add_u32 v58, v4, 5, v58
v_lshlrev_b32 v59, 6, v4
v_and_b32 v4, 1, v1
v_lshl_add_u32 v58, v4, 4, v58
v_lshl_add_u32 v59, v4, 5, v59
v_lshl_add_u32 v59, v2, 3, v59
v_bfe_u32 v4, v1, 1, 1
v_lshl_add_u32 v59, v4, 2, v59
s_lshl_b32 s17, s12, 8
s_add_u32 s17, s17, 8192
v_add_u32 v59, s17, v59
v_mul_u32_u24 v63, 124, v4
v_sub_u32 v63, v58, v63
s_lshl_b32 s17, s12, 10
s_add_u32 s17, s17, 20480
v_add_u32 v63, s17, v63
v_lshlrev_b32 v58, 4, v1
s_lshl_b32 s17, s12, 8
s_add_u32 s17, s17, 16384
v_lshl_add_u32 v60, v1, 2, s17
v_mov_b32 v62, 0
ds_write_b32 v60, v62
s_mul_i32 s30, s14, 28672
s_add_u32 s30, s30, 35651584
s_mov_b32 s15, 0
s_cmp_eq_u32 s12, 2
s_cbranch_scc1 CA_WV_91
s_cmp_eq_u32 s12, 3
s_cbranch_scc1 CA_WV_92
s_mul_i32 s31, s14, 40960
s_mul_i32 s17, s13, 640
s_add_u32 s31, s31, s17
s_add_u32 s31, s31, 35717120
s_mov_b32 s28, -1
s_mov_b32 s29, 0xff
s_lshl_b32 s27, s14, 15
s_add_u32 s27, s27, 38142336
s_cmp_eq_u32 s13, 0
s_cselect_b32 s27, s27, 0x10000000
MS_93:
buffer_load_dword v61, off, s[92:95], s56 sc1
s_sub_u32 s16, s16, 1
s_cbranch_scc1 MS_93_ab
s_waitcnt vmcnt(0)
v_readfirstlane_b32 s58, v61
s_nop 0
s_and_b32 s17, s58, 0xffff
s_cmp_ge_u32 s17, s57
s_nop 0
s_cbranch_scc0 MS_93
s_lshr_b32 s17, s58, 16
s_cbranch_scc1 MS_93_slow
CA_LOOP_94:
s_and_b32 s17, s15, 3
s_mul_i32 s18, s17, 7168
s_add_u32 s21, s18, s30
v_mov_b64 v[28:29], 0
v_mov_b64 v[30:31], 0
v_mov_b64 v[32:33], 0
v_mov_b64 v[34:35], 0
v_mov_b64 v[36:37], 0
v_mov_b64 v[38:39], 0
s_add_u32 s34, s21, s33
s_waitcnt vmcnt(0)
buffer_load_dwordx4 v[40:43], v56, s[8:11], s21 offen sc1
buffer_load_dwordx4 v[44:47], v56, s[8:11], s34 offen sc1
s_sleep 3
PP_95:
buffer_load_dwordx4 v[48:51], v56, s[8:11], s21 offen sc1
buffer_load_dwordx4 v[52:55], v56, s[8:11], s34 offen sc1
s_waitcnt vmcnt(2)
ds_write_b128 v56, v[40:43] offset:0
ds_write_b128 v56, v[44:47] offset:4096
v_max3_u32 v61, v40, v41, v42
v_max3_u32 v61, v61, v43, v44
v_max3_u32 v61, v61, v45, v46
v_max_u32 v61, v61, v47
v_cmp_eq_u32 vcc, -1, v61
s_cbranch_vccz PP_95_d0
buffer_load_dwordx4 v[40:43], v56, s[8:11], s21 offen sc1
buffer_load_dwordx4 v[44:47], v56, s[8:11], s34 offen sc1
s_sub_u32 s16, s16, 1
s_cbranch_scc1 PP_95_abort
s_waitcnt vmcnt(2)
ds_write_b128 v56, v[48:51] offset:0
ds_write_b128 v56, v[52:55] offset:4096
v_max3_u32 v61, v48, v49, v50
v_max3_u32 v61, v61, v51, v52
v_max3_u32 v61, v61, v53, v54
v_max_u32 v61, v61, v55
v_cmp_eq_u32 vcc, -1, v61
s_cbranch_vccnz PP_95
PP_95_d1:
v_smfmac_f32_16x16x64_bf16 v[28:31], v[48:51], a[8:15], v57
v_smfmac_f32_16x16x64_bf16 v[32:35], v[48:51], a[64:71], v57
s_waitcnt lgkmcnt(0)
s_barrier
ds_read_b128 v[0:3], v58 offset:0
ds_read_b128 v[8:11], v58 offset:2048
ds_read_b128 v[12:15], v58 offset:3072
v_smfmac_f32_16x16x64_bf16 v[36:39], v[48:51], a[120:127], v57
ds_read_b128 v[16:19], v58 offset:4096
ds_read_b128 v[24:27], v58 offset:6144
v_smfmac_f32_16x16x64_bf16 v[28:31], v[52:55], a[40:47], v57
ds_read_b128 v[4:7], v58 offset:1024
ds_read_b128 v[20:23], v58 offset:5120
v_smfmac_f32_16x16x64_bf16 v[32:35], v[52:55], a[96:103], v57
ds_write2_b32 v63, v48, v49 offset0:0 offset1:2
ds_write2_b32 v63, v50, v51 offset0:32 offset1:34
v_smfmac_f32_16x16x64_bf16 v[36:39], v[52:55], a[152:159], v57
v_add_u32 v61, 4096, v63
ds_write2_b32 v61, v52, v53 offset0:0 offset1:2
ds_write2_b32 v61, v54, v55 offset0:32 offset1:34
s_branch PP_95_j
PP_95_d0:
v_smfmac_f32_16x16x64_bf16 v[28:31], v[40:43], a[8:15], v57
v_smfmac_f32_16x16x64_bf16 v[32:35], v[40:43], a[64:71], v57
s_waitcnt lgkmcnt(0)
s_barrier
ds_read_b128 v[0:3], v58 offset:0
ds_read_b128 v[8:11], v58 offset:2048
ds_read_b128 v[12:15], v58 offset:3072
v_smfmac_f32_16x16x64_bf16 v[36:39], v[40:43], a[120:127], v57
ds_read_b128 v[16:19], v58 offset:4096
ds_read_b128 v[24:27], v58 offset:6144
v_smfmac_f32_16x16x64_bf16 v[28:31], v[44:47], a[40:47], v57
ds_read_b128 v[4:7], v58 offset:1024
ds_read_b128 v[20:23], v58 offset:5120
v_smfmac_f32_16x16x64_bf16 v[32:35], v[44:47], a[96:103], v57
ds_write2_b32 v63, v40, v41 offset0:0 offset1:2
ds_write2_b32 v63, v42, v43 offset0:32 offset1:34
v_smfmac_f32_16x16x64_bf16 v[36:39], v[44:47], a[152:159], v57
v_add_u32 v61, 4096, v63
ds_write2_b32 v61, v44, v45 offset0:0 offset1:2
ds_write2_b32 v61, v46, v47 offset0:32 offset1:34
PP_95_j:
s_waitcnt lgkmcnt(10)
v_smfmac_f32_16x16x64_bf16 v[28:31], v[0:3], a[0:7], v57
v_smfmac_f32_16x16x64_bf16 v[32:35], v[0:3], a[56:63], v57
s_waitcnt lgkmcnt(9)
v_smfmac_f32_16x16x64_bf16 v[28:31], v[8:11], a[16:23], v57
v_smfmac_f32_16x16x64_bf16 v[32:35], v[8:11], a[72:79], v57
s_waitcnt lgkmcnt(8)
v_smfmac_f32_16x16x64_bf16 v[28:31], v[12:15], a[24:31], v57
v_smfmac_f32_16x16x64_bf16 v[32:35], v[12:15], a[80:87], v57
s_waitcnt lgkmcnt(7)
v_smfmac_f32_16x16x64_bf16 v[28:31], v[16:19], a[32:39], v57
s_waitcnt vmcnt(0) lgkmcnt(0)
v_smfmac_f32_16x16x64_bf16 v[32:35], v[16:19], a[88:95], v57
s_waitcnt lgkmcnt(6)
v_smfmac_f32_16x16x64_bf16 v[28:31], v[24:27], a[48:55], v57
v_mov_b64 v[40:41], 0
v_smfmac_f32_16x16x64_bf16 v[32:35], v[24:27], a[104:111], v57
v_mov_b64 v[42:43], 0
v_smfmac_f32_16x16x64_bf16 v[36:39], v[0:3], a[112:119], v57
s_nop 1
v_add_u32 v62, 1, v62
v_smfmac_f32_16x16x64_bf16 v[36:39], v[8:11], a[128:135], v57
s_nop 0
v_add_f32 v28, v28, v30
v_smfmac_f32_16x16x64_bf16 v[36:39], v[12:15], a[136:143], v57
v_add_f32 v29, v29, v31
v_smfmac_f32_16x16x64_bf16 v[36:39], v[16:19], a[144:151], v57
v_cvt_pk_bf16_f32 v28, v28, v29
ds_write_b32 v59, v28 offset:0
v_smfmac_f32_16x16x64_bf16 v[36:39], v[24:27], a[160:167], v57
v_add_f32 v32, v32, v34
v_smfmac_f32_16x16x64_bf16 v[40:43], v[0:3], a[168:175], v57
s_nop 0
v_add_f32 v33, v33, v35
v_smfmac_f32_16x16x64_bf16 v[40:43], v[8:11], a[184:191], v57
v_cvt_pk_bf16_f32 v32, v32, v33
ds_write_b32 v59, v32 offset:1024
v_smfmac_f32_16x16x64_bf16 v[40:43], v[12:15], a[192:199], v57
s_nop 0
v_add_f32 v36, v36, v38
v_smfmac_f32_16x16x64_bf16 v[40:43], v[16:19], a[200:207], v57
v_add_f32 v37, v37, v39
v_smfmac_f32_16x16x64_bf16 v[40:43], v[24:27], a[216:223], v57
v_cvt_pk_bf16_f32 v36, v36, v37
ds_write_b32 v59, v36 offset:2048
ds_write_b32 v60, v62
v_smfmac_f32_16x16x64_bf16 v[40:43], v[4:7], a[176:183], v57
v_add_u32 v62, 1, v62
v_mov_b64 v[44:45], 0
v_mov_b64 v[46:47], 0
v_smfmac_f32_16x16x64_bf16 v[40:43], v[20:23], a[208:215], v57
s_nop 0
v_smfmac_f32_16x16x64_bf16 v[44:47], v[0:3], a[224:231], v57
s_nop 0
v_mov_b64 v[48:49], 0
v_smfmac_f32_16x16x64_bf16 v[44:47], v[8:11], a[240:247], v57
s_nop 0
v_mov_b64 v[50:51], 0
v_smfmac_f32_16x16x64_bf16 v[44:47], v[12:15], a[248:255], v57
s_nop 0
v_add_f32 v40, v40, v42
v_smfmac_f32_16x16x64_bf16 v[44:47], v[16:19], v[64:71], v57
v_add_f32 v41, v41, v43
v_smfmac_f32_16x16x64_bf16 v[44:47], v[24:27], v[80:87], v57
v_cvt_pk_bf16_f32 v40, v40, v41
ds_write_b32 v59, v40 offset:3072
ds_write_b32 v60, v62
v_smfmac_f32_16x16x64_bf16 v[44:47], v[4:7], a[232:239], v57
v_add_u32 v62, 1, v62
v_smfmac_f32_16x16x64_bf16 v[44:47], v[20:23], v[72:79], v57
v_smfmac_f32_16x16x64_bf16 v[48:51], v[0:3], v[88:95], v57
s_nop 0
v_mov_b64 v[52:53], 0
v_smfmac_f32_16x16x64_bf16 v[48:51], v[8:11], v[104:111], v57
s_nop 0
v_mov_b64 v[54:55], 0
v_smfmac_f32_16x16x64_bf16 v[48:51], v[12:15], v[112:119], v57
s_nop 0
v_add_f32 v44, v44, v46
v_smfmac_f32_16x16x64_bf16 v[48:51], v[16:19], v[120:127], v57
v_add_f32 v45, v45, v47
v_smfmac_f32_16x16x64_bf16 v[48:51], v[24:27], v[136:143], v57
v_cvt_pk_bf16_f32 v44, v44, v45
ds_write_b32 v59, v44 offset:3840
v_smfmac_f32_16x16x64_bf16 v[48:51], v[4:7], v[96:103], v57
v_smfmac_f32_16x16x64_bf16 v[48:51], v[20:23], v[128:135], v57
v_smfmac_f32_16x16x64_bf16 v[52:55], v[0:3], v[144:151], v57
s_nop 0
v_mov_b64 v[28:29], 0
v_smfmac_f32_16x16x64_bf16 v[52:55], v[8:11], v[160:167], v57
s_nop 0
v_mov_b64 v[30:31], 0
v_smfmac_f32_16x16x64_bf16 v[52:55], v[12:15], v[168:175], v57
s_nop 0
v_add_f32 v48, v48, v50
v_smfmac_f32_16x16x64_bf16 v[52:55], v[16:19], v[176:183], v57
v_add_f32 v49, v49, v51
v_smfmac_f32_16x16x64_bf16 v[52:55], v[24:27], v[192:199], v57
v_cvt_pk_bf16_f32 v48, v48, v49
ds_write_b32 v59, v48 offset:4608
ds_write_b32 v60, v62
v_smfmac_f32_16x16x64_bf16 v[52:55], v[4:7], v[152:159], v57
v_add_u32 v62, 1, v62
v_smfmac_f32_16x16x64_bf16 v[52:55], v[20:23], v[184:191], v57
v_smfmac_f32_16x16x64_bf16 v[28:31], v[0:3], v[200:207], v57
s_nop 0
s_nop 0
v_smfmac_f32_16x16x64_bf16 v[28:31], v[8:11], v[216:223], v57
s_nop 0
s_nop 0
v_smfmac_f32_16x16x64_bf16 v[28:31], v[12:15], v[224:231], v57
s_nop 0
v_add_f32 v52, v52, v54
v_smfmac_f32_16x16x64_bf16 v[28:31], v[16:19], v[232:239], v57
v_add_f32 v53, v53, v55
v_smfmac_f32_16x16x64_bf16 v[28:31], v[24:27], v[248:255], v57
v_cvt_pk_bf16_f32 v52, v52, v53
ds_write_b32 v59, v52 offset:5376
ds_write_b32 v60, v62
v_smfmac_f32_16x16x64_bf16 v[28:31], v[4:7], v[208:215], v57
v_add_u32 v62, 1, v62
v_smfmac_f32_16x16x64_bf16 v[28:31], v[20:23], v[240:247], v57
s_nop 7
v_pk_add_f32 v[28:29], v[28:29], v[30:31]
v_cvt_pk_bf16_f32 v28, v28, v29
ds_write_b32 v59, v28 offset:6144
ds_write_b32 v60, v62
s_add_u32 s17, s15, 3
s_and_b32 s17, s17, 3
s_mul_i32 s17, s17, 10240
s_add_u32 s17, s17, s31
v_mov_b64 v[36:37], -1
v_mov_b64 v[38:39], -1
s_mov_b64 exec, s[28:29]
buffer_store_dwordx4 v[36:39], v58, s[8:11], s17 offen
s_mov_b64 exec, 1
v_mov_b32 v32, s15
buffer_store_dword v32, off, s[8:11], s27
s_mov_b64 exec, -1
s_barrier
s_sleep 8
s_add_u32 s15, s15, 1
s_cmp_lt_u32 s15, 63
s_cbranch_scc1 CA_LOOP_94
s_endpgm
MS_93_ab:
s_mov_b32 s16, 0
s_waitcnt vmcnt(0)
MS_93_slow:
CA_LOOP_96:
s_and_b32 s17, s15, 3
s_mul_i32 s18, s17, 7168
s_add_u32 s21, s18, s30
v_mov_b64 v[28:29], 0
v_mov_b64 v[30:31], 0
v_mov_b64 v[32:33], 0
v_mov_b64 v[34:35], 0
v_mov_b64 v[36:37], 0
v_mov_b64 v[38:39], 0
s_add_u32 s34, s21, s33
s_waitcnt vmcnt(0)
buffer_load_dwordx4 v[40:43], v56, s[8:11], s21 offen sc1
buffer_load_dwordx4 v[44:47], v56, s[8:11], s34 offen sc1
s_sleep 3
PP_97:
buffer_load_dwordx4 v[48:51], v56, s[8:11], s21 offen sc1
buffer_load_dwordx4 v[52:55], v56, s[8:11], s34 offen sc1
s_waitcnt vmcnt(2)
ds_write_b128 v56, v[40:43] offset:0
ds_write_b128 v56, v[44:47] offset:4096
v_max3_u32 v61, v40, v41, v42
v_max3_u32 v61, v61, v43, v44
v_max3_u32 v61, v61, v45, v46
v_max_u32 v61, v61, v47
v_cmp_eq_u32 vcc, -1, v61
s_cbranch_vccz PP_97_d0
buffer_load_dwordx4 v[40:43], v56, s[8:11], s21 offen sc1
buffer_load_dwordx4 v[44:47], v56, s[8:11], s34 offen sc1
s_sub_u32 s16, s16, 1
s_cbranch_scc1 PP_97_abort
s_waitcnt vmcnt(2)
ds_write_b128 v56, v[48:51] offset:0
ds_write_b128 v56, v[52:55] offset:4096
v_max3_u32 v61, v48, v49, v50
v_max3_u32 v61, v61, v51, v52
v_max3_u32 v61, v61, v53, v54
v_max_u32 v61, v61, v55
v_cmp_eq_u32 vcc, -1, v61
s_cbranch_vccnz PP_97
PP_97_d1:
v_smfmac_f32_16x16x64_bf16 v[28:31], v[48:51], a[8:15], v57
v_smfmac_f32_16x16x64_bf16 v[32:35], v[48:51], a[64:71], v57
s_waitcnt lgkmcnt(0)
s_barrier
ds_read_b128 v[0:3], v58 offset:0
ds_read_b128 v[8:11], v58 offset:2048
ds_read_b128 v[12:15], v58 offset:3072
v_smfmac_f32_16x16x64_bf16 v[36:39], v[48:51], a[120:127], v57
ds_read_b128 v[16:19], v58 offset:4096
ds_read_b128 v[24:27], v58 offset:6144
v_smfmac_f32_16x16x64_bf16 v[28:31], v[52:55], a[40:47], v57
ds_read_b128 v[4:7], v58 offset:1024
ds_read_b128 v[20:23], v58 offset:5120
v_smfmac_f32_16x16x64_bf16 v[32:35], v[52:55], a[96:103], v57
ds_write2_b32 v63, v48, v49 offset0:0 offset1:2
ds_write2_b32 v63, v50, v51 offset0:32 offset1:34
v_smfmac_f32_16x16x64_bf16 v[36:39], v[52:55], a[152:159], v57
v_add_u32 v61, 4096, v63
ds_write2_b32 v61, v52, v53 offset0:0 offset1:2
ds_write2_b32 v61, v54, v55 offset0:32 offset1:34
s_branch PP_97_j
PP_97_d0:
v_smfmac_f32_16x16x64_bf16 v[28:31], v[40:43], a[8:15], v57
v_smfmac_f32_16x16x64_bf16 v[32:35], v[40:43], a[64:71], v57
s_waitcnt lgkmcnt(0)
s_barrier
ds_read_b128 v[0:3], v58 offset:0
ds_read_b128 v[8:11], v58 offset:2048
ds_read_b128 v[12:15], v58 offset:3072
v_smfmac_f32_16x16x64_bf16 v[36:39], v[40:43], a[120:127], v57
ds_read_b128 v[16:19], v58 offset:4096
ds_read_b128 v[24:27], v58 offset:6144
v_smfmac_f32_16x16x64_bf16 v[28:31], v[44:47], a[40:47], v57
ds_read_b128 v[4:7], v58 offset:1024
ds_read_b128 v[20:23], v58 offset:5120
v_smfmac_f32_16x16x64_bf16 v[32:35], v[44:47], a[96:103], v57
ds_write2_b32 v63, v40, v41 offset0:0 offset1:2
ds_write2_b32 v63, v42, v43 offset0:32 offset1:34
v_smfmac_f32_16x16x64_bf16 v[36:39], v[44:47], a[152:159], v57
v_add_u32 v61, 4096, v63
ds_write2_b32 v61, v44, v45 offset0:0 offset1:2
ds_write2_b32 v61, v46, v47 offset0:32 offset1:34
PP_97_j:
s_waitcnt lgkmcnt(10)
v_smfmac_f32_16x16x64_bf16 v[28:31], v[0:3], a[0:7], v57
v_smfmac_f32_16x16x64_bf16 v[32:35], v[0:3], a[56:63], v57
s_waitcnt lgkmcnt(9)
v_smfmac_f32_16x16x64_bf16 v[28:31], v[8:11], a[16:23], v57
v_smfmac_f32_16x16x64_bf16 v[32:35], v[8:11], a[72:79], v57
s_waitcnt lgkmcnt(8)
v_smfmac_f32_16x16x64_bf16 v[28:31], v[12:15], a[24:31], v57
v_smfmac_f32_16x16x64_bf16 v[32:35], v[12:15], a[80:87], v57
s_waitcnt lgkmcnt(7)
v_smfmac_f32_16x16x64_bf16 v[28:31], v[16:19], a[32:39], v57
s_waitcnt vmcnt(0) lgkmcnt(0)
v_smfmac_f32_16x16x64_bf16 v[32:35], v[16:19], a[88:95], v57
s_waitcnt lgkmcnt(6)
v_smfmac_f32_16x16x64_bf16 v[28:31], v[24:27], a[48:55], v57
v_mov_b64 v[40:41], 0
v_smfmac_f32_16x16x64_bf16 v[32:35], v[24:27], a[104:111], v57
v_mov_b64 v[42:43], 0
v_smfmac_f32_16x16x64_bf16 v[36:39], v[0:3], a[112:119], v57
s_nop 1
v_add_u32 v62, 1, v62
v_smfmac_f32_16x16x64_bf16 v[36:39], v[8:11], a[128:135], v57
s_nop 0
v_add_f32 v28, v28, v30
v_smfmac_f32_16x16x64_bf16 v[36:39], v[12:15], a[136:143], v57
v_add_f32 v29, v29, v31
v_smfmac_f32_16x16x64_bf16 v[36:39], v[16:19], a[144:151], v57
v_cvt_pk_bf16_f32 v28, v28, v29
ds_write_b32 v59, v28 offset:0
v_smfmac_f32_16x16x64_bf16 v[36:39], v[24:27], a[160:167], v57
v_add_f32 v32, v32, v34
v_smfmac_f32_16x16x64_bf16 v[40:43], v[0:3], a[168:175], v57
s_nop 0
v_add_f32 v33, v33, v35
v_smfmac_f32_16x16x64_bf16 v[40:43], v[8:11], a[184:191], v57
v_cvt_pk_bf16_f32 v32, v32, v33
ds_write_b32 v59, v32 offset:1024
v_smfmac_f32_16x16x64_bf16 v[40:43], v[12:15], a[192:199], v57
s_nop 0
v_add_f32 v36, v36, v38
v_smfmac_f32_16x16x64_bf16 v[40:43], v[16:19], a[200:207], v57
v_add_f32 v37, v37, v39
v_smfmac_f32_16x16x64_bf16 v[40:43], v[24:27], a[216:223], v57
v_cvt_pk_bf16_f32 v36, v36, v37
ds_write_b32 v59, v36 offset:2048
ds_write_b32 v60, v62
v_smfmac_f32_16x16x64_bf16 v[40:43], v[4:7], a[176:183], v57
v_add_u32 v62, 1, v62
v_mov_b64 v[44:45], 0
v_mov_b64 v[46:47], 0
v_smfmac_f32_16x16x64_bf16 v[40:43], v[20:23], a[208:215], v57
s_nop 0
v_smfmac_f32_16x16x64_bf16 v[44:47], v[0:3], a[224:231], v57
s_nop 0
v_mov_b64 v[48:49], 0
v_smfmac_f32_16x16x64_bf16 v[44:47], v[8:11], a[240:247], v57
s_nop 0
v_mov_b64 v[50:51], 0
v_smfmac_f32_16x16x64_bf16 v[44:47], v[12:15], a[248:255], v57
s_nop 0
v_add_f32 v40, v40, v42
v_smfmac_f32_16x16x64_bf16 v[44:47], v[16:19], v[64:71], v57
v_add_f32 v41, v41, v43
v_smfmac_f32_16x16x64_bf16 v[44:47], v[24:27], v[80:87], v57
v_cvt_pk_bf16_f32 v40, v40, v41
ds_write_b32 v59, v40 offset:3072
ds_write_b32 v60, v62
v_smfmac_f32_16x16x64_bf16 v[44:47], v[4:7], a[232:239], v57
v_add_u32 v62, 1, v62
v_smfmac_f32_16x16x64_bf16 v[44:47], v[20:23], v[72:79], v57
v_smfmac_f32_16x16x64_bf16 v[48:51], v[0:3], v[88:95], v57
s_nop 0
v_mov_b64 v[52:53], 0
v_smfmac_f32_16x16x64_bf16 v[48:51], v[8:11], v[104:111], v57
s_nop 0
v_mov_b64 v[54:55], 0
v_smfmac_f32_16x16x64_bf16 v[48:51], v[12:15], v[112:119], v57
s_nop 0
v_add_f32 v44, v44, v46
v_smfmac_f32_16x16x64_bf16 v[48:51], v[16:19], v[120:127], v57
v_add_f32 v45, v45, v47
v_smfmac_f32_16x16x64_bf16 v[48:51], v[24:27], v[136:143], v57
v_cvt_pk_bf16_f32 v44, v44, v45
ds_write_b32 v59, v44 offset:3840
v_smfmac_f32_16x16x64_bf16 v[48:51], v[4:7], v[96:103], v57
v_smfmac_f32_16x16x64_bf16 v[48:51], v[20:23], v[128:135], v57
v_smfmac_f32_16x16x64_bf16 v[52:55], v[0:3], v[144:151], v57
s_nop 0
v_mov_b64 v[28:29], 0
v_smfmac_f32_16x16x64_bf16 v[52:55], v[8:11], v[160:167], v57
s_nop 0
v_mov_b64 v[30:31], 0
v_smfmac_f32_16x16x64_bf16 v[52:55], v[12:15], v[168:175], v57
s_nop 0
v_add_f32 v48, v48, v50
v_smfmac_f32_16x16x64_bf16 v[52:55], v[16:19], v[176:183], v57
v_add_f32 v49, v49, v51
v_smfmac_f32_16x16x64_bf16 v[52:55], v[24:27], v[192:199], v57
v_cvt_pk_bf16_f32 v48, v48, v49
ds_write_b32 v59, v48 offset:4608
ds_write_b32 v60, v62
v_smfmac_f32_16x16x64_bf16 v[52:55], v[4:7], v[152:159], v57
v_add_u32 v62, 1, v62
v_smfmac_f32_16x16x64_bf16 v[52:55], v[20:23], v[184:191], v57
v_smfmac_f32_16x16x64_bf16 v[28:31], v[0:3], v[200:207], v57
s_nop 0
s_nop 0
v_smfmac_f32_16x16x64_bf16 v[28:31], v[8:11], v[216:223], v57
s_nop 0
s_nop 0
v_smfmac_f32_16x16x64_bf16 v[28:31], v[12:15], v[224:231], v57
s_nop 0
v_add_f32 v52, v52, v54
v_smfmac_f32_16x16x64_bf16 v[28:31], v[16:19], v[232:239], v57
v_add_f32 v53, v53, v55
v_smfmac_f32_16x16x64_bf16 v[28:31], v[24:27], v[248:255], v57
v_cvt_pk_bf16_f32 v52, v52, v53
ds_write_b32 v59, v52 offset:5376
ds_write_b32 v60, v62
v_smfmac_f32_16x16x64_bf16 v[28:31], v[4:7], v[208:215], v57
v_add_u32 v62, 1, v62
v_smfmac_f32_16x16x64_bf16 v[28:31], v[20:23], v[240:247], v57
s_nop 7
v_pk_add_f32 v[28:29], v[28:29], v[30:31]
v_cvt_pk_bf16_f32 v28, v28, v29
ds_write_b32 v59, v28 offset:6144
ds_write_b32 v60, v62
s_add_u32 s17, s15, 3
s_and_b32 s17, s17, 3
s_mul_i32 s17, s17, 10240
s_add_u32 s17, s17, s31
v_mov_b64 v[36:37], -1
v_mov_b64 v[38:39], -1
s_mov_b64 exec, s[28:29]
buffer_store_dwordx4 v[36:39], v58, s[8:11], s17 offen sc1
s_mov_b64 exec, 1
v_mov_b32 v32, s15
buffer_store_dword v32, off, s[8:11], s27 sc1
s_mov_b64 exec, -1
s_barrier
s_sleep 8
s_add_u32 s15, s15, 1
s_cmp_lt_u32 s15, 63
s_cbranch_scc1 CA_LOOP_96
s_endpgm
CA_WV_91:
CA_LOOP_98:
s_and_b32 s17, s15, 3
s_mul_i32 s18, s17, 7168
s_add_u32 s21, s18, s30
v_mov_b64 v[28:29], 0
v_mov_b64 v[30:31], 0
v_mov_b64 v[32:33], 0
v_mov_b64 v[34:35], 0
v_mov_b64 v[36:37], 0
v_mov_b64 v[38:39], 0
s_add_u32 s34, s21, s33
s_waitcnt vmcnt(0)
buffer_load_dwordx4 v[40:43], v56, s[8:11], s21 offen sc1
buffer_load_dwordx4 v[44:47], v56, s[8:11], s34 offen sc1
s_sleep 3
PP_99:
buffer_load_dwordx4 v[48:51], v56, s[8:11], s21 offen sc1
buffer_load_dwordx4 v[52:55], v56, s[8:11], s34 offen sc1
s_waitcnt vmcnt(2)
ds_write_b128 v56, v[40:43] offset:0
ds_write_b128 v56, v[44:47] offset:4096
v_max3_u32 v61, v40, v41, v42
v_max3_u32 v61, v61, v43, v44
v_max3_u32 v61, v61, v45, v46
v_max_u32 v61, v61, v47
v_cmp_eq_u32 vcc, -1, v61
s_cbranch_vccz PP_99_d0
buffer_load_dwordx4 v[40:43], v56, s[8:11], s21 offen sc1
buffer_load_dwordx4 v[44:47], v56, s[8:11], s34 offen sc1
s_sub_u32 s16, s16, 1
s_cbranch_scc1 PP_99_abort
s_waitcnt vmcnt(2)
ds_write_b128 v56, v[48:51] offset:0
ds_write_b128 v56, v[52:55] offset:4096
v_max3_u32 v61, v48, v49, v50
v_max3_u32 v61, v61, v51, v52
v_max3_u32 v61, v61, v53, v54
v_max_u32 v61, v61, v55
v_cmp_eq_u32 vcc, -1, v61
s_cbranch_vccnz PP_99
PP_99_d1:
v_smfmac_f32_16x16x64_bf16 v[28:31], v[48:51], a[16:23], v57
v_smfmac_f32_16x16x64_bf16 v[32:35], v[48:51], a[72:79], v57
s_waitcnt lgkmcnt(0)
s_barrier
ds_read_b128 v[0:3], v58 offset:0
ds_read_b128 v[4:7], v58 offset:1024
ds_read_b128 v[12:15], v58 offset:3072
v_smfmac_f32_16x16x64_bf16 v[36:39], v[48:51], a[128:135], v57
ds_read_b128 v[16:19], v58 offset:4096
ds_read_b128 v[20:23], v58 offset:5120
v_smfmac_f32_16x16x64_bf16 v[28:31], v[52:55], a[48:55], v57
ds_read_b128 v[8:11], v58 offset:2048
ds_read_b128 v[24:27], v58 offset:6144
v_smfmac_f32_16x16x64_bf16 v[32:35], v[52:55], a[104:111], v57
ds_write2_b32 v63, v48, v49 offset0:0 offset1:2
ds_write2_b32 v63, v50, v51 offset0:32 offset1:34
v_smfmac_f32_16x16x64_bf16 v[36:39], v[52:55], a[160:167], v57
v_add_u32 v61, 4096, v63
ds_write2_b32 v61, v52, v53 offset0:0 offset1:2
ds_write2_b32 v61, v54, v55 offset0:32 offset1:34
s_branch PP_99_j
PP_99_d0:
v_smfmac_f32_16x16x64_bf16 v[28:31], v[40:43], a[16:23], v57
v_smfmac_f32_16x16x64_bf16 v[32:35], v[40:43], a[72:79], v57
s_waitcnt lgkmcnt(0)
s_barrier
ds_read_b128 v[0:3], v58 offset:0
ds_read_b128 v[4:7], v58 offset:1024
ds_read_b128 v[12:15], v58 offset:3072
v_smfmac_f32_16x16x64_bf16 v[36:39], v[40:43], a[128:135], v57
ds_read_b128 v[16:19], v58 offset:4096
ds_read_b128 v[20:23], v58 offset:5120
v_smfmac_f32_16x16x64_bf16 v[28:31], v[44:47], a[48:55], v57
ds_read_b128 v[8:11], v58 offset:2048
ds_read_b128 v[24:27], v58 offset:6144
v_smfmac_f32_16x16x64_bf16 v[32:35], v[44:47], a[104:111], v57
ds_write2_b32 v63, v40, v41 offset0:0 offset1:2
ds_write2_b32 v63, v42, v43 offset0:32 offset1:34
v_smfmac_f32_16x16x64_bf16 v[36:39], v[44:47], a[160:167], v57
v_add_u32 v61, 4096, v63
ds_write2_b32 v61, v44, v45 offset0:0 offset1:2
ds_write2_b32 v61, v46, v47 offset0:32 offset1:34
PP_99_j:
s_waitcnt lgkmcnt(10)
v_smfmac_f32_16x16x64_bf16 v[28:31], v[0:3], a[0:7], v57
v_smfmac_f32_16x16x64_bf16 v[32:35], v[0:3], a[56:63], v57
s_waitcnt lgkmcnt(9)
v_smfmac_f32_16x16x64_bf16 v[28:31], v[4:7], a[8:15], v57
v_smfmac_f32_16x16x64_bf16 v[32:35], v[4:7], a[64:71], v57
s_waitcnt lgkmcnt(8)
v_smfmac_f32_16x16x64_bf16 v[28:31], v[12:15], a[24:31], v57
v_smfmac_f32_16x16x64_bf16 v[32:35], v[12:15], a[80:87], v57
s_waitcnt lgkmcnt(7)
v_smfmac_f32_16x16x64_bf16 v[28:31], v[16:19], a[32:39], v57
s_waitcnt vmcnt(0) lgkmcnt(0)
v_smfmac_f32_16x16x64_bf16 v[32:35], v[16:19], a[88:95], v57
s_waitcnt lgkmcnt(6)
v_smfmac_f32_16x16x64_bf16 v[28:31], v[20:23], a[40:47], v57
v_mov_b64 v[40:41], 0
v_smfmac_f32_16x16x64_bf16 v[32:35], v[20:23], a[96:103], v57
v_mov_b64 v[42:43], 0
v_smfmac_f32_16x16x64_bf16 v[36:39], v[0:3], a[112:119], v57
s_nop 1
v_add_u32 v62, 1, v62
v_smfmac_f32_16x16x64_bf16 v[36:39], v[4:7], a[120:127], v57
s_nop 0
v_add_f32 v28, v28, v30
v_smfmac_f32_16x16x64_bf16 v[36:39], v[12:15], a[136:143], v57
v_add_f32 v29, v29, v31
v_smfmac_f32_16x16x64_bf16 v[36:39], v[16:19], a[144:151], v57
v_cvt_pk_bf16_f32 v28, v28, v29
ds_write_b32 v59, v28 offset:0
v_smfmac_f32_16x16x64_bf16 v[36:39], v[20:23], a[152:159], v57
v_add_f32 v32, v32, v34
v_smfmac_f32_16x16x64_bf16 v[40:43], v[0:3], a[168:175], v57
s_nop 0
v_add_f32 v33, v33, v35
v_smfmac_f32_16x16x64_bf16 v[40:43], v[4:7], a[176:183], v57
v_cvt_pk_bf16_f32 v32, v32, v33
ds_write_b32 v59, v32 offset:1024
v_smfmac_f32_16x16x64_bf16 v[40:43], v[12:15], a[192:199], v57
s_nop 0
v_add_f32 v36, v36, v38
v_smfmac_f32_16x16x64_bf16 v[40:43], v[16:19], a[200:207], v57
v_add_f32 v37, v37, v39
v_smfmac_f32_16x16x64_bf16 v[40:43], v[20:23], a[208:215], v57
v_cvt_pk_bf16_f32 v36, v36, v37
ds_write_b32 v59, v36 offset:2048
ds_write_b32 v60, v62
v_smfmac_f32_16x16x64_bf16 v[40:43], v[8:11], a[184:191], v57
v_add_u32 v62, 1, v62
v_mov_b64 v[44:45], 0
v_mov_b64 v[46:47], 0
v_smfmac_f32_16x16x64_bf16 v[40:43], v[24:27], a[216:223], v57
s_nop 0
v_smfmac_f32_16x16x64_bf16 v[44:47], v[0:3], a[224:231], v57
s_nop 0
v_mov_b64 v[48:49], 0
v_smfmac_f32_16x16x64_bf16 v[44:47], v[4:7], a[232:239], v57
s_nop 0
v_mov_b64 v[50:51], 0
v_smfmac_f32_16x16x64_bf16 v[44:47], v[12:15], a[248:255], v57
s_nop 0
v_add_f32 v40, v40, v42
v_smfmac_f32_16x16x64_bf16 v[44:47], v[16:19], v[64:71], v57
v_add_f32 v41, v41, v43
v_smfmac_f32_16x16x64_bf16 v[44:47], v[20:23], v[72:79], v57
v_cvt_pk_bf16_f32 v40, v40, v41
ds_write_b32 v59, v40 offset:3072
ds_write_b32 v60, v62
v_smfmac_f32_16x16x64_bf16 v[44:47], v[8:11], a[240:247], v57
v_add_u32 v62, 1, v62
v_smfmac_f32_16x16x64_bf16 v[44:47], v[24:27], v[80:87], v57
v_smfmac_f32_16x16x64_bf16 v[48:51], v[0:3], v[88:95], v57
s_nop 0
v_mov_b64 v[52:53], 0
v_smfmac_f32_16x16x64_bf16 v[48:51], v[4:7], v[96:103], v57
s_nop 0
v_mov_b64 v[54:55], 0
v_smfmac_f32_16x16x64_bf16 v[48:51], v[12:15], v[112:119], v57
s_nop 0
v_add_f32 v44, v44, v46
v_smfmac_f32_16x16x64_bf16 v[48:51], v[16:19], v[120:127], v57
v_add_f32 v45, v45, v47
v_smfmac_f32_16x16x64_bf16 v[48:51], v[20:23], v[128:135], v57
v_cvt_pk_bf16_f32 v44, v44, v45
ds_write_b32 v59, v44 offset:3840
v_smfmac_f32_16x16x64_bf16 v[48:51], v[8:11], v[104:111], v57
v_smfmac_f32_16x16x64_bf16 v[48:51], v[24:27], v[136:143], v57
v_smfmac_f32_16x16x64_bf16 v[52:55], v[0:3], v[144:151], v57
s_nop 0
v_mov_b64 v[28:29], 0
v_smfmac_f32_16x16x64_bf16 v[52:55], v[4:7], v[152:159], v57
s_nop 0
v_mov_b64 v[30:31], 0
v_smfmac_f32_16x16x64_bf16 v[52:55], v[12:15], v[168:175], v57
s_nop 0
v_add_f32 v48, v48, v50
v_smfmac_f32_16x16x64_bf16 v[52:55], v[16:19], v[176:183], v57
v_add_f32 v49, v49, v51
v_smfmac_f32_16x16x64_bf16 v[52:55], v[20:23], v[184:191], v57
v_cvt_pk_bf16_f32 v48, v48, v49
ds_write_b32 v59, v48 offset:4608
ds_write_b32 v60, v62
v_smfmac_f32_16x16x64_bf16 v[52:55], v[8:11], v[160:167], v57
v_add_u32 v62, 1, v62
v_smfmac_f32_16x16x64_bf16 v[52:55], v[24:27], v[192:199], v57
v_smfmac_f32_16x16x64_bf16 v[28:31], v[0:3], v[200:207], v57
s_nop 0
s_nop 0
v_smfmac_f32_16x16x64_bf16 v[28:31], v[4:7], v[208:215], v57
s_nop 0
s_nop 0
v_smfmac_f32_16x16x64_bf16 v[28:31], v[12:15], v[224:231], v57
s_nop 0
v_add_f32 v52, v52, v54
v_smfmac_f32_16x16x64_bf16 v[28:31], v[16:19], v[232:239], v57
v_add_f32 v53, v53, v55
v_smfmac_f32_16x16x64_bf16 v[28:31], v[20:23], v[240:247], v57
v_cvt_pk_bf16_f32 v52, v52, v53
ds_write_b32 v59, v52 offset:5376
ds_write_b32 v60, v62
v_smfmac_f32_16x16x64_bf16 v[28:31], v[8:11], v[216:223], v57
v_add_u32 v62, 1, v62
v_smfmac_f32_16x16x64_bf16 v[28:31], v[24:27], v[248:255], v57
s_nop 7
v_pk_add_f32 v[28:29], v[28:29], v[30:31]
v_cvt_pk_bf16_f32 v28, v28, v29
ds_write_b32 v59, v28 offset:6144
ds_write_b32 v60, v62
s_barrier
s_sleep 8
s_add_u32 s15, s15, 1
s_cmp_lt_u32 s15, 63
s_cbranch_scc1 CA_LOOP_98
s_endpgm
CA_WV_92:
CA_LOOP_100:
s_and_b32 s17, s15, 3
s_mul_i32 s18, s17, 7168
s_add_u32 s21, s18, s30
v_mov_b64 v[28:29], 0
v_mov_b64 v[30:31], 0
v_mov_b64 v[32:33], 0
v_mov_b64 v[34:35], 0
v_mov_b64 v[36:37], 0
v_mov_b64 v[38:39], 0
s_add_u32 s34, s21, s33
s_waitcnt vmcnt(0)
buffer_load_dwordx4 v[40:43], v56, s[8:11], s21 offen sc1
buffer_load_dwordx4 v[44:47], v56, s[8:11], s34 offen sc1
s_sleep 3
PP_101:
buffer_load_dwordx4 v[48:51], v56, s[8:11], s21 offen sc1
buffer_load_dwordx4 v[52:55], v56, s[8:11], s34 offen sc1
s_waitcnt vmcnt(2)
ds_write_b128 v56, v[40:43] offset:0
ds_write_b128 v56, v[44:47] offset:4096
v_max3_u32 v61, v40, v41, v42
v_max3_u32 v61, v61, v43, v44
v_max3_u32 v61, v61, v45, v46
v_max_u32 v61, v61, v47
v_cmp_eq_u32 vcc, -1, v61
s_cbranch_vccz PP_101_d0
buffer_load_dwordx4 v[40:43], v56, s[8:11], s21 offen sc1
buffer_load_dwordx4 v[44:47], v56, s[8:11], s34 offen sc1
s_sub_u32 s16, s16, 1
s_cbranch_scc1 PP_101_abort
s_waitcnt vmcnt(2)
ds_write_b128 v56, v[48:51] offset:0
ds_write_b128 v56, v[52:55] offset:4096
v_max3_u32 v61, v48, v49, v50
v_max3_u32 v61, v61, v51, v52
v_max3_u32 v61, v61, v53, v54
v_max_u32 v61, v61, v55
v_cmp_eq_u32 vcc, -1, v61
s_cbranch_vccnz PP_101
PP_101_d1:
v_smfmac_f32_16x16x64_bf16 v[28:31], v[48:51], a[24:31], v57
v_smfmac_f32_16x16x64_bf16 v[32:35], v[48:51], a[80:87], v57
s_waitcnt lgkmcnt(0)
s_barrier
ds_read_b128 v[0:3], v58 offset:0
ds_read_b128 v[4:7], v58 offset:1024
ds_read_b128 v[8:11], v58 offset:2048
v_smfmac_f32_16x16x64_bf16 v[36:39], v[48:51], a[136:143], v57
ds_read_b128 v[16:19], v58 offset:4096
ds_read_b128 v[20:23], v58 offset:5120
v_smfmac_f32_16x16x64_bf16 v[28:31], v[52:55], a[48:55], v57
ds_read_b128 v[12:15], v58 offset:3072
ds_read_b128 v[24:27], v58 offset:6144
v_smfmac_f32_16x16x64_bf16 v[32:35], v[52:55], a[104:111], v57
ds_write2_b32 v63, v48, v49 offset0:0 offset1:2
ds_write2_b32 v63, v50, v51 offset0:32 offset1:34
v_smfmac_f32_16x16x64_bf16 v[36:39], v[52:55], a[160:167], v57
v_add_u32 v61, 4096, v63
ds_write2_b32 v61, v52, v53 offset0:0 offset1:2
ds_write2_b32 v61, v54, v55 offset0:32 offset1:34
s_branch PP_101_j
PP_101_d0:
v_smfmac_f32_16x16x64_bf16 v[28:31], v[40:43], a[24:31], v57
v_smfmac_f32_16x16x64_bf16 v[32:35], v[40:43], a[80:87], v57
s_waitcnt lgkmcnt(0)
s_barrier
ds_read_b128 v[0:3], v58 offset:0
ds_read_b128 v[4:7], v58 offset:1024
ds_read_b128 v[8:11], v58 offset:2048
v_smfmac_f32_16x16x64_bf16 v[36:39], v[40:43], a[136:143], v57
ds_read_b128 v[16:19], v58 offset:4096
ds_read_b128 v[20:23], v58 offset:5120
v_smfmac_f32_16x16x64_bf16 v[28:31], v[44:47], a[48:55], v57
ds_read_b128 v[12:15], v58 offset:3072
ds_read_b128 v[24:27], v58 offset:6144
v_smfmac_f32_16x16x64_bf16 v[32:35], v[44:47], a[104:111], v57
ds_write2_b32 v63, v40, v41 offset0:0 offset1:2
ds_write2_b32 v63, v42, v43 offset0:32 offset1:34
v_smfmac_f32_16x16x64_bf16 v[36:39], v[44:47], a[160:167], v57
v_add_u32 v61, 4096, v63
ds_write2_b32 v61, v44, v45 offset0:0 offset1:2
ds_write2_b32 v61, v46, v47 offset0:32 offset1:34
PP_101_j:
s_waitcnt lgkmcnt(10)
v_smfmac_f32_16x16x64_bf16 v[28:31], v[0:3], a[0:7], v57
v_smfmac_f32_16x16x64_bf16 v[32:35], v[0:3], a[56:63], v57
s_waitcnt lgkmcnt(9)
v_smfmac_f32_16x16x64_bf16 v[28:31], v[4:7], a[8:15], v57
v_smfmac_f32_16x16x64_bf16 v[32:35], v[4:7], a[64:71], v57
s_waitcnt lgkmcnt(8)
v_smfmac_f32_16x16x64_bf16 v[28:31], v[8:11], a[16:23], v57
v_smfmac_f32_16x16x64_bf16 v[32:35], v[8:11], a[72:79], v57
s_waitcnt lgkmcnt(7)
v_smfmac_f32_16x16x64_bf16 v[28:31], v[16:19], a[32:39], v57
s_waitcnt vmcnt(0) lgkmcnt(0)
v_smfmac_f32_16x16x64_bf16 v[32:35], v[16:19], a[88:95], v57
s_waitcnt lgkmcnt(6)
v_smfmac_f32_16x16x64_bf16 v[28:31], v[20:23], a[40:47], v57
v_mov_b64 v[40:41], 0
v_smfmac_f32_16x16x64_bf16 v[32:35], v[20:23], a[96:103], v57
v_mov_b64 v[42:43], 0
v_smfmac_f32_16x16x64_bf16 v[36:39], v[0:3], a[112:119], v57
s_nop 1
v_add_u32 v62, 1, v62
v_smfmac_f32_16x16x64_bf16 v[36:39], v[4:7], a[120:127], v57
s_nop 0
v_add_f32 v28, v28, v30
v_smfmac_f32_16x16x64_bf16 v[36:39], v[8:11], a[128:135], v57
v_add_f32 v29, v29, v31
v_smfmac_f32_16x16x64_bf16 v[36:39], v[16:19], a[144:151], v57
v_cvt_pk_bf16_f32 v28, v28, v29
ds_write_b32 v59, v28 offset:0
v_smfmac_f32_16x16x64_bf16 v[36:39], v[20:23], a[152:159], v57
v_add_f32 v32, v32, v34
v_smfmac_f32_16x16x64_bf16 v[40:43], v[0:3], a[168:175], v57
s_nop 0
v_add_f32 v33, v33, v35
v_smfmac_f32_16x16x64_bf16 v[40:43], v[4:7], a[176:183], v57
v_cvt_pk_bf16_f32 v32, v32, v33
ds_write_b32 v59, v32 offset:1024
v_smfmac_f32_16x16x64_bf16 v[40:43], v[8:11], a[184:191], v57
s_nop 0
v_add_f32 v36, v36, v38
v_smfmac_f32_16x16x64_bf16 v[40:43], v[16:19], a[200:207], v57
v_add_f32 v37, v37, v39
v_smfmac_f32_16x16x64_bf16 v[40:43], v[20:23], a[208:215], v57
v_cvt_pk_bf16_f32 v36, v36, v37
ds_write_b32 v59, v36 offset:2048
ds_write_b32 v60, v62
v_smfmac_f32_16x16x64_bf16 v[40:43], v[12:15], a[192:199], v57
v_add_u32 v62, 1, v62
v_mov_b64 v[44:45], 0
v_mov_b64 v[46:47], 0
v_smfmac_f32_16x16x64_bf16 v[40:43], v[24:27], a[216:223], v57
s_nop 0
v_smfmac_f32_16x16x64_bf16 v[44:47], v[0:3], a[224:231], v57
s_nop 0
v_mov_b64 v[48:49], 0
v_smfmac_f32_16x16x64_bf16 v[44:47], v[4:7], a[232:239], v57
s_nop 0
v_mov_b64 v[50:51], 0
v_smfmac_f32_16x16x64_bf16 v[44:47], v[8:11], a[240:247], v57
s_nop 0
v_add_f32 v40, v40, v42
v_smfmac_f32_16x16x64_bf16 v[44:47], v[16:19], v[64:71], v57
v_add_f32 v41, v41, v43
v_smfmac_f32_16x16x64_bf16 v[44:47], v[20:23], v[72:79], v57
v_cvt_pk_bf16_f32 v40, v40, v41
ds_write_b32 v59, v40 offset:3072
ds_write_b32 v60, v62
v_smfmac_f32_16x16x64_bf16 v[44:47], v[12:15], a[248:255], v57
v_add_u32 v62, 1, v62
v_smfmac_f32_16x16x64_bf16 v[44:47], v[24:27], v[80:87], v57
v_smfmac_f32_16x16x64_bf16 v[48:51], v[0:3], v[88:95], v57
s_nop 0
v_mov_b64 v[52:53], 0
v_smfmac_f32_16x16x64_bf16 v[48:51], v[4:7], v[96:103], v57
s_nop 0
v_mov_b64 v[54:55], 0
v_smfmac_f32_16x16x64_bf16 v[48:51], v[8:11], v[104:111], v57
s_nop 0
v_add_f32 v44, v44, v46
v_smfmac_f32_16x16x64_bf16 v[48:51], v[16:19], v[120:127], v57
v_add_f32 v45, v45, v47
v_smfmac_f32_16x16x64_bf16 v[48:51], v[20:23], v[128:135], v57
v_cvt_pk_bf16_f32 v44, v44, v45
ds_write_b32 v59, v44 offset:3840
v_smfmac_f32_16x16x64_bf16 v[48:51], v[12:15], v[112:119], v57
v_smfmac_f32_16x16x64_bf16 v[48:51], v[24:27], v[136:143], v57
v_smfmac_f32_16x16x64_bf16 v[52:55], v[0:3], v[144:151], v57
s_nop 0
v_mov_b64 v[28:29], 0
v_smfmac_f32_16x16x64_bf16 v[52:55], v[4:7], v[152:159], v57
s_nop 0
v_mov_b64 v[30:31], 0
v_smfmac_f32_16x16x64_bf16 v[52:55], v[8:11], v[160:167], v57
s_nop 0
v_add_f32 v48, v48, v50
v_smfmac_f32_16x16x64_bf16 v[52:55], v[16:19], v[176:183], v57
v_add_f32 v49, v49, v51
v_smfmac_f32_16x16x64_bf16 v[52:55], v[20:23], v[184:191], v57
v_cvt_pk_bf16_f32 v48, v48, v49
ds_write_b32 v59, v48 offset:4608
ds_write_b32 v60, v62
v_smfmac_f32_16x16x64_bf16 v[52:55], v[12:15], v[168:175], v57
v_add_u32 v62, 1, v62
v_smfmac_f32_16x16x64_bf16 v[52:55], v[24:27], v[192:199], v57
v_smfmac_f32_16x16x64_bf16 v[28:31], v[0:3], v[200:207], v57
s_nop 0
s_nop 0
v_smfmac_f32_16x16x64_bf16 v[28:31], v[4:7], v[208:215], v57
s_nop 0
s_nop 0
v_smfmac_f32_16x16x64_bf16 v[28:31], v[8:11], v[216:223], v57
s_nop 0
v_add_f32 v52, v52, v54
v_smfmac_f32_16x16x64_bf16 v[28:31], v[16:19], v[232:239], v57
v_add_f32 v53, v53, v55
v_smfmac_f32_16x16x64_bf16 v[28:31], v[20:23], v[240:247], v57
v_cvt_pk_bf16_f32 v52, v52, v53
ds_write_b32 v59, v52 offset:5376
ds_write_b32 v60, v62
v_smfmac_f32_16x16x64_bf16 v[28:31], v[12:15], v[224:231], v57
v_add_u32 v62, 1, v62
v_smfmac_f32_16x16x64_bf16 v[28:31], v[24:27], v[248:255], v57
s_nop 7
v_pk_add_f32 v[28:29], v[28:29], v[30:31]
v_cvt_pk_bf16_f32 v28, v28, v29
ds_write_b32 v59, v28 offset:6144
ds_write_b32 v60, v62
s_barrier
s_sleep 8
s_add_u32 s15, s15, 1
s_cmp_lt_u32 s15, 63
s_cbranch_scc1 CA_LOOP_100
s_endpgm
CA_W0_68:
s_mul_i32 s19, s13, 401408
s_mul_i32 s17, s12, 14336
s_add_u32 s26, s19, s17
s_add_u32 s26, s26, 0
v_lshlrev_b32 v61, 4, v1
v_min_u32 v56, 13, v1
v_lshlrev_b32 v56, 2, v56
s_lshl_b32 s18, s13, 7
v_add_u32 v56, s18, v56
s_mov_b32 s58, 38797312
s_branch WF_102_in
WF_102:
s_sleep 12
WF_102_in:
buffer_load_dword v57, v56, s[8:11], s58 offen sc1
s_sub_u32 s16, s16, 1
s_cbranch_scc1 WFD_103_abort
s_waitcnt vmcnt(0)
v_cmp_eq_u32 vcc, 0, v57
s_cbranch_vccnz WF_102
WFD_103:
s_add_u32 s58, s58, 2048
buffer_load_dword v57, v56, s[8:11], s58 offen sc1
s_add_u32 s20, s26, 0
buffer_load_dwordx4 a[0:3], v61, s[8:11], s20 offen offset:0 sc1
buffer_load_dwordx4 a[4:7], v61, s[8:11], s20 offen offset:1024 sc1
s_add_u32 s20, s26, 57344
buffer_load_dwordx4 a[56:59], v61, s[8:11], s20 offen offset:0 sc1
buffer_load_dwordx4 a[60:63], v61, s[8:11], s20 offen offset:1024 sc1
s_add_u32 s20, s26, 114688
buffer_load_dwordx4 a[112:115], v61, s[8:11], s20 offen offset:0 sc1
buffer_load_dwordx4 a[116:119], v61, s[8:11], s20 offen offset:1024 sc1
s_add_u32 s20, s26, 172032
buffer_load_dwordx4 a[168:171], v61, s[8:11], s20 offen offset:0 sc1
buffer_load_dwordx4 a[172:175], v61, s[8:11], s20 offen offset:1024 sc1
s_waitcnt vmcnt(8)
v_cmp_eq_u32 vcc, 0, v57
s_cbranch_vccz OPT_104
s_nop 2
s_branch WF_105_in
WF_105:
s_sleep 12
WF_105_in:
buffer_load_dword v57, v56, s[8:11], s58 offen sc1
s_sub_u32 s16, s16, 1
s_cbranch_scc1 WFD_106_abort
s_waitcnt vmcnt(0)
v_cmp_eq_u32 vcc, 0, v57
s_cbranch_vccnz WF_105
WFD_106:
OPT_104:
s_add_u32 s58, s58, 2048
buffer_load_dword v57, v56, s[8:11], s58 offen sc1
s_add_u32 s20, s26, 2048
buffer_load_dwordx4 a[8:11], v61, s[8:11], s20 offen offset:0 sc1
buffer_load_dwordx4 a[12:15], v61, s[8:11], s20 offen offset:1024 sc1
s_add_u32 s20, s26, 59392
buffer_load_dwordx4 a[64:67], v61, s[8:11], s20 offen offset:0 sc1
buffer_load_dwordx4 a[68:71], v61, s[8:11], s20 offen offset:1024 sc1
s_add_u32 s20, s26, 116736
buffer_load_dwordx4 a[120:123], v61, s[8:11], s20 offen offset:0 sc1
buffer_load_dwordx4 a[124:127], v61, s[8:11], s20 offen offset:1024 sc1
s_add_u32 s20, s26, 174080
buffer_load_dwordx4 a[176:179], v61, s[8:11], s20 offen offset:0 sc1
buffer_load_dwordx4 a[180:183], v61, s[8:11], s20 offen offset:1024 sc1
s_waitcnt vmcnt(8)
v_cmp_eq_u32 vcc, 0, v57
s_cbranch_vccz OPT_107
s_nop 2
s_branch WF_108_in
WF_108:
s_sleep 12
WF_108_in:
buffer_load_dword v57, v56, s[8:11], s58 offen sc1
s_sub_u32 s16, s16, 1
s_cbranch_scc1 WFD_109_abort
s_waitcnt vmcnt(0)
v_cmp_eq_u32 vcc, 0, v57
s_cbranch_vccnz WF_108
WFD_109:
OPT_107:
s_add_u32 s58, s58, 2048
buffer_load_dword v57, v56, s[8:11], s58 offen sc1
s_add_u32 s20, s26, 4096
buffer_load_dwordx4 a[16:19], v61, s[8:11], s20 offen offset:0 sc1
buffer_load_dwordx4 a[20:23], v61, s[8:11], s20 offen offset:1024 sc1
s_add_u32 s20, s26, 61440
buffer_load_dwordx4 a[72:75], v61, s[8:11], s20 offen offset:0 sc1
buffer_load_dwordx4 a[76:79], v61, s[8:11], s20 offen offset:1024 sc1
s_add_u32 s20, s26, 118784
buffer_load_dwordx4 a[128:131], v61, s[8:11], s20 offen offset:0 sc1
buffer_load_dwordx4 a[132:135], v61, s[8:11], s20 offen offset:1024 sc1
s_add_u32 s20, s26, 176128
buffer_load_dwordx4 a[184:187], v61, s[8:11], s20 offen offset:0 sc1
buffer_load_dwordx4 a[188:191], v61, s[8:11], s20 offen offset:1024 sc1
s_waitcnt vmcnt(8)
v_cmp_eq_u32 vcc, 0, v57
s_cbranch_vccz OPT_110
s_nop 2
s_branch WF_111_in
WF_111:
s_sleep 12
WF_111_in:
buffer_load_dword v57, v56, s[8:11], s58 offen sc1
s_sub_u32 s16, s16, 1
s_cbranch_scc1 WFD_112_abort
s_waitcnt vmcnt(0)
v_cmp_eq_u32 vcc, 0, v57
s_cbranch_vccnz WF_111
WFD_112:
OPT_110:
s_add_u32 s58, s58, 2048
buffer_load_dword v57, v56, s[8:11], s58 offen sc1
s_add_u32 s20, s26, 6144
buffer_load_dwordx4 a[24:27], v61, s[8:11], s20 offen offset:0 sc1
buffer_load_dwordx4 a[28:31], v61, s[8:11], s20 offen offset:1024 sc1
s_add_u32 s20, s26, 63488
buffer_load_dwordx4 a[80:83], v61, s[8:11], s20 offen offset:0 sc1
buffer_load_dwordx4 a[84:87], v61, s[8:11], s20 offen offset:1024 sc1
s_add_u32 s20, s26, 120832
buffer_load_dwordx4 a[136:139], v61, s[8:11], s20 offen offset:0 sc1
buffer_load_dwordx4 a[140:143], v61, s[8:11], s20 offen offset:1024 sc1
s_add_u32 s20, s26, 178176
buffer_load_dwordx4 a[192:195], v61, s[8:11], s20 offen offset:0 sc1
buffer_load_dwordx4 a[196:199], v61, s[8:11], s20 offen offset:1024 sc1
s_waitcnt vmcnt(8)
v_cmp_eq_u32 vcc, 0, v57
s_cbranch_vccz OPT_113
s_nop 2
s_branch WF_114_in
WF_114:
s_sleep 12
WF_114_in:
buffer_load_dword v57, v56, s[8:11], s58 offen sc1
s_sub_u32 s16, s16, 1
s_cbranch_scc1 WFD_115_abort
s_waitcnt vmcnt(0)
v_cmp_eq_u32 vcc, 0, v57
s_cbranch_vccnz WF_114
WFD_115:
OPT_113:
s_add_u32 s58, s58, 2048
buffer_load_dword v57, v56, s[8:11], s58 offen sc1
s_add_u32 s20, s26, 8192
buffer_load_dwordx4 a[32:35], v61, s[8:11], s20 offen offset:0 sc1
buffer_load_dwordx4 a[36:39], v61, s[8:11], s20 offen offset:1024 sc1
s_add_u32 s20, s26, 65536
buffer_load_dwordx4 a[88:91], v61, s[8:11], s20 offen offset:0 sc1
buffer_load_dwordx4 a[92:95], v61, s[8:11], s20 offen offset:1024 sc1
s_add_u32 s20, s26, 122880
buffer_load_dwordx4 a[144:147], v61, s[8:11], s20 offen offset:0 sc1
buffer_load_dwordx4 a[148:151], v61, s[8:11], s20 offen offset:1024 sc1
s_add_u32 s20, s26, 180224
buffer_load_dwordx4 a[200:203], v61, s[8:11], s20 offen offset:0 sc1
buffer_load_dwordx4 a[204:207], v61, s[8:11], s20 offen offset:1024 sc1
s_waitcnt vmcnt(8)
v_cmp_eq_u32 vcc, 0, v57
s_cbranch_vccz OPT_116
s_nop 2
s_branch WF_117_in
WF_117:
s_sleep 12
WF_117_in:
buffer_load_dword v57, v56, s[8:11], s58 offen sc1
s_sub_u32 s16, s16, 1
s_cbranch_scc1 WFD_118_abort
s_waitcnt vmcnt(0)
v_cmp_eq_u32 vcc, 0, v57
s_cbranch_vccnz WF_117
WFD_118:
OPT_116:
s_getpc_b64 s[54:55]
WCODE_119:
s_sub_u32 s54, s54, WCODE_119-K_START
s_subb_u32 s55, s55, 0
v_mbcnt_lo_u32_b32 v57, -1, 0
v_mbcnt_hi_u32_b32 v57, -1, v57
v_lshl_add_u32 v57, v57, 5, s91
v_lshlrev_b32 v57, 6, v57
v_min_u32 v57, K_END-K_START-4, v57
global_load_dword v57, v57, s[54:55]
s_add_u32 s58, s58, 2048
buffer_load_dword v57, v56, s[8:11], s58 offen sc1
s_add_u32 s20, s26, 10240
buffer_load_dwordx4 a[40:43], v61, s[8:11], s20 offen offset:0 sc1
buffer_load_dwordx4 a[44:47], v61, s[8:11], s20 offen offset:1024 sc1
s_add_u32 s20, s26, 67584
buffer_load_dwordx4 a[96:99], v61, s[8:11], s20 offen offset:0 sc1
buffer_load_dwordx4 a[100:103], v61, s[8:11], s20 offen offset:1024 sc1
s_add_u32 s20, s26, 124928
buffer_load_dwordx4 a[152:155], v61, s[8:11], s20 offen offset:0 sc1
buffer_load_dwordx4 a[156:159], v61, s[8:11], s20 offen offset:1024 sc1
s_add_u32 s20, s26, 182272
buffer_load_dwordx4 a[208:211], v61, s[8:11], s20 offen offset:0 sc1
buffer_load_dwordx4 a[212:215], v61, s[8:11], s20 offen offset:1024 sc1
s_waitcnt vmcnt(8)
v_cmp_eq_u32 vcc, 0, v57
s_cbranch_vccz OPT_120
s_nop 2
s_branch WF_121_in
WF_121:
s_sleep 12
WF_121_in:
buffer_load_dword v57, v56, s[8:11], s58 offen sc1
s_sub_u32 s16, s16, 1
s_cbranch_scc1 WFD_122_abort
s_waitcnt vmcnt(0)
v_cmp_eq_u32 vcc, 0, v57
s_cbranch_vccnz WF_121
WFD_122:
OPT_120:
buffer_load_dword v56, off, s[92:95], 0 offset:16 sc1
s_add_u32 s20, s26, 12288
buffer_load_dwordx4 a[48:51], v61, s[8:11], s20 offen offset:0 sc1
buffer_load_dwordx4 a[52:55], v61, s[8:11], s20 offen offset:1024 sc1
s_add_u32 s20, s26, 69632
buffer_load_dwordx4 a[104:107], v61, s[8:11], s20 offen offset:0 sc1
buffer_load_dwordx4 a[108:111], v61, s[8:11], s20 offen offset:1024 sc1
s_add_u32 s20, s26, 126976
buffer_load_dwordx4 a[160:163], v61, s[8:11], s20 offen offset:0 sc1
buffer_load_dwordx4 a[164:167], v61, s[8:11], s20 offen offset:1024 sc1
s_add_u32 s20, s26, 184320
buffer_load_dwordx4 a[216:219], v61, s[8:11], s20 offen offset:0 sc1
buffer_load_dwordx4 a[220:223], v61, s[8:11], s20 offen offset:1024 sc1
s_waitcnt vmcnt(8)
PL_I_123:
v_cmp_gt_u32 vcc, 32, v56
s_cbranch_vccnz PL_I_123_p
PL_I_123_ok:
s_lshl_b32 s17, s12, 10
s_cmp_eq_u32 s12, 3
s_cselect_b32 s33, 3, 4
s_lshl_b32 s33, s33, 10
v_lshlrev_b32 v56, 4, v1
v_add_u32 v56, s17, v56
v_lshrrev_b32 v2, 4, v1
v_and_b32 v3, 15, v1
v_and_b32 v57, 2, v1
v_cmp_eq_u32 vcc, 2, v57
v_mov_b32 v57, 0x44444444
v_mov_b32 v58, 0xeeeeeeee
v_cndmask_b32 v57, v57, v58, vcc
v_and_b32 v58, 2, v1
v_lshlrev_b32 v58, 6, v58
v_lshl_add_u32 v58, v2, 8, v58
v_bfe_u32 v4, v1, 2, 2
v_lshl_add_u32 v58, v4, 5, v58
v_lshlrev_b32 v59, 6, v4
v_and_b32 v4, 1, v1
v_lshl_add_u32 v58, v4, 4, v58
v_lshl_add_u32 v59, v4, 5, v59
v_lshl_add_u32 v59, v2, 3, v59
v_bfe_u32 v4, v1, 1, 1
v_lshl_add_u32 v59, v4, 2, v59
s_lshl_b32 s17, s12, 8
s_add_u32 s17, s17, 8192
v_add_u32 v59, s17, v59
v_mul_u32_u24 v63, 124, v4
v_sub_u32 v63, v58, v63
s_lshl_b32 s17, s12, 10
s_add_u32 s17, s17, 20480
v_add_u32 v63, s17, v63
v_lshlrev_b32 v58, 4, v1
s_lshl_b32 s17, s12, 8
s_add_u32 s17, s17, 16384
v_lshl_add_u32 v60, v1, 2, s17
v_mov_b32 v62, 0
ds_write_b32 v60, v62
s_mul_i32 s30, s14, 28672
s_add_u32 s30, s30, 35651584
s_mov_b32 s15, 0
v_min_u32 v60, 2, v1
v_mul_u32_u24 v60, 260, v60
v_add_u32 v60, 16640, v60
v_lshlrev_b32 v124, 8, v2
v_lshl_add_u32 v124, v3, 3, v124
v_add_u32 v124, 8192, v124
v_and_b32 v4, 7, v1
v_lshlrev_b32 v125, 7, v2
v_lshl_add_u32 v125, v4, 4, v125
v_lshlrev_b32 v126, 9, v2
v_lshl_add_u32 v126, v3, 4, v126
s_lshr_b32 s17, s13, 2
s_mul_i32 s17, s17, 2560
s_bfe_u32 s18, s13, 0x10001
s_and_b32 s19, s13, 1
v_bfe_u32 v127, v1, 3, 1
v_lshlrev_b32 v127, 8, v127
v_lshl_add_u32 v127, v2, 6, v127
v_bfe_u32 v4, v1, 2, 1
v_lshl_add_u32 v127, v4, 5, v127
v_and_b32 v4, 3, v1
v_lshl_add_u32 v127, v4, 2, v127
v_bfe_u32 v4, v1, 1, 2
s_lshl_b32 s20, s18, 10
s_add_u32 s20, s20, s17
s_lshl_b32 s27, s19, 9
s_add_u32 s20, s20, s27
v_add_u32 v127, s20, v127
v_lshlrev_b32 v128, 7, v4
v_lshl_add_u32 v128, v2, 5, v128
v_bfe_u32 v4, v1, 3, 1
v_lshl_add_u32 v128, v4, 3, v128
s_lshl_b32 s20, s19, 4
s_lshl_b32 s27, s18, 2
s_add_u32 s20, s20, s27
s_add_u32 s20, s20, s17
s_add_u32 s20, s20, 2048
v_add_u32 v128, s20, v128
s_mul_i32 s31, s14, 40960
s_add_u32 s31, s31, 35717120
s_mul_i32 s23, s14, 1835008
s_add_u32 s23, s23, 39845888
v_min_u32 v131, 13, v1
v_lshlrev_b32 v131, 7, v131
s_mul_i32 s25, s13, 1792
s_add_u32 s25, s25, s23
s_add_u32 s25, s25, 57344
s_mov_b32 s28, 0xff00ff00
s_mov_b32 s29, 0xff00ff00
s_mov_b32 s36, 0x55555555
s_mov_b32 s37, 0x55555555
s_lshl_b32 s35, s14, 15
s_add_u32 s35, s35, 38142080
v_mov_b32 v129, 0
v_mov_b32 v130, 0
s_lshl_b32 s39, s13, 2
s_add_u32 s39, s39, s35
s_add_u32 s39, s39, 384
PG_124:
v_readfirstlane_b32 s17, v129
s_nop 0
s_cmp_gt_u32 s17, s15
s_nop 1
s_cbranch_scc0 PG_124_slow
PG_124_ok:
buffer_load_dwordx4 v[144:147], v126, s[8:11], s23 offen offset:0 sc1
buffer_load_dwordx4 v[148:151], v126, s[8:11], s23 offen offset:2048 sc1
buffer_load_dwordx4 v[152:155], v126, s[8:11], s23 offen offset:256 sc1
buffer_load_dwordx4 v[156:159], v126, s[8:11], s23 offen offset:2304 sc1
s_add_u32 s23, s23, 4096
buffer_load_dwordx4 v[160:163], v126, s[8:11], s23 offen offset:0 sc1
buffer_load_dwordx4 v[164:167], v126, s[8:11], s23 offen offset:2048 sc1
buffer_load_dwordx4 v[168:171], v126, s[8:11], s23 offen offset:256 sc1
buffer_load_dwordx4 v[172:175], v126, s[8:11], s23 offen offset:2304 sc1
s_add_u32 s23, s23, 4096
buffer_load_dwordx4 v[176:179], v126, s[8:11], s23 offen offset:0 sc1
buffer_load_dwordx4 v[180:183], v126, s[8:11], s23 offen offset:2048 sc1
buffer_load_dwordx4 v[184:187], v126, s[8:11], s23 offen offset:256 sc1
buffer_load_dwordx4 v[188:191], v126, s[8:11], s23 offen offset:2304 sc1
s_add_u32 s23, s23, 4096
buffer_load_dwordx4 v[192:195], v126, s[8:11], s23 offen offset:0 sc1
buffer_load_dwordx4 v[196:199], v126, s[8:11], s23 offen offset:2048 sc1
buffer_load_dwordx4 v[200:203], v126, s[8:11], s23 offen offset:256 sc1
buffer_load_dwordx4 v[204:207], v126, s[8:11], s23 offen offset:2304 sc1
s_add_u32 s23, s23, 4096
buffer_load_dwordx4 v[208:211], v126, s[8:11], s23 offen offset:0 sc1
buffer_load_dwordx4 v[212:215], v126, s[8:11], s23 offen offset:2048 sc1
buffer_load_dwordx4 v[216:219], v126, s[8:11], s23 offen offset:256 sc1
buffer_load_dwordx4 v[220:223], v126, s[8:11], s23 offen offset:2304 sc1
s_add_u32 s23, s23, 4096
buffer_load_dwordx4 v[224:227], v126, s[8:11], s23 offen offset:0 sc1
buffer_load_dwordx4 v[228:231], v126, s[8:11], s23 offen offset:2048 sc1
buffer_load_dwordx4 v[232:235], v126, s[8:11], s23 offen offset:256 sc1
buffer_load_dwordx4 v[236:239], v126, s[8:11], s23 offen offset:2304 sc1
s_add_u32 s23, s23, 4096
buffer_load_dwordx4 v[240:243], v126, s[8:11], s23 offen offset:0 sc1
buffer_load_dwordx4 v[244:247], v126, s[8:11], s23 offen offset:2048 sc1
buffer_load_dwordx4 v[248:251], v126, s[8:11], s23 offen offset:256 sc1
buffer_load_dwordx4 v[252:255], v126, s[8:11], s23 offen offset:2304 sc1
s_add_u32 s23, s23, 4096
MS_125:
buffer_load_dword v61, off, s[92:95], s56 sc1
s_sub_u32 s16, s16, 1
s_cbranch_scc1 MS_125_ab
s_waitcnt vmcnt(0)
v_readfirstlane_b32 s58, v61
s_nop 0
s_and_b32 s17, s58, 0xffff
s_cmp_ge_u32 s17, s57
s_nop 0
s_cbranch_scc0 MS_125
s_lshr_b32 s17, s58, 16
s_cbranch_scc1 MS_125_slow
CA0_LOOP_126:
s_and_b32 s17, s15, 3
s_mul_i32 s18, s17, 10240
s_add_u32 s22, s18, s31
s_add_u32 s17, s15, 3
s_and_b32 s17, s17, 3
s_mul_i32 s18, s17, 10240
s_add_u32 s32, s18, s31
v_mov_b64 v[112:113], 0
v_mov_b64 v[114:115], 0
v_mov_b64 v[116:117], 0
v_mov_b64 v[118:119], 0
v_mov_b64 v[120:121], 0
v_mov_b64 v[122:123], 0
s_and_b32 s17, s15, 3
s_mul_i32 s18, s17, 7168
s_add_u32 s21, s18, s30
v_mov_b64 v[28:29], 0
v_mov_b64 v[30:31], 0
v_mov_b64 v[32:33], 0
v_mov_b64 v[34:35], 0
v_mov_b64 v[36:37], 0
v_mov_b64 v[38:39], 0
s_add_u32 s34, s21, s33
s_waitcnt vmcnt(0)
buffer_load_dwordx4 v[40:43], v56, s[8:11], s21 offen sc1
buffer_load_dwordx4 v[44:47], v56, s[8:11], s34 offen sc1
s_sleep 3
PP_127:
buffer_load_dwordx4 v[48:51], v56, s[8:11], s21 offen sc1
buffer_load_dwordx4 v[52:55], v56, s[8:11], s34 offen sc1
s_waitcnt vmcnt(2)
ds_write_b128 v56, v[40:43] offset:0
ds_write_b128 v56, v[44:47] offset:4096
v_max3_u32 v61, v40, v41, v42
v_max3_u32 v61, v61, v43, v44
v_max3_u32 v61, v61, v45, v46
v_max_u32 v61, v61, v47
v_cmp_eq_u32 vcc, -1, v61
s_cbranch_vccz PP_127_d0
buffer_load_dwordx4 v[40:43], v56, s[8:11], s21 offen sc1
buffer_load_dwordx4 v[44:47], v56, s[8:11], s34 offen sc1
s_sub_u32 s16, s16, 1
s_cbranch_scc1 PP_127_abort
s_waitcnt vmcnt(2)
ds_write_b128 v56, v[48:51] offset:0
ds_write_b128 v56, v[52:55] offset:4096
v_max3_u32 v61, v48, v49, v50
v_max3_u32 v61, v61, v51, v52
v_max3_u32 v61, v61, v53, v54
v_max_u32 v61, v61, v55
v_cmp_eq_u32 vcc, -1, v61
s_cbranch_vccnz PP_127
PP_127_d1:
v_smfmac_f32_16x16x64_bf16 v[28:31], v[48:51], a[0:7], v57
v_smfmac_f32_16x16x64_bf16 v[32:35], v[48:51], a[56:63], v57
s_waitcnt lgkmcnt(0)
s_barrier
ds_read_b128 v[4:7], v58 offset:1024
ds_read_b128 v[8:11], v58 offset:2048
ds_read_b128 v[12:15], v58 offset:3072
v_smfmac_f32_16x16x64_bf16 v[36:39], v[48:51], a[112:119], v57
ds_read_b128 v[20:23], v58 offset:5120
ds_read_b128 v[24:27], v58 offset:6144
v_smfmac_f32_16x16x64_bf16 v[28:31], v[52:55], a[32:39], v57
ds_read_b128 v[0:3], v58 offset:0
ds_read_b128 v[16:19], v58 offset:4096
v_smfmac_f32_16x16x64_bf16 v[32:35], v[52:55], a[88:95], v57
ds_write2_b32 v63, v48, v49 offset0:0 offset1:2
ds_write2_b32 v63, v50, v51 offset0:32 offset1:34
v_smfmac_f32_16x16x64_bf16 v[36:39], v[52:55], a[144:151], v57
v_add_u32 v61, 4096, v63
ds_write2_b32 v61, v52, v53 offset0:0 offset1:2
ds_write2_b32 v61, v54, v55 offset0:32 offset1:34
s_branch PP_127_j
PP_127_d0:
v_smfmac_f32_16x16x64_bf16 v[28:31], v[40:43], a[0:7], v57
v_smfmac_f32_16x16x64_bf16 v[32:35], v[40:43], a[56:63], v57
s_waitcnt lgkmcnt(0)
s_barrier
ds_read_b128 v[4:7], v58 offset:1024
ds_read_b128 v[8:11], v58 offset:2048
ds_read_b128 v[12:15], v58 offset:3072
v_smfmac_f32_16x16x64_bf16 v[36:39], v[40:43], a[112:119], v57
ds_read_b128 v[20:23], v58 offset:5120
ds_read_b128 v[24:27], v58 offset:6144
v_smfmac_f32_16x16x64_bf16 v[28:31], v[44:47], a[32:39], v57
ds_read_b128 v[0:3], v58 offset:0
ds_read_b128 v[16:19], v58 offset:4096
v_smfmac_f32_16x16x64_bf16 v[32:35], v[44:47], a[88:95], v57
ds_write2_b32 v63, v40, v41 offset0:0 offset1:2
ds_write2_b32 v63, v42, v43 offset0:32 offset1:34
v_smfmac_f32_16x16x64_bf16 v[36:39], v[44:47], a[144:151], v57
v_add_u32 v61, 4096, v63
ds_write2_b32 v61, v44, v45 offset0:0 offset1:2
ds_write2_b32 v61, v46, v47 offset0:32 offset1:34
PP_127_j:
buffer_load_dword v129, off, s[8:11], s35 sc1
s_add_u32 s15, s15, 1
s_waitcnt lgkmcnt(10)
v_smfmac_f32_16x16x64_bf16 v[28:31], v[4:7], a[8:15], v57
v_smfmac_f32_16x16x64_bf16 v[32:35], v[4:7], a[64:71], v57
s_waitcnt lgkmcnt(9)
v_smfmac_f32_16x16x64_bf16 v[28:31], v[8:11], a[16:23], v57
v_smfmac_f32_16x16x64_bf16 v[32:35], v[8:11], a[72:79], v57
s_waitcnt lgkmcnt(8)
v_smfmac_f32_16x16x64_bf16 v[28:31], v[12:15], a[24:31], v57
v_smfmac_f32_16x16x64_bf16 v[32:35], v[12:15], a[80:87], v57
s_waitcnt lgkmcnt(7)
v_smfmac_f32_16x16x64_bf16 v[28:31], v[20:23], a[40:47], v57
s_waitcnt lgkmcnt(4)
v_smfmac_f32_16x16x64_bf16 v[32:35], v[20:23], a[96:103], v57
s_waitcnt lgkmcnt(6)
v_smfmac_f32_16x16x64_bf16 v[28:31], v[24:27], a[48:55], v57
v_mov_b64 v[140:141], 0
v_smfmac_f32_16x16x64_bf16 v[32:35], v[24:27], a[104:111], v57
v_mov_b64 v[142:143], 0
v_smfmac_f32_16x16x64_bf16 v[36:39], v[4:7], a[120:127], v57
s_nop 1
v_smfmac_f32_16x16x64_bf16 v[36:39], v[8:11], a[128:135], v57
s_nop 0
v_add_f32 v28, v28, v30
v_smfmac_f32_16x16x64_bf16 v[36:39], v[12:15], a[136:143], v57
v_add_f32 v29, v29, v31
v_smfmac_f32_16x16x64_bf16 v[36:39], v[20:23], a[152:159], v57
v_cvt_pk_bf16_f32 v28, v28, v29
ds_write_b32 v59, v28 offset:0
v_smfmac_f32_16x16x64_bf16 v[36:39], v[24:27], a[160:167], v57
v_add_f32 v32, v32, v34
v_smfmac_f32_16x16x64_bf16 v[140:143], v[4:7], a[176:183], v57
s_nop 0
v_add_f32 v33, v33, v35
v_smfmac_f32_16x16x64_bf16 v[140:143], v[8:11], a[184:191], v57
v_cvt_pk_bf16_f32 v32, v32, v33
ds_write_b32 v59, v32 offset:1024
v_smfmac_f32_16x16x64_bf16 v[140:143], v[12:15], a[192:199], v57
s_nop 0
v_add_f32 v36, v36, v38
s_waitcnt vmcnt(0)
v_readfirstlane_b32 s17, v129
v_smfmac_f32_16x16x64_bf16 v[140:143], v[20:23], a[208:215], v57
v_add_f32 v37, v37, v39
v_smfmac_f32_16x16x64_bf16 v[140:143], v[24:27], a[216:223], v57
v_cvt_pk_bf16_f32 v36, v36, v37
ds_write_b32 v59, v36 offset:2048
v_smfmac_f32_16x16x64_bf16 v[140:143], v[0:3], a[168:175], v57
s_cmp_gt_u32 s17, s15
s_cselect_b32 s38, 1, 0
v_smfmac_f32_16x16x64_bf16 v[140:143], v[16:19], a[200:207], v57
v_add_u32 v62, 1, v62
ds_read_b32 v136, v60
ds_read_b64_tr_b16 v[64:65], v124 offset:0
ds_read_b64_tr_b16 v[66:67], v124 offset:128
ds_read_b128 v[80:83], v125 offset:20480
ds_read_b128 v[84:87], v125 offset:20992
ds_read_b64_tr_b16 v[68:69], v124 offset:1024
ds_read_b64_tr_b16 v[70:71], v124 offset:1152
ds_read_b128 v[88:91], v125 offset:21504
ds_read_b128 v[92:95], v125 offset:22016
ds_read_b64_tr_b16 v[72:73], v124 offset:2048
ds_read_b64_tr_b16 v[74:75], v124 offset:2176
ds_read_b128 v[96:99], v125 offset:22528
ds_read_b128 v[100:103], v125 offset:23040
v_pk_add_f32 v[140:141], v[140:141], v[142:143]
v_cvt_pk_bf16_f32 v140, v140, v141
s_waitcnt lgkmcnt(12)
v_cmp_lt_u32 vcc, v136, v62
s_cbranch_vccnz CA_PW_128
CA_PW_128_ok:
s_waitcnt lgkmcnt(8)
v_smfmac_f32_16x16x64_bf16 v[112:115], v[64:67], v[144:151], v57
v_smfmac_f32_16x16x64_bf16 v[116:119], v[64:67], v[152:159], v57
v_smfmac_f32_16x16x64_bf16 v[120:123], v[64:67], v[80:87], v57
s_waitcnt lgkmcnt(4)
v_smfmac_f32_16x16x64_bf16 v[112:115], v[68:71], v[160:167], v57
v_smfmac_f32_16x16x64_bf16 v[116:119], v[68:71], v[168:175], v57
v_smfmac_f32_16x16x64_bf16 v[120:123], v[68:71], v[88:95], v57
s_waitcnt lgkmcnt(0)
ds_write_b32 v59, v140 offset:3072
v_add_u32 v62, 1, v62
ds_read_b32 v136, v60
ds_read_b64_tr_b16 v[76:77], v124 offset:3072
ds_read_b64_tr_b16 v[78:79], v124 offset:3200
ds_read_b128 v[104:107], v125 offset:23552
ds_read_b128 v[108:111], v125 offset:24064
v_smfmac_f32_16x16x64_bf16 v[112:115], v[72:75], v[176:183], v57
v_smfmac_f32_16x16x64_bf16 v[116:119], v[72:75], v[184:191], v57
v_smfmac_f32_16x16x64_bf16 v[120:123], v[72:75], v[96:103], v57
s_waitcnt lgkmcnt(4)
v_cmp_lt_u32 vcc, v136, v62
s_cbranch_vccnz CA_PW_129
CA_PW_129_ok:
s_waitcnt lgkmcnt(0)
v_smfmac_f32_16x16x64_bf16 v[112:115], v[76:79], v[192:199], v57
v_smfmac_f32_16x16x64_bf16 v[116:119], v[76:79], v[200:207], v57
v_smfmac_f32_16x16x64_bf16 v[120:123], v[76:79], v[104:111], v57
ds_read_b128 v[80:83], v125 offset:24576
ds_read_b128 v[84:87], v125 offset:25088
ds_read_b128 v[88:91], v125 offset:25600
ds_read_b128 v[92:95], v125 offset:26112
ds_read_b128 v[96:99], v125 offset:26624
ds_read_b128 v[100:103], v125 offset:27136
s_cmp_eq_u32 s38, 1
s_cbranch_scc0 OPT_130
buffer_load_dwordx4 v[144:147], v126, s[8:11], s23 offen offset:0 sc1
buffer_load_dwordx4 v[148:151], v126, s[8:11], s23 offen offset:2048 sc1
buffer_load_dwordx4 v[152:155], v126, s[8:11], s23 offen offset:256 sc1
buffer_load_dwordx4 v[156:159], v126, s[8:11], s23 offen offset:2304 sc1
s_add_u32 s23, s23, 4096
OPT_130:
v_add_u32 v62, 1, v62
ds_read_b32 v136, v60
ds_read_b64_tr_b16 v[64:65], v124 offset:4096
ds_read_b64_tr_b16 v[66:67], v124 offset:4224
s_cmp_eq_u32 s38, 1
s_cbranch_scc0 OPT_131
buffer_load_dwordx4 v[160:163], v126, s[8:11], s23 offen offset:0 sc1
buffer_load_dwordx4 v[164:167], v126, s[8:11], s23 offen offset:2048 sc1
buffer_load_dwordx4 v[168:171], v126, s[8:11], s23 offen offset:256 sc1
buffer_load_dwordx4 v[172:175], v126, s[8:11], s23 offen offset:2304 sc1
s_add_u32 s23, s23, 4096
OPT_131:
s_waitcnt lgkmcnt(2)
v_cmp_lt_u32 vcc, v136, v62
s_cbranch_vccnz CA_PW_132
CA_PW_132_ok:
s_waitcnt lgkmcnt(0)
v_smfmac_f32_16x16x64_bf16 v[112:115], v[64:67], v[208:215], v57
v_smfmac_f32_16x16x64_bf16 v[116:119], v[64:67], v[216:223], v57
v_smfmac_f32_16x16x64_bf16 v[120:123], v[64:67], v[80:87], v57
v_add_u32 v62, 1, v62
ds_read_b32 v136, v60
ds_read_b64_tr_b16 v[68:69], v124 offset:5120
ds_read_b64_tr_b16 v[70:71], v124 offset:5248
s_cmp_eq_u32 s38, 1
s_cbranch_scc0 OPT_133
buffer_load_dwordx4 v[176:179], v126, s[8:11], s23 offen offset:0 sc1
buffer_load_dwordx4 v[180:183], v126, s[8:11], s23 offen offset:2048 sc1
buffer_load_dwordx4 v[184:187], v126, s[8:11], s23 offen offset:256 sc1
buffer_load_dwordx4 v[188:191], v126, s[8:11], s23 offen offset:2304 sc1
s_add_u32 s23, s23, 4096
OPT_133:
s_waitcnt lgkmcnt(2)
v_cmp_lt_u32 vcc, v136, v62
s_cbranch_vccnz CA_PW_134
CA_PW_134_ok:
s_waitcnt lgkmcnt(0)
v_mov_b32 v137, s15
v_add_u32 v62, 1, v62
ds_read_b32 v136, v60
ds_read_b64_tr_b16 v[72:73], v124 offset:6144
ds_read_b64_tr_b16 v[74:75], v124 offset:6272
v_smfmac_f32_16x16x64_bf16 v[112:115], v[68:71], v[224:231], v57
v_smfmac_f32_16x16x64_bf16 v[116:119], v[68:71], v[232:239], v57
v_smfmac_f32_16x16x64_bf16 v[120:123], v[68:71], v[88:95], v57
s_waitcnt lgkmcnt(2)
v_cmp_lt_u32 vcc, v136, v62
s_cbranch_vccnz CA_PW_135
CA_PW_135_ok:
s_waitcnt lgkmcnt(0)
v_smfmac_f32_16x16x64_bf16 v[112:115], v[72:75], v[240:247], v57
v_smfmac_f32_16x16x64_bf16 v[116:119], v[72:75], v[248:255], v57
v_smfmac_f32_16x16x64_bf16 v[120:123], v[72:75], v[96:103], v57
s_nop 5
v_pk_add_f32 v[112:113], v[112:113], v[114:115]
v_pk_add_f32 v[116:117], v[116:117], v[118:119]
v_pk_add_f32 v[120:121], v[120:121], v[122:123]
v_max3_f32 v132, v112, v116, v120
v_max3_f32 v133, v113, v117, v121
s_nop 0
v_max_f32_dpp v132, v132, v132 row_ror:8 row_mask:0xf bank_mask:0xf
v_max_f32_dpp v133, v133, v133 row_ror:8 row_mask:0xf bank_mask:0xf
s_nop 0
v_max_f32_dpp v132, v132, v132 row_ror:4 row_mask:0xf bank_mask:0xf
v_max_f32_dpp v133, v133, v133 row_ror:4 row_mask:0xf bank_mask:0xf
s_nop 0
v_max_f32_dpp v132, v132, v132 row_ror:2 row_mask:0xf bank_mask:0xf
v_max_f32_dpp v133, v133, v133 row_ror:2 row_mask:0xf bank_mask:0xf
s_nop 0
v_max_f32_dpp v132, v132, v132 row_ror:1 row_mask:0xf bank_mask:0xf
v_max_f32_dpp v133, v133, v133 row_ror:1 row_mask:0xf bank_mask:0xf
v_pk_add_f32 v[112:113], v[112:113], v[132:133] neg_lo:[0,1] neg_hi:[0,1]
v_pk_add_f32 v[116:117], v[116:117], v[132:133] neg_lo:[0,1] neg_hi:[0,1]
v_pk_add_f32 v[120:121], v[120:121], v[132:133] neg_lo:[0,1] neg_hi:[0,1]
v_exp_f32 v112, v112
v_exp_f32 v116, v116
v_exp_f32 v120, v120
v_add_f32 v134, v112, v116
v_exp_f32 v113, v113
v_fma_f32 v134, v120, 0.5, v134
v_exp_f32 v117, v117
v_exp_f32 v121, v121
v_add_f32_dpp v134, v134, v134 row_ror:8 row_mask:0xf bank_mask:0xf
v_add_f32 v135, v113, v117
v_fma_f32 v135, v121, 0.5, v135
v_add_f32_dpp v134, v134, v134 row_ror:4 row_mask:0xf bank_mask:0xf
v_cndmask_b32 v120, v120, v121, s[28:29]
v_add_f32_dpp v135, v135, v135 row_ror:8 row_mask:0xf bank_mask:0xf
v_add_f32_dpp v134, v134, v134 row_ror:2 row_mask:0xf bank_mask:0xf
v_mov_b32_dpp v121, v120 quad_perm:[1,0,3,2] row_mask:0xf bank_mask:0xf
v_add_f32_dpp v135, v135, v135 row_ror:4 row_mask:0xf bank_mask:0xf
v_add_f32_dpp v134, v134, v134 row_ror:1 row_mask:0xf bank_mask:0xf
v_rcp_f32 v134, v134
v_add_f32_dpp v135, v135, v135 row_ror:2 row_mask:0xf bank_mask:0xf
v_mul_f32 v112, v112, v134 clamp
v_mul_f32 v116, v116, v134 clamp
v_add_f32_dpp v135, v135, v135 row_ror:1 row_mask:0xf bank_mask:0xf
v_cvt_pk_bf16_f32 v112, v112, v116
v_rcp_f32 v135, v135
buffer_store_dword v112, v127, s[8:11], s22 offen
v_mul_f32 v113, v113, v135 clamp
v_mul_f32 v117, v117, v135 clamp
v_cndmask_b32 v134, v134, v135, s[28:29]
v_cvt_pk_bf16_f32 v113, v113, v117
v_pk_mul_f32 v[120:121], v[120:121], v[134:135] op_sel_hi:[1,0] clamp
buffer_store_dword v113, v127, s[8:11], s22 offen offset:16
v_cvt_pk_bf16_f32 v120, v120, v121
s_mov_b64 exec, s[36:37]
buffer_store_dword v120, v128, s[8:11], s22 offen
s_mov_b64 exec, -1
s_barrier
s_cmp_ge_u32 s15, 63
s_cbranch_scc1 CA0_LOOP_126_end
s_cmp_eq_u32 s38, 1
s_cbranch_scc1 CA0_LATE_136
PG_137:
v_readfirstlane_b32 s17, v129
s_nop 0
s_cmp_gt_u32 s17, s15
s_nop 1
s_cbranch_scc0 PG_137_slow
PG_137_ok:
buffer_load_dwordx4 v[144:147], v126, s[8:11], s23 offen offset:0 sc1
buffer_load_dwordx4 v[148:151], v126, s[8:11], s23 offen offset:2048 sc1
buffer_load_dwordx4 v[152:155], v126, s[8:11], s23 offen offset:256 sc1
buffer_load_dwordx4 v[156:159], v126, s[8:11], s23 offen offset:2304 sc1
s_add_u32 s23, s23, 4096
buffer_load_dwordx4 v[160:163], v126, s[8:11], s23 offen offset:0 sc1
buffer_load_dwordx4 v[164:167], v126, s[8:11], s23 offen offset:2048 sc1
buffer_load_dwordx4 v[168:171], v126, s[8:11], s23 offen offset:256 sc1
buffer_load_dwordx4 v[172:175], v126, s[8:11], s23 offen offset:2304 sc1
s_add_u32 s23, s23, 4096
buffer_load_dwordx4 v[176:179], v126, s[8:11], s23 offen offset:0 sc1
buffer_load_dwordx4 v[180:183], v126, s[8:11], s23 offen offset:2048 sc1
buffer_load_dwordx4 v[184:187], v126, s[8:11], s23 offen offset:256 sc1
buffer_load_dwordx4 v[188:191], v126, s[8:11], s23 offen offset:2304 sc1
s_add_u32 s23, s23, 4096
CA0_LATE_136:
buffer_load_dwordx4 v[192:195], v126, s[8:11], s23 offen offset:0 sc1
buffer_load_dwordx4 v[196:199], v126, s[8:11], s23 offen offset:2048 sc1
buffer_load_dwordx4 v[200:203], v126, s[8:11], s23 offen offset:256 sc1
buffer_load_dwordx4 v[204:207], v126, s[8:11], s23 offen offset:2304 sc1
s_add_u32 s23, s23, 4096
buffer_load_dwordx4 v[208:211], v126, s[8:11], s23 offen offset:0 sc1
buffer_load_dwordx4 v[212:215], v126, s[8:11], s23 offen offset:2048 sc1
buffer_load_dwordx4 v[216:219], v126, s[8:11], s23 offen offset:256 sc1
buffer_load_dwordx4 v[220:223], v126, s[8:11], s23 offen offset:2304 sc1
s_add_u32 s23, s23, 4096
buffer_load_dwordx4 v[224:227], v126, s[8:11], s23 offen offset:0 sc1
buffer_load_dwordx4 v[228:231], v126, s[8:11], s23 offen offset:2048 sc1
buffer_load_dwordx4 v[232:235], v126, s[8:11], s23 offen offset:256 sc1
buffer_load_dwordx4 v[236:239], v126, s[8:11], s23 offen offset:2304 sc1
s_add_u32 s23, s23, 4096
buffer_load_dwordx4 v[240:243], v126, s[8:11], s23 offen offset:0 sc1
buffer_load_dwordx4 v[244:247], v126, s[8:11], s23 offen offset:2048 sc1
buffer_load_dwordx4 v[248:251], v126, s[8:11], s23 offen offset:256 sc1
buffer_load_dwordx4 v[252:255], v126, s[8:11], s23 offen offset:2304 sc1
s_add_u32 s23, s23, 4096
v_readfirstlane_b32 s17, v129
s_add_u32 s18, s15, 100
s_cmp_gt_u32 s17, s18
s_cbranch_scc0 OPT_138
buffer_load_dword v137, v131, s[8:11], s25 offen sc1
OPT_138:
s_add_u32 s25, s25, 28672
s_branch CA0_LOOP_126
CA0_LOOP_126_end:
s_endpgm
MS_125_ab:
s_mov_b32 s16, 0
s_waitcnt vmcnt(0)
MS_125_slow:
CA0_LOOP_139:
s_and_b32 s17, s15, 3
s_mul_i32 s18, s17, 10240
s_add_u32 s22, s18, s31
s_add_u32 s17, s15, 3
s_and_b32 s17, s17, 3
s_mul_i32 s18, s17, 10240
s_add_u32 s32, s18, s31
v_mov_b64 v[112:113], 0
v_mov_b64 v[114:115], 0
v_mov_b64 v[116:117], 0
v_mov_b64 v[118:119], 0
v_mov_b64 v[120:121], 0
v_mov_b64 v[122:123], 0
s_and_b32 s17, s15, 3
s_mul_i32 s18, s17, 7168
s_add_u32 s21, s18, s30
v_mov_b64 v[28:29], 0
v_mov_b64 v[30:31], 0
v_mov_b64 v[32:33], 0
v_mov_b64 v[34:35], 0
v_mov_b64 v[36:37], 0
v_mov_b64 v[38:39], 0
s_add_u32 s34, s21, s33
s_waitcnt vmcnt(0)
buffer_load_dwordx4 v[40:43], v56, s[8:11], s21 offen sc1
buffer_load_dwordx4 v[44:47], v56, s[8:11], s34 offen sc1
s_sleep 3
PP_140:
buffer_load_dwordx4 v[48:51], v56, s[8:11], s21 offen sc1
buffer_load_dwordx4 v[52:55], v56, s[8:11], s34 offen sc1
s_waitcnt vmcnt(2)
ds_write_b128 v56, v[40:43] offset:0
ds_write_b128 v56, v[44:47] offset:4096
v_max3_u32 v61, v40, v41, v42
v_max3_u32 v61, v61, v43, v44
v_max3_u32 v61, v61, v45, v46
v_max_u32 v61, v61, v47
v_cmp_eq_u32 vcc, -1, v61
s_cbranch_vccz PP_140_d0
buffer_load_dwordx4 v[40:43], v56, s[8:11], s21 offen sc1
buffer_load_dwordx4 v[44:47], v56, s[8:11], s34 offen sc1
s_sub_u32 s16, s16, 1
s_cbranch_scc1 PP_140_abort
s_waitcnt vmcnt(2)
ds_write_b128 v56, v[48:51] offset:0
ds_write_b128 v56, v[52:55] offset:4096
v_max3_u32 v61, v48, v49, v50
v_max3_u32 v61, v61, v51, v52
v_max3_u32 v61, v61, v53, v54
v_max_u32 v61, v61, v55
v_cmp_eq_u32 vcc, -1, v61
s_cbranch_vccnz PP_140
PP_140_d1:
v_smfmac_f32_16x16x64_bf16 v[28:31], v[48:51], a[0:7], v57
v_smfmac_f32_16x16x64_bf16 v[32:35], v[48:51], a[56:63], v57
s_waitcnt lgkmcnt(0)
s_barrier
ds_read_b128 v[4:7], v58 offset:1024
ds_read_b128 v[8:11], v58 offset:2048
ds_read_b128 v[12:15], v58 offset:3072
v_smfmac_f32_16x16x64_bf16 v[36:39], v[48:51], a[112:119], v57
ds_read_b128 v[20:23], v58 offset:5120
ds_read_b128 v[24:27], v58 offset:6144
v_smfmac_f32_16x16x64_bf16 v[28:31], v[52:55], a[32:39], v57
ds_read_b128 v[0:3], v58 offset:0
ds_read_b128 v[16:19], v58 offset:4096
v_smfmac_f32_16x16x64_bf16 v[32:35], v[52:55], a[88:95], v57
ds_write2_b32 v63, v48, v49 offset0:0 offset1:2
ds_write2_b32 v63, v50, v51 offset0:32 offset1:34
v_smfmac_f32_16x16x64_bf16 v[36:39], v[52:55], a[144:151], v57
v_add_u32 v61, 4096, v63
ds_write2_b32 v61, v52, v53 offset0:0 offset1:2
ds_write2_b32 v61, v54, v55 offset0:32 offset1:34
s_branch PP_140_j
PP_140_d0:
v_smfmac_f32_16x16x64_bf16 v[28:31], v[40:43], a[0:7], v57
v_smfmac_f32_16x16x64_bf16 v[32:35], v[40:43], a[56:63], v57
s_waitcnt lgkmcnt(0)
s_barrier
ds_read_b128 v[4:7], v58 offset:1024
ds_read_b128 v[8:11], v58 offset:2048
ds_read_b128 v[12:15], v58 offset:3072
v_smfmac_f32_16x16x64_bf16 v[36:39], v[40:43], a[112:119], v57
ds_read_b128 v[20:23], v58 offset:5120
ds_read_b128 v[24:27], v58 offset:6144
v_smfmac_f32_16x16x64_bf16 v[28:31], v[44:47], a[32:39], v57
ds_read_b128 v[0:3], v58 offset:0
ds_read_b128 v[16:19], v58 offset:4096
v_smfmac_f32_16x16x64_bf16 v[32:35], v[44:47], a[88:95], v57
ds_write2_b32 v63, v40, v41 offset0:0 offset1:2
ds_write2_b32 v63, v42, v43 offset0:32 offset1:34
v_smfmac_f32_16x16x64_bf16 v[36:39], v[44:47], a[144:151], v57
v_add_u32 v61, 4096, v63
ds_write2_b32 v61, v44, v45 offset0:0 offset1:2
ds_write2_b32 v61, v46, v47 offset0:32 offset1:34
PP_140_j:
buffer_load_dword v129, off, s[8:11], s35 sc1
s_add_u32 s15, s15, 1
s_waitcnt lgkmcnt(10)
v_smfmac_f32_16x16x64_bf16 v[28:31], v[4:7], a[8:15], v57
v_smfmac_f32_16x16x64_bf16 v[32:35], v[4:7], a[64:71], v57
s_waitcnt lgkmcnt(9)
v_smfmac_f32_16x16x64_bf16 v[28:31], v[8:11], a[16:23], v57
v_smfmac_f32_16x16x64_bf16 v[32:35], v[8:11], a[72:79], v57
s_waitcnt lgkmcnt(8)
v_smfmac_f32_16x16x64_bf16 v[28:31], v[12:15], a[24:31], v57
v_smfmac_f32_16x16x64_bf16 v[32:35], v[12:15], a[80:87], v57
s_waitcnt lgkmcnt(7)
v_smfmac_f32_16x16x64_bf16 v[28:31], v[20:23], a[40:47], v57
s_waitcnt lgkmcnt(4)
v_smfmac_f32_16x16x64_bf16 v[32:35], v[20:23], a[96:103], v57
s_waitcnt lgkmcnt(6)
v_smfmac_f32_16x16x64_bf16 v[28:31], v[24:27], a[48:55], v57
v_mov_b64 v[140:141], 0
v_smfmac_f32_16x16x64_bf16 v[32:35], v[24:27], a[104:111], v57
v_mov_b64 v[142:143], 0
v_smfmac_f32_16x16x64_bf16 v[36:39], v[4:7], a[120:127], v57
s_nop 1
v_smfmac_f32_16x16x64_bf16 v[36:39], v[8:11], a[128:135], v57
s_nop 0
v_add_f32 v28, v28, v30
v_smfmac_f32_16x16x64_bf16 v[36:39], v[12:15], a[136:143], v57
v_add_f32 v29, v29, v31
v_smfmac_f32_16x16x64_bf16 v[36:39], v[20:23], a[152:159], v57
v_cvt_pk_bf16_f32 v28, v28, v29
ds_write_b32 v59, v28 offset:0
v_smfmac_f32_16x16x64_bf16 v[36:39], v[24:27], a[160:167], v57
v_add_f32 v32, v32, v34
v_smfmac_f32_16x16x64_bf16 v[140:143], v[4:7], a[176:183], v57
s_nop 0
v_add_f32 v33, v33, v35
v_smfmac_f32_16x16x64_bf16 v[140:143], v[8:11], a[184:191], v57
v_cvt_pk_bf16_f32 v32, v32, v33
ds_write_b32 v59, v32 offset:1024
v_smfmac_f32_16x16x64_bf16 v[140:143], v[12:15], a[192:199], v57
s_nop 0
v_add_f32 v36, v36, v38
s_waitcnt vmcnt(0)
v_readfirstlane_b32 s17, v129
v_smfmac_f32_16x16x64_bf16 v[140:143], v[20:23], a[208:215], v57
v_add_f32 v37, v37, v39
v_smfmac_f32_16x16x64_bf16 v[140:143], v[24:27], a[216:223], v57
v_cvt_pk_bf16_f32 v36, v36, v37
ds_write_b32 v59, v36 offset:2048
v_smfmac_f32_16x16x64_bf16 v[140:143], v[0:3], a[168:175], v57
s_cmp_gt_u32 s17, s15
s_cselect_b32 s38, 1, 0
v_smfmac_f32_16x16x64_bf16 v[140:143], v[16:19], a[200:207], v57
v_add_u32 v62, 1, v62
ds_read_b32 v136, v60
ds_read_b64_tr_b16 v[64:65], v124 offset:0
ds_read_b64_tr_b16 v[66:67], v124 offset:128
ds_read_b128 v[80:83], v125 offset:20480
ds_read_b128 v[84:87], v125 offset:20992
ds_read_b64_tr_b16 v[68:69], v124 offset:1024
ds_read_b64_tr_b16 v[70:71], v124 offset:1152
ds_read_b128 v[88:91], v125 offset:21504
ds_read_b128 v[92:95], v125 offset:22016
ds_read_b64_tr_b16 v[72:73], v124 offset:2048
ds_read_b64_tr_b16 v[74:75], v124 offset:2176
ds_read_b128 v[96:99], v125 offset:22528
ds_read_b128 v[100:103], v125 offset:23040
v_pk_add_f32 v[140:141], v[140:141], v[142:143]
v_cvt_pk_bf16_f32 v140, v140, v141
s_waitcnt lgkmcnt(12)
v_cmp_lt_u32 vcc, v136, v62
s_cbranch_vccnz CA_PW_141
CA_PW_141_ok:
s_waitcnt lgkmcnt(8)
v_smfmac_f32_16x16x64_bf16 v[112:115], v[64:67], v[144:151], v57
v_smfmac_f32_16x16x64_bf16 v[116:119], v[64:67], v[152:159], v57
v_smfmac_f32_16x16x64_bf16 v[120:123], v[64:67], v[80:87], v57
s_waitcnt lgkmcnt(4)
v_smfmac_f32_16x16x64_bf16 v[112:115], v[68:71], v[160:167], v57
v_smfmac_f32_16x16x64_bf16 v[116:119], v[68:71], v[168:175], v57
v_smfmac_f32_16x16x64_bf16 v[120:123], v[68:71], v[88:95], v57
s_waitcnt lgkmcnt(0)
ds_write_b32 v59, v140 offset:3072
v_add_u32 v62, 1, v62
ds_read_b32 v136, v60
ds_read_b64_tr_b16 v[76:77], v124 offset:3072
ds_read_b64_tr_b16 v[78:79], v124 offset:3200
ds_read_b128 v[104:107], v125 offset:23552
ds_read_b128 v[108:111], v125 offset:24064
v_smfmac_f32_16x16x64_bf16 v[112:115], v[72:75], v[176:183], v57
v_smfmac_f32_16x16x64_bf16 v[116:119], v[72:75], v[184:191], v57
v_smfmac_f32_16x16x64_bf16 v[120:123], v[72:75], v[96:103], v57
s_waitcnt lgkmcnt(4)
v_cmp_lt_u32 vcc, v136, v62
s_cbranch_vccnz CA_PW_142
CA_PW_142_ok:
s_waitcnt lgkmcnt(0)
v_smfmac_f32_16x16x64_bf16 v[112:115], v[76:79], v[192:199], v57
v_smfmac_f32_16x16x64_bf16 v[116:119], v[76:79], v[200:207], v57
v_smfmac_f32_16x16x64_bf16 v[120:123], v[76:79], v[104:111], v57
ds_read_b128 v[80:83], v125 offset:24576
ds_read_b128 v[84:87], v125 offset:25088
ds_read_b128 v[88:91], v125 offset:25600
ds_read_b128 v[92:95], v125 offset:26112
ds_read_b128 v[96:99], v125 offset:26624
ds_read_b128 v[100:103], v125 offset:27136
s_cmp_eq_u32 s38, 1
s_cbranch_scc0 OPT_143
buffer_load_dwordx4 v[144:147], v126, s[8:11], s23 offen offset:0 sc1
buffer_load_dwordx4 v[148:151], v126, s[8:11], s23 offen offset:2048 sc1
buffer_load_dwordx4 v[152:155], v126, s[8:11], s23 offen offset:256 sc1
buffer_load_dwordx4 v[156:159], v126, s[8:11], s23 offen offset:2304 sc1
s_add_u32 s23, s23, 4096
OPT_143:
v_add_u32 v62, 1, v62
ds_read_b32 v136, v60
ds_read_b64_tr_b16 v[64:65], v124 offset:4096
ds_read_b64_tr_b16 v[66:67], v124 offset:4224
s_cmp_eq_u32 s38, 1
s_cbranch_scc0 OPT_144
buffer_load_dwordx4 v[160:163], v126, s[8:11], s23 offen offset:0 sc1
buffer_load_dwordx4 v[164:167], v126, s[8:11], s23 offen offset:2048 sc1
buffer_load_dwordx4 v[168:171], v126, s[8:11], s23 offen offset:256 sc1
buffer_load_dwordx4 v[172:175], v126, s[8:11], s23 offen offset:2304 sc1
s_add_u32 s23, s23, 4096
OPT_144:
s_waitcnt lgkmcnt(2)
v_cmp_lt_u32 vcc, v136, v62
s_cbranch_vccnz CA_PW_145
CA_PW_145_ok:
s_waitcnt lgkmcnt(0)
v_smfmac_f32_16x16x64_bf16 v[112:115], v[64:67], v[208:215], v57
v_smfmac_f32_16x16x64_bf16 v[116:119], v[64:67], v[216:223], v57
v_smfmac_f32_16x16x64_bf16 v[120:123], v[64:67], v[80:87], v57
v_add_u32 v62, 1, v62
ds_read_b32 v136, v60
ds_read_b64_tr_b16 v[68:69], v124 offset:5120
ds_read_b64_tr_b16 v[70:71], v124 offset:5248
s_cmp_eq_u32 s38, 1
s_cbranch_scc0 OPT_146
buffer_load_dwordx4 v[176:179], v126, s[8:11], s23 offen offset:0 sc1
buffer_load_dwordx4 v[180:183], v126, s[8:11], s23 offen offset:2048 sc1
buffer_load_dwordx4 v[184:187], v126, s[8:11], s23 offen offset:256 sc1
buffer_load_dwordx4 v[188:191], v126, s[8:11], s23 offen offset:2304 sc1
s_add_u32 s23, s23, 4096
OPT_146:
s_waitcnt lgkmcnt(2)
v_cmp_lt_u32 vcc, v136, v62
s_cbranch_vccnz CA_PW_147
CA_PW_147_ok:
s_waitcnt lgkmcnt(0)
v_mov_b32 v137, s15
v_add_u32 v62, 1, v62
ds_read_b32 v136, v60
ds_read_b64_tr_b16 v[72:73], v124 offset:6144
ds_read_b64_tr_b16 v[74:75], v124 offset:6272
v_smfmac_f32_16x16x64_bf16 v[112:115], v[68:71], v[224:231], v57
v_smfmac_f32_16x16x64_bf16 v[116:119], v[68:71], v[232:239], v57
v_smfmac_f32_16x16x64_bf16 v[120:123], v[68:71], v[88:95], v57
s_waitcnt lgkmcnt(2)
v_cmp_lt_u32 vcc, v136, v62
s_cbranch_vccnz CA_PW_148
CA_PW_148_ok:
s_waitcnt lgkmcnt(0)
v_smfmac_f32_16x16x64_bf16 v[112:115], v[72:75], v[240:247], v57
v_smfmac_f32_16x16x64_bf16 v[116:119], v[72:75], v[248:255], v57
v_smfmac_f32_16x16x64_bf16 v[120:123], v[72:75], v[96:103], v57
s_nop 5
v_pk_add_f32 v[112:113], v[112:113], v[114:115]
v_pk_add_f32 v[116:117], v[116:117], v[118:119]
v_pk_add_f32 v[120:121], v[120:121], v[122:123]
v_max3_f32 v132, v112, v116, v120
v_max3_f32 v133, v113, v117, v121
s_nop 0
v_max_f32_dpp v132, v132, v132 row_ror:8 row_mask:0xf bank_mask:0xf
v_max_f32_dpp v133, v133, v133 row_ror:8 row_mask:0xf bank_mask:0xf
s_nop 0
v_max_f32_dpp v132, v132, v132 row_ror:4 row_mask:0xf bank_mask:0xf
v_max_f32_dpp v133, v133, v133 row_ror:4 row_mask:0xf bank_mask:0xf
s_nop 0
v_max_f32_dpp v132, v132, v132 row_ror:2 row_mask:0xf bank_mask:0xf
v_max_f32_dpp v133, v133, v133 row_ror:2 row_mask:0xf bank_mask:0xf
s_nop 0
v_max_f32_dpp v132, v132, v132 row_ror:1 row_mask:0xf bank_mask:0xf
v_max_f32_dpp v133, v133, v133 row_ror:1 row_mask:0xf bank_mask:0xf
v_pk_add_f32 v[112:113], v[112:113], v[132:133] neg_lo:[0,1] neg_hi:[0,1]
v_pk_add_f32 v[116:117], v[116:117], v[132:133] neg_lo:[0,1] neg_hi:[0,1]
v_pk_add_f32 v[120:121], v[120:121], v[132:133] neg_lo:[0,1] neg_hi:[0,1]
v_exp_f32 v112, v112
v_exp_f32 v116, v116
v_exp_f32 v120, v120
v_add_f32 v134, v112, v116
v_exp_f32 v113, v113
v_fma_f32 v134, v120, 0.5, v134
v_exp_f32 v117, v117
v_exp_f32 v121, v121
v_add_f32_dpp v134, v134, v134 row_ror:8 row_mask:0xf bank_mask:0xf
v_add_f32 v135, v113, v117
v_fma_f32 v135, v121, 0.5, v135
v_add_f32_dpp v134, v134, v134 row_ror:4 row_mask:0xf bank_mask:0xf
v_cndmask_b32 v120, v120, v121, s[28:29]
v_add_f32_dpp v135, v135, v135 row_ror:8 row_mask:0xf bank_mask:0xf
v_add_f32_dpp v134, v134, v134 row_ror:2 row_mask:0xf bank_mask:0xf
v_mov_b32_dpp v121, v120 quad_perm:[1,0,3,2] row_mask:0xf bank_mask:0xf
v_add_f32_dpp v135, v135, v135 row_ror:4 row_mask:0xf bank_mask:0xf
v_add_f32_dpp v134, v134, v134 row_ror:1 row_mask:0xf bank_mask:0xf
v_rcp_f32 v134, v134
v_add_f32_dpp v135, v135, v135 row_ror:2 row_mask:0xf bank_mask:0xf
v_mul_f32 v112, v112, v134 clamp
v_mul_f32 v116, v116, v134 clamp
v_add_f32_dpp v135, v135, v135 row_ror:1 row_mask:0xf bank_mask:0xf
v_cvt_pk_bf16_f32 v112, v112, v116
v_rcp_f32 v135, v135
buffer_store_dword v112, v127, s[8:11], s22 offen sc1
v_mul_f32 v113, v113, v135 clamp
v_mul_f32 v117, v117, v135 clamp
v_cndmask_b32 v134, v134, v135, s[28:29]
v_cvt_pk_bf16_f32 v113, v113, v117
v_pk_mul_f32 v[120:121], v[120:121], v[134:135] op_sel_hi:[1,0] clamp
buffer_store_dword v113, v127, s[8:11], s22 offen offset:16 sc1
v_cvt_pk_bf16_f32 v120, v120, v121
s_mov_b64 exec, s[36:37]
buffer_store_dword v120, v128, s[8:11], s22 offen sc1
s_mov_b64 exec, -1
s_barrier
s_cmp_ge_u32 s15, 63
s_cbranch_scc1 CA0_LOOP_139_end
s_cmp_eq_u32 s38, 1
s_cbranch_scc1 CA0_LATE_149
PG_150:
v_readfirstlane_b32 s17, v129
s_nop 0
s_cmp_gt_u32 s17, s15
s_nop 1
s_cbranch_scc0 PG_150_slow
PG_150_ok:
buffer_load_dwordx4 v[144:147], v126, s[8:11], s23 offen offset:0 sc1
buffer_load_dwordx4 v[148:151], v126, s[8:11], s23 offen offset:2048 sc1
buffer_load_dwordx4 v[152:155], v126, s[8:11], s23 offen offset:256 sc1
buffer_load_dwordx4 v[156:159], v126, s[8:11], s23 offen offset:2304 sc1
s_add_u32 s23, s23, 4096
buffer_load_dwordx4 v[160:163], v126, s[8:11], s23 offen offset:0 sc1
buffer_load_dwordx4 v[164:167], v126, s[8:11], s23 offen offset:2048 sc1
buffer_load_dwordx4 v[168:171], v126, s[8:11], s23 offen offset:256 sc1
buffer_load_dwordx4 v[172:175], v126, s[8:11], s23 offen offset:2304 sc1
s_add_u32 s23, s23, 4096
buffer_load_dwordx4 v[176:179], v126, s[8:11], s23 offen offset:0 sc1
buffer_load_dwordx4 v[180:183], v126, s[8:11], s23 offen offset:2048 sc1
buffer_load_dwordx4 v[184:187], v126, s[8:11], s23 offen offset:256 sc1
buffer_load_dwordx4 v[188:191], v126, s[8:11], s23 offen offset:2304 sc1
s_add_u32 s23, s23, 4096
CA0_LATE_149:
buffer_load_dwordx4 v[192:195], v126, s[8:11], s23 offen offset:0 sc1
buffer_load_dwordx4 v[196:199], v126, s[8:11], s23 offen offset:2048 sc1
buffer_load_dwordx4 v[200:203], v126, s[8:11], s23 offen offset:256 sc1
buffer_load_dwordx4 v[204:207], v126, s[8:11], s23 offen offset:2304 sc1
s_add_u32 s23, s23, 4096
buffer_load_dwordx4 v[208:211], v126, s[8:11], s23 offen offset:0 sc1
buffer_load_dwordx4 v[212:215], v126, s[8:11], s23 offen offset:2048 sc1
buffer_load_dwordx4 v[216:219], v126, s[8:11], s23 offen offset:256 sc1
buffer_load_dwordx4 v[220:223], v126, s[8:11], s23 offen offset:2304 sc1
s_add_u32 s23, s23, 4096
buffer_load_dwordx4 v[224:227], v126, s[8:11], s23 offen offset:0 sc1
buffer_load_dwordx4 v[228:231], v126, s[8:11], s23 offen offset:2048 sc1
buffer_load_dwordx4 v[232:235], v126, s[8:11], s23 offen offset:256 sc1
buffer_load_dwordx4 v[236:239], v126, s[8:11], s23 offen offset:2304 sc1
s_add_u32 s23, s23, 4096
buffer_load_dwordx4 v[240:243], v126, s[8:11], s23 offen offset:0 sc1
buffer_load_dwordx4 v[244:247], v126, s[8:11], s23 offen offset:2048 sc1
buffer_load_dwordx4 v[248:251], v126, s[8:11], s23 offen offset:256 sc1
buffer_load_dwordx4 v[252:255], v126, s[8:11], s23 offen offset:2304 sc1
s_add_u32 s23, s23, 4096
v_readfirstlane_b32 s17, v129
s_add_u32 s18, s15, 100
s_cmp_gt_u32 s17, s18
s_cbranch_scc0 OPT_151
buffer_load_dword v137, v131, s[8:11], s25 offen sc1
OPT_151:
s_add_u32 s25, s25, 28672
s_branch CA0_LOOP_139
CA0_LOOP_139_end:
s_endpgm
M_CB:
s_sub_u32 s13, s13, 16
s_lshl_b32 s17, s13, 2
s_add_u32 s17, s17, s12
s_mul_i32 s17, s12, 56
s_add_u32 s17, s17, s13
s_mul_i32 s17, s17, 28672
s_add_u32 s19, s17, 7340032
v_lshrrev_b32 v123, 4, v1
v_lshlrev_b32 v123, 9, v123
v_and_b32 v122, 15, v1
v_lshl_add_u32 v123, v122, 4, v123
v_lshlrev_b32 v124, 4, v1
s_lshl_b32 s20, s12, 14
s_add_u32 s20, s20, 12288
v_and_b32 v120, 3, v1
v_lshlrev_b32 v120, 7, v120
s_lshl_b32 s17, s12, 9
s_lshl_b32 s18, s13, 2
s_add_u32 s17, s17, s18
s_add_u32 s17, s17, 14336
v_add_u32 v120, s17, v120
s_mov_b32 s58, 38797312
s_branch WF_152_in
WF_152:
s_sleep 12
WF_152_in:
buffer_load_dword v2, v120, s[8:11], s58 offen sc1
s_sub_u32 s16, s16, 1
s_cbranch_scc1 WFD_153_abort
s_waitcnt vmcnt(0)
v_cmp_eq_u32 vcc, 0, v2
s_cbranch_vccnz WF_152
WFD_153:
s_add_u32 s58, s58, 2048
buffer_load_dword v2, v120, s[8:11], s58 offen sc1
s_add_u32 s26, s19, 0
buffer_load_dwordx4 a[0:3], v123, s[8:11], s26 offen offset:0 sc1
buffer_load_dwordx4 a[4:7], v123, s[8:11], s26 offen offset:2048 sc1
s_add_u32 s26, s19, 256
buffer_load_dwordx4 a[48:51], v123, s[8:11], s26 offen offset:0 sc1
buffer_load_dwordx4 a[52:55], v123, s[8:11], s26 offen offset:2048 sc1
s_add_u32 s26, s19, 401408
buffer_load_dwordx4 a[96:99], v123, s[8:11], s26 offen offset:0 sc1
buffer_load_dwordx4 a[100:103], v123, s[8:11], s26 offen offset:2048 sc1
s_add_u32 s26, s19, 401664
buffer_load_dwordx4 a[144:147], v123, s[8:11], s26 offen offset:0 sc1
buffer_load_dwordx4 a[148:151], v123, s[8:11], s26 offen offset:2048 sc1
s_add_u32 s26, s19, 802816
buffer_load_dwordx4 a[192:195], v123, s[8:11], s26 offen offset:0 sc1
buffer_load_dwordx4 a[196:199], v123, s[8:11], s26 offen offset:2048 sc1
s_add_u32 s26, s19, 803072
buffer_load_dwordx4 a[240:243], v123, s[8:11], s26 offen offset:0 sc1
buffer_load_dwordx4 a[244:247], v123, s[8:11], s26 offen offset:2048 sc1
s_add_u32 s26, s19, 1204224
buffer_load_dwordx4 v[160:163], v123, s[8:11], s26 offen offset:0 sc1
buffer_load_dwordx4 v[164:167], v123, s[8:11], s26 offen offset:2048 sc1
s_add_u32 s26, s19, 1204480
buffer_load_dwordx4 v[208:211], v123, s[8:11], s26 offen offset:0 sc1
buffer_load_dwordx4 v[212:215], v123, s[8:11], s26 offen offset:2048 sc1
s_waitcnt vmcnt(16)
v_cmp_eq_u32 vcc, 0, v2
s_cbranch_vccz OPT_154
s_nop 2
s_branch WF_155_in
WF_155:
s_sleep 12
WF_155_in:
buffer_load_dword v2, v120, s[8:11], s58 offen sc1
s_sub_u32 s16, s16, 1
s_cbranch_scc1 WFD_156_abort
s_waitcnt vmcnt(0)
v_cmp_eq_u32 vcc, 0, v2
s_cbranch_vccnz WF_155
WFD_156:
OPT_154:
s_add_u32 s58, s58, 2048
buffer_load_dword v2, v120, s[8:11], s58 offen sc1
s_add_u32 s26, s19, 4096
buffer_load_dwordx4 a[8:11], v123, s[8:11], s26 offen offset:0 sc1
buffer_load_dwordx4 a[12:15], v123, s[8:11], s26 offen offset:2048 sc1
s_add_u32 s26, s19, 4352
buffer_load_dwordx4 a[56:59], v123, s[8:11], s26 offen offset:0 sc1
buffer_load_dwordx4 a[60:63], v123, s[8:11], s26 offen offset:2048 sc1
s_add_u32 s26, s19, 405504
buffer_load_dwordx4 a[104:107], v123, s[8:11], s26 offen offset:0 sc1
buffer_load_dwordx4 a[108:111], v123, s[8:11], s26 offen offset:2048 sc1
s_add_u32 s26, s19, 405760
buffer_load_dwordx4 a[152:155], v123, s[8:11], s26 offen offset:0 sc1
buffer_load_dwordx4 a[156:159], v123, s[8:11], s26 offen offset:2048 sc1
s_add_u32 s26, s19, 806912
buffer_load_dwordx4 a[200:203], v123, s[8:11], s26 offen offset:0 sc1
buffer_load_dwordx4 a[204:207], v123, s[8:11], s26 offen offset:2048 sc1
s_add_u32 s26, s19, 807168
buffer_load_dwordx4 a[248:251], v123, s[8:11], s26 offen offset:0 sc1
buffer_load_dwordx4 a[252:255], v123, s[8:11], s26 offen offset:2048 sc1
s_add_u32 s26, s19, 1208320
buffer_load_dwordx4 v[168:171], v123, s[8:11], s26 offen offset:0 sc1
buffer_load_dwordx4 v[172:175], v123, s[8:11], s26 offen offset:2048 sc1
s_add_u32 s26, s19, 1208576
buffer_load_dwordx4 v[216:219], v123, s[8:11], s26 offen offset:0 sc1
buffer_load_dwordx4 v[220:223], v123, s[8:11], s26 offen offset:2048 sc1
s_waitcnt vmcnt(16)
v_cmp_eq_u32 vcc, 0, v2
s_cbranch_vccz OPT_157
s_nop 2
s_branch WF_158_in
WF_158:
s_sleep 12
WF_158_in:
buffer_load_dword v2, v120, s[8:11], s58 offen sc1
s_sub_u32 s16, s16, 1
s_cbranch_scc1 WFD_159_abort
s_waitcnt vmcnt(0)
v_cmp_eq_u32 vcc, 0, v2
s_cbranch_vccnz WF_158
WFD_159:
OPT_157:
s_add_u32 s58, s58, 2048
buffer_load_dword v2, v120, s[8:11], s58 offen sc1
s_add_u32 s26, s19, 8192
buffer_load_dwordx4 a[16:19], v123, s[8:11], s26 offen offset:0 sc1
buffer_load_dwordx4 a[20:23], v123, s[8:11], s26 offen offset:2048 sc1
s_add_u32 s26, s19, 8448
buffer_load_dwordx4 a[64:67], v123, s[8:11], s26 offen offset:0 sc1
buffer_load_dwordx4 a[68:71], v123, s[8:11], s26 offen offset:2048 sc1
s_add_u32 s26, s19, 409600
buffer_load_dwordx4 a[112:115], v123, s[8:11], s26 offen offset:0 sc1
buffer_load_dwordx4 a[116:119], v123, s[8:11], s26 offen offset:2048 sc1
s_add_u32 s26, s19, 409856
buffer_load_dwordx4 a[160:163], v123, s[8:11], s26 offen offset:0 sc1
buffer_load_dwordx4 a[164:167], v123, s[8:11], s26 offen offset:2048 sc1
s_add_u32 s26, s19, 811008
buffer_load_dwordx4 a[208:211], v123, s[8:11], s26 offen offset:0 sc1
buffer_load_dwordx4 a[212:215], v123, s[8:11], s26 offen offset:2048 sc1
s_add_u32 s26, s19, 811264
buffer_load_dwordx4 v[128:131], v123, s[8:11], s26 offen offset:0 sc1
buffer_load_dwordx4 v[132:135], v123, s[8:11], s26 offen offset:2048 sc1
s_add_u32 s26, s19, 1212416
buffer_load_dwordx4 v[176:179], v123, s[8:11], s26 offen offset:0 sc1
buffer_load_dwordx4 v[180:183], v123, s[8:11], s26 offen offset:2048 sc1
s_add_u32 s26, s19, 1212672
buffer_load_dwordx4 v[224:227], v123, s[8:11], s26 offen offset:0 sc1
buffer_load_dwordx4 v[228:231], v123, s[8:11], s26 offen offset:2048 sc1
s_waitcnt vmcnt(16)
v_cmp_eq_u32 vcc, 0, v2
s_cbranch_vccz OPT_160
s_nop 2
s_branch WF_161_in
WF_161:
s_sleep 12
WF_161_in:
buffer_load_dword v2, v120, s[8:11], s58 offen sc1
s_sub_u32 s16, s16, 1
s_cbranch_scc1 WFD_162_abort
s_waitcnt vmcnt(0)
v_cmp_eq_u32 vcc, 0, v2
s_cbranch_vccnz WF_161
WFD_162:
OPT_160:
s_add_u32 s58, s58, 2048
buffer_load_dword v2, v120, s[8:11], s58 offen sc1
s_add_u32 s26, s19, 12288
buffer_load_dwordx4 a[24:27], v123, s[8:11], s26 offen offset:0 sc1
buffer_load_dwordx4 a[28:31], v123, s[8:11], s26 offen offset:2048 sc1
s_add_u32 s26, s19, 12544
buffer_load_dwordx4 a[72:75], v123, s[8:11], s26 offen offset:0 sc1
buffer_load_dwordx4 a[76:79], v123, s[8:11], s26 offen offset:2048 sc1
s_add_u32 s26, s19, 413696
buffer_load_dwordx4 a[120:123], v123, s[8:11], s26 offen offset:0 sc1
buffer_load_dwordx4 a[124:127], v123, s[8:11], s26 offen offset:2048 sc1
s_add_u32 s26, s19, 413952
buffer_load_dwordx4 a[168:171], v123, s[8:11], s26 offen offset:0 sc1
buffer_load_dwordx4 a[172:175], v123, s[8:11], s26 offen offset:2048 sc1
s_add_u32 s26, s19, 815104
buffer_load_dwordx4 a[216:219], v123, s[8:11], s26 offen offset:0 sc1
buffer_load_dwordx4 a[220:223], v123, s[8:11], s26 offen offset:2048 sc1
s_add_u32 s26, s19, 815360
buffer_load_dwordx4 v[136:139], v123, s[8:11], s26 offen offset:0 sc1
buffer_load_dwordx4 v[140:143], v123, s[8:11], s26 offen offset:2048 sc1
s_add_u32 s26, s19, 1216512
buffer_load_dwordx4 v[184:187], v123, s[8:11], s26 offen offset:0 sc1
buffer_load_dwordx4 v[188:191], v123, s[8:11], s26 offen offset:2048 sc1
s_add_u32 s26, s19, 1216768
buffer_load_dwordx4 v[232:235], v123, s[8:11], s26 offen offset:0 sc1
buffer_load_dwordx4 v[236:239], v123, s[8:11], s26 offen offset:2048 sc1
s_waitcnt vmcnt(16)
v_cmp_eq_u32 vcc, 0, v2
s_cbranch_vccz OPT_163
s_nop 2
s_branch WF_164_in
WF_164:
s_sleep 12
WF_164_in:
buffer_load_dword v2, v120, s[8:11], s58 offen sc1
s_sub_u32 s16, s16, 1
s_cbranch_scc1 WFD_165_abort
s_waitcnt vmcnt(0)
v_cmp_eq_u32 vcc, 0, v2
s_cbranch_vccnz WF_164
WFD_165:
OPT_163:
s_add_u32 s58, s58, 2048
buffer_load_dword v2, v120, s[8:11], s58 offen sc1
s_add_u32 s26, s19, 16384
buffer_load_dwordx4 a[32:35], v123, s[8:11], s26 offen offset:0 sc1
buffer_load_dwordx4 a[36:39], v123, s[8:11], s26 offen offset:2048 sc1
s_add_u32 s26, s19, 16640
buffer_load_dwordx4 a[80:83], v123, s[8:11], s26 offen offset:0 sc1
buffer_load_dwordx4 a[84:87], v123, s[8:11], s26 offen offset:2048 sc1
s_add_u32 s26, s19, 417792
buffer_load_dwordx4 a[128:131], v123, s[8:11], s26 offen offset:0 sc1
buffer_load_dwordx4 a[132:135], v123, s[8:11], s26 offen offset:2048 sc1
s_add_u32 s26, s19, 418048
buffer_load_dwordx4 a[176:179], v123, s[8:11], s26 offen offset:0 sc1
buffer_load_dwordx4 a[180:183], v123, s[8:11], s26 offen offset:2048 sc1
s_add_u32 s26, s19, 819200
buffer_load_dwordx4 a[224:227], v123, s[8:11], s26 offen offset:0 sc1
buffer_load_dwordx4 a[228:231], v123, s[8:11], s26 offen offset:2048 sc1
s_add_u32 s26, s19, 819456
buffer_load_dwordx4 v[144:147], v123, s[8:11], s26 offen offset:0 sc1
buffer_load_dwordx4 v[148:151], v123, s[8:11], s26 offen offset:2048 sc1
s_add_u32 s26, s19, 1220608
buffer_load_dwordx4 v[192:195], v123, s[8:11], s26 offen offset:0 sc1
buffer_load_dwordx4 v[196:199], v123, s[8:11], s26 offen offset:2048 sc1
s_add_u32 s26, s19, 1220864
buffer_load_dwordx4 v[240:243], v123, s[8:11], s26 offen offset:0 sc1
buffer_load_dwordx4 v[244:247], v123, s[8:11], s26 offen offset:2048 sc1
s_waitcnt vmcnt(16)
v_cmp_eq_u32 vcc, 0, v2
s_cbranch_vccz OPT_166
s_nop 2
s_branch WF_167_in
WF_167:
s_sleep 12
WF_167_in:
buffer_load_dword v2, v120, s[8:11], s58 offen sc1
s_sub_u32 s16, s16, 1
s_cbranch_scc1 WFD_168_abort
s_waitcnt vmcnt(0)
v_cmp_eq_u32 vcc, 0, v2
s_cbranch_vccnz WF_167
WFD_168:
OPT_166:
s_getpc_b64 s[54:55]
WCODE_169:
s_sub_u32 s54, s54, WCODE_169-K_START
s_subb_u32 s55, s55, 0
v_mbcnt_lo_u32_b32 v2, -1, 0
v_mbcnt_hi_u32_b32 v2, -1, v2
v_lshl_add_u32 v2, v2, 5, s91
v_lshlrev_b32 v2, 6, v2
v_min_u32 v2, K_END-K_START-4, v2
global_load_dword v2, v2, s[54:55]
s_add_u32 s58, s58, 2048
buffer_load_dword v2, v120, s[8:11], s58 offen sc1
s_add_u32 s26, s19, 20480
buffer_load_dwordx4 a[40:43], v123, s[8:11], s26 offen offset:0 sc1
buffer_load_dwordx4 a[44:47], v123, s[8:11], s26 offen offset:2048 sc1
s_add_u32 s26, s19, 20736
buffer_load_dwordx4 a[88:91], v123, s[8:11], s26 offen offset:0 sc1
buffer_load_dwordx4 a[92:95], v123, s[8:11], s26 offen offset:2048 sc1
s_add_u32 s26, s19, 421888
buffer_load_dwordx4 a[136:139], v123, s[8:11], s26 offen offset:0 sc1
buffer_load_dwordx4 a[140:143], v123, s[8:11], s26 offen offset:2048 sc1
s_add_u32 s26, s19, 422144
buffer_load_dwordx4 a[184:187], v123, s[8:11], s26 offen offset:0 sc1
buffer_load_dwordx4 a[188:191], v123, s[8:11], s26 offen offset:2048 sc1
s_add_u32 s26, s19, 823296
buffer_load_dwordx4 a[232:235], v123, s[8:11], s26 offen offset:0 sc1
buffer_load_dwordx4 a[236:239], v123, s[8:11], s26 offen offset:2048 sc1
s_add_u32 s26, s19, 823552
buffer_load_dwordx4 v[152:155], v123, s[8:11], s26 offen offset:0 sc1
buffer_load_dwordx4 v[156:159], v123, s[8:11], s26 offen offset:2048 sc1
s_add_u32 s26, s19, 1224704
buffer_load_dwordx4 v[200:203], v123, s[8:11], s26 offen offset:0 sc1
buffer_load_dwordx4 v[204:207], v123, s[8:11], s26 offen offset:2048 sc1
s_add_u32 s26, s19, 1224960
buffer_load_dwordx4 v[248:251], v123, s[8:11], s26 offen offset:0 sc1
buffer_load_dwordx4 v[252:255], v123, s[8:11], s26 offen offset:2048 sc1
s_waitcnt vmcnt(16)
v_cmp_eq_u32 vcc, 0, v2
s_cbranch_vccz OPT_170
s_nop 2
s_branch WF_171_in
WF_171:
s_sleep 12
WF_171_in:
buffer_load_dword v2, v120, s[8:11], s58 offen sc1
s_sub_u32 s16, s16, 1
s_cbranch_scc1 WFD_172_abort
s_waitcnt vmcnt(0)
v_cmp_eq_u32 vcc, 0, v2
s_cbranch_vccnz WF_171
WFD_172:
OPT_170:
buffer_load_dword v120, off, s[92:95], 0 offset:16 sc1
s_add_u32 s26, s19, 24576
s_add_u32 m0, s20, 0
s_nop 0
buffer_load_dwordx4 v123, s[8:11], s26 offen sc1 lds
s_add_u32 s26, s19, 26624
s_add_u32 m0, s20, 1024
s_nop 0
buffer_load_dwordx4 v123, s[8:11], s26 offen sc1 lds
s_add_u32 s26, s19, 24832
s_add_u32 m0, s20, 2048
s_nop 0
buffer_load_dwordx4 v123, s[8:11], s26 offen sc1 lds
s_add_u32 s26, s19, 26880
s_add_u32 m0, s20, 3072
s_nop 0
buffer_load_dwordx4 v123, s[8:11], s26 offen sc1 lds
s_add_u32 s26, s19, 425984
s_add_u32 m0, s20, 4096
s_nop 0
buffer_load_dwordx4 v123, s[8:11], s26 offen sc1 lds
s_add_u32 s26, s19, 428032
s_add_u32 m0, s20, 5120
s_nop 0
buffer_load_dwordx4 v123, s[8:11], s26 offen sc1 lds
s_add_u32 s26, s19, 426240
s_add_u32 m0, s20, 6144
s_nop 0
buffer_load_dwordx4 v123, s[8:11], s26 offen sc1 lds
s_add_u32 s26, s19, 428288
s_add_u32 m0, s20, 7168
s_nop 0
buffer_load_dwordx4 v123, s[8:11], s26 offen sc1 lds
s_add_u32 s26, s19, 827392
s_add_u32 m0, s20, 8192
s_nop 0
buffer_load_dwordx4 v123, s[8:11], s26 offen sc1 lds
s_add_u32 s26, s19, 829440
s_add_u32 m0, s20, 9216
s_nop 0
buffer_load_dwordx4 v123, s[8:11], s26 offen sc1 lds
s_add_u32 s26, s19, 827648
s_add_u32 m0, s20, 10240
s_nop 0
buffer_load_dwordx4 v123, s[8:11], s26 offen sc1 lds
s_add_u32 s26, s19, 829696
s_add_u32 m0, s20, 11264
s_nop 0
buffer_load_dwordx4 v123, s[8:11], s26 offen sc1 lds
s_add_u32 s26, s19, 1228800
s_add_u32 m0, s20, 12288
s_nop 0
buffer_load_dwordx4 v123, s[8:11], s26 offen sc1 lds
s_add_u32 s26, s19, 1230848
s_add_u32 m0, s20, 13312
s_nop 0
buffer_load_dwordx4 v123, s[8:11], s26 offen sc1 lds
s_add_u32 s26, s19, 1229056
s_add_u32 m0, s20, 14336
s_nop 0
buffer_load_dwordx4 v123, s[8:11], s26 offen sc1 lds
s_add_u32 s26, s19, 1231104
s_add_u32 m0, s20, 15360
s_nop 0
buffer_load_dwordx4 v123, s[8:11], s26 offen sc1 lds
s_waitcnt vmcnt(16)
PL_I_173:
v_cmp_gt_u32 vcc, 32, v120
s_cbranch_vccnz PL_I_173_p
PL_I_173_ok:
s_lshl_b32 s17, s12, 10
s_cmp_eq_u32 s12, 3
s_cselect_b32 s33, 3, 4
s_lshl_b32 s33, s33, 10
v_lshlrev_b32 v120, 4, v1
v_add_u32 v120, s17, v120
v_lshrrev_b32 v2, 4, v1
v_and_b32 v3, 15, v1
v_and_b32 v122, 2, v1
v_cmp_eq_u32 vcc, 2, v122
v_mov_b32 v122, 0x44444444
v_mov_b32 v123, 0xeeeeeeee
v_cndmask_b32 v122, v122, v123, vcc
v_bfe_u32 v123, v1, 1, 2
v_lshlrev_b32 v123, 6, v123
v_and_b32 v125, 1, v1
v_lshl_add_u32 v123, v125, 4, v123
s_mul_i32 s17, s12, 114688
s_lshl_b32 s18, s13, 11
s_add_u32 s17, s17, s18
v_lshlrev_b32 v125, 4, v3
v_lshl_add_u32 v125, v2, 9, v125
v_add_u32 v125, s17, v125
s_lshr_b32 s17, s12, 1
s_lshl_b32 s17, s17, 10
s_and_b32 s18, s12, 1
s_lshl_b32 s18, s18, 3
s_add_u32 s17, s17, s18
s_add_u32 s17, s17, 8192
v_add_u32 v126, s17, v124
v_lshrrev_b32 v127, 3, v3
v_lshlrev_b32 v127, 8, v127
v_lshl_add_u32 v127, v2, 5, v127
v_and_b32 v3, 1, v1
v_lshl_add_u32 v127, v3, 7, v127
v_bfe_u32 v3, v1, 1, 2
v_lshl_add_u32 v127, v3, 2, v127
s_lshl_b32 s17, s13, 9
s_lshl_b32 s18, s18, 1
s_add_u32 s17, s17, s18
v_add_u32 v127, s17, v127
s_mul_i32 s25, s14, 458752
s_add_u32 s25, s25, 35815424
s_mul_i32 s30, s14, 28672
s_add_u32 s30, s30, 35651584
s_mul_i32 s31, s14, 40960
s_mul_i32 s17, s12, 2560
s_add_u32 s31, s31, s17
s_add_u32 s31, s31, 35717120
s_mul_i32 s23, s14, 29360128
s_add_u32 s23, s23, 100663296
s_mul_i32 s24, s14, 7340032
s_lshl_b32 s17, s13, 2
s_add_u32 s17, s17, s12
s_lshl_b32 s17, s17, 11
s_add_u32 s24, s24, s17
s_add_u32 s24, s24, 60817408
s_lshl_b32 s26, s12, 14
s_add_u32 s26, s26, 12288
v_add_u32 v121, s26, v124
s_and_b32 s27, s12, 1
s_lshl_b32 s17, s27, 7
s_add_u32 s17, s17, 8192
v_bfe_u32 v0, v1, 2, 1
v_lshlrev_b32 v0, 11, v0
v_lshrrev_b32 v2, 4, v1
v_lshl_add_u32 v0, v2, 8, v0
v_and_b32 v2, 3, v1
v_lshl_add_u32 v0, v2, 5, v0
v_bfe_u32 v2, v1, 3, 1
v_lshl_add_u32 v0, v2, 4, v0
v_add_u32 v0, s17, v0
s_lshl_b32 s17, s13, 9
s_lshl_b32 s27, s27, 8
s_add_u32 s17, s17, s27
v_lshl_add_u32 v127, v1, 2, s17
v_lshrrev_b32 v1, 1, v124
s_lshl_b32 s35, s14, 15
s_lshl_b32 s36, s13, 2
s_add_u32 s36, s36, s12
s_lshl_b32 s17, s36, 7
s_add_u32 s25, s25, s17
s_and_b32 s37, s12, 1
s_mul_i32 s37, s37, 120
s_sub_u32 s37, s17, s37
v_add_u32 v123, s37, v123
s_add_u32 s35, s35, 38141952
s_mov_b32 s15, 0
MS_174:
buffer_load_dword v2, off, s[92:95], s56 sc1
s_sub_u32 s16, s16, 1
s_cbranch_scc1 MS_174_ab
s_waitcnt vmcnt(0)
v_readfirstlane_b32 s58, v2
s_nop 0
s_and_b32 s17, s58, 0xffff
s_cmp_ge_u32 s17, s57
s_nop 0
s_cbranch_scc0 MS_174
s_lshr_b32 s17, s58, 16
s_cbranch_scc1 MS_174_slow
CB_LOOP_175:
s_and_b32 s17, s15, 3
s_mul_i32 s18, s17, 7168
s_add_u32 s21, s18, s30
s_mul_i32 s18, s17, 10240
s_add_u32 s22, s18, s31
s_add_u32 s17, s15, 1
s_and_b32 s17, s17, 3
s_mul_i32 s18, s17, 7168
s_add_u32 s28, s18, s30
s_add_u32 s17, s15, 3
s_and_b32 s17, s17, 3
s_mul_i32 s18, s17, 7168
s_add_u32 s29, s18, s30
v_mov_b64 v[4:5], 0
v_mov_b64 v[6:7], 0
v_mov_b64 v[8:9], 0
v_mov_b64 v[10:11], 0
v_mov_b64 v[12:13], 0
v_mov_b64 v[14:15], 0
v_mov_b64 v[16:17], 0
v_mov_b64 v[18:19], 0
v_mov_b64 v[20:21], 0
v_mov_b64 v[22:23], 0
v_mov_b64 v[24:25], 0
v_mov_b64 v[26:27], 0
v_mov_b64 v[28:29], 0
v_mov_b64 v[30:31], 0
v_mov_b64 v[32:33], 0
v_mov_b64 v[34:35], 0
s_add_u32 s34, s21, s33
POLL_178:
buffer_load_dword v3, off, s[8:11], s35 sc1
buffer_load_dwordx4 v[96:99], v120, s[8:11], s21 offen sc1
buffer_load_dwordx4 v[100:103], v120, s[8:11], s34 offen sc1
s_sub_u32 s16, s16, 1
s_cbranch_scc1 POLLD_179_abort
s_waitcnt vmcnt(0)
v_max3_u32 v2, v96, v97, v98
v_max3_u32 v2, v2, v99, v100
v_max3_u32 v2, v2, v101, v102
v_max_u32 v2, v2, v103
v_cmp_eq_u32 vcc, -1, v2
s_cbranch_vccnz POLL_178
POLLD_179:
ds_write_b128 v120, v[96:99] offset:0
ds_write_b128 v120, v[100:103] offset:4096
s_waitcnt lgkmcnt(0)
s_barrier
ds_read_b128 v[68:71], v124 offset:0
ds_read_b128 v[72:75], v124 offset:1024
ds_read_b128 v[76:79], v124 offset:2048
ds_read_b128 v[80:83], v124 offset:3072
ds_read_b128 v[84:87], v124 offset:4096
ds_read_b128 v[88:91], v124 offset:5120
ds_read_b128 v[92:95], v124 offset:6144
ds_read2_b32 v[64:65], v123 offset0:0 offset1:8
ds_read2_b32 v[66:67], v123 offset0:1 offset1:9
v_mov_b32 v2, 0
v_readfirstlane_b32 s17, v3
s_nop 0
s_cmp_gt_u32 s17, s15
s_cselect_b64 vcc, -1, 0
ds_read_b128 v[96:99], v121 offset:0
ds_read_b128 v[100:103], v121 offset:1024
ds_read_b128 v[104:107], v121 offset:2048
ds_read_b128 v[108:111], v121 offset:3072
s_waitcnt lgkmcnt(12)
v_smfmac_f32_16x16x64_bf16 v[4:7], v[68:71], a[0:7], v122
v_smfmac_f32_16x16x64_bf16 v[8:11], v[68:71], a[48:55], v122
s_cbranch_vccz OPT_180
buffer_load_dwordx4 v[36:39], v125, s[8:11], s23 offen offset:0 sc1
OPT_180:
v_smfmac_f32_16x16x64_bf16 v[12:15], v[68:71], a[96:103], v122
v_smfmac_f32_16x16x64_bf16 v[16:19], v[68:71], a[144:151], v122
s_cbranch_vccz OPT_181
buffer_load_dwordx4 v[52:55], v125, s[8:11], s23 offen offset:256 sc1
s_add_u32 s23, s23, 28672
OPT_181:
v_smfmac_f32_16x16x64_bf16 v[20:23], v[68:71], a[192:199], v122
v_smfmac_f32_16x16x64_bf16 v[24:27], v[68:71], a[240:247], v122
s_cbranch_vccz OPT_182
buffer_load_dwordx4 v[40:43], v125, s[8:11], s23 offen offset:0 sc1
OPT_182:
v_smfmac_f32_16x16x64_bf16 v[28:31], v[68:71], v[160:167], v122
v_smfmac_f32_16x16x64_bf16 v[32:35], v[68:71], v[208:215], v122
s_cbranch_vccz OPT_183
buffer_load_dwordx4 v[56:59], v125, s[8:11], s23 offen offset:256 sc1
s_add_u32 s23, s23, 28672
OPT_183:
s_waitcnt lgkmcnt(4)
v_smfmac_f32_16x16x64_bf16 v[4:7], v[72:75], a[8:15], v122
s_mov_b64 exec, 0xff
buffer_store_dwordx4 v[64:67], v124, s[8:11], s25 offen sc1
s_mov_b64 exec, -1
s_cmp_eq_u32 s15, 0
s_cbranch_scc1 OPT_184
buffer_store_dwordx4 v[112:115], v124, s[8:11], s24 offen sc1
buffer_store_dwordx4 v[116:119], v124, s[8:11], s24 offen offset:1024 sc1
s_add_u32 s24, s24, 114688
OPT_184:
v_smfmac_f32_16x16x64_bf16 v[8:11], v[72:75], a[56:63], v122
v_smfmac_f32_16x16x64_bf16 v[12:15], v[72:75], a[104:111], v122
v_smfmac_f32_16x16x64_bf16 v[16:19], v[72:75], a[152:159], v122
s_cbranch_vccz OPT_185
buffer_load_dwordx4 v[44:47], v125, s[8:11], s23 offen offset:0 sc1
OPT_185:
v_smfmac_f32_16x16x64_bf16 v[20:23], v[72:75], a[200:207], v122
v_smfmac_f32_16x16x64_bf16 v[24:27], v[72:75], a[248:255], v122
s_cbranch_vccz OPT_186
buffer_load_dwordx4 v[60:63], v125, s[8:11], s23 offen offset:256 sc1
s_add_u32 s23, s23, 28672
OPT_186:
v_smfmac_f32_16x16x64_bf16 v[28:31], v[72:75], v[168:175], v122
v_smfmac_f32_16x16x64_bf16 v[32:35], v[72:75], v[216:223], v122
s_cbranch_vccz OPT_187
buffer_load_dwordx4 v[48:51], v125, s[8:11], s23 offen offset:0 sc1
OPT_187:
s_waitcnt lgkmcnt(0)
v_smfmac_f32_16x16x64_bf16 v[4:7], v[92:95], v[96:103], v122
v_smfmac_f32_16x16x64_bf16 v[8:11], v[92:95], v[104:111], v122
ds_read_b128 v[96:99], v121 offset:4096
ds_read_b128 v[100:103], v121 offset:5120
ds_read_b128 v[104:107], v121 offset:6144
ds_read_b128 v[108:111], v121 offset:7168
v_smfmac_f32_16x16x64_bf16 v[4:7], v[76:79], a[16:23], v122
v_smfmac_f32_16x16x64_bf16 v[8:11], v[76:79], a[64:71], v122
s_cbranch_vccz OPT_188
buffer_load_dwordx4 v[64:67], v125, s[8:11], s23 offen offset:256 sc1
s_add_u32 s23, s23, 372736
OPT_188:
v_smfmac_f32_16x16x64_bf16 v[12:15], v[76:79], a[112:119], v122
v_smfmac_f32_16x16x64_bf16 v[16:19], v[76:79], a[160:167], v122
v_smfmac_f32_16x16x64_bf16 v[20:23], v[76:79], a[208:215], v122
v_smfmac_f32_16x16x64_bf16 v[24:27], v[76:79], v[128:135], v122
v_smfmac_f32_16x16x64_bf16 v[28:31], v[76:79], v[176:183], v122
v_smfmac_f32_16x16x64_bf16 v[32:35], v[76:79], v[224:231], v122
s_waitcnt lgkmcnt(0)
v_smfmac_f32_16x16x64_bf16 v[12:15], v[92:95], v[96:103], v122
v_smfmac_f32_16x16x64_bf16 v[16:19], v[92:95], v[104:111], v122
ds_read_b128 v[96:99], v121 offset:8192
ds_read_b128 v[100:103], v121 offset:9216
ds_read_b128 v[104:107], v121 offset:10240
ds_read_b128 v[108:111], v121 offset:11264
v_smfmac_f32_16x16x64_bf16 v[4:7], v[80:83], a[24:31], v122
v_smfmac_f32_16x16x64_bf16 v[8:11], v[80:83], a[72:79], v122
v_smfmac_f32_16x16x64_bf16 v[12:15], v[80:83], a[120:127], v122
v_smfmac_f32_16x16x64_bf16 v[16:19], v[80:83], a[168:175], v122
v_smfmac_f32_16x16x64_bf16 v[20:23], v[80:83], a[216:223], v122
v_smfmac_f32_16x16x64_bf16 v[24:27], v[80:83], v[136:143], v122
v_smfmac_f32_16x16x64_bf16 v[28:31], v[80:83], v[184:191], v122
v_smfmac_f32_16x16x64_bf16 v[32:35], v[80:83], v[232:239], v122
s_waitcnt lgkmcnt(0)
v_smfmac_f32_16x16x64_bf16 v[20:23], v[92:95], v[96:103], v122
v_smfmac_f32_16x16x64_bf16 v[24:27], v[92:95], v[104:111], v122
ds_read_b128 v[96:99], v121 offset:12288
ds_read_b128 v[100:103], v121 offset:13312
ds_read_b128 v[104:107], v121 offset:14336
ds_read_b128 v[108:111], v121 offset:15360
v_smfmac_f32_16x16x64_bf16 v[4:7], v[84:87], a[32:39], v122
v_smfmac_f32_16x16x64_bf16 v[8:11], v[84:87], a[80:87], v122
v_smfmac_f32_16x16x64_bf16 v[12:15], v[84:87], a[128:135], v122
v_smfmac_f32_16x16x64_bf16 v[16:19], v[84:87], a[176:183], v122
buffer_load_dword v3, off, s[8:11], s35 sc1
v_smfmac_f32_16x16x64_bf16 v[20:23], v[84:87], a[224:231], v122
v_smfmac_f32_16x16x64_bf16 v[24:27], v[84:87], v[144:151], v122
v_smfmac_f32_16x16x64_bf16 v[28:31], v[84:87], v[192:199], v122
v_smfmac_f32_16x16x64_bf16 v[32:35], v[84:87], v[240:247], v122
s_waitcnt lgkmcnt(0)
v_smfmac_f32_16x16x64_bf16 v[28:31], v[92:95], v[96:103], v122
v_smfmac_f32_16x16x64_bf16 v[32:35], v[92:95], v[104:111], v122
v_smfmac_f32_16x16x64_bf16 v[4:7], v[88:91], a[40:47], v122
v_smfmac_f32_16x16x64_bf16 v[8:11], v[88:91], a[88:95], v122
v_smfmac_f32_16x16x64_bf16 v[12:15], v[88:91], a[136:143], v122
v_smfmac_f32_16x16x64_bf16 v[16:19], v[88:91], a[184:191], v122
v_smfmac_f32_16x16x64_bf16 v[20:23], v[88:91], a[232:239], v122
v_smfmac_f32_16x16x64_bf16 v[24:27], v[88:91], v[152:159], v122
v_smfmac_f32_16x16x64_bf16 v[28:31], v[88:91], v[200:207], v122
v_smfmac_f32_16x16x64_bf16 v[32:35], v[88:91], v[248:255], v122
s_nop 0
v_pk_add_f32 v[4:5], v[4:5], v[6:7]
v_cvt_pk_bf16_f32 v112, v4, v5
v_min_u32 v112, -2, v112
v_pk_add_f32 v[8:9], v[8:9], v[10:11]
v_cvt_pk_bf16_f32 v116, v8, v9
v_min_u32 v116, -2, v116
v_pk_add_f32 v[12:13], v[12:13], v[14:15]
v_cvt_pk_bf16_f32 v113, v12, v13
v_min_u32 v113, -2, v113
v_pk_add_f32 v[16:17], v[16:17], v[18:19]
v_cvt_pk_bf16_f32 v117, v16, v17
v_min_u32 v117, -2, v117
v_pk_add_f32 v[20:21], v[20:21], v[22:23]
v_cvt_pk_bf16_f32 v114, v20, v21
v_min_u32 v114, -2, v114
v_pk_add_f32 v[24:25], v[24:25], v[26:27]
v_cvt_pk_bf16_f32 v118, v24, v25
v_min_u32 v118, -2, v118
v_pk_add_f32 v[28:29], v[28:29], v[30:31]
v_cvt_pk_bf16_f32 v115, v28, v29
v_min_u32 v115, -2, v115
v_pk_add_f32 v[32:33], v[32:33], v[34:35]
v_cvt_pk_bf16_f32 v119, v32, v33
v_min_u32 v119, -2, v119
s_cmp_eq_u32 s15, 63
s_cbranch_scc1 CB_END_176
s_cbranch_vccnz CB_LATE_189
s_waitcnt vmcnt(0)
PG_190:
v_readfirstlane_b32 s17, v3
s_nop 0
s_cmp_gt_u32 s17, s15
s_nop 1
s_cbranch_scc0 PG_190_slow
PG_190_ok:
buffer_load_dwordx4 v[36:39], v125, s[8:11], s23 offen offset:0 sc1
buffer_load_dwordx4 v[52:55], v125, s[8:11], s23 offen offset:256 sc1
s_add_u32 s23, s23, 28672
buffer_load_dwordx4 v[40:43], v125, s[8:11], s23 offen offset:0 sc1
buffer_load_dwordx4 v[56:59], v125, s[8:11], s23 offen offset:256 sc1
s_add_u32 s23, s23, 28672
buffer_load_dwordx4 v[44:47], v125, s[8:11], s23 offen offset:0 sc1
buffer_load_dwordx4 v[60:63], v125, s[8:11], s23 offen offset:256 sc1
s_add_u32 s23, s23, 28672
buffer_load_dwordx4 v[48:51], v125, s[8:11], s23 offen offset:0 sc1
buffer_load_dwordx4 v[64:67], v125, s[8:11], s23 offen offset:256 sc1
s_add_u32 s23, s23, 372736
CB_LATE_189:
v_mov_b64 v[4:5], 0
v_mov_b64 v[6:7], 0
v_mov_b64 v[8:9], 0
v_mov_b64 v[10:11], 0
s_waitcnt vmcnt(0)
buffer_load_dwordx4 v[68:71], v124, s[8:11], s22 offen sc1
buffer_load_dwordx4 v[72:75], v124, s[8:11], s22 offen offset:1024 sc1
buffer_load_dwordx2 v[76:77], v1, s[8:11], s22 offen offset:2048 sc1
s_sleep 3
PP_191:
buffer_load_dwordx4 v[80:83], v124, s[8:11], s22 offen sc1
buffer_load_dwordx4 v[84:87], v124, s[8:11], s22 offen offset:1024 sc1
buffer_load_dwordx2 v[88:89], v1, s[8:11], s22 offen offset:2048 sc1
s_waitcnt vmcnt(3)
v_max3_u32 v2, v68, v69, v70
v_max3_u32 v2, v2, v71, v72
v_max3_u32 v2, v2, v73, v74
v_max3_u32 v2, v2, v75, v76
v_max_u32 v2, v2, v77
v_cmp_eq_u32 vcc, -1, v2
s_cbranch_vccz PP_191_d0
buffer_load_dwordx4 v[68:71], v124, s[8:11], s22 offen sc1
buffer_load_dwordx4 v[72:75], v124, s[8:11], s22 offen offset:1024 sc1
buffer_load_dwordx2 v[76:77], v1, s[8:11], s22 offen offset:2048 sc1
s_sub_u32 s16, s16, 1
s_cbranch_scc1 PP_191_abort
s_waitcnt vmcnt(3)
v_max3_u32 v2, v80, v81, v82
v_max3_u32 v2, v2, v83, v84
v_max3_u32 v2, v2, v85, v86
v_max3_u32 v2, v2, v87, v88
v_max_u32 v2, v2, v89
v_cmp_eq_u32 vcc, -1, v2
s_cbranch_vccnz PP_191
PP_191_d1:
v_smfmac_f32_16x16x64_bf16 v[4:7], v[80:83], v[36:43], v122
v_smfmac_f32_16x16x64_bf16 v[8:11], v[80:83], v[52:59], v122
v_smfmac_f32_16x16x64_bf16 v[4:7], v[84:87], v[44:51], v122
v_smfmac_f32_16x16x64_bf16 v[8:11], v[84:87], v[60:67], v122
v_smfmac_f32_16x16x32_bf16 v[4:7], v[88:89], v[112:115], v122
v_smfmac_f32_16x16x32_bf16 v[8:11], v[88:89], v[116:119], v122
s_branch PP_191_j
PP_191_d0:
v_smfmac_f32_16x16x64_bf16 v[4:7], v[68:71], v[36:43], v122
v_smfmac_f32_16x16x64_bf16 v[8:11], v[68:71], v[52:59], v122
v_smfmac_f32_16x16x64_bf16 v[4:7], v[72:75], v[44:51], v122
v_smfmac_f32_16x16x64_bf16 v[8:11], v[72:75], v[60:67], v122
v_smfmac_f32_16x16x32_bf16 v[4:7], v[76:77], v[112:115], v122
v_smfmac_f32_16x16x32_bf16 v[8:11], v[76:77], v[116:119], v122
PP_191_j:
v_mov_b32 v2, -1
s_cmp_ge_u32 s12, 2
s_nop 4
v_add_f32 v12, v4, v6
v_add_f32 v14, v5, v7
v_add_f32 v13, v8, v10
v_add_f32 v15, v9, v11
ds_write2st64_b64 v126, v[12:13], v[14:15] offset0:0 offset1:4
s_waitcnt lgkmcnt(0)
s_barrier
s_cbranch_scc1 CB_SKIP_177
ds_read_b128 v[12:15], v0
ds_read_b128 v[16:19], v0 offset:1024
s_waitcnt lgkmcnt(1)
v_pk_add_f32 v[12:13], v[12:13], v[14:15]
s_waitcnt lgkmcnt(0)
v_pk_add_f32 v[16:17], v[16:17], v[18:19]
v_pk_add_f32 v[12:13], v[12:13], v[16:17]
v_cvt_pk_bf16_f32 v12, v12, v13
v_min_u32 v12, -2, v12
buffer_store_dword v12, v127, s[8:11], s28 offen
buffer_store_dword v2, v127, s[8:11], s29 offen
CB_SKIP_177:
s_add_u32 s25, s25, 7168
s_add_u32 s15, s15, 1
s_branch CB_LOOP_175
CB_END_176:
buffer_store_dwordx4 v[112:115], v124, s[8:11], s24 offen sc1
buffer_store_dwordx4 v[116:119], v124, s[8:11], s24 offen offset:1024 sc1
s_add_u32 s24, s24, 114688
s_endpgm
MS_174_ab:
s_mov_b32 s16, 0
s_waitcnt vmcnt(0)
MS_174_slow:
CB_LOOP_192:
s_and_b32 s17, s15, 3
s_mul_i32 s18, s17, 7168
s_add_u32 s21, s18, s30
s_mul_i32 s18, s17, 10240
s_add_u32 s22, s18, s31
s_add_u32 s17, s15, 1
s_and_b32 s17, s17, 3
s_mul_i32 s18, s17, 7168
s_add_u32 s28, s18, s30
s_add_u32 s17, s15, 3
s_and_b32 s17, s17, 3
s_mul_i32 s18, s17, 7168
s_add_u32 s29, s18, s30
v_mov_b64 v[4:5], 0
v_mov_b64 v[6:7], 0
v_mov_b64 v[8:9], 0
v_mov_b64 v[10:11], 0
v_mov_b64 v[12:13], 0
v_mov_b64 v[14:15], 0
v_mov_b64 v[16:17], 0
v_mov_b64 v[18:19], 0
v_mov_b64 v[20:21], 0
v_mov_b64 v[22:23], 0
v_mov_b64 v[24:25], 0
v_mov_b64 v[26:27], 0
v_mov_b64 v[28:29], 0
v_mov_b64 v[30:31], 0
v_mov_b64 v[32:33], 0
v_mov_b64 v[34:35], 0
s_add_u32 s34, s21, s33
POLL_195:
buffer_load_dword v3, off, s[8:11], s35 sc1
buffer_load_dwordx4 v[96:99], v120, s[8:11], s21 offen sc1
buffer_load_dwordx4 v[100:103], v120, s[8:11], s34 offen sc1
s_sub_u32 s16, s16, 1
s_cbranch_scc1 POLLD_196_abort
s_waitcnt vmcnt(0)
v_max3_u32 v2, v96, v97, v98
v_max3_u32 v2, v2, v99, v100
v_max3_u32 v2, v2, v101, v102
v_max_u32 v2, v2, v103
v_cmp_eq_u32 vcc, -1, v2
s_cbranch_vccnz POLL_195
POLLD_196:
ds_write_b128 v120, v[96:99] offset:0
ds_write_b128 v120, v[100:103] offset:4096
s_waitcnt lgkmcnt(0)
s_barrier
ds_read_b128 v[68:71], v124 offset:0
ds_read_b128 v[72:75], v124 offset:1024
ds_read_b128 v[76:79], v124 offset:2048
ds_read_b128 v[80:83], v124 offset:3072
ds_read_b128 v[84:87], v124 offset:4096
ds_read_b128 v[88:91], v124 offset:5120
ds_read_b128 v[92:95], v124 offset:6144
ds_read2_b32 v[64:65], v123 offset0:0 offset1:8
ds_read2_b32 v[66:67], v123 offset0:1 offset1:9
v_mov_b32 v2, 0
v_readfirstlane_b32 s17, v3
s_nop 0
s_cmp_gt_u32 s17, s15
s_cselect_b64 vcc, -1, 0
ds_read_b128 v[96:99], v121 offset:0
ds_read_b128 v[100:103], v121 offset:1024
ds_read_b128 v[104:107], v121 offset:2048
ds_read_b128 v[108:111], v121 offset:3072
s_waitcnt lgkmcnt(12)
v_smfmac_f32_16x16x64_bf16 v[4:7], v[68:71], a[0:7], v122
v_smfmac_f32_16x16x64_bf16 v[8:11], v[68:71], a[48:55], v122
s_cbranch_vccz OPT_197
buffer_load_dwordx4 v[36:39], v125, s[8:11], s23 offen offset:0 sc1
OPT_197:
v_smfmac_f32_16x16x64_bf16 v[12:15], v[68:71], a[96:103], v122
v_smfmac_f32_16x16x64_bf16 v[16:19], v[68:71], a[144:151], v122
s_cbranch_vccz OPT_198
buffer_load_dwordx4 v[52:55], v125, s[8:11], s23 offen offset:256 sc1
s_add_u32 s23, s23, 28672
OPT_198:
v_smfmac_f32_16x16x64_bf16 v[20:23], v[68:71], a[192:199], v122
v_smfmac_f32_16x16x64_bf16 v[24:27], v[68:71], a[240:247], v122
s_cbranch_vccz OPT_199
buffer_load_dwordx4 v[40:43], v125, s[8:11], s23 offen offset:0 sc1
OPT_199:
v_smfmac_f32_16x16x64_bf16 v[28:31], v[68:71], v[160:167], v122
v_smfmac_f32_16x16x64_bf16 v[32:35], v[68:71], v[208:215], v122
s_cbranch_vccz OPT_200
buffer_load_dwordx4 v[56:59], v125, s[8:11], s23 offen offset:256 sc1
s_add_u32 s23, s23, 28672
OPT_200:
s_waitcnt lgkmcnt(4)
v_smfmac_f32_16x16x64_bf16 v[4:7], v[72:75], a[8:15], v122
s_mov_b64 exec, 0xff
buffer_store_dwordx4 v[64:67], v124, s[8:11], s25 offen sc1
s_mov_b64 exec, -1
s_cmp_eq_u32 s15, 0
s_cbranch_scc1 OPT_201
buffer_store_dwordx4 v[112:115], v124, s[8:11], s24 offen sc1
buffer_store_dwordx4 v[116:119], v124, s[8:11], s24 offen offset:1024 sc1
s_add_u32 s24, s24, 114688
OPT_201:
v_smfmac_f32_16x16x64_bf16 v[8:11], v[72:75], a[56:63], v122
v_smfmac_f32_16x16x64_bf16 v[12:15], v[72:75], a[104:111], v122
v_smfmac_f32_16x16x64_bf16 v[16:19], v[72:75], a[152:159], v122
s_cbranch_vccz OPT_202
buffer_load_dwordx4 v[44:47], v125, s[8:11], s23 offen offset:0 sc1
OPT_202:
v_smfmac_f32_16x16x64_bf16 v[20:23], v[72:75], a[200:207], v122
v_smfmac_f32_16x16x64_bf16 v[24:27], v[72:75], a[248:255], v122
s_cbranch_vccz OPT_203
buffer_load_dwordx4 v[60:63], v125, s[8:11], s23 offen offset:256 sc1
s_add_u32 s23, s23, 28672
OPT_203:
v_smfmac_f32_16x16x64_bf16 v[28:31], v[72:75], v[168:175], v122
v_smfmac_f32_16x16x64_bf16 v[32:35], v[72:75], v[216:223], v122
s_cbranch_vccz OPT_204
buffer_load_dwordx4 v[48:51], v125, s[8:11], s23 offen offset:0 sc1
OPT_204:
s_waitcnt lgkmcnt(0)
v_smfmac_f32_16x16x64_bf16 v[4:7], v[92:95], v[96:103], v122
v_smfmac_f32_16x16x64_bf16 v[8:11], v[92:95], v[104:111], v122
ds_read_b128 v[96:99], v121 offset:4096
ds_read_b128 v[100:103], v121 offset:5120
ds_read_b128 v[104:107], v121 offset:6144
ds_read_b128 v[108:111], v121 offset:7168
v_smfmac_f32_16x16x64_bf16 v[4:7], v[76:79], a[16:23], v122
v_smfmac_f32_16x16x64_bf16 v[8:11], v[76:79], a[64:71], v122
s_cbranch_vccz OPT_205
buffer_load_dwordx4 v[64:67], v125, s[8:11], s23 offen offset:256 sc1
s_add_u32 s23, s23, 372736
OPT_205:
v_smfmac_f32_16x16x64_bf16 v[12:15], v[76:79], a[112:119], v122
v_smfmac_f32_16x16x64_bf16 v[16:19], v[76:79], a[160:167], v122
v_smfmac_f32_16x16x64_bf16 v[20:23], v[76:79], a[208:215], v122
v_smfmac_f32_16x16x64_bf16 v[24:27], v[76:79], v[128:135], v122
v_smfmac_f32_16x16x64_bf16 v[28:31], v[76:79], v[176:183], v122
v_smfmac_f32_16x16x64_bf16 v[32:35], v[76:79], v[224:231], v122
s_waitcnt lgkmcnt(0)
v_smfmac_f32_16x16x64_bf16 v[12:15], v[92:95], v[96:103], v122
v_smfmac_f32_16x16x64_bf16 v[16:19], v[92:95], v[104:111], v122
ds_read_b128 v[96:99], v121 offset:8192
ds_read_b128 v[100:103], v121 offset:9216
ds_read_b128 v[104:107], v121 offset:10240
ds_read_b128 v[108:111], v121 offset:11264
v_smfmac_f32_16x16x64_bf16 v[4:7], v[80:83], a[24:31], v122
v_smfmac_f32_16x16x64_bf16 v[8:11], v[80:83], a[72:79], v122
v_smfmac_f32_16x16x64_bf16 v[12:15], v[80:83], a[120:127], v122
v_smfmac_f32_16x16x64_bf16 v[16:19], v[80:83], a[168:175], v122
v_smfmac_f32_16x16x64_bf16 v[20:23], v[80:83], a[216:223], v122
v_smfmac_f32_16x16x64_bf16 v[24:27], v[80:83], v[136:143], v122
v_smfmac_f32_16x16x64_bf16 v[28:31], v[80:83], v[184:191], v122
v_smfmac_f32_16x16x64_bf16 v[32:35], v[80:83], v[232:239], v122
s_waitcnt lgkmcnt(0)
v_smfmac_f32_16x16x64_bf16 v[20:23], v[92:95], v[96:103], v122
v_smfmac_f32_16x16x64_bf16 v[24:27], v[92:95], v[104:111], v122
ds_read_b128 v[96:99], v121 offset:12288
ds_read_b128 v[100:103], v121 offset:13312
ds_read_b128 v[104:107], v121 offset:14336
ds_read_b128 v[108:111], v121 offset:15360
v_smfmac_f32_16x16x64_bf16 v[4:7], v[84:87], a[32:39], v122
v_smfmac_f32_16x16x64_bf16 v[8:11], v[84:87], a[80:87], v122
v_smfmac_f32_16x16x64_bf16 v[12:15], v[84:87], a[128:135], v122
v_smfmac_f32_16x16x64_bf16 v[16:19], v[84:87], a[176:183], v122
buffer_load_dword v3, off, s[8:11], s35 sc1
v_smfmac_f32_16x16x64_bf16 v[20:23], v[84:87], a[224:231], v122
v_smfmac_f32_16x16x64_bf16 v[24:27], v[84:87], v[144:151], v122
v_smfmac_f32_16x16x64_bf16 v[28:31], v[84:87], v[192:199], v122
v_smfmac_f32_16x16x64_bf16 v[32:35], v[84:87], v[240:247], v122
s_waitcnt lgkmcnt(0)
v_smfmac_f32_16x16x64_bf16 v[28:31], v[92:95], v[96:103], v122
v_smfmac_f32_16x16x64_bf16 v[32:35], v[92:95], v[104:111], v122
v_smfmac_f32_16x16x64_bf16 v[4:7], v[88:91], a[40:47], v122
v_smfmac_f32_16x16x64_bf16 v[8:11], v[88:91], a[88:95], v122
v_smfmac_f32_16x16x64_bf16 v[12:15], v[88:91], a[136:143], v122
v_smfmac_f32_16x16x64_bf16 v[16:19], v[88:91], a[184:191], v122
v_smfmac_f32_16x16x64_bf16 v[20:23], v[88:91], a[232:239], v122
v_smfmac_f32_16x16x64_bf16 v[24:27], v[88:91], v[152:159], v122
v_smfmac_f32_16x16x64_bf16 v[28:31], v[88:91], v[200:207], v122
v_smfmac_f32_16x16x64_bf16 v[32:35], v[88:91], v[248:255], v122
s_nop 0
v_pk_add_f32 v[4:5], v[4:5], v[6:7]
v_cvt_pk_bf16_f32 v112, v4, v5
v_min_u32 v112, -2, v112
v_pk_add_f32 v[8:9], v[8:9], v[10:11]
v_cvt_pk_bf16_f32 v116, v8, v9
v_min_u32 v116, -2, v116
v_pk_add_f32 v[12:13], v[12:13], v[14:15]
v_cvt_pk_bf16_f32 v113, v12, v13
v_min_u32 v113, -2, v113
v_pk_add_f32 v[16:17], v[16:17], v[18:19]
v_cvt_pk_bf16_f32 v117, v16, v17
v_min_u32 v117, -2, v117
v_pk_add_f32 v[20:21], v[20:21], v[22:23]
v_cvt_pk_bf16_f32 v114, v20, v21
v_min_u32 v114, -2, v114
v_pk_add_f32 v[24:25], v[24:25], v[26:27]
v_cvt_pk_bf16_f32 v118, v24, v25
v_min_u32 v118, -2, v118
v_pk_add_f32 v[28:29], v[28:29], v[30:31]
v_cvt_pk_bf16_f32 v115, v28, v29
v_min_u32 v115, -2, v115
v_pk_add_f32 v[32:33], v[32:33], v[34:35]
v_cvt_pk_bf16_f32 v119, v32, v33
v_min_u32 v119, -2, v119
s_cmp_eq_u32 s15, 63
s_cbranch_scc1 CB_END_193
s_cbranch_vccnz CB_LATE_206
s_waitcnt vmcnt(0)
PG_207:
v_readfirstlane_b32 s17, v3
s_nop 0
s_cmp_gt_u32 s17, s15
s_nop 1
s_cbranch_scc0 PG_207_slow
PG_207_ok:
buffer_load_dwordx4 v[36:39], v125, s[8:11], s23 offen offset:0 sc1
buffer_load_dwordx4 v[52:55], v125, s[8:11], s23 offen offset:256 sc1
s_add_u32 s23, s23, 28672
buffer_load_dwordx4 v[40:43], v125, s[8:11], s23 offen offset:0 sc1
buffer_load_dwordx4 v[56:59], v125, s[8:11], s23 offen offset:256 sc1
s_add_u32 s23, s23, 28672
buffer_load_dwordx4 v[44:47], v125, s[8:11], s23 offen offset:0 sc1
buffer_load_dwordx4 v[60:63], v125, s[8:11], s23 offen offset:256 sc1
s_add_u32 s23, s23, 28672
buffer_load_dwordx4 v[48:51], v125, s[8:11], s23 offen offset:0 sc1
buffer_load_dwordx4 v[64:67], v125, s[8:11], s23 offen offset:256 sc1
s_add_u32 s23, s23, 372736
CB_LATE_206:
v_mov_b64 v[4:5], 0
v_mov_b64 v[6:7], 0
v_mov_b64 v[8:9], 0
v_mov_b64 v[10:11], 0
s_waitcnt vmcnt(0)
buffer_load_dwordx4 v[68:71], v124, s[8:11], s22 offen sc1
buffer_load_dwordx4 v[72:75], v124, s[8:11], s22 offen offset:1024 sc1
buffer_load_dwordx2 v[76:77], v1, s[8:11], s22 offen offset:2048 sc1
s_sleep 3
PP_208:
buffer_load_dwordx4 v[80:83], v124, s[8:11], s22 offen sc1
buffer_load_dwordx4 v[84:87], v124, s[8:11], s22 offen offset:1024 sc1
buffer_load_dwordx2 v[88:89], v1, s[8:11], s22 offen offset:2048 sc1
s_waitcnt vmcnt(3)
v_max3_u32 v2, v68, v69, v70
v_max3_u32 v2, v2, v71, v72
v_max3_u32 v2, v2, v73, v74
v_max3_u32 v2, v2, v75, v76
v_max_u32 v2, v2, v77
v_cmp_eq_u32 vcc, -1, v2
s_cbranch_vccz PP_208_d0
buffer_load_dwordx4 v[68:71], v124, s[8:11], s22 offen sc1
buffer_load_dwordx4 v[72:75], v124, s[8:11], s22 offen offset:1024 sc1
buffer_load_dwordx2 v[76:77], v1, s[8:11], s22 offen offset:2048 sc1
s_sub_u32 s16, s16, 1
s_cbranch_scc1 PP_208_abort
s_waitcnt vmcnt(3)
v_max3_u32 v2, v80, v81, v82
v_max3_u32 v2, v2, v83, v84
v_max3_u32 v2, v2, v85, v86
v_max3_u32 v2, v2, v87, v88
v_max_u32 v2, v2, v89
v_cmp_eq_u32 vcc, -1, v2
s_cbranch_vccnz PP_208
PP_208_d1:
v_smfmac_f32_16x16x64_bf16 v[4:7], v[80:83], v[36:43], v122
v_smfmac_f32_16x16x64_bf16 v[8:11], v[80:83], v[52:59], v122
v_smfmac_f32_16x16x64_bf16 v[4:7], v[84:87], v[44:51], v122
v_smfmac_f32_16x16x64_bf16 v[8:11], v[84:87], v[60:67], v122
v_smfmac_f32_16x16x32_bf16 v[4:7], v[88:89], v[112:115], v122
v_smfmac_f32_16x16x32_bf16 v[8:11], v[88:89], v[116:119], v122
s_branch PP_208_j
PP_208_d0:
v_smfmac_f32_16x16x64_bf16 v[4:7], v[68:71], v[36:43], v122
v_smfmac_f32_16x16x64_bf16 v[8:11], v[68:71], v[52:59], v122
v_smfmac_f32_16x16x64_bf16 v[4:7], v[72:75], v[44:51], v122
v_smfmac_f32_16x16x64_bf16 v[8:11], v[72:75], v[60:67], v122
v_smfmac_f32_16x16x32_bf16 v[4:7], v[76:77], v[112:115], v122
v_smfmac_f32_16x16x32_bf16 v[8:11], v[76:77], v[116:119], v122
PP_208_j:
v_mov_b32 v2, -1
s_cmp_ge_u32 s12, 2
s_nop 4
v_add_f32 v12, v4, v6
v_add_f32 v14, v5, v7
v_add_f32 v13, v8, v10
v_add_f32 v15, v9, v11
ds_write2st64_b64 v126, v[12:13], v[14:15] offset0:0 offset1:4
s_waitcnt lgkmcnt(0)
s_barrier
s_cbranch_scc1 CB_SKIP_194
ds_read_b128 v[12:15], v0
ds_read_b128 v[16:19], v0 offset:1024
s_waitcnt lgkmcnt(1)
v_pk_add_f32 v[12:13], v[12:13], v[14:15]
s_waitcnt lgkmcnt(0)
v_pk_add_f32 v[16:17], v[16:17], v[18:19]
v_pk_add_f32 v[12:13], v[12:13], v[16:17]
v_cvt_pk_bf16_f32 v12, v12, v13
v_min_u32 v12, -2, v12
buffer_store_dword v12, v127, s[8:11], s28 offen sc1
buffer_store_dword v2, v127, s[8:11], s29 offen sc1
CB_SKIP_194:
s_add_u32 s25, s25, 7168
s_add_u32 s15, s15, 1
s_branch CB_LOOP_192
CB_END_193:
buffer_store_dwordx4 v[112:115], v124, s[8:11], s24 offen sc1
buffer_store_dwordx4 v[116:119], v124, s[8:11], s24 offen offset:1024 sc1
s_add_u32 s24, s24, 114688
s_endpgm
M_HP:
s_cmp_ge_u32 s12, 2
s_cbranch_scc1 M_EXIT
s_cmp_eq_u32 s12, 0
s_cselect_b32 s17, 59, 55
s_cselect_b32 s18, 0, 262144
v_min_u32 v2, s17, v1
v_lshrrev_b32 v3, 2, v2
v_mul_u32_u24 v3, 12, v3
v_add_lshl_u32 v2, v2, v3, 3
v_mov_b32 v3, 0
s_lshl_b32 s21, s14, 15
s_lshl_b32 s17, s12, 7
s_add_u32 s22, s21, s17
s_add_u32 s22, s22, 38141952
s_lshl_b32 s21, s21, 2
s_add_u32 s21, s21, s18
s_add_u32 s21, s21, 38273024
s_mov_b32 s15, 0
MS_209:
buffer_load_dword v4, off, s[92:95], s56 sc1
s_sub_u32 s16, s16, 1
s_cbranch_scc1 MS_209_ab
s_waitcnt vmcnt(0)
v_readfirstlane_b32 s58, v4
s_nop 0
s_and_b32 s17, s58, 0xffff
s_cmp_ge_u32 s17, s57
s_nop 0
s_cbranch_scc0 MS_209
s_lshr_b32 s17, s58, 16
s_cbranch_scc1 MS_209_slow
HP_210:
s_branch WF_211_in
WF_211:
s_sleep 1
WF_211_in:
buffer_load_dwordx2 v[4:5], v2, s[8:11], s21 offen sc1
s_sub_u32 s16, s16, 1
s_cbranch_scc1 WFD_212_abort
s_waitcnt vmcnt(0)
v_min_u32 v4, v4, v5
v_cmp_eq_u32 vcc, 0, v4
s_cbranch_vccnz WF_211
WFD_212:
s_add_u32 s15, s15, 1
s_add_u32 s21, s21, 2048
v_mov_b32 v6, s15
s_mov_b64 exec, 1
buffer_store_dword v6, v3, s[8:11], s22 offen
s_mov_b64 exec, -1
s_cmp_lt_u32 s15, 64
s_cbranch_scc1 HP_210
s_endpgm
MS_209_ab:
s_mov_b32 s16, 0
s_waitcnt vmcnt(0)
MS_209_slow:
HP_213:
s_branch WF_214_in
WF_214:
s_sleep 1
WF_214_in:
buffer_load_dwordx2 v[4:5], v2, s[8:11], s21 offen sc1
s_sub_u32 s16, s16, 1
s_cbranch_scc1 WFD_215_abort
s_waitcnt vmcnt(0)
v_min_u32 v4, v4, v5
v_cmp_eq_u32 vcc, 0, v4
s_cbranch_vccnz WF_214
WFD_215:
s_add_u32 s15, s15, 1
s_add_u32 s21, s21, 2048
v_mov_b32 v6, s15
s_mov_b64 exec, 1
buffer_store_dword v6, v3, s[8:11], s22 offen sc1
s_mov_b64 exec, -1
s_cmp_lt_u32 s15, 64
s_cbranch_scc1 HP_213
s_endpgm
M_HT:
v_min_u32 v2, 55, v1
v_lshlrev_b32 v2, 7, v2
s_lshl_b32 s23, s14, 15
s_add_u32 s23, s23, 38141952
s_mul_i32 s26, s14, 29360128
s_mul_i32 s17, s12, 114688
s_add_u32 s26, s26, s17
s_add_u32 s26, s26, 100756480
s_mov_b32 s15, 0
WX_216:
s_sleep 2
buffer_load_dword v8, off, s[8:11], s23 offset:384 sc1
buffer_load_dword v9, off, s[8:11], s23 sc1
s_sub_u32 s16, s16, 1
s_cbranch_scc1 WX_216_end
s_waitcnt vmcnt(0)
v_readfirstlane_b32 s24, v9
v_readfirstlane_b32 s25, v8
s_cmp_gt_u32 s24, s15
s_nop 2
s_cbranch_scc0 WX_216
s_add_u32 s25, s25, 2
s_cmp_lt_u32 s25, s15
s_cbranch_scc1 WX_216
s_sub_u32 s25, s25, 1
s_cmp_ge_u32 s25, s15
s_cbranch_scc1 WX_216_sk
s_add_u32 s27, s26, 0
buffer_load_dword v4, v2, s[8:11], s27 offen sc1
s_add_u32 s27, s26, 7168
buffer_load_dword v4, v2, s[8:11], s27 offen sc1
s_add_u32 s27, s26, 14336
buffer_load_dword v4, v2, s[8:11], s27 offen sc1
WX_216_sk:
s_add_u32 s26, s26, 458752
s_add_u32 s15, s15, 1
s_cmp_lt_u32 s15, 63
s_cbranch_scc1 WX_216
WX_216_end:
s_endpgm
M_T:
s_and_b32 s27, s13, 15
s_lshr_b32 s15, s13, 4
s_lshl_b32 s17, s27, 2
s_add_u32 s17, s17, s12
s_mul_i32 s19, s17, 100352
s_add_u32 s19, s19, 0
v_lshlrev_b32 v96, 4, v1
v_min_u32 v113, 13, v1
v_lshlrev_b32 v113, 2, v113
s_lshl_b32 s18, s27, 7
v_add_u32 v113, s18, v113
s_mov_b32 s58, 38797312
s_branch WF_217_in
WF_217:
s_sleep 12
WF_217_in:
buffer_load_dword v112, v113, s[8:11], s58 offen sc1
s_sub_u32 s16, s16, 1
s_cbranch_scc1 WFD_218_abort
s_waitcnt vmcnt(0)
v_cmp_eq_u32 vcc, 0, v112
s_cbranch_vccnz WF_217
WFD_218:
s_add_u32 s58, s58, 2048
buffer_load_dword v112, v113, s[8:11], s58 offen sc1
s_add_u32 s20, s19, 0
buffer_load_dwordx4 a[0:3], v96, s[8:11], s20 offen offset:0 sc1
buffer_load_dwordx4 a[4:7], v96, s[8:11], s20 offen offset:1024 sc1
s_add_u32 s20, s19, 14336
buffer_load_dwordx4 a[56:59], v96, s[8:11], s20 offen offset:0 sc1
buffer_load_dwordx4 a[60:63], v96, s[8:11], s20 offen offset:1024 sc1
s_add_u32 s20, s19, 28672
buffer_load_dwordx4 a[112:115], v96, s[8:11], s20 offen offset:0 sc1
buffer_load_dwordx4 a[116:119], v96, s[8:11], s20 offen offset:1024 sc1
s_add_u32 s20, s19, 43008
buffer_load_dwordx4 a[168:171], v96, s[8:11], s20 offen offset:0 sc1
buffer_load_dwordx4 a[172:175], v96, s[8:11], s20 offen offset:1024 sc1
s_add_u32 s20, s19, 57344
buffer_load_dwordx4 a[224:227], v96, s[8:11], s20 offen offset:0 sc1
buffer_load_dwordx4 a[228:231], v96, s[8:11], s20 offen offset:1024 sc1
s_add_u32 s20, s19, 71680
buffer_load_dwordx4 v[144:147], v96, s[8:11], s20 offen offset:0 sc1
buffer_load_dwordx4 v[148:151], v96, s[8:11], s20 offen offset:1024 sc1
s_add_u32 s20, s19, 86016
buffer_load_dwordx4 v[200:203], v96, s[8:11], s20 offen offset:0 sc1
buffer_load_dwordx4 v[204:207], v96, s[8:11], s20 offen offset:1024 sc1
s_waitcnt vmcnt(14)
v_cmp_eq_u32 vcc, 0, v112
s_cbranch_vccz OPT_219
s_nop 2
s_branch WF_220_in
WF_220:
s_sleep 12
WF_220_in:
buffer_load_dword v112, v113, s[8:11], s58 offen sc1
s_sub_u32 s16, s16, 1
s_cbranch_scc1 WFD_221_abort
s_waitcnt vmcnt(0)
v_cmp_eq_u32 vcc, 0, v112
s_cbranch_vccnz WF_220
WFD_221:
OPT_219:
s_add_u32 s58, s58, 2048
buffer_load_dword v112, v113, s[8:11], s58 offen sc1
s_add_u32 s20, s19, 2048
buffer_load_dwordx4 a[8:11], v96, s[8:11], s20 offen offset:0 sc1
buffer_load_dwordx4 a[12:15], v96, s[8:11], s20 offen offset:1024 sc1
s_add_u32 s20, s19, 16384
buffer_load_dwordx4 a[64:67], v96, s[8:11], s20 offen offset:0 sc1
buffer_load_dwordx4 a[68:71], v96, s[8:11], s20 offen offset:1024 sc1
s_add_u32 s20, s19, 30720
buffer_load_dwordx4 a[120:123], v96, s[8:11], s20 offen offset:0 sc1
buffer_load_dwordx4 a[124:127], v96, s[8:11], s20 offen offset:1024 sc1
s_add_u32 s20, s19, 45056
buffer_load_dwordx4 a[176:179], v96, s[8:11], s20 offen offset:0 sc1
buffer_load_dwordx4 a[180:183], v96, s[8:11], s20 offen offset:1024 sc1
s_add_u32 s20, s19, 59392
buffer_load_dwordx4 a[232:235], v96, s[8:11], s20 offen offset:0 sc1
buffer_load_dwordx4 a[236:239], v96, s[8:11], s20 offen offset:1024 sc1
s_add_u32 s20, s19, 73728
buffer_load_dwordx4 v[152:155], v96, s[8:11], s20 offen offset:0 sc1
buffer_load_dwordx4 v[156:159], v96, s[8:11], s20 offen offset:1024 sc1
s_add_u32 s20, s19, 88064
buffer_load_dwordx4 v[208:211], v96, s[8:11], s20 offen offset:0 sc1
buffer_load_dwordx4 v[212:215], v96, s[8:11], s20 offen offset:1024 sc1
s_waitcnt vmcnt(14)
v_cmp_eq_u32 vcc, 0, v112
s_cbranch_vccz OPT_222
s_nop 2
s_branch WF_223_in
WF_223:
s_sleep 12
WF_223_in:
buffer_load_dword v112, v113, s[8:11], s58 offen sc1
s_sub_u32 s16, s16, 1
s_cbranch_scc1 WFD_224_abort
s_waitcnt vmcnt(0)
v_cmp_eq_u32 vcc, 0, v112
s_cbranch_vccnz WF_223
WFD_224:
OPT_222:
s_add_u32 s58, s58, 2048
buffer_load_dword v112, v113, s[8:11], s58 offen sc1
s_add_u32 s20, s19, 4096
buffer_load_dwordx4 a[16:19], v96, s[8:11], s20 offen offset:0 sc1
buffer_load_dwordx4 a[20:23], v96, s[8:11], s20 offen offset:1024 sc1
s_add_u32 s20, s19, 18432
buffer_load_dwordx4 a[72:75], v96, s[8:11], s20 offen offset:0 sc1
buffer_load_dwordx4 a[76:79], v96, s[8:11], s20 offen offset:1024 sc1
s_add_u32 s20, s19, 32768
buffer_load_dwordx4 a[128:131], v96, s[8:11], s20 offen offset:0 sc1
buffer_load_dwordx4 a[132:135], v96, s[8:11], s20 offen offset:1024 sc1
s_add_u32 s20, s19, 47104
buffer_load_dwordx4 a[184:187], v96, s[8:11], s20 offen offset:0 sc1
buffer_load_dwordx4 a[188:191], v96, s[8:11], s20 offen offset:1024 sc1
s_add_u32 s20, s19, 61440
buffer_load_dwordx4 a[240:243], v96, s[8:11], s20 offen offset:0 sc1
buffer_load_dwordx4 a[244:247], v96, s[8:11], s20 offen offset:1024 sc1
s_add_u32 s20, s19, 75776
buffer_load_dwordx4 v[160:163], v96, s[8:11], s20 offen offset:0 sc1
buffer_load_dwordx4 v[164:167], v96, s[8:11], s20 offen offset:1024 sc1
s_add_u32 s20, s19, 90112
buffer_load_dwordx4 v[216:219], v96, s[8:11], s20 offen offset:0 sc1
buffer_load_dwordx4 v[220:223], v96, s[8:11], s20 offen offset:1024 sc1
s_waitcnt vmcnt(14)
v_cmp_eq_u32 vcc, 0, v112
s_cbranch_vccz OPT_225
s_nop 2
s_branch WF_226_in
WF_226:
s_sleep 12
WF_226_in:
buffer_load_dword v112, v113, s[8:11], s58 offen sc1
s_sub_u32 s16, s16, 1
s_cbranch_scc1 WFD_227_abort
s_waitcnt vmcnt(0)
v_cmp_eq_u32 vcc, 0, v112
s_cbranch_vccnz WF_226
WFD_227:
OPT_225:
s_add_u32 s58, s58, 2048
buffer_load_dword v112, v113, s[8:11], s58 offen sc1
s_add_u32 s20, s19, 6144
buffer_load_dwordx4 a[24:27], v96, s[8:11], s20 offen offset:0 sc1
buffer_load_dwordx4 a[28:31], v96, s[8:11], s20 offen offset:1024 sc1
s_add_u32 s20, s19, 20480
buffer_load_dwordx4 a[80:83], v96, s[8:11], s20 offen offset:0 sc1
buffer_load_dwordx4 a[84:87], v96, s[8:11], s20 offen offset:1024 sc1
s_add_u32 s20, s19, 34816
buffer_load_dwordx4 a[136:139], v96, s[8:11], s20 offen offset:0 sc1
buffer_load_dwordx4 a[140:143], v96, s[8:11], s20 offen offset:1024 sc1
s_add_u32 s20, s19, 49152
buffer_load_dwordx4 a[192:195], v96, s[8:11], s20 offen offset:0 sc1
buffer_load_dwordx4 a[196:199], v96, s[8:11], s20 offen offset:1024 sc1
s_add_u32 s20, s19, 63488
buffer_load_dwordx4 a[248:251], v96, s[8:11], s20 offen offset:0 sc1
buffer_load_dwordx4 a[252:255], v96, s[8:11], s20 offen offset:1024 sc1
s_add_u32 s20, s19, 77824
buffer_load_dwordx4 v[168:171], v96, s[8:11], s20 offen offset:0 sc1
buffer_load_dwordx4 v[172:175], v96, s[8:11], s20 offen offset:1024 sc1
s_add_u32 s20, s19, 92160
buffer_load_dwordx4 v[224:227], v96, s[8:11], s20 offen offset:0 sc1
buffer_load_dwordx4 v[228:231], v96, s[8:11], s20 offen offset:1024 sc1
s_waitcnt vmcnt(14)
v_cmp_eq_u32 vcc, 0, v112
s_cbranch_vccz OPT_228
s_nop 2
s_branch WF_229_in
WF_229:
s_sleep 12
WF_229_in:
buffer_load_dword v112, v113, s[8:11], s58 offen sc1
s_sub_u32 s16, s16, 1
s_cbranch_scc1 WFD_230_abort
s_waitcnt vmcnt(0)
v_cmp_eq_u32 vcc, 0, v112
s_cbranch_vccnz WF_229
WFD_230:
OPT_228:
s_add_u32 s58, s58, 2048
buffer_load_dword v112, v113, s[8:11], s58 offen sc1
s_add_u32 s20, s19, 8192
buffer_load_dwordx4 a[32:35], v96, s[8:11], s20 offen offset:0 sc1
buffer_load_dwordx4 a[36:39], v96, s[8:11], s20 offen offset:1024 sc1
s_add_u32 s20, s19, 22528
buffer_load_dwordx4 a[88:91], v96, s[8:11], s20 offen offset:0 sc1
buffer_load_dwordx4 a[92:95], v96, s[8:11], s20 offen offset:1024 sc1
s_add_u32 s20, s19, 36864
buffer_load_dwordx4 a[144:147], v96, s[8:11], s20 offen offset:0 sc1
buffer_load_dwordx4 a[148:151], v96, s[8:11], s20 offen offset:1024 sc1
s_add_u32 s20, s19, 51200
buffer_load_dwordx4 a[200:203], v96, s[8:11], s20 offen offset:0 sc1
buffer_load_dwordx4 a[204:207], v96, s[8:11], s20 offen offset:1024 sc1
s_add_u32 s20, s19, 65536
buffer_load_dwordx4 v[120:123], v96, s[8:11], s20 offen offset:0 sc1
buffer_load_dwordx4 v[124:127], v96, s[8:11], s20 offen offset:1024 sc1
s_add_u32 s20, s19, 79872
buffer_load_dwordx4 v[176:179], v96, s[8:11], s20 offen offset:0 sc1
buffer_load_dwordx4 v[180:183], v96, s[8:11], s20 offen offset:1024 sc1
s_add_u32 s20, s19, 94208
buffer_load_dwordx4 v[232:235], v96, s[8:11], s20 offen offset:0 sc1
buffer_load_dwordx4 v[236:239], v96, s[8:11], s20 offen offset:1024 sc1
s_waitcnt vmcnt(14)
v_cmp_eq_u32 vcc, 0, v112
s_cbranch_vccz OPT_231
s_nop 2
s_branch WF_232_in
WF_232:
s_sleep 12
WF_232_in:
buffer_load_dword v112, v113, s[8:11], s58 offen sc1
s_sub_u32 s16, s16, 1
s_cbranch_scc1 WFD_233_abort
s_waitcnt vmcnt(0)
v_cmp_eq_u32 vcc, 0, v112
s_cbranch_vccnz WF_232
WFD_233:
OPT_231:
s_getpc_b64 s[54:55]
WCODE_234:
s_sub_u32 s54, s54, WCODE_234-K_START
s_subb_u32 s55, s55, 0
v_mbcnt_lo_u32_b32 v112, -1, 0
v_mbcnt_hi_u32_b32 v112, -1, v112
v_lshl_add_u32 v112, v112, 5, s91
v_lshlrev_b32 v112, 6, v112
v_min_u32 v112, K_END-K_START-4, v112
global_load_dword v112, v112, s[54:55]
s_add_u32 s58, s58, 2048
buffer_load_dword v112, v113, s[8:11], s58 offen sc1
s_add_u32 s20, s19, 10240
buffer_load_dwordx4 a[40:43], v96, s[8:11], s20 offen offset:0 sc1
buffer_load_dwordx4 a[44:47], v96, s[8:11], s20 offen offset:1024 sc1
s_add_u32 s20, s19, 24576
buffer_load_dwordx4 a[96:99], v96, s[8:11], s20 offen offset:0 sc1
buffer_load_dwordx4 a[100:103], v96, s[8:11], s20 offen offset:1024 sc1
s_add_u32 s20, s19, 38912
buffer_load_dwordx4 a[152:155], v96, s[8:11], s20 offen offset:0 sc1
buffer_load_dwordx4 a[156:159], v96, s[8:11], s20 offen offset:1024 sc1
s_add_u32 s20, s19, 53248
buffer_load_dwordx4 a[208:211], v96, s[8:11], s20 offen offset:0 sc1
buffer_load_dwordx4 a[212:215], v96, s[8:11], s20 offen offset:1024 sc1
s_add_u32 s20, s19, 67584
buffer_load_dwordx4 v[128:131], v96, s[8:11], s20 offen offset:0 sc1
buffer_load_dwordx4 v[132:135], v96, s[8:11], s20 offen offset:1024 sc1
s_add_u32 s20, s19, 81920
buffer_load_dwordx4 v[184:187], v96, s[8:11], s20 offen offset:0 sc1
buffer_load_dwordx4 v[188:191], v96, s[8:11], s20 offen offset:1024 sc1
s_add_u32 s20, s19, 96256
buffer_load_dwordx4 v[240:243], v96, s[8:11], s20 offen offset:0 sc1
buffer_load_dwordx4 v[244:247], v96, s[8:11], s20 offen offset:1024 sc1
s_waitcnt vmcnt(14)
v_cmp_eq_u32 vcc, 0, v112
s_cbranch_vccz OPT_235
s_nop 2
s_branch WF_236_in
WF_236:
s_sleep 12
WF_236_in:
buffer_load_dword v112, v113, s[8:11], s58 offen sc1
s_sub_u32 s16, s16, 1
s_cbranch_scc1 WFD_237_abort
s_waitcnt vmcnt(0)
v_cmp_eq_u32 vcc, 0, v112
s_cbranch_vccnz WF_236
WFD_237:
OPT_235:
buffer_load_dword v113, off, s[92:95], 0 offset:16 sc1
s_add_u32 s20, s19, 12288
buffer_load_dwordx4 a[48:51], v96, s[8:11], s20 offen offset:0 sc1
buffer_load_dwordx4 a[52:55], v96, s[8:11], s20 offen offset:1024 sc1
s_add_u32 s20, s19, 26624
buffer_load_dwordx4 a[104:107], v96, s[8:11], s20 offen offset:0 sc1
buffer_load_dwordx4 a[108:111], v96, s[8:11], s20 offen offset:1024 sc1
s_add_u32 s20, s19, 40960
buffer_load_dwordx4 a[160:163], v96, s[8:11], s20 offen offset:0 sc1
buffer_load_dwordx4 a[164:167], v96, s[8:11], s20 offen offset:1024 sc1
s_add_u32 s20, s19, 55296
buffer_load_dwordx4 a[216:219], v96, s[8:11], s20 offen offset:0 sc1
buffer_load_dwordx4 a[220:223], v96, s[8:11], s20 offen offset:1024 sc1
s_add_u32 s20, s19, 69632
buffer_load_dwordx4 v[136:139], v96, s[8:11], s20 offen offset:0 sc1
buffer_load_dwordx4 v[140:143], v96, s[8:11], s20 offen offset:1024 sc1
s_add_u32 s20, s19, 83968
buffer_load_dwordx4 v[192:195], v96, s[8:11], s20 offen offset:0 sc1
buffer_load_dwordx4 v[196:199], v96, s[8:11], s20 offen offset:1024 sc1
s_add_u32 s20, s19, 98304
buffer_load_dwordx4 v[248:251], v96, s[8:11], s20 offen offset:0 sc1
buffer_load_dwordx4 v[252:255], v96, s[8:11], s20 offen offset:1024 sc1
s_waitcnt vmcnt(14)
PL_I_238:
v_cmp_gt_u32 vcc, 32, v113
s_cbranch_vccnz PL_I_238_p
PL_I_238_ok:
s_lshl_b32 s18, s14, 6
s_add_u32 s18, s18, s15
s_mul_i32 s21, s18, 28672
s_add_u32 s21, s21, 39845888
s_mul_i32 s22, s18, 7168
s_add_u32 s22, s22, 35815424
s_mul_i32 s23, s18, 40960
s_add_u32 s23, s23, 54525952
s_lshl_b32 s24, s18, 9
s_lshl_b32 s25, s17, 2
s_add_u32 s25, s25, s24
s_add_u32 s25, s25, 37814272
s_lshr_b32 s20, s27, 2
s_lshl_b32 s20, s20, 6
s_add_u32 s25, s25, s20
s_lshl_b32 s24, s24, 2
s_add_u32 s24, s24, 38535168
s_mov_b32 s26, 0
v_mov_b32 v109, 0
v_mov_b32 v110, 1
v_min_u32 v108, 55, v1
v_lshrrev_b32 v112, 2, v108
v_mul_u32_u24 v112, 12, v112
v_add_lshl_u32 v108, v108, v112, 3
v_lshrrev_b32 v112, 4, v1
v_and_b32 v113, 15, v1
v_and_b32 v118, 1, v1
v_lshlrev_b32 v118, 4, v118
v_bfe_u32 v119, v1, 1, 1
v_lshl_add_u32 v118, v119, 2, v118
v_bfe_u32 v119, v1, 2, 2
v_add_u32 v118, v118, v119
v_lshlrev_b32 v97, 9, v112
v_lshl_add_u32 v97, v118, 4, v97
s_mul_i32 s18, s12, 14
s_lshl_b32 s19, s18, 9
v_add_u32 v98, s19, v97
v_lshrrev_b32 v114, 5, v1
v_add_u32 v114, s18, v114
v_and_b32 v115, 1, v112
v_lshlrev_b32 v99, 9, v114
v_lshl_add_u32 v99, v118, 4, v99
v_lshl_add_u32 v99, v115, 3, v99
v_and_b32 v116, 7, v1
v_add_u32 v100, s18, v112
v_lshlrev_b32 v100, 7, v100
v_lshl_add_u32 v100, v116, 4, v100
v_lshlrev_b32 v101, 7, v114
v_lshl_add_u32 v101, v116, 4, v101
v_lshl_add_u32 v101, v115, 3, v101
s_mul_i32 s19, s12, 4608
s_add_u32 s19, s19, 57344
v_mul_u32_u24 v102, 144, v113
v_lshl_add_u32 v102, v112, 4, v102
v_add_u32 v102, s19, v102
s_lshl_b32 s19, s12, 10
s_add_u32 s19, s19, 75776
v_lshlrev_b32 v104, 5, v113
v_lshl_add_u32 v104, v115, 4, v104
v_add_u32 v104, s19, v104
v_lshrrev_b32 v111, 3, v1
s_lshl_b32 s19, s12, 3
v_add_u32 v111, s19, v111
v_mul_u32_u24 v103, 144, v111
v_lshl_add_u32 v103, v116, 4, v103
v_add_u32 v103, 57344, v103
v_lshlrev_b32 v105, 5, v111
v_lshl_add_u32 v105, v116, 2, v105
v_add_u32 v105, 75776, v105
v_lshrrev_b32 v117, 1, v116
v_lshlrev_b32 v107, 9, v117
v_lshl_add_u32 v107, v111, 4, v107
v_and_b32 v117, 1, v1
v_lshl_add_u32 v106, v117, 3, v107
s_lshr_b32 s18, s27, 2
s_mul_i32 s18, s18, 10240
s_and_b32 s19, s27, 3
s_lshl_b32 s20, s19, 11
s_add_u32 s20, s20, s18
v_add_u32 v106, s20, v106
s_lshl_b32 s20, s19, 2
s_add_u32 s20, s20, s18
s_add_u32 s20, s20, 8192
v_add_u32 v107, s20, v107
v_lshlrev_b32 v117, 2, v116
v_sub_u32 v111, v111, v117
v_cmp_le_i32 s[40:41], 0, v111
v_cmp_le_i32 s[42:43], 1, v111
v_cmp_le_i32 s[44:45], 2, v111
v_cmp_le_i32 s[46:47], 3, v111
v_mov_b32 v111, 0xf149f2ca
s_mov_b32 s48, 0x55555555
s_mov_b32 s49, 0x55555555
s_mov_b32 s52, 28672
s_lshl_b32 s36, s12, 10
s_add_u32 s21, s21, s36
s_mov_b64 vcc, 0
s_mov_b64 vcc, 0
T_LOOP_239:
s_lshr_b32 s17, s15, 1
s_lshl_b32 s18, s14, 2
s_add_u32 s17, s17, s18
s_cmp_lg_u32 s17, 4
s_cbranch_scc1 PXG_241
s_mov_b64 s[54:55], vcc
s_cmp_lg_u32 s12, 0
s_cbranch_scc1 WC_242_d
s_branch WC_242_in
WC_242:
s_sleep 16
WC_242_in:
s_mov_b32 s58, 38207488
buffer_load_dword v112, off, s[8:11], s58 sc1
s_sub_u32 s16, s16, 1
s_cbranch_scc1 WC_242_ab
s_waitcnt vmcnt(0)
v_cmp_gt_u32 vcc, 96, v112
s_cbranch_vccnz WC_242
WC_242_d:
s_barrier
s_mov_b64 vcc, s[54:55]
PXG_241:
s_add_u32 s37, s26, s36
s_cbranch_vccnz T_ND_240
s_branch WF_243_in
WF_243:
s_sleep 1
WF_243_in:
buffer_load_dwordx2 v[112:113], v108, s[8:11], s24 offen sc1
s_sub_u32 s16, s16, 1
s_cbranch_scc1 WFD_244_abort
s_waitcnt vmcnt(0)
v_min_u32 v112, v112, v113
v_cmp_eq_u32 vcc, 0, v112
s_cbranch_vccnz WF_243
WFD_244:
s_mov_b32 m0, s37
s_nop 0
buffer_load_dwordx4 v96, s[8:11], s21 offen sc1 lds
s_add_u32 m0, m0, 4096
s_add_u32 s21, s21, 4096
buffer_load_dwordx4 v96, s[8:11], s21 offen sc1 lds
s_add_u32 m0, m0, 4096
s_add_u32 s21, s21, 4096
buffer_load_dwordx4 v96, s[8:11], s21 offen sc1 lds
s_add_u32 m0, m0, 4096
s_add_u32 s21, s21, 4096
buffer_load_dwordx4 v96, s[8:11], s21 offen sc1 lds
s_add_u32 m0, m0, 4096
s_add_u32 s21, s21, 4096
buffer_load_dwordx4 v96, s[8:11], s21 offen sc1 lds
s_add_u32 m0, m0, 4096
s_add_u32 s21, s21, 4096
buffer_load_dwordx4 v96, s[8:11], s21 offen sc1 lds
s_add_u32 m0, m0, 4096
s_add_u32 s21, s21, 4096
buffer_load_dwordx4 v96, s[8:11], s21 offen sc1 lds
s_add_u32 m0, m0, 4096
s_add_u32 s21, s21, 4096
s_add_u32 s21, s21, 28672
T_ND_240:
s_xor_b32 s26, s26, 28672
s_add_u32 s37, s26, s36
s_add_u32 s24, s24, 4096
s_waitcnt vmcnt(6)
s_barrier
ds_read_b128 v[84:87], v97 offset:0
ds_read_b128 v[88:91], v97 offset:2048
s_waitcnt lgkmcnt(1)
v_mfma_f32_16x16x32_bf16 v[0:3], a[0:3], v[84:87], 0
v_mfma_f32_16x16x32_bf16 v[4:7], a[56:59], v[84:87], 0
v_mfma_f32_16x16x32_bf16 v[8:11], a[112:115], v[84:87], 0
v_mfma_f32_16x16x32_bf16 v[12:15], a[168:171], v[84:87], 0
v_mfma_f32_16x16x32_bf16 v[16:19], a[224:227], v[84:87], 0
v_mfma_f32_16x16x32_bf16 v[20:23], v[144:147], v[84:87], 0
v_mfma_f32_16x16x32_bf16 v[24:27], v[200:203], v[84:87], 0
s_waitcnt vmcnt(5)
s_barrier
ds_read_b128 v[92:95], v97 offset:4096
s_waitcnt lgkmcnt(1)
v_mfma_f32_16x16x32_bf16 v[0:3], a[4:7], v[88:91], v[0:3]
v_mfma_f32_16x16x32_bf16 v[4:7], a[60:63], v[88:91], v[4:7]
v_mfma_f32_16x16x32_bf16 v[8:11], a[116:119], v[88:91], v[8:11]
v_mfma_f32_16x16x32_bf16 v[12:15], a[172:175], v[88:91], v[12:15]
v_mfma_f32_16x16x32_bf16 v[16:19], a[228:231], v[88:91], v[16:19]
v_mfma_f32_16x16x32_bf16 v[20:23], v[148:151], v[88:91], v[20:23]
v_mfma_f32_16x16x32_bf16 v[24:27], v[204:207], v[88:91], v[24:27]
ds_read_b128 v[84:87], v97 offset:6144
s_waitcnt lgkmcnt(1)
v_mfma_f32_16x16x32_bf16 v[0:3], a[8:11], v[92:95], v[0:3]
v_mfma_f32_16x16x32_bf16 v[4:7], a[64:67], v[92:95], v[4:7]
v_mfma_f32_16x16x32_bf16 v[8:11], a[120:123], v[92:95], v[8:11]
v_mfma_f32_16x16x32_bf16 v[12:15], a[176:179], v[92:95], v[12:15]
v_mfma_f32_16x16x32_bf16 v[16:19], a[232:235], v[92:95], v[16:19]
v_mfma_f32_16x16x32_bf16 v[20:23], v[152:155], v[92:95], v[20:23]
v_mfma_f32_16x16x32_bf16 v[24:27], v[208:211], v[92:95], v[24:27]
s_waitcnt vmcnt(3)
s_barrier
ds_read_b128 v[88:91], v97 offset:8192
s_waitcnt lgkmcnt(1)
v_mfma_f32_16x16x32_bf16 v[0:3], a[12:15], v[84:87], v[0:3]
v_mfma_f32_16x16x32_bf16 v[4:7], a[68:71], v[84:87], v[4:7]
v_mfma_f32_16x16x32_bf16 v[8:11], a[124:127], v[84:87], v[8:11]
v_mfma_f32_16x16x32_bf16 v[12:15], a[180:183], v[84:87], v[12:15]
v_mfma_f32_16x16x32_bf16 v[16:19], a[236:239], v[84:87], v[16:19]
v_mfma_f32_16x16x32_bf16 v[20:23], v[156:159], v[84:87], v[20:23]
v_mfma_f32_16x16x32_bf16 v[24:27], v[212:215], v[84:87], v[24:27]
ds_read_b128 v[92:95], v97 offset:10240
s_waitcnt lgkmcnt(1)
v_mfma_f32_16x16x32_bf16 v[0:3], a[16:19], v[88:91], v[0:3]
v_mfma_f32_16x16x32_bf16 v[4:7], a[72:75], v[88:91], v[4:7]
v_mfma_f32_16x16x32_bf16 v[8:11], a[128:131], v[88:91], v[8:11]
v_mfma_f32_16x16x32_bf16 v[12:15], a[184:187], v[88:91], v[12:15]
v_mfma_f32_16x16x32_bf16 v[16:19], a[240:243], v[88:91], v[16:19]
v_mfma_f32_16x16x32_bf16 v[20:23], v[160:163], v[88:91], v[20:23]
v_mfma_f32_16x16x32_bf16 v[24:27], v[216:219], v[88:91], v[24:27]
ds_read_b128 v[84:87], v97 offset:12288
s_waitcnt lgkmcnt(1)
v_mfma_f32_16x16x32_bf16 v[0:3], a[20:23], v[92:95], v[0:3]
v_mfma_f32_16x16x32_bf16 v[4:7], a[76:79], v[92:95], v[4:7]
v_mfma_f32_16x16x32_bf16 v[8:11], a[132:135], v[92:95], v[8:11]
v_mfma_f32_16x16x32_bf16 v[12:15], a[188:191], v[92:95], v[12:15]
v_mfma_f32_16x16x32_bf16 v[16:19], a[244:247], v[92:95], v[16:19]
v_mfma_f32_16x16x32_bf16 v[20:23], v[164:167], v[92:95], v[20:23]
v_mfma_f32_16x16x32_bf16 v[24:27], v[220:223], v[92:95], v[24:27]
ds_read_b128 v[88:91], v97 offset:14336
s_waitcnt lgkmcnt(1)
v_mfma_f32_16x16x32_bf16 v[0:3], a[24:27], v[84:87], v[0:3]
v_mfma_f32_16x16x32_bf16 v[4:7], a[80:83], v[84:87], v[4:7]
v_mfma_f32_16x16x32_bf16 v[8:11], a[136:139], v[84:87], v[8:11]
v_mfma_f32_16x16x32_bf16 v[12:15], a[192:195], v[84:87], v[12:15]
v_mfma_f32_16x16x32_bf16 v[16:19], a[248:251], v[84:87], v[16:19]
v_mfma_f32_16x16x32_bf16 v[20:23], v[168:171], v[84:87], v[20:23]
v_mfma_f32_16x16x32_bf16 v[24:27], v[224:227], v[84:87], v[24:27]
s_cbranch_vccnz OPT_245
s_waitcnt vmcnt(0)
OPT_245:
s_barrier
ds_read_b128 v[92:95], v97 offset:16384
s_waitcnt lgkmcnt(1)
v_mfma_f32_16x16x32_bf16 v[0:3], a[28:31], v[88:91], v[0:3]
v_mfma_f32_16x16x32_bf16 v[4:7], a[84:87], v[88:91], v[4:7]
v_mfma_f32_16x16x32_bf16 v[8:11], a[140:143], v[88:91], v[8:11]
v_mfma_f32_16x16x32_bf16 v[12:15], a[196:199], v[88:91], v[12:15]
v_mfma_f32_16x16x32_bf16 v[16:19], a[252:255], v[88:91], v[16:19]
v_mfma_f32_16x16x32_bf16 v[20:23], v[172:175], v[88:91], v[20:23]
v_mfma_f32_16x16x32_bf16 v[24:27], v[228:231], v[88:91], v[24:27]
ds_read_b128 v[84:87], v97 offset:18432
s_waitcnt lgkmcnt(1)
v_mfma_f32_16x16x32_bf16 v[0:3], a[32:35], v[92:95], v[0:3]
buffer_load_dwordx2 v[118:119], v108, s[8:11], s24 offen sc1
v_mfma_f32_16x16x32_bf16 v[4:7], a[88:91], v[92:95], v[4:7]
v_mfma_f32_16x16x32_bf16 v[8:11], a[144:147], v[92:95], v[8:11]
v_mfma_f32_16x16x32_bf16 v[12:15], a[200:203], v[92:95], v[12:15]
v_mfma_f32_16x16x32_bf16 v[16:19], v[120:123], v[92:95], v[16:19]
v_mfma_f32_16x16x32_bf16 v[20:23], v[176:179], v[92:95], v[20:23]
v_mfma_f32_16x16x32_bf16 v[24:27], v[232:235], v[92:95], v[24:27]
ds_read_b128 v[88:91], v97 offset:20480
s_waitcnt lgkmcnt(1)
v_mfma_f32_16x16x32_bf16 v[0:3], a[36:39], v[84:87], v[0:3]
v_mfma_f32_16x16x32_bf16 v[4:7], a[92:95], v[84:87], v[4:7]
v_mfma_f32_16x16x32_bf16 v[8:11], a[148:151], v[84:87], v[8:11]
v_mfma_f32_16x16x32_bf16 v[12:15], a[204:207], v[84:87], v[12:15]
v_mfma_f32_16x16x32_bf16 v[16:19], v[124:127], v[84:87], v[16:19]
v_mfma_f32_16x16x32_bf16 v[20:23], v[180:183], v[84:87], v[20:23]
v_mfma_f32_16x16x32_bf16 v[24:27], v[236:239], v[84:87], v[24:27]
ds_read_b128 v[92:95], v97 offset:22528
s_waitcnt lgkmcnt(1)
v_mfma_f32_16x16x32_bf16 v[0:3], a[40:43], v[88:91], v[0:3]
v_mfma_f32_16x16x32_bf16 v[4:7], a[96:99], v[88:91], v[4:7]
v_mfma_f32_16x16x32_bf16 v[8:11], a[152:155], v[88:91], v[8:11]
v_mfma_f32_16x16x32_bf16 v[12:15], a[208:211], v[88:91], v[12:15]
v_mfma_f32_16x16x32_bf16 v[16:19], v[128:131], v[88:91], v[16:19]
v_mfma_f32_16x16x32_bf16 v[20:23], v[184:187], v[88:91], v[20:23]
v_mfma_f32_16x16x32_bf16 v[24:27], v[240:243], v[88:91], v[24:27]
ds_read_b128 v[84:87], v97 offset:24576
s_waitcnt lgkmcnt(1)
v_mfma_f32_16x16x32_bf16 v[0:3], a[44:47], v[92:95], v[0:3]
v_mfma_f32_16x16x32_bf16 v[4:7], a[100:103], v[92:95], v[4:7]
v_mfma_f32_16x16x32_bf16 v[8:11], a[156:159], v[92:95], v[8:11]
v_mfma_f32_16x16x32_bf16 v[12:15], a[212:215], v[92:95], v[12:15]
v_mfma_f32_16x16x32_bf16 v[16:19], v[132:135], v[92:95], v[16:19]
v_mfma_f32_16x16x32_bf16 v[20:23], v[188:191], v[92:95], v[20:23]
v_mfma_f32_16x16x32_bf16 v[24:27], v[244:247], v[92:95], v[24:27]
ds_read_b128 v[88:91], v97 offset:26624
s_waitcnt lgkmcnt(1)
v_mfma_f32_16x16x32_bf16 v[0:3], a[48:51], v[84:87], v[0:3]
v_mfma_f32_16x16x32_bf16 v[4:7], a[104:107], v[84:87], v[4:7]
v_mfma_f32_16x16x32_bf16 v[8:11], a[160:163], v[84:87], v[8:11]
v_mfma_f32_16x16x32_bf16 v[12:15], a[216:219], v[84:87], v[12:15]
v_mfma_f32_16x16x32_bf16 v[16:19], v[136:139], v[84:87], v[16:19]
v_mfma_f32_16x16x32_bf16 v[20:23], v[192:195], v[84:87], v[20:23]
v_mfma_f32_16x16x32_bf16 v[24:27], v[248:251], v[84:87], v[24:27]
ds_read_b128 v[92:95], v97 offset:128
s_waitcnt lgkmcnt(1)
v_mfma_f32_16x16x32_bf16 v[0:3], a[52:55], v[88:91], v[0:3]
v_mfma_f32_16x16x32_bf16 v[4:7], a[108:111], v[88:91], v[4:7]
v_mfma_f32_16x16x32_bf16 v[8:11], a[164:167], v[88:91], v[8:11]
v_mfma_f32_16x16x32_bf16 v[12:15], a[220:223], v[88:91], v[12:15]
v_mfma_f32_16x16x32_bf16 v[16:19], v[140:143], v[88:91], v[16:19]
v_mfma_f32_16x16x32_bf16 v[20:23], v[196:199], v[88:91], v[20:23]
v_mfma_f32_16x16x32_bf16 v[24:27], v[252:255], v[88:91], v[24:27]
ds_read_b128 v[84:87], v97 offset:2176
s_waitcnt lgkmcnt(1)
v_mfma_f32_16x16x32_bf16 v[28:31], a[0:3], v[92:95], 0
v_mfma_f32_16x16x32_bf16 v[32:35], a[56:59], v[92:95], 0
v_mfma_f32_16x16x32_bf16 v[36:39], a[112:115], v[92:95], 0
v_mfma_f32_16x16x32_bf16 v[40:43], a[168:171], v[92:95], 0
v_mfma_f32_16x16x32_bf16 v[44:47], a[224:227], v[92:95], 0
v_mfma_f32_16x16x32_bf16 v[48:51], v[144:147], v[92:95], 0
v_mfma_f32_16x16x32_bf16 v[52:55], v[200:203], v[92:95], 0
ds_read_b128 v[88:91], v97 offset:4224
s_waitcnt lgkmcnt(1)
v_mfma_f32_16x16x32_bf16 v[28:31], a[4:7], v[84:87], v[28:31]
v_cvt_pk_bf16_f32 v56, v0, v1
v_cvt_pk_bf16_f32 v57, v2, v3
v_mfma_f32_16x16x32_bf16 v[32:35], a[60:63], v[84:87], v[32:35]
v_cvt_pk_bf16_f32 v58, v4, v5
v_cvt_pk_bf16_f32 v59, v6, v7
v_mfma_f32_16x16x32_bf16 v[36:39], a[116:119], v[84:87], v[36:39]
v_cvt_pk_bf16_f32 v60, v8, v9
v_cvt_pk_bf16_f32 v61, v10, v11
v_mfma_f32_16x16x32_bf16 v[40:43], a[172:175], v[84:87], v[40:43]
v_cvt_pk_bf16_f32 v62, v12, v13
v_cvt_pk_bf16_f32 v63, v14, v15
v_mfma_f32_16x16x32_bf16 v[44:47], a[228:231], v[84:87], v[44:47]
v_cvt_pk_bf16_f32 v64, v16, v17
v_cvt_pk_bf16_f32 v65, v18, v19
v_mfma_f32_16x16x32_bf16 v[48:51], v[148:151], v[84:87], v[48:51]
v_cvt_pk_bf16_f32 v66, v20, v21
v_cvt_pk_bf16_f32 v67, v22, v23
v_mfma_f32_16x16x32_bf16 v[52:55], v[204:207], v[84:87], v[52:55]
ds_read_b128 v[92:95], v97 offset:6272
s_waitcnt lgkmcnt(1)
v_mfma_f32_16x16x32_bf16 v[28:31], a[8:11], v[88:91], v[28:31]
v_cvt_pk_bf16_f32 v68, v24, v25
v_cvt_pk_bf16_f32 v69, v26, v27
v_mfma_f32_16x16x32_bf16 v[32:35], a[64:67], v[88:91], v[32:35]
v_mfma_f32_16x16x32_bf16 v[36:39], a[120:123], v[88:91], v[36:39]
v_mfma_f32_16x16x32_bf16 v[40:43], a[176:179], v[88:91], v[40:43]
v_mfma_f32_16x16x32_bf16 v[44:47], a[232:235], v[88:91], v[44:47]
v_mfma_f32_16x16x32_bf16 v[48:51], v[152:155], v[88:91], v[48:51]
v_mfma_f32_16x16x32_bf16 v[52:55], v[208:211], v[88:91], v[52:55]
ds_read_b128 v[84:87], v97 offset:8320
s_waitcnt lgkmcnt(1)
v_mfma_f32_16x16x32_bf16 v[28:31], a[12:15], v[92:95], v[28:31]
v_mfma_f32_16x16x32_bf16 v[32:35], a[68:71], v[92:95], v[32:35]
v_mfma_f32_16x16x32_bf16 v[36:39], a[124:127], v[92:95], v[36:39]
v_mfma_f32_16x16x32_bf16 v[40:43], a[180:183], v[92:95], v[40:43]
v_mfma_f32_16x16x32_bf16 v[44:47], a[236:239], v[92:95], v[44:47]
v_mfma_f32_16x16x32_bf16 v[48:51], v[156:159], v[92:95], v[48:51]
v_mfma_f32_16x16x32_bf16 v[52:55], v[212:215], v[92:95], v[52:55]
ds_read_b128 v[88:91], v97 offset:10368
s_waitcnt lgkmcnt(1)
v_mfma_f32_16x16x32_bf16 v[28:31], a[16:19], v[84:87], v[28:31]
v_mfma_f32_16x16x32_bf16 v[32:35], a[72:75], v[84:87], v[32:35]
v_mfma_f32_16x16x32_bf16 v[36:39], a[128:131], v[84:87], v[36:39]
v_mfma_f32_16x16x32_bf16 v[40:43], a[184:187], v[84:87], v[40:43]
v_mfma_f32_16x16x32_bf16 v[44:47], a[240:243], v[84:87], v[44:47]
v_mfma_f32_16x16x32_bf16 v[48:51], v[160:163], v[84:87], v[48:51]
v_mfma_f32_16x16x32_bf16 v[52:55], v[216:219], v[84:87], v[52:55]
ds_read_b128 v[92:95], v97 offset:12416
s_waitcnt lgkmcnt(1)
v_mfma_f32_16x16x32_bf16 v[28:31], a[20:23], v[88:91], v[28:31]
v_mfma_f32_16x16x32_bf16 v[32:35], a[76:79], v[88:91], v[32:35]
v_mfma_f32_16x16x32_bf16 v[36:39], a[132:135], v[88:91], v[36:39]
v_mfma_f32_16x16x32_bf16 v[40:43], a[188:191], v[88:91], v[40:43]
v_mfma_f32_16x16x32_bf16 v[44:47], a[244:247], v[88:91], v[44:47]
v_mfma_f32_16x16x32_bf16 v[48:51], v[164:167], v[88:91], v[48:51]
v_mfma_f32_16x16x32_bf16 v[52:55], v[220:223], v[88:91], v[52:55]
ds_read_b128 v[84:87], v97 offset:14464
s_waitcnt lgkmcnt(1)
v_mfma_f32_16x16x32_bf16 v[28:31], a[24:27], v[92:95], v[28:31]
s_waitcnt vmcnt(0)
v_min_u32 v118, v118, v119
v_cmp_eq_u32 vcc, 0, v118
s_nop 0
s_cmp_eq_u64 vcc, 0
s_cselect_b64 vcc, -1, 0
v_mfma_f32_16x16x32_bf16 v[32:35], a[80:83], v[92:95], v[32:35]
v_mfma_f32_16x16x32_bf16 v[36:39], a[136:139], v[92:95], v[36:39]
v_mfma_f32_16x16x32_bf16 v[40:43], a[192:195], v[92:95], v[40:43]
v_mfma_f32_16x16x32_bf16 v[44:47], a[248:251], v[92:95], v[44:47]
v_mfma_f32_16x16x32_bf16 v[48:51], v[168:171], v[92:95], v[48:51]
v_mfma_f32_16x16x32_bf16 v[52:55], v[224:227], v[92:95], v[52:55]
ds_read_b128 v[88:91], v97 offset:16512
s_waitcnt lgkmcnt(1)
v_mfma_f32_16x16x32_bf16 v[28:31], a[28:31], v[84:87], v[28:31]
s_cbranch_vccz OPT_246
s_mov_b32 m0, s37
s_nop 0
buffer_load_dwordx4 v96, s[8:11], s21 offen sc1 lds
s_add_u32 m0, m0, 4096
s_add_u32 s21, s21, 4096
OPT_246:
v_mfma_f32_16x16x32_bf16 v[32:35], a[84:87], v[84:87], v[32:35]
v_mfma_f32_16x16x32_bf16 v[36:39], a[140:143], v[84:87], v[36:39]
v_mfma_f32_16x16x32_bf16 v[40:43], a[196:199], v[84:87], v[40:43]
v_mfma_f32_16x16x32_bf16 v[44:47], a[252:255], v[84:87], v[44:47]
v_mfma_f32_16x16x32_bf16 v[48:51], v[172:175], v[84:87], v[48:51]
v_mfma_f32_16x16x32_bf16 v[52:55], v[228:231], v[84:87], v[52:55]
ds_read_b128 v[92:95], v97 offset:18560
s_waitcnt lgkmcnt(1)
v_mfma_f32_16x16x32_bf16 v[28:31], a[32:35], v[88:91], v[28:31]
s_cbranch_vccz OPT_247
buffer_load_dwordx4 v96, s[8:11], s21 offen sc1 lds
s_add_u32 m0, m0, 4096
s_add_u32 s21, s21, 4096
OPT_247:
v_mfma_f32_16x16x32_bf16 v[32:35], a[88:91], v[88:91], v[32:35]
v_mfma_f32_16x16x32_bf16 v[36:39], a[144:147], v[88:91], v[36:39]
v_mfma_f32_16x16x32_bf16 v[40:43], a[200:203], v[88:91], v[40:43]
v_mfma_f32_16x16x32_bf16 v[44:47], v[120:123], v[88:91], v[44:47]
v_mfma_f32_16x16x32_bf16 v[48:51], v[176:179], v[88:91], v[48:51]
v_mfma_f32_16x16x32_bf16 v[52:55], v[232:235], v[88:91], v[52:55]
ds_read_b128 v[84:87], v97 offset:20608
s_waitcnt lgkmcnt(1)
v_mfma_f32_16x16x32_bf16 v[28:31], a[36:39], v[92:95], v[28:31]
s_cbranch_vccz OPT_248
buffer_load_dwordx4 v96, s[8:11], s21 offen sc1 lds
s_add_u32 m0, m0, 4096
s_add_u32 s21, s21, 4096
OPT_248:
v_mfma_f32_16x16x32_bf16 v[32:35], a[92:95], v[92:95], v[32:35]
v_mfma_f32_16x16x32_bf16 v[36:39], a[148:151], v[92:95], v[36:39]
v_mfma_f32_16x16x32_bf16 v[40:43], a[204:207], v[92:95], v[40:43]
v_mfma_f32_16x16x32_bf16 v[44:47], v[124:127], v[92:95], v[44:47]
v_mfma_f32_16x16x32_bf16 v[48:51], v[180:183], v[92:95], v[48:51]
v_mfma_f32_16x16x32_bf16 v[52:55], v[236:239], v[92:95], v[52:55]
ds_read_b128 v[88:91], v97 offset:22656
s_waitcnt lgkmcnt(1)
v_mfma_f32_16x16x32_bf16 v[28:31], a[40:43], v[84:87], v[28:31]
s_cbranch_vccz OPT_249
buffer_load_dwordx4 v96, s[8:11], s21 offen sc1 lds
s_add_u32 m0, m0, 4096
s_add_u32 s21, s21, 4096
OPT_249:
v_mfma_f32_16x16x32_bf16 v[32:35], a[96:99], v[84:87], v[32:35]
v_mfma_f32_16x16x32_bf16 v[36:39], a[152:155], v[84:87], v[36:39]
v_mfma_f32_16x16x32_bf16 v[40:43], a[208:211], v[84:87], v[40:43]
v_mfma_f32_16x16x32_bf16 v[44:47], v[128:131], v[84:87], v[44:47]
v_mfma_f32_16x16x32_bf16 v[48:51], v[184:187], v[84:87], v[48:51]
v_mfma_f32_16x16x32_bf16 v[52:55], v[240:243], v[84:87], v[52:55]
ds_read_b128 v[92:95], v97 offset:24704
s_waitcnt lgkmcnt(1)
v_mfma_f32_16x16x32_bf16 v[28:31], a[44:47], v[88:91], v[28:31]
s_cbranch_vccz OPT_250
buffer_load_dwordx4 v96, s[8:11], s21 offen sc1 lds
s_add_u32 m0, m0, 4096
s_add_u32 s21, s21, 4096
OPT_250:
v_mfma_f32_16x16x32_bf16 v[32:35], a[100:103], v[88:91], v[32:35]
v_mfma_f32_16x16x32_bf16 v[36:39], a[156:159], v[88:91], v[36:39]
v_mfma_f32_16x16x32_bf16 v[40:43], a[212:215], v[88:91], v[40:43]
v_mfma_f32_16x16x32_bf16 v[44:47], v[132:135], v[88:91], v[44:47]
v_mfma_f32_16x16x32_bf16 v[48:51], v[188:191], v[88:91], v[48:51]
v_mfma_f32_16x16x32_bf16 v[52:55], v[244:247], v[88:91], v[52:55]
ds_read_b128 v[84:87], v97 offset:26752
s_waitcnt lgkmcnt(1)
v_mfma_f32_16x16x32_bf16 v[28:31], a[48:51], v[92:95], v[28:31]
s_cbranch_vccz OPT_251
buffer_load_dwordx4 v96, s[8:11], s21 offen sc1 lds
s_add_u32 m0, m0, 4096
s_add_u32 s21, s21, 4096
OPT_251:
v_mfma_f32_16x16x32_bf16 v[32:35], a[104:107], v[92:95], v[32:35]
v_mfma_f32_16x16x32_bf16 v[36:39], a[160:163], v[92:95], v[36:39]
v_mfma_f32_16x16x32_bf16 v[40:43], a[216:219], v[92:95], v[40:43]
v_mfma_f32_16x16x32_bf16 v[44:47], v[136:139], v[92:95], v[44:47]
v_mfma_f32_16x16x32_bf16 v[48:51], v[192:195], v[92:95], v[48:51]
v_mfma_f32_16x16x32_bf16 v[52:55], v[248:251], v[92:95], v[52:55]
s_waitcnt lgkmcnt(0)
v_mfma_f32_16x16x32_bf16 v[28:31], a[52:55], v[84:87], v[28:31]
s_cbranch_vccz OPT_252
buffer_load_dwordx4 v96, s[8:11], s21 offen sc1 lds
s_add_u32 m0, m0, 4096
s_add_u32 s21, s21, 4096
s_add_u32 s21, s21, 28672
OPT_252:
v_mfma_f32_16x16x32_bf16 v[32:35], a[108:111], v[84:87], v[32:35]
v_mfma_f32_16x16x32_bf16 v[36:39], a[164:167], v[84:87], v[36:39]
v_mfma_f32_16x16x32_bf16 v[40:43], a[220:223], v[84:87], v[40:43]
v_mfma_f32_16x16x32_bf16 v[44:47], v[140:143], v[84:87], v[44:47]
v_mfma_f32_16x16x32_bf16 v[48:51], v[196:199], v[84:87], v[48:51]
v_mfma_f32_16x16x32_bf16 v[52:55], v[252:255], v[84:87], v[52:55]
s_mov_b64 s[50:51], vcc
ds_read_b64 v[12:13], v99 offset:0
ds_read_b64 v[14:15], v99 offset:1024
ds_read_b64 v[16:17], v99 offset:128
ds_read_b64 v[18:19], v99 offset:1152
ds_read_b64 v[20:21], v99 offset:2048
ds_read_b64 v[22:23], v99 offset:3072
ds_read_b64 v[24:25], v99 offset:2176
ds_read_b64 v[26:27], v99 offset:3200
v_cvt_pk_bf16_f32 v70, v28, v29
v_cvt_pk_bf16_f32 v71, v30, v31
v_cvt_pk_bf16_f32 v72, v32, v33
v_cvt_pk_bf16_f32 v73, v34, v35
v_cvt_pk_bf16_f32 v74, v36, v37
v_cvt_pk_bf16_f32 v75, v38, v39
v_cvt_pk_bf16_f32 v76, v40, v41
v_cvt_pk_bf16_f32 v77, v42, v43
v_cvt_pk_bf16_f32 v78, v44, v45
v_cvt_pk_bf16_f32 v79, v46, v47
v_cvt_pk_bf16_f32 v80, v48, v49
v_cvt_pk_bf16_f32 v81, v50, v51
v_cvt_pk_bf16_f32 v82, v52, v53
v_cvt_pk_bf16_f32 v83, v54, v55
buffer_load_dwordx2 v[36:37], v101, s[8:11], s22 offen offset:0 sc1
buffer_load_dwordx2 v[38:39], v101, s[8:11], s22 offen offset:256 sc1
buffer_load_dwordx2 v[40:41], v101, s[8:11], s22 offen offset:512 sc1
buffer_load_dwordx2 v[42:43], v101, s[8:11], s22 offen offset:768 sc1
buffer_load_dwordx2 v[44:45], v101, s[8:11], s22 offen offset:1024 sc1
buffer_load_dwordx2 v[46:47], v101, s[8:11], s22 offen offset:1280 sc1
buffer_load_dwordx2 v[48:49], v101, s[8:11], s22 offen offset:1536 sc1
s_waitcnt lgkmcnt(4)
v_mfma_f32_16x16x32_bf16 v[0:3], v[12:15], v[56:59], 0
v_mfma_f32_16x16x32_bf16 v[4:7], v[12:15], v[70:73], 0
v_mfma_f32_16x16x32_bf16 v[8:11], v[16:19], v[70:73], 0
ds_read_b64 v[12:13], v99 offset:4096
ds_read_b64 v[14:15], v99 offset:5120
ds_read_b64 v[16:17], v99 offset:4224
ds_read_b64 v[18:19], v99 offset:5248
s_waitcnt lgkmcnt(4)
v_mfma_f32_16x16x32_bf16 v[0:3], v[20:23], v[60:63], v[0:3]
v_mfma_f32_16x16x32_bf16 v[4:7], v[20:23], v[74:77], v[4:7]
v_mfma_f32_16x16x32_bf16 v[8:11], v[24:27], v[74:77], v[8:11]
ds_read_b64 v[20:21], v99 offset:6144
ds_read_b64 v[24:25], v99 offset:6272
s_waitcnt lgkmcnt(2)
v_mfma_f32_16x16x32_bf16 v[0:3], v[12:15], v[64:67], v[0:3]
v_mfma_f32_16x16x32_bf16 v[4:7], v[12:15], v[78:81], v[4:7]
v_mfma_f32_16x16x32_bf16 v[8:11], v[16:19], v[78:81], v[8:11]
s_waitcnt lgkmcnt(0)
v_mfma_f32_16x16x16_bf16 v[0:3], v[20:21], v[68:69], v[0:3]
v_mfma_f32_16x16x16_bf16 v[4:7], v[20:21], v[82:83], v[4:7]
v_mfma_f32_16x16x16_bf16 v[8:11], v[24:25], v[82:83], v[8:11]
s_nop 5
ds_write_b128 v102, v[0:3] offset:0
ds_write_b128 v102, v[4:7] offset:2304
ds_write_b128 v102, v[8:11] offset:2368
s_waitcnt lgkmcnt(0)
s_barrier
ds_read_b128 v[12:15], v103 offset:0
ds_read_b128 v[16:19], v103 offset:4608
ds_read_b128 v[20:23], v103 offset:9216
ds_read_b128 v[24:27], v103 offset:13824
s_waitcnt lgkmcnt(2)
v_pk_add_f32 v[50:51], v[12:13], v[16:17]
v_pk_add_f32 v[52:53], v[14:15], v[18:19]
s_waitcnt lgkmcnt(0)
v_pk_add_f32 v[20:21], v[20:21], v[24:25]
v_pk_add_f32 v[22:23], v[22:23], v[26:27]
v_pk_add_f32 v[50:51], v[50:51], v[20:21]
v_pk_add_f32 v[52:53], v[52:53], v[22:23]
v_cndmask_b32 v50, v111, v50, s[40:41]
v_cndmask_b32 v51, v111, v51, s[42:43]
v_cndmask_b32 v52, v111, v52, s[44:45]
v_cndmask_b32 v53, v111, v53, s[46:47]
v_max3_f32 v54, v50, v51, v52
v_max_f32 v54, v54, v53
s_waitcnt vmcnt(0)
v_max3_u32 v112, v36, v37, v38
v_max3_u32 v112, v112, v39, v40
v_max3_u32 v112, v112, v41, v42
v_max3_u32 v112, v112, v43, v44
v_max3_u32 v112, v112, v45, v46
v_max3_u32 v112, v112, v47, v48
v_max_u32 v112, v112, v49
v_cmp_eq_u32 vcc, -1, v112
s_cbranch_vccz OPT_253
s_nop 2
s_branch POLL_254_in
POLL_254:
s_sleep 1
POLL_254_in:
buffer_load_dwordx2 v[36:37], v101, s[8:11], s22 offen offset:0 sc1
buffer_load_dwordx2 v[38:39], v101, s[8:11], s22 offen offset:256 sc1
buffer_load_dwordx2 v[40:41], v101, s[8:11], s22 offen offset:512 sc1
buffer_load_dwordx2 v[42:43], v101, s[8:11], s22 offen offset:768 sc1
buffer_load_dwordx2 v[44:45], v101, s[8:11], s22 offen offset:1024 sc1
buffer_load_dwordx2 v[46:47], v101, s[8:11], s22 offen offset:1280 sc1
buffer_load_dwordx2 v[48:49], v101, s[8:11], s22 offen offset:1536 sc1
s_sub_u32 s16, s16, 1
s_cbranch_scc1 POLLD_255_abort
s_waitcnt vmcnt(0)
v_max3_u32 v112, v36, v37, v38
v_max3_u32 v112, v112, v39, v40
v_max3_u32 v112, v112, v41, v42
v_max3_u32 v112, v112, v43, v44
v_max3_u32 v112, v112, v45, v46
v_max3_u32 v112, v112, v47, v48
v_max_u32 v112, v112, v49
v_cmp_eq_u32 vcc, -1, v112
s_cbranch_vccnz POLL_254
POLLD_255:
OPT_253:
v_mfma_f32_16x16x32_bf16 v[28:31], v[36:39], v[56:59], 0
v_mfma_f32_16x16x32_bf16 v[32:35], v[36:39], v[70:73], 0
v_mfma_f32_16x16x32_bf16 v[28:31], v[40:43], v[60:63], v[28:31]
v_mfma_f32_16x16x32_bf16 v[32:35], v[40:43], v[74:77], v[32:35]
v_mfma_f32_16x16x32_bf16 v[28:31], v[44:47], v[64:67], v[28:31]
v_mfma_f32_16x16x32_bf16 v[32:35], v[44:47], v[78:81], v[32:35]
v_mfma_f32_16x16x16_bf16 v[28:31], v[48:49], v[68:69], v[28:31]
v_mfma_f32_16x16x16_bf16 v[32:35], v[48:49], v[82:83], v[32:35]
s_nop 6
ds_write_b128 v104, v[28:31] offset:0
ds_write_b128 v104, v[32:35] offset:512
s_waitcnt lgkmcnt(0)
s_barrier
ds_read2st64_b32 v[114:115], v105 offset0:0 offset1:4
ds_read2st64_b32 v[116:117], v105 offset0:8 offset1:12
s_waitcnt lgkmcnt(0)
v_pk_add_f32 v[114:115], v[114:115], v[116:117]
v_add_f32 v114, v114, v115
v_max_f32 v112, v54, v114
s_nop 1
v_max_f32_dpp v112, v112, v112 quad_perm:[1,0,3,2] row_mask:0xf bank_mask:0xf
s_nop 1
v_max_f32_dpp v112, v112, v112 quad_perm:[2,3,0,1] row_mask:0xf bank_mask:0xf
s_nop 1
v_max_f32_dpp v112, v112, v112 row_half_mirror row_mask:0xf bank_mask:0xf
v_sub_f32 v114, v114, v112
v_pk_add_f32 v[50:51], v[50:51], v[112:113] op_sel_hi:[1,0] neg_lo:[0,1] neg_hi:[0,1]
v_pk_add_f32 v[52:53], v[52:53], v[112:113] op_sel_hi:[1,0] neg_lo:[0,1] neg_hi:[0,1]
v_exp_f32 v114, v114
v_exp_f32 v50, v50
v_exp_f32 v51, v51
v_exp_f32 v52, v52
v_exp_f32 v53, v53
v_add_f32 v112, v114, v50
v_add_f32 v112, v112, v51
v_add_f32 v112, v112, v52
v_add_f32 v112, v112, v53
s_nop 1
v_add_f32_dpp v112, v112, v112 quad_perm:[1,0,3,2] row_mask:0xf bank_mask:0xf
s_nop 1
v_add_f32_dpp v112, v112, v112 quad_perm:[2,3,0,1] row_mask:0xf bank_mask:0xf
s_nop 1
v_add_f32_dpp v112, v112, v112 row_half_mirror row_mask:0xf bank_mask:0xf
v_rcp_f32 v112, v112
s_nop 0
v_mul_f32 v114, v114, v112
v_pk_mul_f32 v[50:51], v[50:51], v[112:113] op_sel_hi:[1,0]
v_pk_mul_f32 v[52:53], v[52:53], v[112:113] op_sel_hi:[1,0]
v_mov_b32_dpp v115, v114 quad_perm:[1,0,3,2] row_mask:0xf bank_mask:0xf
v_cvt_pk_bf16_f32 v50, v50, v51
v_cvt_pk_bf16_f32 v51, v52, v53
v_cvt_pk_bf16_f32 v114, v114, v115
v_min_u32 v50, -2, v50
v_min_u32 v51, -2, v51
v_min_u32 v114, -2, v114
buffer_store_dwordx2 v[50:51], v106, s[8:11], s23 offen sc1
s_mov_b64 exec, s[48:49]
buffer_store_dword v114, v107, s[8:11], s23 offen sc1
s_mov_b64 exec, -1
s_mov_b64 vcc, s[50:51]
v_xor_b32 v97, 28672, v97
v_add_u32 v98, s52, v98
v_add_u32 v99, s52, v99
s_sub_u32 s52, 0, s52
s_add_u32 s22, s22, 14336
s_add_u32 s23, s23, 81920
s_add_u32 s25, s25, 1024
s_add_u32 s15, s15, 2
s_cmp_lt_u32 s15, 64
s_cbranch_scc1 T_LOOP_239
s_endpgm
M_U:
s_cmp_ge_u32 s13, 28
s_cbranch_scc1 M_FILL
buffer_load_dword v17, off, s[92:95], 0 offset:144 sc1
s_lshl_b32 s17, s13, 2
s_add_u32 s17, s17, s12
s_mul_i32 s19, s17, 57344
s_add_u32 s19, s19, 22020096
v_lshlrev_b32 v2, 4, v1
s_mul_i32 s18, s17, 4682
s_lshr_b32 s18, s18, 16
s_mul_i32 s19, s18, 14
s_sub_u32 s19, s17, s19
s_mul_i32 s27, s18, 57344
s_lshl_b32 s19, s19, 11
s_add_u32 s27, s27, s19
s_add_u32 s27, s27, 100663296
s_lshr_b32 s31, s17, 3
s_mul_i32 s31, s31, 24
s_add_u32 s31, s31, s17
s_lshl_b32 s31, s31, 2
s_add_u32 s31, s31, 38273024
v_mov_b32 v4, 0
v_mov_b32 v5, 1
s_mul_i32 s44, s18, 14
s_add_u32 s44, s44, s17
s_mul_i32 s44, s44, 28672
s_add_u32 s44, s44, 7340032
s_add_u32 s45, s44, 401408
v_and_b32 v3, 1, v1
v_lshlrev_b32 v3, 7, v3
s_lshl_b32 s18, s18, 8
s_lshr_b32 s19, s19, 9
s_add_u32 s18, s18, s19
s_add_u32 s18, s18, 14336
v_add_u32 v3, s18, v3
v_mov_b32 v28, 0x3f803f80
v_mov_b32 v29, 0x3f803f80
v_mov_b32 v30, 0x3f803f80
v_mov_b32 v31, 0x3f803f80
s_mov_b32 s58, 38797312
s_branch WF_256_in
WF_256:
s_sleep 12
WF_256_in:
buffer_load_dword v18, v3, s[8:11], s58 offen sc1
s_sub_u32 s16, s16, 1
s_cbranch_scc1 WFD_257_abort
s_waitcnt vmcnt(0)
v_cmp_eq_u32 vcc, 0, v18
s_cbranch_vccnz WF_256
WFD_257:
s_add_u32 s58, s58, 2048
buffer_load_dword v18, v3, s[8:11], s58 offen sc1
buffer_load_dwordx4 a[0:3], v2, s[8:11], s44 offen offset:0 sc1
buffer_load_dwordx4 a[4:7], v2, s[8:11], s44 offen offset:1024 sc1
buffer_load_dwordx4 a[8:11], v2, s[8:11], s44 offen offset:2048 sc1
buffer_load_dwordx4 a[12:15], v2, s[8:11], s44 offen offset:3072 sc1
s_add_u32 s44, s44, 4096
buffer_load_dwordx4 a[112:115], v2, s[8:11], s45 offen offset:0 sc1
buffer_load_dwordx4 a[116:119], v2, s[8:11], s45 offen offset:1024 sc1
buffer_load_dwordx4 a[120:123], v2, s[8:11], s45 offen offset:2048 sc1
buffer_load_dwordx4 a[124:127], v2, s[8:11], s45 offen offset:3072 sc1
s_add_u32 s45, s45, 4096
s_waitcnt vmcnt(8)
v_cmp_eq_u32 vcc, 0, v18
s_cbranch_vccz OPT_258
s_nop 2
s_branch WF_259_in
WF_259:
s_sleep 12
WF_259_in:
buffer_load_dword v18, v3, s[8:11], s58 offen sc1
s_sub_u32 s16, s16, 1
s_cbranch_scc1 WFD_260_abort
s_waitcnt vmcnt(0)
v_cmp_eq_u32 vcc, 0, v18
s_cbranch_vccnz WF_259
WFD_260:
OPT_258:
s_add_u32 s58, s58, 2048
buffer_load_dword v18, v3, s[8:11], s58 offen sc1
buffer_load_dwordx4 a[16:19], v2, s[8:11], s44 offen offset:0 sc1
buffer_load_dwordx4 a[20:23], v2, s[8:11], s44 offen offset:1024 sc1
buffer_load_dwordx4 a[24:27], v2, s[8:11], s44 offen offset:2048 sc1
buffer_load_dwordx4 a[28:31], v2, s[8:11], s44 offen offset:3072 sc1
s_add_u32 s44, s44, 4096
buffer_load_dwordx4 a[128:131], v2, s[8:11], s45 offen offset:0 sc1
buffer_load_dwordx4 a[132:135], v2, s[8:11], s45 offen offset:1024 sc1
buffer_load_dwordx4 a[136:139], v2, s[8:11], s45 offen offset:2048 sc1
buffer_load_dwordx4 a[140:143], v2, s[8:11], s45 offen offset:3072 sc1
s_add_u32 s45, s45, 4096
s_waitcnt vmcnt(9)
v_mfma_f32_32x32x16_bf16 v[48:63], v[28:31], a[0:3], 0
v_mfma_f32_32x32x16_bf16 v[64:79], v[28:31], a[112:115], 0
v_mfma_f32_32x32x16_bf16 v[48:63], v[28:31], a[4:7], v[48:63]
v_mfma_f32_32x32x16_bf16 v[64:79], v[28:31], a[116:119], v[64:79]
v_mfma_f32_32x32x16_bf16 v[48:63], v[28:31], a[8:11], v[48:63]
v_mfma_f32_32x32x16_bf16 v[64:79], v[28:31], a[120:123], v[64:79]
v_mfma_f32_32x32x16_bf16 v[48:63], v[28:31], a[12:15], v[48:63]
v_mfma_f32_32x32x16_bf16 v[64:79], v[28:31], a[124:127], v[64:79]
s_waitcnt vmcnt(8)
v_cmp_eq_u32 vcc, 0, v18
s_cbranch_vccz OPT_261
s_nop 7
s_branch WF_262_in
WF_262:
s_sleep 12
WF_262_in:
buffer_load_dword v18, v3, s[8:11], s58 offen sc1
s_sub_u32 s16, s16, 1
s_cbranch_scc1 WFD_263_abort
s_waitcnt vmcnt(0)
v_cmp_eq_u32 vcc, 0, v18
s_cbranch_vccnz WF_262
WFD_263:
OPT_261:
s_add_u32 s58, s58, 2048
buffer_load_dword v18, v3, s[8:11], s58 offen sc1
buffer_load_dwordx4 a[32:35], v2, s[8:11], s44 offen offset:0 sc1
buffer_load_dwordx4 a[36:39], v2, s[8:11], s44 offen offset:1024 sc1
buffer_load_dwordx4 a[40:43], v2, s[8:11], s44 offen offset:2048 sc1
buffer_load_dwordx4 a[44:47], v2, s[8:11], s44 offen offset:3072 sc1
s_add_u32 s44, s44, 4096
buffer_load_dwordx4 a[144:147], v2, s[8:11], s45 offen offset:0 sc1
buffer_load_dwordx4 a[148:151], v2, s[8:11], s45 offen offset:1024 sc1
buffer_load_dwordx4 a[152:155], v2, s[8:11], s45 offen offset:2048 sc1
buffer_load_dwordx4 a[156:159], v2, s[8:11], s45 offen offset:3072 sc1
s_add_u32 s45, s45, 4096
s_waitcnt vmcnt(9)
v_mfma_f32_32x32x16_bf16 v[48:63], v[28:31], a[16:19], v[48:63]
v_mfma_f32_32x32x16_bf16 v[64:79], v[28:31], a[128:131], v[64:79]
v_mfma_f32_32x32x16_bf16 v[48:63], v[28:31], a[20:23], v[48:63]
v_mfma_f32_32x32x16_bf16 v[64:79], v[28:31], a[132:135], v[64:79]
v_mfma_f32_32x32x16_bf16 v[48:63], v[28:31], a[24:27], v[48:63]
v_mfma_f32_32x32x16_bf16 v[64:79], v[28:31], a[136:139], v[64:79]
v_mfma_f32_32x32x16_bf16 v[48:63], v[28:31], a[28:31], v[48:63]
v_mfma_f32_32x32x16_bf16 v[64:79], v[28:31], a[140:143], v[64:79]
s_waitcnt vmcnt(8)
v_cmp_eq_u32 vcc, 0, v18
s_cbranch_vccz OPT_264
s_nop 7
s_branch WF_265_in
WF_265:
s_sleep 12
WF_265_in:
buffer_load_dword v18, v3, s[8:11], s58 offen sc1
s_sub_u32 s16, s16, 1
s_cbranch_scc1 WFD_266_abort
s_waitcnt vmcnt(0)
v_cmp_eq_u32 vcc, 0, v18
s_cbranch_vccnz WF_265
WFD_266:
OPT_264:
s_add_u32 s58, s58, 2048
buffer_load_dword v18, v3, s[8:11], s58 offen sc1
buffer_load_dwordx4 a[48:51], v2, s[8:11], s44 offen offset:0 sc1
buffer_load_dwordx4 a[52:55], v2, s[8:11], s44 offen offset:1024 sc1
buffer_load_dwordx4 a[56:59], v2, s[8:11], s44 offen offset:2048 sc1
buffer_load_dwordx4 a[60:63], v2, s[8:11], s44 offen offset:3072 sc1
s_add_u32 s44, s44, 4096
buffer_load_dwordx4 a[160:163], v2, s[8:11], s45 offen offset:0 sc1
buffer_load_dwordx4 a[164:167], v2, s[8:11], s45 offen offset:1024 sc1
buffer_load_dwordx4 a[168:171], v2, s[8:11], s45 offen offset:2048 sc1
buffer_load_dwordx4 a[172:175], v2, s[8:11], s45 offen offset:3072 sc1
s_add_u32 s45, s45, 4096
s_waitcnt vmcnt(9)
v_mfma_f32_32x32x16_bf16 v[48:63], v[28:31], a[32:35], v[48:63]
v_mfma_f32_32x32x16_bf16 v[64:79], v[28:31], a[144:147], v[64:79]
v_mfma_f32_32x32x16_bf16 v[48:63], v[28:31], a[36:39], v[48:63]
v_mfma_f32_32x32x16_bf16 v[64:79], v[28:31], a[148:151], v[64:79]
v_mfma_f32_32x32x16_bf16 v[48:63], v[28:31], a[40:43], v[48:63]
v_mfma_f32_32x32x16_bf16 v[64:79], v[28:31], a[152:155], v[64:79]
v_mfma_f32_32x32x16_bf16 v[48:63], v[28:31], a[44:47], v[48:63]
v_mfma_f32_32x32x16_bf16 v[64:79], v[28:31], a[156:159], v[64:79]
s_waitcnt vmcnt(8)
v_cmp_eq_u32 vcc, 0, v18
s_cbranch_vccz OPT_267
s_nop 7
s_branch WF_268_in
WF_268:
s_sleep 12
WF_268_in:
buffer_load_dword v18, v3, s[8:11], s58 offen sc1
s_sub_u32 s16, s16, 1
s_cbranch_scc1 WFD_269_abort
s_waitcnt vmcnt(0)
v_cmp_eq_u32 vcc, 0, v18
s_cbranch_vccnz WF_268
WFD_269:
OPT_267:
s_add_u32 s58, s58, 2048
buffer_load_dword v18, v3, s[8:11], s58 offen sc1
buffer_load_dwordx4 a[64:67], v2, s[8:11], s44 offen offset:0 sc1
buffer_load_dwordx4 a[68:71], v2, s[8:11], s44 offen offset:1024 sc1
buffer_load_dwordx4 a[72:75], v2, s[8:11], s44 offen offset:2048 sc1
buffer_load_dwordx4 a[76:79], v2, s[8:11], s44 offen offset:3072 sc1
s_add_u32 s44, s44, 4096
buffer_load_dwordx4 a[176:179], v2, s[8:11], s45 offen offset:0 sc1
buffer_load_dwordx4 a[180:183], v2, s[8:11], s45 offen offset:1024 sc1
buffer_load_dwordx4 a[184:187], v2, s[8:11], s45 offen offset:2048 sc1
buffer_load_dwordx4 a[188:191], v2, s[8:11], s45 offen offset:3072 sc1
s_add_u32 s45, s45, 4096
s_waitcnt vmcnt(9)
v_mfma_f32_32x32x16_bf16 v[48:63], v[28:31], a[48:51], v[48:63]
v_mfma_f32_32x32x16_bf16 v[64:79], v[28:31], a[160:163], v[64:79]
v_mfma_f32_32x32x16_bf16 v[48:63], v[28:31], a[52:55], v[48:63]
v_mfma_f32_32x32x16_bf16 v[64:79], v[28:31], a[164:167], v[64:79]
v_mfma_f32_32x32x16_bf16 v[48:63], v[28:31], a[56:59], v[48:63]
v_mfma_f32_32x32x16_bf16 v[64:79], v[28:31], a[168:171], v[64:79]
v_mfma_f32_32x32x16_bf16 v[48:63], v[28:31], a[60:63], v[48:63]
v_mfma_f32_32x32x16_bf16 v[64:79], v[28:31], a[172:175], v[64:79]
s_waitcnt vmcnt(8)
v_cmp_eq_u32 vcc, 0, v18
s_cbranch_vccz OPT_270
s_nop 7
s_branch WF_271_in
WF_271:
s_sleep 12
WF_271_in:
buffer_load_dword v18, v3, s[8:11], s58 offen sc1
s_sub_u32 s16, s16, 1
s_cbranch_scc1 WFD_272_abort
s_waitcnt vmcnt(0)
v_cmp_eq_u32 vcc, 0, v18
s_cbranch_vccnz WF_271
WFD_272:
OPT_270:
s_getpc_b64 s[54:55]
WCODE_273:
s_sub_u32 s54, s54, WCODE_273-K_START
s_subb_u32 s55, s55, 0
v_mbcnt_lo_u32_b32 v18, -1, 0
v_mbcnt_hi_u32_b32 v18, -1, v18
v_lshl_add_u32 v18, v18, 5, s91
v_lshlrev_b32 v18, 6, v18
v_min_u32 v18, K_END-K_START-4, v18
global_load_dword v18, v18, s[54:55]
s_add_u32 s58, s58, 2048
buffer_load_dword v18, v3, s[8:11], s58 offen sc1
buffer_load_dwordx4 a[80:83], v2, s[8:11], s44 offen offset:0 sc1
buffer_load_dwordx4 a[84:87], v2, s[8:11], s44 offen offset:1024 sc1
buffer_load_dwordx4 a[88:91], v2, s[8:11], s44 offen offset:2048 sc1
buffer_load_dwordx4 a[92:95], v2, s[8:11], s44 offen offset:3072 sc1
s_add_u32 s44, s44, 4096
buffer_load_dwordx4 a[192:195], v2, s[8:11], s45 offen offset:0 sc1
buffer_load_dwordx4 a[196:199], v2, s[8:11], s45 offen offset:1024 sc1
buffer_load_dwordx4 a[200:203], v2, s[8:11], s45 offen offset:2048 sc1
buffer_load_dwordx4 a[204:207], v2, s[8:11], s45 offen offset:3072 sc1
s_add_u32 s45, s45, 4096
s_waitcnt vmcnt(10)
buffer_load_dword v17, off, s[92:95], 0 offset:144 sc1
v_mfma_f32_32x32x16_bf16 v[48:63], v[28:31], a[64:67], v[48:63]
v_mfma_f32_32x32x16_bf16 v[64:79], v[28:31], a[176:179], v[64:79]
v_mfma_f32_32x32x16_bf16 v[48:63], v[28:31], a[68:71], v[48:63]
v_mfma_f32_32x32x16_bf16 v[64:79], v[28:31], a[180:183], v[64:79]
v_mfma_f32_32x32x16_bf16 v[48:63], v[28:31], a[72:75], v[48:63]
v_mfma_f32_32x32x16_bf16 v[64:79], v[28:31], a[184:187], v[64:79]
v_mfma_f32_32x32x16_bf16 v[48:63], v[28:31], a[76:79], v[48:63]
v_mfma_f32_32x32x16_bf16 v[64:79], v[28:31], a[188:191], v[64:79]
s_waitcnt vmcnt(9)
v_cmp_eq_u32 vcc, 0, v18
s_cbranch_vccz OPT_274
s_nop 7
s_branch WF_275_in
WF_275:
s_sleep 12
WF_275_in:
buffer_load_dword v18, v3, s[8:11], s58 offen sc1
s_sub_u32 s16, s16, 1
s_cbranch_scc1 WFD_276_abort
s_waitcnt vmcnt(0)
v_cmp_eq_u32 vcc, 0, v18
s_cbranch_vccnz WF_275
WFD_276:
OPT_274:
buffer_load_dword v3, off, s[92:95], 0 offset:16 sc1
buffer_load_dwordx4 a[96:99], v2, s[8:11], s44 offen offset:0 sc1
buffer_load_dwordx4 a[100:103], v2, s[8:11], s44 offen offset:1024 sc1
buffer_load_dwordx4 a[104:107], v2, s[8:11], s44 offen offset:2048 sc1
buffer_load_dwordx4 a[108:111], v2, s[8:11], s44 offen offset:3072 sc1
s_add_u32 s44, s44, 4096
buffer_load_dwordx4 a[208:211], v2, s[8:11], s45 offen offset:0 sc1
buffer_load_dwordx4 a[212:215], v2, s[8:11], s45 offen offset:1024 sc1
buffer_load_dwordx4 a[216:219], v2, s[8:11], s45 offen offset:2048 sc1
buffer_load_dwordx4 a[220:223], v2, s[8:11], s45 offen offset:3072 sc1
s_add_u32 s45, s45, 4096
s_waitcnt vmcnt(10)
v_mfma_f32_32x32x16_bf16 v[48:63], v[28:31], a[80:83], v[48:63]
v_mfma_f32_32x32x16_bf16 v[64:79], v[28:31], a[192:195], v[64:79]
v_mfma_f32_32x32x16_bf16 v[48:63], v[28:31], a[84:87], v[48:63]
v_mfma_f32_32x32x16_bf16 v[64:79], v[28:31], a[196:199], v[64:79]
v_mfma_f32_32x32x16_bf16 v[48:63], v[28:31], a[88:91], v[48:63]
v_mfma_f32_32x32x16_bf16 v[64:79], v[28:31], a[200:203], v[64:79]
v_mfma_f32_32x32x16_bf16 v[48:63], v[28:31], a[92:95], v[48:63]
v_mfma_f32_32x32x16_bf16 v[64:79], v[28:31], a[204:207], v[64:79]
s_waitcnt vmcnt(8)
PL_I_277:
v_cmp_gt_u32 vcc, 32, v3
s_cbranch_vccnz PL_I_277_p
PL_I_277_ok:
s_waitcnt vmcnt(0)
v_mfma_f32_32x32x16_bf16 v[48:63], v[28:31], a[96:99], v[48:63]
v_mfma_f32_32x32x16_bf16 v[64:79], v[28:31], a[208:211], v[64:79]
v_mfma_f32_32x32x16_bf16 v[48:63], v[28:31], a[100:103], v[48:63]
v_mfma_f32_32x32x16_bf16 v[64:79], v[28:31], a[212:215], v[64:79]
v_mfma_f32_32x32x16_bf16 v[48:63], v[28:31], a[104:107], v[48:63]
v_mfma_f32_32x32x16_bf16 v[64:79], v[28:31], a[216:219], v[64:79]
v_mfma_f32_32x32x16_bf16 v[48:63], v[28:31], a[108:111], v[48:63]
v_mfma_f32_32x32x16_bf16 v[64:79], v[28:31], a[220:223], v[64:79]
U_X0_278:
v_cmp_gt_u32 vcc, 64, v17
s_cbranch_vccnz U_X0_278_p
U_X0_278_ok:
v_and_b32 v3, 0x13, v1
v_and_b32 v18, 4, v1
v_lshl_or_b32 v3, v18, 1, v3
v_and_b32 v18, 8, v1
v_lshrrev_b32 v18, 1, v18
v_or_b32 v3, v3, v18
v_and_b32 v13, 32, v1
v_lshlrev_b32 v13, 4, v13
v_and_b32 v18, 1, v1
v_lshl_add_u32 v13, v18, 8, v13
v_bfe_u32 v18, v1, 4, 1
v_lshl_add_u32 v13, v18, 7, v13
v_bfe_u32 v18, v1, 1, 1
v_lshl_add_u32 v13, v18, 6, v13
v_bfe_u32 v18, v1, 2, 2
v_lshl_add_u32 v13, v18, 4, v13
v_lshrrev_b32 v18, 5, v1
v_lshlrev_b32 v3, 4, v3
v_lshl_add_u32 v3, v18, 9, v3
v_and_b32 v19, 31, v1
v_mov_b32 v6, v2
v_min_u32 v7, 27, v1
v_lshrrev_b32 v4, 3, v7
v_mul_u32_u24 v4, 24, v4
v_add_lshl_u32 v7, v7, v4, 2
v_mov_b32 v4, 0
s_lshl_b32 s17, s12, 8
s_add_u32 s17, s17, 57344
v_lshlrev_b32 v8, 2, v19
v_add_u32 v8, s17, v8
v_lshlrev_b32 v9, 5, v18
v_add_u32 v9, s17, v9
v_mov_b32 v10, v2
s_lshl_b32 s17, s12, 4
s_mov_b64 s[32:33], 0xffff
s_lshl_b64 s[32:33], s[32:33], s17
v_mov_b32 v14, v48
v_mov_b32 v16, v64
s_mov_b32 s21, s14
s_mov_b32 s22, s14
s_mov_b32 s25, 0
s_mov_b32 s26, 0
s_lshl_b32 s36, s12, 10
s_lshl_b32 s41, s13, 10
s_mov_b32 s35, 0
s_add_u32 s17, s22, 14
s_min_u32 s17, s17, 64
s_cmp_lt_u32 s21, s17
s_cselect_b32 s23, 0, 1
s_cselect_b32 s24, s21, s22
s_cselect_b32 s17, 2, 0
s_add_u32 s21, s21, s17
s_lshl_b32 s17, s23, 1
s_add_u32 s22, s22, s17
s_lshl_b32 s19, s23, 7
s_add_u32 s19, s19, s24
s_mul_i32 s40, s19, 28672
s_add_u32 s40, s40, 44040192
s_add_u32 s28, s40, s36
s_add_u32 s40, s40, s41
s_add_u32 s37, s25, s36
s_lshl_b32 s39, s19, 11
s_add_u32 s39, s39, 39321600
s_lshl_b32 s42, s24, 9
s_add_u32 s42, s42, 38076416
s_branch U_COLD_279
U_CW_282:
s_branch WF_284_in
WF_284:
s_sleep 1
WF_284_in:
buffer_load_dword v18, v7, s[8:11], s42 offen sc1
s_sub_u32 s16, s16, 1
s_cbranch_scc1 WFD_285_abort
s_waitcnt vmcnt(0)
v_cmp_eq_u32 vcc, 0, v18
s_cbranch_vccnz WF_284
WFD_285:
U_COLD_279:
buffer_load_dwordx4 v[20:23], v6, s[8:11], s39 offen sc1
buffer_load_dwordx4 v[24:27], v6, s[8:11], s39 offen offset:1024 sc1
s_mov_b64 exec, s[32:33]
buffer_load_dwordx4 v[160:163], v2, s[8:11], s40 offen sc1
s_mov_b64 exec, -1
s_mov_b32 m0, s37
s_nop 0
buffer_load_dwordx4 v2, s[8:11], s28 offen sc1 lds
s_add_u32 m0, m0, 4096
s_add_u32 s28, s28, 4096
buffer_load_dwordx4 v2, s[8:11], s28 offen sc1 lds
s_add_u32 m0, m0, 4096
s_add_u32 s28, s28, 4096
buffer_load_dwordx4 v2, s[8:11], s28 offen sc1 lds
s_add_u32 m0, m0, 4096
s_add_u32 s28, s28, 4096
buffer_load_dwordx4 v2, s[8:11], s28 offen sc1 lds
s_add_u32 m0, m0, 4096
s_add_u32 s28, s28, 4096
buffer_load_dwordx4 v2, s[8:11], s28 offen sc1 lds
s_add_u32 m0, m0, 4096
s_add_u32 s28, s28, 4096
buffer_load_dwordx4 v2, s[8:11], s28 offen sc1 lds
s_add_u32 m0, m0, 4096
s_add_u32 s28, s28, 4096
buffer_load_dwordx4 v2, s[8:11], s28 offen sc1 lds
s_add_u32 m0, m0, 4096
s_add_u32 s28, s28, 4096
v_add_u32 v11, s25, v3
s_xor_b32 s25, s25, 28672
s_lshl_b32 s19, s23, 6
s_add_u32 s15, s19, s24
s_add_u32 s17, s22, 14
s_min_u32 s17, s17, 64
s_cmp_lt_u32 s21, s17
s_cselect_b32 s23, 0, 1
s_cselect_b32 s24, s21, s22
s_cselect_b32 s17, 2, 0
s_add_u32 s21, s21, s17
s_lshl_b32 s17, s23, 1
s_add_u32 s22, s22, s17
s_cmp_eq_u32 s23, 1
s_cbranch_scc1 U_N1_286
s_waitcnt vmcnt(6)
s_barrier
ds_read_b128 v[176:179], v11 offset:0
ds_read_b128 v[180:183], v11 offset:1024
ds_read_b128 v[184:187], v11 offset:2048
s_waitcnt lgkmcnt(2)
v_mfma_f32_32x32x16_bf16 v[48:63], v[176:179], a[0:3], 0
ds_read_b128 v[188:191], v11 offset:3072
v_add_f32 v20, v20, v22
v_add_f32 v21, v21, v23
v_add_f32 v24, v24, v26
v_add_f32 v25, v25, v27
v_add_f32 v20, v20, v24
v_mfma_f32_32x32x16_bf16 v[64:79], v[176:179], a[112:115], 0
s_waitcnt vmcnt(5)
s_barrier
ds_read_b128 v[192:195], v11 offset:4096
v_add_f32 v21, v21, v25
v_mov_b32 v18, v20
s_waitcnt lgkmcnt(3)
v_mfma_f32_32x32x16_bf16 v[48:63], v[180:183], a[4:7], v[48:63]
ds_read_b128 v[196:199], v11 offset:5120
v_mov_b32 v19, v21
v_permlane32_swap_b32 v18, v20
s_nop 0
v_permlane32_swap_b32 v19, v21
v_add_f32 v20, v20, v18
v_mfma_f32_32x32x16_bf16 v[64:79], v[180:183], a[116:119], v[64:79]
ds_read_b128 v[200:203], v11 offset:6144
v_add_f32 v21, v21, v19
v_mul_f32 v18, 0x3b124925, v20
v_mul_f32 v19, 0x3b124925, v21
v_fma_f32 v19, -v18, v18, v19
s_waitcnt lgkmcnt(4)
v_mfma_f32_32x32x16_bf16 v[48:63], v[184:187], a[8:11], v[48:63]
ds_read_b128 v[204:207], v11 offset:7168
v_max_f32 v19, 0, v19
v_add_f32 v19, 0x3727c5ac, v19
v_rsq_f32 v20, v19
v_mov_b32 v21, v18
v_mfma_f32_32x32x16_bf16 v[64:79], v[184:187], a[120:123], v[64:79]
s_waitcnt vmcnt(3)
s_barrier
ds_read_b128 v[176:179], v11 offset:8192
s_mul_i32 s29, s15, 458752
s_add_u32 s29, s29, s27
s_waitcnt lgkmcnt(5)
v_mfma_f32_32x32x16_bf16 v[48:63], v[188:191], a[12:15], v[48:63]
ds_read_b128 v[180:183], v11 offset:9216
s_lshl_b32 s30, s15, 11
s_add_u32 s30, s30, s31
s_mul_i32 s34, s15, 28672
s_add_u32 s34, s34, s41
s_add_u32 s34, s34, 39845888
v_mfma_f32_32x32x16_bf16 v[64:79], v[188:191], a[124:127], v[64:79]
ds_read_b128 v[184:187], v11 offset:10240
s_add_u32 s43, s30, 262144
s_mov_b32 s46, 1
v_mul_f32 v22, v20, v21
v_sub_f32 v22, 0, v22
s_waitcnt lgkmcnt(6)
v_mfma_f32_32x32x16_bf16 v[48:63], v[192:195], a[16:19], v[48:63]
ds_write2_b32 v8, v20, v22 offset0:0 offset1:32
v_lshlrev_b32 v164, 16, v160
v_and_b32 v165, 0xffff0000, v160
v_fma_f32 v164, v164, v20, v22
v_fma_f32 v165, v165, v20, v22
v_cvt_pk_bf16_f32 v172, v164, v165
v_mfma_f32_32x32x16_bf16 v[64:79], v[192:195], a[128:131], v[64:79]
ds_read_b128 v[188:191], v11 offset:11264
v_lshlrev_b32 v166, 16, v161
v_and_b32 v167, 0xffff0000, v161
v_fma_f32 v166, v166, v20, v22
v_fma_f32 v167, v167, v20, v22
s_waitcnt lgkmcnt(7)
v_mfma_f32_32x32x16_bf16 v[48:63], v[196:199], a[20:23], v[48:63]
v_cvt_pk_bf16_f32 v173, v166, v167
v_lshlrev_b32 v168, 16, v162
v_and_b32 v169, 0xffff0000, v162
v_fma_f32 v168, v168, v20, v22
v_fma_f32 v169, v169, v20, v22
v_cvt_pk_bf16_f32 v174, v168, v169
v_mfma_f32_32x32x16_bf16 v[64:79], v[196:199], a[132:135], v[64:79]
ds_read_b128 v[192:195], v11 offset:12288
v_lshlrev_b32 v170, 16, v163
v_and_b32 v171, 0xffff0000, v163
v_fma_f32 v170, v170, v20, v22
v_fma_f32 v171, v171, v20, v22
s_waitcnt lgkmcnt(7)
v_mfma_f32_32x32x16_bf16 v[48:63], v[200:203], a[24:27], v[48:63]
v_cvt_pk_bf16_f32 v175, v170, v171
s_mov_b64 exec, s[32:33]
buffer_store_dwordx4 v[172:175], v13, s[8:11], s34 offen sc1
s_mov_b64 exec, -1
ds_read_b128 v[80:83], v9 offset:0
ds_read_b128 v[96:99], v9 offset:128
v_mfma_f32_32x32x16_bf16 v[64:79], v[200:203], a[136:139], v[64:79]
ds_read_b128 v[196:199], v11 offset:13312
ds_read_b128 v[84:87], v9 offset:16
ds_read_b128 v[100:103], v9 offset:144
ds_read_b128 v[88:91], v9 offset:64
ds_read_b128 v[104:107], v9 offset:192
s_waitcnt lgkmcnt(13)
v_mfma_f32_32x32x16_bf16 v[48:63], v[204:207], a[28:31], v[48:63]
ds_read_b128 v[92:95], v9 offset:80
ds_read_b128 v[108:111], v9 offset:208
s_lshl_b32 s19, s23, 7
s_add_u32 s19, s19, s24
s_mul_i32 s40, s19, 28672
s_add_u32 s40, s40, 44040192
v_mfma_f32_32x32x16_bf16 v[64:79], v[204:207], a[140:143], v[64:79]
ds_read_b128 v[200:203], v11 offset:14336
s_add_u32 s28, s40, s36
s_add_u32 s40, s40, s41
s_add_u32 s37, s25, s36
s_lshl_b32 s39, s19, 11
s_waitcnt lgkmcnt(15)
v_mfma_f32_32x32x16_bf16 v[48:63], v[176:179], a[32:35], v[48:63]
s_add_u32 s39, s39, 39321600
s_lshl_b32 s42, s24, 9
s_add_u32 s42, s42, 38076416
s_waitcnt lgkmcnt(1)
v_mul_f32 v112, v96, v14
v_mul_f32 v113, v97, v14
v_mfma_f32_32x32x16_bf16 v[64:79], v[176:179], a[144:147], v[64:79]
ds_read_b128 v[204:207], v11 offset:15360
v_mul_f32 v114, v98, v14
v_mul_f32 v115, v99, v14
v_mul_f32 v116, v100, v14
v_mul_f32 v117, v101, v14
v_mfma_f32_32x32x16_bf16 v[48:63], v[180:183], a[36:39], v[48:63]
v_mul_f32 v118, v102, v14
v_mul_f32 v119, v103, v14
v_mul_f32 v120, v104, v14
v_mul_f32 v121, v105, v14
v_mul_f32 v122, v106, v14
v_mul_f32 v123, v107, v14
v_mfma_f32_32x32x16_bf16 v[64:79], v[180:183], a[148:151], v[64:79]
s_waitcnt vmcnt(1)
s_barrier
ds_read_b128 v[176:179], v11 offset:16384
v_mul_f32 v124, v108, v14
v_mul_f32 v125, v109, v14
v_mfma_f32_32x32x16_bf16 v[48:63], v[184:187], a[40:43], v[48:63]
buffer_load_dwordx4 v[20:23], v6, s[8:11], s39 offen sc1
v_mul_f32 v126, v110, v14
v_mul_f32 v127, v111, v14
v_mul_f32 v128, v96, v16
v_mul_f32 v129, v97, v16
v_mul_f32 v130, v98, v16
v_mfma_f32_32x32x16_bf16 v[64:79], v[184:187], a[152:155], v[64:79]
ds_read_b128 v[180:183], v11 offset:17408
v_mul_f32 v131, v99, v16
v_mul_f32 v132, v100, v16
v_mul_f32 v133, v101, v16
v_mul_f32 v134, v102, v16
v_mfma_f32_32x32x16_bf16 v[48:63], v[188:191], a[44:47], v[48:63]
buffer_load_dwordx4 v[24:27], v6, s[8:11], s39 offen offset:1024 sc1
v_mul_f32 v135, v103, v16
v_mul_f32 v136, v104, v16
v_mul_f32 v137, v105, v16
v_mul_f32 v138, v106, v16
v_mul_f32 v139, v107, v16
v_mfma_f32_32x32x16_bf16 v[64:79], v[188:191], a[156:159], v[64:79]
ds_read_b128 v[184:187], v11 offset:18432
v_mul_f32 v140, v108, v16
v_mul_f32 v141, v109, v16
v_mul_f32 v142, v110, v16
v_mul_f32 v143, v111, v16
v_mfma_f32_32x32x16_bf16 v[48:63], v[192:195], a[48:51], v[48:63]
s_mov_b64 exec, s[32:33]
buffer_load_dwordx4 v[160:163], v2, s[8:11], s40 offen sc1
s_mov_b64 exec, -1
v_mfma_f32_32x32x16_bf16 v[64:79], v[192:195], a[160:163], v[64:79]
ds_read_b128 v[188:191], v11 offset:19456
v_mfma_f32_32x32x16_bf16 v[48:63], v[196:199], a[52:55], v[48:63]
s_cmp_eq_u32 s46, 0
s_cbranch_scc1 OPT_288
s_getreg_b32 s20, hwreg(HW_REG_IB_STS)
s_and_b32 s20, s20, 0xc0000f
s_cmp_gt_u32 s20, 3
s_cbranch_scc1 OPT_288
s_waitcnt vmcnt(3)
s_mov_b64 exec, 1
buffer_store_dword v5, v4, s[8:11], s43 offen sc1
s_mov_b64 exec, -1
s_mov_b32 s46, 0
OPT_288:
v_mfma_f32_32x32x16_bf16 v[64:79], v[196:199], a[164:167], v[64:79]
ds_read_b128 v[192:195], v11 offset:20480
s_waitcnt lgkmcnt(6)
v_mfma_f32_32x32x16_bf16 v[48:63], v[200:203], a[56:59], v[48:63]
s_mov_b32 m0, s37
s_nop 0
buffer_load_dwordx4 v2, s[8:11], s28 offen sc1 lds
s_add_u32 m0, m0, 4096
s_add_u32 s28, s28, 4096
ds_read_b128 v[196:199], v11 offset:21504
s_waitcnt lgkmcnt(6)
v_mfma_f32_32x32x16_bf16 v[48:63], v[204:207], a[60:63], v[48:63]
ds_read_b128 v[200:203], v11 offset:22528
s_waitcnt lgkmcnt(6)
v_mfma_f32_32x32x16_bf16 v[48:63], v[176:179], a[64:67], v[48:63]
buffer_load_dwordx4 v2, s[8:11], s28 offen sc1 lds
s_add_u32 m0, m0, 4096
s_add_u32 s28, s28, 4096
ds_read_b128 v[204:207], v11 offset:23552
s_waitcnt lgkmcnt(6)
v_mfma_f32_32x32x16_bf16 v[48:63], v[180:183], a[68:71], v[48:63]
ds_read_b128 v[176:179], v11 offset:24576
s_waitcnt lgkmcnt(6)
v_mfma_f32_32x32x16_bf16 v[48:63], v[184:187], a[72:75], v[48:63]
buffer_load_dwordx4 v2, s[8:11], s28 offen sc1 lds
s_add_u32 m0, m0, 4096
s_add_u32 s28, s28, 4096
ds_read_b128 v[180:183], v11 offset:25600
s_waitcnt lgkmcnt(6)
v_mfma_f32_32x32x16_bf16 v[48:63], v[188:191], a[76:79], v[48:63]
ds_read_b128 v[184:187], v11 offset:26624
s_waitcnt lgkmcnt(6)
v_mfma_f32_32x32x16_bf16 v[48:63], v[192:195], a[80:83], v[48:63]
s_cmp_eq_u32 s46, 0
s_cbranch_scc1 OPT_290
s_getreg_b32 s20, hwreg(HW_REG_IB_STS)
s_and_b32 s20, s20, 0xc0000f
s_cmp_gt_u32 s20, 6
s_cbranch_scc1 OPT_290
s_waitcnt vmcnt(6)
s_mov_b64 exec, 1
buffer_store_dword v5, v4, s[8:11], s43 offen sc1
s_mov_b64 exec, -1
s_mov_b32 s46, 0
OPT_290:
ds_read_b128 v[188:191], v11 offset:27648
s_waitcnt lgkmcnt(6)
v_mfma_f32_32x32x16_bf16 v[48:63], v[196:199], a[84:87], v[48:63]
ds_read_b128 v[192:195], v11 offset:14336
s_waitcnt lgkmcnt(6)
v_mfma_f32_32x32x16_bf16 v[48:63], v[200:203], a[88:91], v[48:63]
buffer_load_dwordx4 v2, s[8:11], s28 offen sc1 lds
s_add_u32 m0, m0, 4096
s_add_u32 s28, s28, 4096
ds_read_b128 v[196:199], v11 offset:15360
s_waitcnt lgkmcnt(6)
v_mfma_f32_32x32x16_bf16 v[48:63], v[204:207], a[92:95], v[48:63]
ds_read_b128 v[200:203], v11 offset:16384
s_waitcnt lgkmcnt(6)
v_mfma_f32_32x32x16_bf16 v[48:63], v[176:179], a[96:99], v[48:63]
buffer_load_dwordx4 v2, s[8:11], s28 offen sc1 lds
s_add_u32 m0, m0, 4096
s_add_u32 s28, s28, 4096
ds_read_b128 v[204:207], v11 offset:17408
s_waitcnt lgkmcnt(6)
v_mfma_f32_32x32x16_bf16 v[48:63], v[180:183], a[100:103], v[48:63]
ds_read_b128 v[176:179], v11 offset:18432
s_waitcnt lgkmcnt(6)
v_mfma_f32_32x32x16_bf16 v[48:63], v[184:187], a[104:107], v[48:63]
buffer_load_dwordx4 v2, s[8:11], s28 offen sc1 lds
s_add_u32 m0, m0, 4096
s_add_u32 s28, s28, 4096
ds_read_b128 v[180:183], v11 offset:19456
s_waitcnt lgkmcnt(6)
v_mfma_f32_32x32x16_bf16 v[48:63], v[188:191], a[108:111], v[48:63]
ds_read_b128 v[184:187], v11 offset:20480
s_waitcnt lgkmcnt(6)
v_mfma_f32_32x32x16_bf16 v[64:79], v[192:195], a[168:171], v[64:79]
buffer_load_dwordx4 v2, s[8:11], s28 offen sc1 lds
s_add_u32 m0, m0, 4096
s_add_u32 s28, s28, 4096
ds_read_b128 v[188:191], v11 offset:21504
s_waitcnt lgkmcnt(6)
v_mfma_f32_32x32x16_bf16 v[64:79], v[196:199], a[172:175], v[64:79]
s_cmp_eq_u32 s46, 0
s_cbranch_scc1 OPT_292
s_waitcnt vmcnt(10)
s_mov_b64 exec, 1
buffer_store_dword v5, v4, s[8:11], s43 offen sc1
s_mov_b64 exec, -1
s_mov_b32 s46, 0
OPT_292:
ds_read_b128 v[192:195], v11 offset:22528
s_waitcnt lgkmcnt(6)
v_mfma_f32_32x32x16_bf16 v[64:79], v[200:203], a[176:179], v[64:79]
ds_read_b128 v[196:199], v11 offset:23552
s_waitcnt lgkmcnt(6)
v_mfma_f32_32x32x16_bf16 v[64:79], v[204:207], a[180:183], v[64:79]
ds_read_b128 v[200:203], v11 offset:24576
v_fma_f32 v48, v48, v80, v112
v_fma_f32 v49, v49, v81, v113
v_cvt_pk_bf16_f32 v144, v48, v49
v_fma_f32 v50, v50, v82, v114
s_waitcnt lgkmcnt(6)
v_mfma_f32_32x32x16_bf16 v[64:79], v[176:179], a[184:187], v[64:79]
ds_read_b128 v[204:207], v11 offset:25600
v_fma_f32 v51, v51, v83, v115
v_cvt_pk_bf16_f32 v145, v50, v51
v_fma_f32 v52, v52, v84, v116
v_fma_f32 v53, v53, v85, v117
s_waitcnt lgkmcnt(6)
v_mfma_f32_32x32x16_bf16 v[64:79], v[180:183], a[188:191], v[64:79]
ds_read_b128 v[176:179], v11 offset:26624
v_cvt_pk_bf16_f32 v146, v52, v53
v_fma_f32 v54, v54, v86, v118
v_fma_f32 v55, v55, v87, v119
v_cvt_pk_bf16_f32 v147, v54, v55
s_waitcnt lgkmcnt(6)
v_mfma_f32_32x32x16_bf16 v[64:79], v[184:187], a[192:195], v[64:79]
ds_read_b128 v[180:183], v11 offset:27648
buffer_store_dwordx4 v[144:147], v10, s[8:11], s29 offen offset:0 sc1
v_fma_f32 v56, v56, v88, v120
v_fma_f32 v57, v57, v89, v121
v_cvt_pk_bf16_f32 v148, v56, v57
s_waitcnt lgkmcnt(6)
v_mfma_f32_32x32x16_bf16 v[64:79], v[188:191], a[196:199], v[64:79]
v_fma_f32 v58, v58, v90, v122
v_fma_f32 v59, v59, v91, v123
v_cvt_pk_bf16_f32 v149, v58, v59
v_fma_f32 v60, v60, v92, v124
v_fma_f32 v61, v61, v93, v125
s_waitcnt lgkmcnt(5)
v_mfma_f32_32x32x16_bf16 v[64:79], v[192:195], a[200:203], v[64:79]
v_cvt_pk_bf16_f32 v150, v60, v61
v_fma_f32 v62, v62, v94, v126
v_fma_f32 v63, v63, v95, v127
v_cvt_pk_bf16_f32 v151, v62, v63
buffer_store_dwordx4 v[148:151], v10, s[8:11], s29 offen offset:1024 sc1
s_waitcnt lgkmcnt(4)
v_mfma_f32_32x32x16_bf16 v[64:79], v[196:199], a[204:207], v[64:79]
s_add_u32 s29, s29, 28672
s_waitcnt lgkmcnt(3)
v_mfma_f32_32x32x16_bf16 v[64:79], v[200:203], a[208:211], v[64:79]
s_waitcnt lgkmcnt(2)
v_mfma_f32_32x32x16_bf16 v[64:79], v[204:207], a[212:215], v[64:79]
s_waitcnt lgkmcnt(1)
v_mfma_f32_32x32x16_bf16 v[64:79], v[176:179], a[216:219], v[64:79]
s_waitcnt lgkmcnt(0)
v_mfma_f32_32x32x16_bf16 v[64:79], v[180:183], a[220:223], v[64:79]
s_nop 11
v_pk_fma_f32 v[64:65], v[64:65], v[80:81], v[128:129]
v_cvt_pk_bf16_f32 v152, v64, v65
v_pk_fma_f32 v[66:67], v[66:67], v[82:83], v[130:131]
v_cvt_pk_bf16_f32 v153, v66, v67
v_pk_fma_f32 v[68:69], v[68:69], v[84:85], v[132:133]
v_cvt_pk_bf16_f32 v154, v68, v69
v_pk_fma_f32 v[70:71], v[70:71], v[86:87], v[134:135]
v_cvt_pk_bf16_f32 v155, v70, v71
buffer_store_dwordx4 v[152:155], v10, s[8:11], s29 offen offset:0 sc1
v_pk_fma_f32 v[72:73], v[72:73], v[88:89], v[136:137]
v_cvt_pk_bf16_f32 v156, v72, v73
v_pk_fma_f32 v[74:75], v[74:75], v[90:91], v[138:139]
v_cvt_pk_bf16_f32 v157, v74, v75
v_pk_fma_f32 v[76:77], v[76:77], v[92:93], v[140:141]
v_cvt_pk_bf16_f32 v158, v76, v77
v_pk_fma_f32 v[78:79], v[78:79], v[94:95], v[142:143]
v_cvt_pk_bf16_f32 v159, v78, v79
buffer_store_dwordx4 v[156:159], v10, s[8:11], s29 offen offset:1024 sc1
s_mov_b32 s35, s30
s_branch U_WARM0_283
U_N1_286:
s_waitcnt vmcnt(6)
s_barrier
ds_read_b128 v[176:179], v11 offset:0
ds_read_b128 v[180:183], v11 offset:1024
ds_read_b128 v[184:187], v11 offset:2048
s_waitcnt lgkmcnt(2)
v_mfma_f32_32x32x16_bf16 v[48:63], v[176:179], a[0:3], 0
ds_read_b128 v[188:191], v11 offset:3072
v_add_f32 v20, v20, v22
v_add_f32 v21, v21, v23
v_add_f32 v24, v24, v26
v_add_f32 v25, v25, v27
v_add_f32 v20, v20, v24
v_mfma_f32_32x32x16_bf16 v[64:79], v[176:179], a[112:115], 0
s_waitcnt vmcnt(5)
s_barrier
ds_read_b128 v[192:195], v11 offset:4096
v_add_f32 v21, v21, v25
v_mov_b32 v18, v20
s_waitcnt lgkmcnt(3)
v_mfma_f32_32x32x16_bf16 v[48:63], v[180:183], a[4:7], v[48:63]
ds_read_b128 v[196:199], v11 offset:5120
v_mov_b32 v19, v21
v_permlane32_swap_b32 v18, v20
s_nop 0
v_permlane32_swap_b32 v19, v21
v_add_f32 v20, v20, v18
v_mfma_f32_32x32x16_bf16 v[64:79], v[180:183], a[116:119], v[64:79]
ds_read_b128 v[200:203], v11 offset:6144
v_add_f32 v21, v21, v19
v_mul_f32 v18, 0x3b124925, v20
v_mul_f32 v19, 0x3b124925, v21
v_fma_f32 v19, -v18, v18, v19
s_waitcnt lgkmcnt(4)
v_mfma_f32_32x32x16_bf16 v[48:63], v[184:187], a[8:11], v[48:63]
ds_read_b128 v[204:207], v11 offset:7168
v_max_f32 v19, 0, v19
v_add_f32 v19, 0x3727c5ac, v19
v_rsq_f32 v20, v19
v_mov_b32 v21, v18
v_mfma_f32_32x32x16_bf16 v[64:79], v[184:187], a[120:123], v[64:79]
s_waitcnt vmcnt(3)
s_barrier
ds_read_b128 v[176:179], v11 offset:8192
s_mul_i32 s29, s15, 458752
s_add_u32 s29, s29, s27
s_waitcnt lgkmcnt(5)
v_mfma_f32_32x32x16_bf16 v[48:63], v[188:191], a[12:15], v[48:63]
ds_read_b128 v[180:183], v11 offset:9216
s_lshl_b32 s30, s15, 11
s_add_u32 s30, s30, s31
s_mul_i32 s34, s15, 28672
s_add_u32 s34, s34, s41
s_add_u32 s34, s34, 39845888
v_mfma_f32_32x32x16_bf16 v[64:79], v[188:191], a[124:127], v[64:79]
ds_read_b128 v[184:187], v11 offset:10240
s_add_u32 s43, s30, 262144
s_mov_b32 s46, 1
v_mul_f32 v22, v20, v21
v_sub_f32 v22, 0, v22
s_waitcnt lgkmcnt(6)
v_mfma_f32_32x32x16_bf16 v[48:63], v[192:195], a[16:19], v[48:63]
ds_write2_b32 v8, v20, v22 offset0:0 offset1:32
v_lshlrev_b32 v164, 16, v160
v_and_b32 v165, 0xffff0000, v160
v_fma_f32 v164, v164, v20, v22
v_fma_f32 v165, v165, v20, v22
v_cvt_pk_bf16_f32 v172, v164, v165
v_mfma_f32_32x32x16_bf16 v[64:79], v[192:195], a[128:131], v[64:79]
ds_read_b128 v[188:191], v11 offset:11264
v_lshlrev_b32 v166, 16, v161
v_and_b32 v167, 0xffff0000, v161
v_fma_f32 v166, v166, v20, v22
v_fma_f32 v167, v167, v20, v22
s_waitcnt lgkmcnt(7)
v_mfma_f32_32x32x16_bf16 v[48:63], v[196:199], a[20:23], v[48:63]
v_cvt_pk_bf16_f32 v173, v166, v167
v_lshlrev_b32 v168, 16, v162
v_and_b32 v169, 0xffff0000, v162
v_fma_f32 v168, v168, v20, v22
v_fma_f32 v169, v169, v20, v22
v_cvt_pk_bf16_f32 v174, v168, v169
v_mfma_f32_32x32x16_bf16 v[64:79], v[196:199], a[132:135], v[64:79]
ds_read_b128 v[192:195], v11 offset:12288
v_lshlrev_b32 v170, 16, v163
v_and_b32 v171, 0xffff0000, v163
v_fma_f32 v170, v170, v20, v22
v_fma_f32 v171, v171, v20, v22
s_waitcnt lgkmcnt(7)
v_mfma_f32_32x32x16_bf16 v[48:63], v[200:203], a[24:27], v[48:63]
v_cvt_pk_bf16_f32 v175, v170, v171
s_mov_b64 exec, s[32:33]
buffer_store_dwordx4 v[172:175], v13, s[8:11], s34 offen sc1
s_mov_b64 exec, -1
ds_read_b128 v[80:83], v9 offset:0
ds_read_b128 v[96:99], v9 offset:128
v_mfma_f32_32x32x16_bf16 v[64:79], v[200:203], a[136:139], v[64:79]
ds_read_b128 v[196:199], v11 offset:13312
ds_read_b128 v[84:87], v9 offset:16
ds_read_b128 v[100:103], v9 offset:144
ds_read_b128 v[88:91], v9 offset:64
ds_read_b128 v[104:107], v9 offset:192
s_waitcnt lgkmcnt(13)
v_mfma_f32_32x32x16_bf16 v[48:63], v[204:207], a[28:31], v[48:63]
ds_read_b128 v[92:95], v9 offset:80
ds_read_b128 v[108:111], v9 offset:208
s_lshl_b32 s19, s23, 7
s_add_u32 s19, s19, s24
s_mul_i32 s40, s19, 28672
s_add_u32 s40, s40, 44040192
v_mfma_f32_32x32x16_bf16 v[64:79], v[204:207], a[140:143], v[64:79]
ds_read_b128 v[200:203], v11 offset:14336
s_add_u32 s28, s40, s36
s_add_u32 s40, s40, s41
s_add_u32 s37, s25, s36
s_lshl_b32 s39, s19, 11
s_waitcnt lgkmcnt(15)
v_mfma_f32_32x32x16_bf16 v[48:63], v[176:179], a[32:35], v[48:63]
s_add_u32 s39, s39, 39321600
s_lshl_b32 s42, s24, 9
s_add_u32 s42, s42, 38076416
s_waitcnt lgkmcnt(1)
v_mul_f32 v112, v96, v14
v_mul_f32 v113, v97, v14
v_mfma_f32_32x32x16_bf16 v[64:79], v[176:179], a[144:147], v[64:79]
ds_read_b128 v[204:207], v11 offset:15360
v_mul_f32 v114, v98, v14
v_mul_f32 v115, v99, v14
v_mul_f32 v116, v100, v14
v_mul_f32 v117, v101, v14
v_mfma_f32_32x32x16_bf16 v[48:63], v[180:183], a[36:39], v[48:63]
v_mul_f32 v118, v102, v14
v_mul_f32 v119, v103, v14
v_mul_f32 v120, v104, v14
v_mul_f32 v121, v105, v14
v_mul_f32 v122, v106, v14
v_mul_f32 v123, v107, v14
v_mfma_f32_32x32x16_bf16 v[64:79], v[180:183], a[148:151], v[64:79]
s_waitcnt vmcnt(1)
s_barrier
ds_read_b128 v[176:179], v11 offset:16384
v_mul_f32 v124, v108, v14
v_mul_f32 v125, v109, v14
v_mfma_f32_32x32x16_bf16 v[48:63], v[184:187], a[40:43], v[48:63]
v_mul_f32 v126, v110, v14
v_mul_f32 v127, v111, v14
v_mul_f32 v128, v96, v16
v_mul_f32 v129, v97, v16
v_mul_f32 v130, v98, v16
v_mul_f32 v131, v99, v16
v_mfma_f32_32x32x16_bf16 v[64:79], v[184:187], a[152:155], v[64:79]
ds_read_b128 v[180:183], v11 offset:17408
v_mul_f32 v132, v100, v16
v_mul_f32 v133, v101, v16
v_mul_f32 v134, v102, v16
v_mul_f32 v135, v103, v16
v_mfma_f32_32x32x16_bf16 v[48:63], v[188:191], a[44:47], v[48:63]
v_mul_f32 v136, v104, v16
v_mul_f32 v137, v105, v16
v_mul_f32 v138, v106, v16
v_mul_f32 v139, v107, v16
v_mul_f32 v140, v108, v16
v_mul_f32 v141, v109, v16
v_mfma_f32_32x32x16_bf16 v[64:79], v[188:191], a[156:159], v[64:79]
ds_read_b128 v[184:187], v11 offset:18432
v_mul_f32 v142, v110, v16
v_mul_f32 v143, v111, v16
v_mfma_f32_32x32x16_bf16 v[48:63], v[192:195], a[48:51], v[48:63]
buffer_load_dword v12, v7, s[8:11], s42 offen sc1
v_mfma_f32_32x32x16_bf16 v[64:79], v[192:195], a[160:163], v[64:79]
ds_read_b128 v[188:191], v11 offset:19456
v_mfma_f32_32x32x16_bf16 v[48:63], v[196:199], a[52:55], v[48:63]
s_cmp_eq_u32 s46, 0
s_cbranch_scc1 OPT_294
s_getreg_b32 s20, hwreg(HW_REG_IB_STS)
s_and_b32 s20, s20, 0xc0000f
s_cmp_gt_u32 s20, 1
s_cbranch_scc1 OPT_294
s_waitcnt vmcnt(1)
s_mov_b64 exec, 1
buffer_store_dword v5, v4, s[8:11], s43 offen sc1
s_mov_b64 exec, -1
s_mov_b32 s46, 0
OPT_294:
v_mfma_f32_32x32x16_bf16 v[64:79], v[196:199], a[164:167], v[64:79]
ds_read_b128 v[192:195], v11 offset:20480
s_waitcnt lgkmcnt(6)
v_mfma_f32_32x32x16_bf16 v[48:63], v[200:203], a[56:59], v[48:63]
ds_read_b128 v[196:199], v11 offset:21504
s_waitcnt lgkmcnt(6)
v_mfma_f32_32x32x16_bf16 v[48:63], v[204:207], a[60:63], v[48:63]
ds_read_b128 v[200:203], v11 offset:22528
s_waitcnt lgkmcnt(6)
v_mfma_f32_32x32x16_bf16 v[48:63], v[176:179], a[64:67], v[48:63]
ds_read_b128 v[204:207], v11 offset:23552
s_waitcnt lgkmcnt(6)
v_mfma_f32_32x32x16_bf16 v[48:63], v[180:183], a[68:71], v[48:63]
ds_read_b128 v[176:179], v11 offset:24576
s_waitcnt lgkmcnt(6)
v_mfma_f32_32x32x16_bf16 v[48:63], v[184:187], a[72:75], v[48:63]
ds_read_b128 v[180:183], v11 offset:25600
s_waitcnt lgkmcnt(6)
v_mfma_f32_32x32x16_bf16 v[48:63], v[188:191], a[76:79], v[48:63]
ds_read_b128 v[184:187], v11 offset:26624
s_waitcnt lgkmcnt(6)
v_mfma_f32_32x32x16_bf16 v[48:63], v[192:195], a[80:83], v[48:63]
s_cmp_eq_u32 s46, 0
s_cbranch_scc1 OPT_296
s_getreg_b32 s20, hwreg(HW_REG_IB_STS)
s_and_b32 s20, s20, 0xc0000f
s_cmp_gt_u32 s20, 1
s_cbranch_scc1 OPT_296
s_waitcnt vmcnt(1)
s_mov_b64 exec, 1
buffer_store_dword v5, v4, s[8:11], s43 offen sc1
s_mov_b64 exec, -1
s_mov_b32 s46, 0
OPT_296:
ds_read_b128 v[188:191], v11 offset:27648
s_waitcnt lgkmcnt(6)
v_mfma_f32_32x32x16_bf16 v[48:63], v[196:199], a[84:87], v[48:63]
ds_read_b128 v[192:195], v11 offset:14336
s_waitcnt lgkmcnt(6)
v_mfma_f32_32x32x16_bf16 v[48:63], v[200:203], a[88:91], v[48:63]
ds_read_b128 v[196:199], v11 offset:15360
s_waitcnt lgkmcnt(6)
v_mfma_f32_32x32x16_bf16 v[48:63], v[204:207], a[92:95], v[48:63]
ds_read_b128 v[200:203], v11 offset:16384
s_waitcnt lgkmcnt(6)
v_mfma_f32_32x32x16_bf16 v[48:63], v[176:179], a[96:99], v[48:63]
ds_read_b128 v[204:207], v11 offset:17408
s_waitcnt lgkmcnt(6)
v_mfma_f32_32x32x16_bf16 v[48:63], v[180:183], a[100:103], v[48:63]
ds_read_b128 v[176:179], v11 offset:18432
s_waitcnt lgkmcnt(6)
v_mfma_f32_32x32x16_bf16 v[48:63], v[184:187], a[104:107], v[48:63]
ds_read_b128 v[180:183], v11 offset:19456
s_waitcnt lgkmcnt(6)
v_mfma_f32_32x32x16_bf16 v[48:63], v[188:191], a[108:111], v[48:63]
ds_read_b128 v[184:187], v11 offset:20480
s_waitcnt lgkmcnt(6)
v_mfma_f32_32x32x16_bf16 v[64:79], v[192:195], a[168:171], v[64:79]
ds_read_b128 v[188:191], v11 offset:21504
s_waitcnt lgkmcnt(6)
v_mfma_f32_32x32x16_bf16 v[64:79], v[196:199], a[172:175], v[64:79]
s_cmp_eq_u32 s46, 0
s_cbranch_scc1 OPT_298
s_waitcnt vmcnt(1)
s_mov_b64 exec, 1
buffer_store_dword v5, v4, s[8:11], s43 offen sc1
s_mov_b64 exec, -1
s_mov_b32 s46, 0
OPT_298:
ds_read_b128 v[192:195], v11 offset:22528
s_waitcnt vmcnt(1)
v_cmp_eq_u32 vcc, 0, v12
s_cmp_ge_u32 s24, 64
s_cselect_b64 vcc, -1, vcc
s_cbranch_vccnz U_NP_299
s_waitcnt lgkmcnt(6)
v_mfma_f32_32x32x16_bf16 v[64:79], v[200:203], a[176:179], v[64:79]
buffer_load_dwordx4 v[20:23], v6, s[8:11], s39 offen sc1
ds_read_b128 v[196:199], v11 offset:23552
s_waitcnt lgkmcnt(6)
v_mfma_f32_32x32x16_bf16 v[64:79], v[204:207], a[180:183], v[64:79]
buffer_load_dwordx4 v[24:27], v6, s[8:11], s39 offen offset:1024 sc1
ds_read_b128 v[200:203], v11 offset:24576
v_fma_f32 v48, v48, v80, v112
v_fma_f32 v49, v49, v81, v113
v_cvt_pk_bf16_f32 v144, v48, v49
s_waitcnt lgkmcnt(6)
v_mfma_f32_32x32x16_bf16 v[64:79], v[176:179], a[184:187], v[64:79]
s_mov_b64 exec, s[32:33]
buffer_load_dwordx4 v[160:163], v2, s[8:11], s40 offen sc1
s_mov_b64 exec, -1
ds_read_b128 v[204:207], v11 offset:25600
v_fma_f32 v50, v50, v82, v114
s_waitcnt lgkmcnt(6)
v_mfma_f32_32x32x16_bf16 v[64:79], v[180:183], a[188:191], v[64:79]
s_mov_b32 m0, s37
s_nop 0
buffer_load_dwordx4 v2, s[8:11], s28 offen sc1 lds
s_add_u32 m0, m0, 4096
s_add_u32 s28, s28, 4096
ds_read_b128 v[176:179], v11 offset:26624
s_waitcnt lgkmcnt(6)
v_mfma_f32_32x32x16_bf16 v[64:79], v[184:187], a[192:195], v[64:79]
buffer_load_dwordx4 v2, s[8:11], s28 offen sc1 lds
s_add_u32 m0, m0, 4096
s_add_u32 s28, s28, 4096
ds_read_b128 v[180:183], v11 offset:27648
v_fma_f32 v51, v51, v83, v115
s_waitcnt lgkmcnt(6)
v_mfma_f32_32x32x16_bf16 v[64:79], v[188:191], a[196:199], v[64:79]
buffer_load_dwordx4 v2, s[8:11], s28 offen sc1 lds
s_add_u32 m0, m0, 4096
s_add_u32 s28, s28, 4096
v_cvt_pk_bf16_f32 v145, v50, v51
v_fma_f32 v52, v52, v84, v116
s_waitcnt lgkmcnt(5)
v_mfma_f32_32x32x16_bf16 v[64:79], v[192:195], a[200:203], v[64:79]
buffer_load_dwordx4 v2, s[8:11], s28 offen sc1 lds
s_add_u32 m0, m0, 4096
s_add_u32 s28, s28, 4096
v_fma_f32 v53, v53, v85, v117
v_cvt_pk_bf16_f32 v146, v52, v53
s_waitcnt lgkmcnt(4)
v_mfma_f32_32x32x16_bf16 v[64:79], v[196:199], a[204:207], v[64:79]
buffer_load_dwordx4 v2, s[8:11], s28 offen sc1 lds
s_add_u32 m0, m0, 4096
s_add_u32 s28, s28, 4096
v_fma_f32 v54, v54, v86, v118
v_fma_f32 v55, v55, v87, v119
s_waitcnt lgkmcnt(3)
v_mfma_f32_32x32x16_bf16 v[64:79], v[200:203], a[208:211], v[64:79]
buffer_load_dwordx4 v2, s[8:11], s28 offen sc1 lds
s_add_u32 m0, m0, 4096
s_add_u32 s28, s28, 4096
v_cvt_pk_bf16_f32 v147, v54, v55
v_fma_f32 v56, v56, v88, v120
s_waitcnt lgkmcnt(2)
v_mfma_f32_32x32x16_bf16 v[64:79], v[204:207], a[212:215], v[64:79]
buffer_load_dwordx4 v2, s[8:11], s28 offen sc1 lds
s_add_u32 m0, m0, 4096
s_add_u32 s28, s28, 4096
v_fma_f32 v57, v57, v89, v121
v_cvt_pk_bf16_f32 v148, v56, v57
s_waitcnt lgkmcnt(1)
v_mfma_f32_32x32x16_bf16 v[64:79], v[176:179], a[216:219], v[64:79]
v_fma_f32 v58, v58, v90, v122
v_fma_f32 v59, v59, v91, v123
v_cvt_pk_bf16_f32 v149, v58, v59
v_fma_f32 v60, v60, v92, v124
v_fma_f32 v61, v61, v93, v125
s_waitcnt lgkmcnt(0)
v_mfma_f32_32x32x16_bf16 v[64:79], v[180:183], a[220:223], v[64:79]
v_cvt_pk_bf16_f32 v150, v60, v61
v_fma_f32 v62, v62, v94, v126
v_fma_f32 v63, v63, v95, v127
v_cvt_pk_bf16_f32 v151, v62, v63
buffer_store_dwordx4 v[144:147], v10, s[8:11], s29 offen offset:0 sc1
buffer_store_dwordx4 v[148:151], v10, s[8:11], s29 offen offset:1024 sc1
s_add_u32 s29, s29, 28672
s_nop 4
v_pk_fma_f32 v[64:65], v[64:65], v[80:81], v[128:129]
v_cvt_pk_bf16_f32 v152, v64, v65
v_pk_fma_f32 v[66:67], v[66:67], v[82:83], v[130:131]
v_cvt_pk_bf16_f32 v153, v66, v67
v_pk_fma_f32 v[68:69], v[68:69], v[84:85], v[132:133]
v_cvt_pk_bf16_f32 v154, v68, v69
v_pk_fma_f32 v[70:71], v[70:71], v[86:87], v[134:135]
v_cvt_pk_bf16_f32 v155, v70, v71
buffer_store_dwordx4 v[152:155], v10, s[8:11], s29 offen offset:0 sc1
v_pk_fma_f32 v[72:73], v[72:73], v[88:89], v[136:137]
v_cvt_pk_bf16_f32 v156, v72, v73
v_pk_fma_f32 v[74:75], v[74:75], v[90:91], v[138:139]
v_cvt_pk_bf16_f32 v157, v74, v75
v_pk_fma_f32 v[76:77], v[76:77], v[92:93], v[140:141]
v_cvt_pk_bf16_f32 v158, v76, v77
v_pk_fma_f32 v[78:79], v[78:79], v[94:95], v[142:143]
v_cvt_pk_bf16_f32 v159, v78, v79
buffer_store_dwordx4 v[156:159], v10, s[8:11], s29 offen offset:1024 sc1
s_mov_b32 s35, s30
s_branch U_WARM0_283
U_NP_299:
s_waitcnt lgkmcnt(6)
v_mfma_f32_32x32x16_bf16 v[64:79], v[200:203], a[176:179], v[64:79]
ds_read_b128 v[196:199], v11 offset:23552
s_waitcnt lgkmcnt(6)
v_mfma_f32_32x32x16_bf16 v[64:79], v[204:207], a[180:183], v[64:79]
ds_read_b128 v[200:203], v11 offset:24576
v_fma_f32 v48, v48, v80, v112
v_fma_f32 v49, v49, v81, v113
v_cvt_pk_bf16_f32 v144, v48, v49
v_fma_f32 v50, v50, v82, v114
s_waitcnt lgkmcnt(6)
v_mfma_f32_32x32x16_bf16 v[64:79], v[176:179], a[184:187], v[64:79]
ds_read_b128 v[204:207], v11 offset:25600
v_fma_f32 v51, v51, v83, v115
v_cvt_pk_bf16_f32 v145, v50, v51
v_fma_f32 v52, v52, v84, v116
v_fma_f32 v53, v53, v85, v117
s_waitcnt lgkmcnt(6)
v_mfma_f32_32x32x16_bf16 v[64:79], v[180:183], a[188:191], v[64:79]
ds_read_b128 v[176:179], v11 offset:26624
v_cvt_pk_bf16_f32 v146, v52, v53
v_fma_f32 v54, v54, v86, v118
v_fma_f32 v55, v55, v87, v119
v_cvt_pk_bf16_f32 v147, v54, v55
s_waitcnt lgkmcnt(6)
v_mfma_f32_32x32x16_bf16 v[64:79], v[184:187], a[192:195], v[64:79]
ds_read_b128 v[180:183], v11 offset:27648
buffer_store_dwordx4 v[144:147], v10, s[8:11], s29 offen offset:0 sc1
v_fma_f32 v56, v56, v88, v120
v_fma_f32 v57, v57, v89, v121
v_cvt_pk_bf16_f32 v148, v56, v57
s_waitcnt lgkmcnt(6)
v_mfma_f32_32x32x16_bf16 v[64:79], v[188:191], a[196:199], v[64:79]
v_fma_f32 v58, v58, v90, v122
v_fma_f32 v59, v59, v91, v123
v_cvt_pk_bf16_f32 v149, v58, v59
v_fma_f32 v60, v60, v92, v124
v_fma_f32 v61, v61, v93, v125
s_waitcnt lgkmcnt(5)
v_mfma_f32_32x32x16_bf16 v[64:79], v[192:195], a[200:203], v[64:79]
v_cvt_pk_bf16_f32 v150, v60, v61
v_fma_f32 v62, v62, v94, v126
v_fma_f32 v63, v63, v95, v127
v_cvt_pk_bf16_f32 v151, v62, v63
buffer_store_dwordx4 v[148:151], v10, s[8:11], s29 offen offset:1024 sc1
s_waitcnt lgkmcnt(4)
v_mfma_f32_32x32x16_bf16 v[64:79], v[196:199], a[204:207], v[64:79]
s_add_u32 s29, s29, 28672
s_waitcnt lgkmcnt(3)
v_mfma_f32_32x32x16_bf16 v[64:79], v[200:203], a[208:211], v[64:79]
s_waitcnt lgkmcnt(2)
v_mfma_f32_32x32x16_bf16 v[64:79], v[204:207], a[212:215], v[64:79]
s_waitcnt lgkmcnt(1)
v_mfma_f32_32x32x16_bf16 v[64:79], v[176:179], a[216:219], v[64:79]
s_waitcnt lgkmcnt(0)
v_mfma_f32_32x32x16_bf16 v[64:79], v[180:183], a[220:223], v[64:79]
s_nop 11
v_pk_fma_f32 v[64:65], v[64:65], v[80:81], v[128:129]
v_cvt_pk_bf16_f32 v152, v64, v65
v_pk_fma_f32 v[66:67], v[66:67], v[82:83], v[130:131]
v_cvt_pk_bf16_f32 v153, v66, v67
v_pk_fma_f32 v[68:69], v[68:69], v[84:85], v[132:133]
v_cvt_pk_bf16_f32 v154, v68, v69
v_pk_fma_f32 v[70:71], v[70:71], v[86:87], v[134:135]
v_cvt_pk_bf16_f32 v155, v70, v71
buffer_store_dwordx4 v[152:155], v10, s[8:11], s29 offen offset:0 sc1
v_pk_fma_f32 v[72:73], v[72:73], v[88:89], v[136:137]
v_cvt_pk_bf16_f32 v156, v72, v73
v_pk_fma_f32 v[74:75], v[74:75], v[90:91], v[138:139]
v_cvt_pk_bf16_f32 v157, v74, v75
v_pk_fma_f32 v[76:77], v[76:77], v[92:93], v[140:141]
v_cvt_pk_bf16_f32 v158, v76, v77
v_pk_fma_f32 v[78:79], v[78:79], v[94:95], v[142:143]
v_cvt_pk_bf16_f32 v159, v78, v79
buffer_store_dwordx4 v[156:159], v10, s[8:11], s29 offen offset:1024 sc1
s_mov_b32 s35, s30
buffer_load_dword v12, v7, s[8:11], s42 offen sc1
s_waitcnt vmcnt(1)
s_mov_b64 exec, 1
buffer_store_dword v5, v4, s[8:11], s30 offen sc1
s_mov_b64 exec, -1
s_cmp_ge_u32 s24, 64
s_cbranch_scc1 U_END_281
s_waitcnt vmcnt(1)
v_cmp_eq_u32 vcc, 0, v12
s_cbranch_vccz U_COLD_279
s_nop 2
s_branch U_CW_282
U_WARM0_283:
v_add_u32 v11, s25, v3
s_xor_b32 s25, s25, 28672
s_lshl_b32 s19, s23, 6
s_add_u32 s15, s19, s24
s_add_u32 s17, s22, 14
s_min_u32 s17, s17, 64
s_cmp_lt_u32 s21, s17
s_cselect_b32 s23, 0, 1
s_cselect_b32 s24, s21, s22
s_cselect_b32 s17, 2, 0
s_add_u32 s21, s21, s17
s_lshl_b32 s17, s23, 1
s_add_u32 s22, s22, s17
s_cmp_eq_u32 s23, 1
s_cbranch_scc1 U_N1_300
s_waitcnt vmcnt(10)
s_barrier
ds_read_b128 v[176:179], v11 offset:0
ds_read_b128 v[180:183], v11 offset:1024
ds_read_b128 v[184:187], v11 offset:2048
s_waitcnt lgkmcnt(2)
v_mfma_f32_32x32x16_bf16 v[48:63], v[176:179], a[0:3], 0
ds_read_b128 v[188:191], v11 offset:3072
v_add_f32 v20, v20, v22
v_add_f32 v21, v21, v23
v_add_f32 v24, v24, v26
v_add_f32 v25, v25, v27
v_add_f32 v20, v20, v24
v_mfma_f32_32x32x16_bf16 v[64:79], v[176:179], a[112:115], 0
s_waitcnt vmcnt(9)
s_barrier
ds_read_b128 v[192:195], v11 offset:4096
v_add_f32 v21, v21, v25
v_mov_b32 v18, v20
s_waitcnt lgkmcnt(3)
v_mfma_f32_32x32x16_bf16 v[48:63], v[180:183], a[4:7], v[48:63]
ds_read_b128 v[196:199], v11 offset:5120
v_mov_b32 v19, v21
v_permlane32_swap_b32 v18, v20
s_nop 0
v_permlane32_swap_b32 v19, v21
v_add_f32 v20, v20, v18
v_mfma_f32_32x32x16_bf16 v[64:79], v[180:183], a[116:119], v[64:79]
ds_read_b128 v[200:203], v11 offset:6144
v_add_f32 v21, v21, v19
v_mul_f32 v18, 0x3b124925, v20
v_mul_f32 v19, 0x3b124925, v21
v_fma_f32 v19, -v18, v18, v19
s_waitcnt lgkmcnt(4)
v_mfma_f32_32x32x16_bf16 v[48:63], v[184:187], a[8:11], v[48:63]
ds_read_b128 v[204:207], v11 offset:7168
v_max_f32 v19, 0, v19
v_add_f32 v19, 0x3727c5ac, v19
v_rsq_f32 v20, v19
v_mov_b32 v21, v18
v_mfma_f32_32x32x16_bf16 v[64:79], v[184:187], a[120:123], v[64:79]
s_waitcnt vmcnt(7)
s_barrier
ds_read_b128 v[176:179], v11 offset:8192
s_mul_i32 s29, s15, 458752
s_add_u32 s29, s29, s27
s_waitcnt lgkmcnt(5)
v_mfma_f32_32x32x16_bf16 v[48:63], v[188:191], a[12:15], v[48:63]
ds_read_b128 v[180:183], v11 offset:9216
s_lshl_b32 s30, s15, 11
s_add_u32 s30, s30, s31
s_mul_i32 s34, s15, 28672
s_add_u32 s34, s34, s41
s_add_u32 s34, s34, 39845888
v_mfma_f32_32x32x16_bf16 v[64:79], v[188:191], a[124:127], v[64:79]
ds_read_b128 v[184:187], v11 offset:10240
s_add_u32 s43, s30, 262144
s_mov_b32 s46, 1
v_mul_f32 v22, v20, v21
v_sub_f32 v22, 0, v22
s_waitcnt lgkmcnt(6)
v_mfma_f32_32x32x16_bf16 v[48:63], v[192:195], a[16:19], v[48:63]
ds_write2_b32 v8, v20, v22 offset0:0 offset1:32
v_lshlrev_b32 v164, 16, v160
v_and_b32 v165, 0xffff0000, v160
v_fma_f32 v164, v164, v20, v22
v_fma_f32 v165, v165, v20, v22
v_cvt_pk_bf16_f32 v172, v164, v165
v_mfma_f32_32x32x16_bf16 v[64:79], v[192:195], a[128:131], v[64:79]
ds_read_b128 v[188:191], v11 offset:11264
v_lshlrev_b32 v166, 16, v161
v_and_b32 v167, 0xffff0000, v161
v_fma_f32 v166, v166, v20, v22
v_fma_f32 v167, v167, v20, v22
s_waitcnt lgkmcnt(7)
v_mfma_f32_32x32x16_bf16 v[48:63], v[196:199], a[20:23], v[48:63]
v_cvt_pk_bf16_f32 v173, v166, v167
v_lshlrev_b32 v168, 16, v162
v_and_b32 v169, 0xffff0000, v162
v_fma_f32 v168, v168, v20, v22
v_fma_f32 v169, v169, v20, v22
v_cvt_pk_bf16_f32 v174, v168, v169
v_mfma_f32_32x32x16_bf16 v[64:79], v[196:199], a[132:135], v[64:79]
ds_read_b128 v[192:195], v11 offset:12288
v_lshlrev_b32 v170, 16, v163
v_and_b32 v171, 0xffff0000, v163
v_fma_f32 v170, v170, v20, v22
v_fma_f32 v171, v171, v20, v22
s_waitcnt lgkmcnt(7)
v_mfma_f32_32x32x16_bf16 v[48:63], v[200:203], a[24:27], v[48:63]
v_cvt_pk_bf16_f32 v175, v170, v171
s_mov_b64 exec, s[32:33]
buffer_store_dwordx4 v[172:175], v13, s[8:11], s34 offen sc1
s_mov_b64 exec, -1
ds_read_b128 v[80:83], v9 offset:0
ds_read_b128 v[96:99], v9 offset:128
v_mfma_f32_32x32x16_bf16 v[64:79], v[200:203], a[136:139], v[64:79]
ds_read_b128 v[196:199], v11 offset:13312
ds_read_b128 v[84:87], v9 offset:16
ds_read_b128 v[100:103], v9 offset:144
ds_read_b128 v[88:91], v9 offset:64
ds_read_b128 v[104:107], v9 offset:192
s_waitcnt lgkmcnt(13)
v_mfma_f32_32x32x16_bf16 v[48:63], v[204:207], a[28:31], v[48:63]
ds_read_b128 v[92:95], v9 offset:80
ds_read_b128 v[108:111], v9 offset:208
s_lshl_b32 s19, s23, 7
s_add_u32 s19, s19, s24
s_mul_i32 s40, s19, 28672
s_add_u32 s40, s40, 44040192
v_mfma_f32_32x32x16_bf16 v[64:79], v[204:207], a[140:143], v[64:79]
ds_read_b128 v[200:203], v11 offset:14336
s_add_u32 s28, s40, s36
s_add_u32 s40, s40, s41
s_add_u32 s37, s25, s36
s_lshl_b32 s39, s19, 11
s_waitcnt lgkmcnt(15)
v_mfma_f32_32x32x16_bf16 v[48:63], v[176:179], a[32:35], v[48:63]
s_add_u32 s39, s39, 39321600
s_lshl_b32 s42, s24, 9
s_add_u32 s42, s42, 38076416
s_waitcnt lgkmcnt(1)
v_mul_f32 v112, v96, v14
v_mul_f32 v113, v97, v14
v_mfma_f32_32x32x16_bf16 v[64:79], v[176:179], a[144:147], v[64:79]
ds_read_b128 v[204:207], v11 offset:15360
v_mul_f32 v114, v98, v14
v_mul_f32 v115, v99, v14
v_mul_f32 v116, v100, v14
v_mul_f32 v117, v101, v14
v_mfma_f32_32x32x16_bf16 v[48:63], v[180:183], a[36:39], v[48:63]
v_mul_f32 v118, v102, v14
v_mul_f32 v119, v103, v14
v_mul_f32 v120, v104, v14
v_mul_f32 v121, v105, v14
v_mul_f32 v122, v106, v14
v_mul_f32 v123, v107, v14
v_mfma_f32_32x32x16_bf16 v[64:79], v[180:183], a[148:151], v[64:79]
s_waitcnt vmcnt(5)
s_barrier
ds_read_b128 v[176:179], v11 offset:16384
v_mul_f32 v124, v108, v14
v_mul_f32 v125, v109, v14
v_mfma_f32_32x32x16_bf16 v[48:63], v[184:187], a[40:43], v[48:63]
buffer_load_dwordx4 v[20:23], v6, s[8:11], s39 offen sc1
v_mul_f32 v126, v110, v14
v_mul_f32 v127, v111, v14
v_mul_f32 v128, v96, v16
v_mul_f32 v129, v97, v16
v_mul_f32 v130, v98, v16
v_mfma_f32_32x32x16_bf16 v[64:79], v[184:187], a[152:155], v[64:79]
ds_read_b128 v[180:183], v11 offset:17408
v_mul_f32 v131, v99, v16
v_mul_f32 v132, v100, v16
v_mul_f32 v133, v101, v16
v_mul_f32 v134, v102, v16
v_mfma_f32_32x32x16_bf16 v[48:63], v[188:191], a[44:47], v[48:63]
buffer_load_dwordx4 v[24:27], v6, s[8:11], s39 offen offset:1024 sc1
v_mul_f32 v135, v103, v16
v_mul_f32 v136, v104, v16
v_mul_f32 v137, v105, v16
v_mul_f32 v138, v106, v16
v_mul_f32 v139, v107, v16
v_mfma_f32_32x32x16_bf16 v[64:79], v[188:191], a[156:159], v[64:79]
ds_read_b128 v[184:187], v11 offset:18432
v_mul_f32 v140, v108, v16
v_mul_f32 v141, v109, v16
v_mul_f32 v142, v110, v16
v_mul_f32 v143, v111, v16
v_mfma_f32_32x32x16_bf16 v[48:63], v[192:195], a[48:51], v[48:63]
s_mov_b64 exec, s[32:33]
buffer_load_dwordx4 v[160:163], v2, s[8:11], s40 offen sc1
s_mov_b64 exec, -1
v_mfma_f32_32x32x16_bf16 v[64:79], v[192:195], a[160:163], v[64:79]
ds_read_b128 v[188:191], v11 offset:19456
v_mfma_f32_32x32x16_bf16 v[48:63], v[196:199], a[52:55], v[48:63]
s_cmp_eq_u32 s46, 0
s_cbranch_scc1 OPT_302
s_getreg_b32 s20, hwreg(HW_REG_IB_STS)
s_and_b32 s20, s20, 0xc0000f
s_cmp_gt_u32 s20, 3
s_cbranch_scc1 OPT_302
s_waitcnt vmcnt(3)
s_mov_b64 exec, 1
buffer_store_dword v5, v4, s[8:11], s35 offen sc1
s_mov_b64 exec, -1
s_mov_b64 exec, 1
buffer_store_dword v5, v4, s[8:11], s43 offen sc1
s_mov_b64 exec, -1
s_mov_b32 s46, 0
OPT_302:
v_mfma_f32_32x32x16_bf16 v[64:79], v[196:199], a[164:167], v[64:79]
ds_read_b128 v[192:195], v11 offset:20480
s_waitcnt lgkmcnt(6)
v_mfma_f32_32x32x16_bf16 v[48:63], v[200:203], a[56:59], v[48:63]
s_mov_b32 m0, s37
s_nop 0
buffer_load_dwordx4 v2, s[8:11], s28 offen sc1 lds
s_add_u32 m0, m0, 4096
s_add_u32 s28, s28, 4096
ds_read_b128 v[196:199], v11 offset:21504
s_waitcnt lgkmcnt(6)
v_mfma_f32_32x32x16_bf16 v[48:63], v[204:207], a[60:63], v[48:63]
ds_read_b128 v[200:203], v11 offset:22528
s_waitcnt lgkmcnt(6)
v_mfma_f32_32x32x16_bf16 v[48:63], v[176:179], a[64:67], v[48:63]
buffer_load_dwordx4 v2, s[8:11], s28 offen sc1 lds
s_add_u32 m0, m0, 4096
s_add_u32 s28, s28, 4096
ds_read_b128 v[204:207], v11 offset:23552
s_waitcnt lgkmcnt(6)
v_mfma_f32_32x32x16_bf16 v[48:63], v[180:183], a[68:71], v[48:63]
ds_read_b128 v[176:179], v11 offset:24576
s_waitcnt lgkmcnt(6)
v_mfma_f32_32x32x16_bf16 v[48:63], v[184:187], a[72:75], v[48:63]
buffer_load_dwordx4 v2, s[8:11], s28 offen sc1 lds
s_add_u32 m0, m0, 4096
s_add_u32 s28, s28, 4096
ds_read_b128 v[180:183], v11 offset:25600
s_waitcnt lgkmcnt(6)
v_mfma_f32_32x32x16_bf16 v[48:63], v[188:191], a[76:79], v[48:63]
ds_read_b128 v[184:187], v11 offset:26624
s_waitcnt lgkmcnt(6)
v_mfma_f32_32x32x16_bf16 v[48:63], v[192:195], a[80:83], v[48:63]
s_cmp_eq_u32 s46, 0
s_cbranch_scc1 OPT_304
s_getreg_b32 s20, hwreg(HW_REG_IB_STS)
s_and_b32 s20, s20, 0xc0000f
s_cmp_gt_u32 s20, 6
s_cbranch_scc1 OPT_304
s_waitcnt vmcnt(6)
s_mov_b64 exec, 1
buffer_store_dword v5, v4, s[8:11], s35 offen sc1
s_mov_b64 exec, -1
s_mov_b64 exec, 1
buffer_store_dword v5, v4, s[8:11], s43 offen sc1
s_mov_b64 exec, -1
s_mov_b32 s46, 0
OPT_304:
ds_read_b128 v[188:191], v11 offset:27648
s_waitcnt lgkmcnt(6)
v_mfma_f32_32x32x16_bf16 v[48:63], v[196:199], a[84:87], v[48:63]
ds_read_b128 v[192:195], v11 offset:14336
s_waitcnt lgkmcnt(6)
v_mfma_f32_32x32x16_bf16 v[48:63], v[200:203], a[88:91], v[48:63]
buffer_load_dwordx4 v2, s[8:11], s28 offen sc1 lds
s_add_u32 m0, m0, 4096
s_add_u32 s28, s28, 4096
ds_read_b128 v[196:199], v11 offset:15360
s_waitcnt lgkmcnt(6)
v_mfma_f32_32x32x16_bf16 v[48:63], v[204:207], a[92:95], v[48:63]
ds_read_b128 v[200:203], v11 offset:16384
s_waitcnt lgkmcnt(6)
v_mfma_f32_32x32x16_bf16 v[48:63], v[176:179], a[96:99], v[48:63]
buffer_load_dwordx4 v2, s[8:11], s28 offen sc1 lds
s_add_u32 m0, m0, 4096
s_add_u32 s28, s28, 4096
ds_read_b128 v[204:207], v11 offset:17408
s_waitcnt lgkmcnt(6)
v_mfma_f32_32x32x16_bf16 v[48:63], v[180:183], a[100:103], v[48:63]
ds_read_b128 v[176:179], v11 offset:18432
s_waitcnt lgkmcnt(6)
v_mfma_f32_32x32x16_bf16 v[48:63], v[184:187], a[104:107], v[48:63]
buffer_load_dwordx4 v2, s[8:11], s28 offen sc1 lds
s_add_u32 m0, m0, 4096
s_add_u32 s28, s28, 4096
ds_read_b128 v[180:183], v11 offset:19456
s_waitcnt lgkmcnt(6)
v_mfma_f32_32x32x16_bf16 v[48:63], v[188:191], a[108:111], v[48:63]
ds_read_b128 v[184:187], v11 offset:20480
s_waitcnt lgkmcnt(6)
v_mfma_f32_32x32x16_bf16 v[64:79], v[192:195], a[168:171], v[64:79]
buffer_load_dwordx4 v2, s[8:11], s28 offen sc1 lds
s_add_u32 m0, m0, 4096
s_add_u32 s28, s28, 4096
ds_read_b128 v[188:191], v11 offset:21504
s_waitcnt lgkmcnt(6)
v_mfma_f32_32x32x16_bf16 v[64:79], v[196:199], a[172:175], v[64:79]
s_cmp_eq_u32 s46, 0
s_cbranch_scc1 OPT_306
s_waitcnt vmcnt(10)
s_mov_b64 exec, 1
buffer_store_dword v5, v4, s[8:11], s35 offen sc1
s_mov_b64 exec, -1
s_mov_b64 exec, 1
buffer_store_dword v5, v4, s[8:11], s43 offen sc1
s_mov_b64 exec, -1
s_mov_b32 s46, 0
OPT_306:
ds_read_b128 v[192:195], v11 offset:22528
s_waitcnt lgkmcnt(6)
v_mfma_f32_32x32x16_bf16 v[64:79], v[200:203], a[176:179], v[64:79]
ds_read_b128 v[196:199], v11 offset:23552
s_waitcnt lgkmcnt(6)
v_mfma_f32_32x32x16_bf16 v[64:79], v[204:207], a[180:183], v[64:79]
ds_read_b128 v[200:203], v11 offset:24576
v_fma_f32 v48, v48, v80, v112
v_fma_f32 v49, v49, v81, v113
v_cvt_pk_bf16_f32 v144, v48, v49
v_fma_f32 v50, v50, v82, v114
s_waitcnt lgkmcnt(6)
v_mfma_f32_32x32x16_bf16 v[64:79], v[176:179], a[184:187], v[64:79]
ds_read_b128 v[204:207], v11 offset:25600
v_fma_f32 v51, v51, v83, v115
v_cvt_pk_bf16_f32 v145, v50, v51
v_fma_f32 v52, v52, v84, v116
v_fma_f32 v53, v53, v85, v117
s_waitcnt lgkmcnt(6)
v_mfma_f32_32x32x16_bf16 v[64:79], v[180:183], a[188:191], v[64:79]
ds_read_b128 v[176:179], v11 offset:26624
v_cvt_pk_bf16_f32 v146, v52, v53
v_fma_f32 v54, v54, v86, v118
v_fma_f32 v55, v55, v87, v119
v_cvt_pk_bf16_f32 v147, v54, v55
s_waitcnt lgkmcnt(6)
v_mfma_f32_32x32x16_bf16 v[64:79], v[184:187], a[192:195], v[64:79]
ds_read_b128 v[180:183], v11 offset:27648
buffer_store_dwordx4 v[144:147], v10, s[8:11], s29 offen offset:0 sc1
v_fma_f32 v56, v56, v88, v120
v_fma_f32 v57, v57, v89, v121
v_cvt_pk_bf16_f32 v148, v56, v57
s_waitcnt lgkmcnt(6)
v_mfma_f32_32x32x16_bf16 v[64:79], v[188:191], a[196:199], v[64:79]
v_fma_f32 v58, v58, v90, v122
v_fma_f32 v59, v59, v91, v123
v_cvt_pk_bf16_f32 v149, v58, v59
v_fma_f32 v60, v60, v92, v124
v_fma_f32 v61, v61, v93, v125
s_waitcnt lgkmcnt(5)
v_mfma_f32_32x32x16_bf16 v[64:79], v[192:195], a[200:203], v[64:79]
v_cvt_pk_bf16_f32 v150, v60, v61
v_fma_f32 v62, v62, v94, v126
v_fma_f32 v63, v63, v95, v127
v_cvt_pk_bf16_f32 v151, v62, v63
buffer_store_dwordx4 v[148:151], v10, s[8:11], s29 offen offset:1024 sc1
s_waitcnt lgkmcnt(4)
v_mfma_f32_32x32x16_bf16 v[64:79], v[196:199], a[204:207], v[64:79]
s_add_u32 s29, s29, 28672
s_waitcnt lgkmcnt(3)
v_mfma_f32_32x32x16_bf16 v[64:79], v[200:203], a[208:211], v[64:79]
s_waitcnt lgkmcnt(2)
v_mfma_f32_32x32x16_bf16 v[64:79], v[204:207], a[212:215], v[64:79]
s_waitcnt lgkmcnt(1)
v_mfma_f32_32x32x16_bf16 v[64:79], v[176:179], a[216:219], v[64:79]
s_waitcnt lgkmcnt(0)
v_mfma_f32_32x32x16_bf16 v[64:79], v[180:183], a[220:223], v[64:79]
s_nop 11
v_pk_fma_f32 v[64:65], v[64:65], v[80:81], v[128:129]
v_cvt_pk_bf16_f32 v152, v64, v65
v_pk_fma_f32 v[66:67], v[66:67], v[82:83], v[130:131]
v_cvt_pk_bf16_f32 v153, v66, v67
v_pk_fma_f32 v[68:69], v[68:69], v[84:85], v[132:133]
v_cvt_pk_bf16_f32 v154, v68, v69
v_pk_fma_f32 v[70:71], v[70:71], v[86:87], v[134:135]
v_cvt_pk_bf16_f32 v155, v70, v71
buffer_store_dwordx4 v[152:155], v10, s[8:11], s29 offen offset:0 sc1
v_pk_fma_f32 v[72:73], v[72:73], v[88:89], v[136:137]
v_cvt_pk_bf16_f32 v156, v72, v73
v_pk_fma_f32 v[74:75], v[74:75], v[90:91], v[138:139]
v_cvt_pk_bf16_f32 v157, v74, v75
v_pk_fma_f32 v[76:77], v[76:77], v[92:93], v[140:141]
v_cvt_pk_bf16_f32 v158, v76, v77
v_pk_fma_f32 v[78:79], v[78:79], v[94:95], v[142:143]
v_cvt_pk_bf16_f32 v159, v78, v79
buffer_store_dwordx4 v[156:159], v10, s[8:11], s29 offen offset:1024 sc1
s_mov_b32 s35, s30
s_branch U_WARM0_283
U_N1_300:
s_waitcnt vmcnt(10)
s_barrier
ds_read_b128 v[176:179], v11 offset:0
ds_read_b128 v[180:183], v11 offset:1024
ds_read_b128 v[184:187], v11 offset:2048
s_waitcnt lgkmcnt(2)
v_mfma_f32_32x32x16_bf16 v[48:63], v[176:179], a[0:3], 0
ds_read_b128 v[188:191], v11 offset:3072
v_add_f32 v20, v20, v22
v_add_f32 v21, v21, v23
v_add_f32 v24, v24, v26
v_add_f32 v25, v25, v27
v_add_f32 v20, v20, v24
v_mfma_f32_32x32x16_bf16 v[64:79], v[176:179], a[112:115], 0
s_waitcnt vmcnt(9)
s_barrier
ds_read_b128 v[192:195], v11 offset:4096
v_add_f32 v21, v21, v25
v_mov_b32 v18, v20
s_waitcnt lgkmcnt(3)
v_mfma_f32_32x32x16_bf16 v[48:63], v[180:183], a[4:7], v[48:63]
ds_read_b128 v[196:199], v11 offset:5120
v_mov_b32 v19, v21
v_permlane32_swap_b32 v18, v20
s_nop 0
v_permlane32_swap_b32 v19, v21
v_add_f32 v20, v20, v18
v_mfma_f32_32x32x16_bf16 v[64:79], v[180:183], a[116:119], v[64:79]
ds_read_b128 v[200:203], v11 offset:6144
v_add_f32 v21, v21, v19
v_mul_f32 v18, 0x3b124925, v20
v_mul_f32 v19, 0x3b124925, v21
v_fma_f32 v19, -v18, v18, v19
s_waitcnt lgkmcnt(4)
v_mfma_f32_32x32x16_bf16 v[48:63], v[184:187], a[8:11], v[48:63]
ds_read_b128 v[204:207], v11 offset:7168
v_max_f32 v19, 0, v19
v_add_f32 v19, 0x3727c5ac, v19
v_rsq_f32 v20, v19
v_mov_b32 v21, v18
v_mfma_f32_32x32x16_bf16 v[64:79], v[184:187], a[120:123], v[64:79]
s_waitcnt vmcnt(7)
s_barrier
ds_read_b128 v[176:179], v11 offset:8192
s_mul_i32 s29, s15, 458752
s_add_u32 s29, s29, s27
s_waitcnt lgkmcnt(5)
v_mfma_f32_32x32x16_bf16 v[48:63], v[188:191], a[12:15], v[48:63]
ds_read_b128 v[180:183], v11 offset:9216
s_lshl_b32 s30, s15, 11
s_add_u32 s30, s30, s31
s_mul_i32 s34, s15, 28672
s_add_u32 s34, s34, s41
s_add_u32 s34, s34, 39845888
v_mfma_f32_32x32x16_bf16 v[64:79], v[188:191], a[124:127], v[64:79]
ds_read_b128 v[184:187], v11 offset:10240
s_add_u32 s43, s30, 262144
s_mov_b32 s46, 1
v_mul_f32 v22, v20, v21
v_sub_f32 v22, 0, v22
s_waitcnt lgkmcnt(6)
v_mfma_f32_32x32x16_bf16 v[48:63], v[192:195], a[16:19], v[48:63]
ds_write2_b32 v8, v20, v22 offset0:0 offset1:32
v_lshlrev_b32 v164, 16, v160
v_and_b32 v165, 0xffff0000, v160
v_fma_f32 v164, v164, v20, v22
v_fma_f32 v165, v165, v20, v22
v_cvt_pk_bf16_f32 v172, v164, v165
v_mfma_f32_32x32x16_bf16 v[64:79], v[192:195], a[128:131], v[64:79]
ds_read_b128 v[188:191], v11 offset:11264
v_lshlrev_b32 v166, 16, v161
v_and_b32 v167, 0xffff0000, v161
v_fma_f32 v166, v166, v20, v22
v_fma_f32 v167, v167, v20, v22
s_waitcnt lgkmcnt(7)
v_mfma_f32_32x32x16_bf16 v[48:63], v[196:199], a[20:23], v[48:63]
v_cvt_pk_bf16_f32 v173, v166, v167
v_lshlrev_b32 v168, 16, v162
v_and_b32 v169, 0xffff0000, v162
v_fma_f32 v168, v168, v20, v22
v_fma_f32 v169, v169, v20, v22
v_cvt_pk_bf16_f32 v174, v168, v169
v_mfma_f32_32x32x16_bf16 v[64:79], v[196:199], a[132:135], v[64:79]
ds_read_b128 v[192:195], v11 offset:12288
v_lshlrev_b32 v170, 16, v163
v_and_b32 v171, 0xffff0000, v163
v_fma_f32 v170, v170, v20, v22
v_fma_f32 v171, v171, v20, v22
s_waitcnt lgkmcnt(7)
v_mfma_f32_32x32x16_bf16 v[48:63], v[200:203], a[24:27], v[48:63]
v_cvt_pk_bf16_f32 v175, v170, v171
s_mov_b64 exec, s[32:33]
buffer_store_dwordx4 v[172:175], v13, s[8:11], s34 offen sc1
s_mov_b64 exec, -1
ds_read_b128 v[80:83], v9 offset:0
ds_read_b128 v[96:99], v9 offset:128
v_mfma_f32_32x32x16_bf16 v[64:79], v[200:203], a[136:139], v[64:79]
ds_read_b128 v[196:199], v11 offset:13312
ds_read_b128 v[84:87], v9 offset:16
ds_read_b128 v[100:103], v9 offset:144
ds_read_b128 v[88:91], v9 offset:64
ds_read_b128 v[104:107], v9 offset:192
s_waitcnt lgkmcnt(13)
v_mfma_f32_32x32x16_bf16 v[48:63], v[204:207], a[28:31], v[48:63]
ds_read_b128 v[92:95], v9 offset:80
ds_read_b128 v[108:111], v9 offset:208
s_lshl_b32 s19, s23, 7
s_add_u32 s19, s19, s24
s_mul_i32 s40, s19, 28672
s_add_u32 s40, s40, 44040192
v_mfma_f32_32x32x16_bf16 v[64:79], v[204:207], a[140:143], v[64:79]
ds_read_b128 v[200:203], v11 offset:14336
s_add_u32 s28, s40, s36
s_add_u32 s40, s40, s41
s_add_u32 s37, s25, s36
s_lshl_b32 s39, s19, 11
s_waitcnt lgkmcnt(15)
v_mfma_f32_32x32x16_bf16 v[48:63], v[176:179], a[32:35], v[48:63]
s_add_u32 s39, s39, 39321600
s_lshl_b32 s42, s24, 9
s_add_u32 s42, s42, 38076416
s_waitcnt lgkmcnt(1)
v_mul_f32 v112, v96, v14
v_mul_f32 v113, v97, v14
v_mfma_f32_32x32x16_bf16 v[64:79], v[176:179], a[144:147], v[64:79]
ds_read_b128 v[204:207], v11 offset:15360
v_mul_f32 v114, v98, v14
v_mul_f32 v115, v99, v14
v_mul_f32 v116, v100, v14
v_mul_f32 v117, v101, v14
v_mfma_f32_32x32x16_bf16 v[48:63], v[180:183], a[36:39], v[48:63]
v_mul_f32 v118, v102, v14
v_mul_f32 v119, v103, v14
v_mul_f32 v120, v104, v14
v_mul_f32 v121, v105, v14
v_mul_f32 v122, v106, v14
v_mul_f32 v123, v107, v14
v_mfma_f32_32x32x16_bf16 v[64:79], v[180:183], a[148:151], v[64:79]
s_waitcnt vmcnt(5)
s_barrier
ds_read_b128 v[176:179], v11 offset:16384
v_mul_f32 v124, v108, v14
v_mul_f32 v125, v109, v14
v_mfma_f32_32x32x16_bf16 v[48:63], v[184:187], a[40:43], v[48:63]
v_mul_f32 v126, v110, v14
v_mul_f32 v127, v111, v14
v_mul_f32 v128, v96, v16
v_mul_f32 v129, v97, v16
v_mul_f32 v130, v98, v16
v_mul_f32 v131, v99, v16
v_mfma_f32_32x32x16_bf16 v[64:79], v[184:187], a[152:155], v[64:79]
ds_read_b128 v[180:183], v11 offset:17408
v_mul_f32 v132, v100, v16
v_mul_f32 v133, v101, v16
v_mul_f32 v134, v102, v16
v_mul_f32 v135, v103, v16
v_mfma_f32_32x32x16_bf16 v[48:63], v[188:191], a[44:47], v[48:63]
v_mul_f32 v136, v104, v16
v_mul_f32 v137, v105, v16
v_mul_f32 v138, v106, v16
v_mul_f32 v139, v107, v16
v_mul_f32 v140, v108, v16
v_mul_f32 v141, v109, v16
v_mfma_f32_32x32x16_bf16 v[64:79], v[188:191], a[156:159], v[64:79]
ds_read_b128 v[184:187], v11 offset:18432
v_mul_f32 v142, v110, v16
v_mul_f32 v143, v111, v16
v_mfma_f32_32x32x16_bf16 v[48:63], v[192:195], a[48:51], v[48:63]
buffer_load_dword v12, v7, s[8:11], s42 offen sc1
v_mfma_f32_32x32x16_bf16 v[64:79], v[192:195], a[160:163], v[64:79]
ds_read_b128 v[188:191], v11 offset:19456
v_mfma_f32_32x32x16_bf16 v[48:63], v[196:199], a[52:55], v[48:63]
s_cmp_eq_u32 s46, 0
s_cbranch_scc1 OPT_308
s_getreg_b32 s20, hwreg(HW_REG_IB_STS)
s_and_b32 s20, s20, 0xc0000f
s_cmp_gt_u32 s20, 1
s_cbranch_scc1 OPT_308
s_waitcnt vmcnt(1)
s_mov_b64 exec, 1
buffer_store_dword v5, v4, s[8:11], s35 offen sc1
s_mov_b64 exec, -1
s_mov_b64 exec, 1
buffer_store_dword v5, v4, s[8:11], s43 offen sc1
s_mov_b64 exec, -1
s_mov_b32 s46, 0
OPT_308:
v_mfma_f32_32x32x16_bf16 v[64:79], v[196:199], a[164:167], v[64:79]
ds_read_b128 v[192:195], v11 offset:20480
s_waitcnt lgkmcnt(6)
v_mfma_f32_32x32x16_bf16 v[48:63], v[200:203], a[56:59], v[48:63]
ds_read_b128 v[196:199], v11 offset:21504
s_waitcnt lgkmcnt(6)
v_mfma_f32_32x32x16_bf16 v[48:63], v[204:207], a[60:63], v[48:63]
ds_read_b128 v[200:203], v11 offset:22528
s_waitcnt lgkmcnt(6)
v_mfma_f32_32x32x16_bf16 v[48:63], v[176:179], a[64:67], v[48:63]
ds_read_b128 v[204:207], v11 offset:23552
s_waitcnt lgkmcnt(6)
v_mfma_f32_32x32x16_bf16 v[48:63], v[180:183], a[68:71], v[48:63]
ds_read_b128 v[176:179], v11 offset:24576
s_waitcnt lgkmcnt(6)
v_mfma_f32_32x32x16_bf16 v[48:63], v[184:187], a[72:75], v[48:63]
ds_read_b128 v[180:183], v11 offset:25600
s_waitcnt lgkmcnt(6)
v_mfma_f32_32x32x16_bf16 v[48:63], v[188:191], a[76:79], v[48:63]
ds_read_b128 v[184:187], v11 offset:26624
s_waitcnt lgkmcnt(6)
v_mfma_f32_32x32x16_bf16 v[48:63], v[192:195], a[80:83], v[48:63]
s_cmp_eq_u32 s46, 0
s_cbranch_scc1 OPT_310
s_getreg_b32 s20, hwreg(HW_REG_IB_STS)
s_and_b32 s20, s20, 0xc0000f
s_cmp_gt_u32 s20, 1
s_cbranch_scc1 OPT_310
s_waitcnt vmcnt(1)
s_mov_b64 exec, 1
buffer_store_dword v5, v4, s[8:11], s35 offen sc1
s_mov_b64 exec, -1
s_mov_b64 exec, 1
buffer_store_dword v5, v4, s[8:11], s43 offen sc1
s_mov_b64 exec, -1
s_mov_b32 s46, 0
OPT_310:
ds_read_b128 v[188:191], v11 offset:27648
s_waitcnt lgkmcnt(6)
v_mfma_f32_32x32x16_bf16 v[48:63], v[196:199], a[84:87], v[48:63]
ds_read_b128 v[192:195], v11 offset:14336
s_waitcnt lgkmcnt(6)
v_mfma_f32_32x32x16_bf16 v[48:63], v[200:203], a[88:91], v[48:63]
ds_read_b128 v[196:199], v11 offset:15360
s_waitcnt lgkmcnt(6)
v_mfma_f32_32x32x16_bf16 v[48:63], v[204:207], a[92:95], v[48:63]
ds_read_b128 v[200:203], v11 offset:16384
s_waitcnt lgkmcnt(6)
v_mfma_f32_32x32x16_bf16 v[48:63], v[176:179], a[96:99], v[48:63]
ds_read_b128 v[204:207], v11 offset:17408
s_waitcnt lgkmcnt(6)
v_mfma_f32_32x32x16_bf16 v[48:63], v[180:183], a[100:103], v[48:63]
ds_read_b128 v[176:179], v11 offset:18432
s_waitcnt lgkmcnt(6)
v_mfma_f32_32x32x16_bf16 v[48:63], v[184:187], a[104:107], v[48:63]
ds_read_b128 v[180:183], v11 offset:19456
s_waitcnt lgkmcnt(6)
v_mfma_f32_32x32x16_bf16 v[48:63], v[188:191], a[108:111], v[48:63]
ds_read_b128 v[184:187], v11 offset:20480
s_waitcnt lgkmcnt(6)
v_mfma_f32_32x32x16_bf16 v[64:79], v[192:195], a[168:171], v[64:79]
ds_read_b128 v[188:191], v11 offset:21504
s_waitcnt lgkmcnt(6)
v_mfma_f32_32x32x16_bf16 v[64:79], v[196:199], a[172:175], v[64:79]
s_cmp_eq_u32 s46, 0
s_cbranch_scc1 OPT_312
s_waitcnt vmcnt(1)
s_mov_b64 exec, 1
buffer_store_dword v5, v4, s[8:11], s35 offen sc1
s_mov_b64 exec, -1
s_mov_b64 exec, 1
buffer_store_dword v5, v4, s[8:11], s43 offen sc1
s_mov_b64 exec, -1
s_mov_b32 s46, 0
OPT_312:
ds_read_b128 v[192:195], v11 offset:22528
s_waitcnt vmcnt(2)
v_cmp_eq_u32 vcc, 0, v12
s_cmp_ge_u32 s24, 64
s_cselect_b64 vcc, -1, vcc
s_cbranch_vccnz U_NP_313
s_waitcnt lgkmcnt(6)
v_mfma_f32_32x32x16_bf16 v[64:79], v[200:203], a[176:179], v[64:79]
buffer_load_dwordx4 v[20:23], v6, s[8:11], s39 offen sc1
ds_read_b128 v[196:199], v11 offset:23552
s_waitcnt lgkmcnt(6)
v_mfma_f32_32x32x16_bf16 v[64:79], v[204:207], a[180:183], v[64:79]
buffer_load_dwordx4 v[24:27], v6, s[8:11], s39 offen offset:1024 sc1
ds_read_b128 v[200:203], v11 offset:24576
v_fma_f32 v48, v48, v80, v112
v_fma_f32 v49, v49, v81, v113
v_cvt_pk_bf16_f32 v144, v48, v49
s_waitcnt lgkmcnt(6)
v_mfma_f32_32x32x16_bf16 v[64:79], v[176:179], a[184:187], v[64:79]
s_mov_b64 exec, s[32:33]
buffer_load_dwordx4 v[160:163], v2, s[8:11], s40 offen sc1
s_mov_b64 exec, -1
ds_read_b128 v[204:207], v11 offset:25600
v_fma_f32 v50, v50, v82, v114
s_waitcnt lgkmcnt(6)
v_mfma_f32_32x32x16_bf16 v[64:79], v[180:183], a[188:191], v[64:79]
s_mov_b32 m0, s37
s_nop 0
buffer_load_dwordx4 v2, s[8:11], s28 offen sc1 lds
s_add_u32 m0, m0, 4096
s_add_u32 s28, s28, 4096
ds_read_b128 v[176:179], v11 offset:26624
s_waitcnt lgkmcnt(6)
v_mfma_f32_32x32x16_bf16 v[64:79], v[184:187], a[192:195], v[64:79]
buffer_load_dwordx4 v2, s[8:11], s28 offen sc1 lds
s_add_u32 m0, m0, 4096
s_add_u32 s28, s28, 4096
ds_read_b128 v[180:183], v11 offset:27648
v_fma_f32 v51, v51, v83, v115
s_waitcnt lgkmcnt(6)
v_mfma_f32_32x32x16_bf16 v[64:79], v[188:191], a[196:199], v[64:79]
buffer_load_dwordx4 v2, s[8:11], s28 offen sc1 lds
s_add_u32 m0, m0, 4096
s_add_u32 s28, s28, 4096
v_cvt_pk_bf16_f32 v145, v50, v51
v_fma_f32 v52, v52, v84, v116
s_waitcnt lgkmcnt(5)
v_mfma_f32_32x32x16_bf16 v[64:79], v[192:195], a[200:203], v[64:79]
buffer_load_dwordx4 v2, s[8:11], s28 offen sc1 lds
s_add_u32 m0, m0, 4096
s_add_u32 s28, s28, 4096
v_fma_f32 v53, v53, v85, v117
v_cvt_pk_bf16_f32 v146, v52, v53
s_waitcnt lgkmcnt(4)
v_mfma_f32_32x32x16_bf16 v[64:79], v[196:199], a[204:207], v[64:79]
buffer_load_dwordx4 v2, s[8:11], s28 offen sc1 lds
s_add_u32 m0, m0, 4096
s_add_u32 s28, s28, 4096
v_fma_f32 v54, v54, v86, v118
v_fma_f32 v55, v55, v87, v119
s_waitcnt lgkmcnt(3)
v_mfma_f32_32x32x16_bf16 v[64:79], v[200:203], a[208:211], v[64:79]
buffer_load_dwordx4 v2, s[8:11], s28 offen sc1 lds
s_add_u32 m0, m0, 4096
s_add_u32 s28, s28, 4096
v_cvt_pk_bf16_f32 v147, v54, v55
v_fma_f32 v56, v56, v88, v120
s_waitcnt lgkmcnt(2)
v_mfma_f32_32x32x16_bf16 v[64:79], v[204:207], a[212:215], v[64:79]
buffer_load_dwordx4 v2, s[8:11], s28 offen sc1 lds
s_add_u32 m0, m0, 4096
s_add_u32 s28, s28, 4096
v_fma_f32 v57, v57, v89, v121
v_cvt_pk_bf16_f32 v148, v56, v57
s_waitcnt lgkmcnt(1)
v_mfma_f32_32x32x16_bf16 v[64:79], v[176:179], a[216:219], v[64:79]
v_fma_f32 v58, v58, v90, v122
v_fma_f32 v59, v59, v91, v123
v_cvt_pk_bf16_f32 v149, v58, v59
v_fma_f32 v60, v60, v92, v124
v_fma_f32 v61, v61, v93, v125
s_waitcnt lgkmcnt(0)
v_mfma_f32_32x32x16_bf16 v[64:79], v[180:183], a[220:223], v[64:79]
v_cvt_pk_bf16_f32 v150, v60, v61
v_fma_f32 v62, v62, v94, v126
v_fma_f32 v63, v63, v95, v127
v_cvt_pk_bf16_f32 v151, v62, v63
buffer_store_dwordx4 v[144:147], v10, s[8:11], s29 offen offset:0 sc1
buffer_store_dwordx4 v[148:151], v10, s[8:11], s29 offen offset:1024 sc1
s_add_u32 s29, s29, 28672
s_nop 4
v_pk_fma_f32 v[64:65], v[64:65], v[80:81], v[128:129]
v_cvt_pk_bf16_f32 v152, v64, v65
v_pk_fma_f32 v[66:67], v[66:67], v[82:83], v[130:131]
v_cvt_pk_bf16_f32 v153, v66, v67
v_pk_fma_f32 v[68:69], v[68:69], v[84:85], v[132:133]
v_cvt_pk_bf16_f32 v154, v68, v69
v_pk_fma_f32 v[70:71], v[70:71], v[86:87], v[134:135]
v_cvt_pk_bf16_f32 v155, v70, v71
buffer_store_dwordx4 v[152:155], v10, s[8:11], s29 offen offset:0 sc1
v_pk_fma_f32 v[72:73], v[72:73], v[88:89], v[136:137]
v_cvt_pk_bf16_f32 v156, v72, v73
v_pk_fma_f32 v[74:75], v[74:75], v[90:91], v[138:139]
v_cvt_pk_bf16_f32 v157, v74, v75
v_pk_fma_f32 v[76:77], v[76:77], v[92:93], v[140:141]
v_cvt_pk_bf16_f32 v158, v76, v77
v_pk_fma_f32 v[78:79], v[78:79], v[94:95], v[142:143]
v_cvt_pk_bf16_f32 v159, v78, v79
buffer_store_dwordx4 v[156:159], v10, s[8:11], s29 offen offset:1024 sc1
s_mov_b32 s35, s30
s_branch U_WARM0_283
U_NP_313:
s_waitcnt lgkmcnt(6)
v_mfma_f32_32x32x16_bf16 v[64:79], v[200:203], a[176:179], v[64:79]
ds_read_b128 v[196:199], v11 offset:23552
s_waitcnt lgkmcnt(6)
v_mfma_f32_32x32x16_bf16 v[64:79], v[204:207], a[180:183], v[64:79]
ds_read_b128 v[200:203], v11 offset:24576
v_fma_f32 v48, v48, v80, v112
v_fma_f32 v49, v49, v81, v113
v_cvt_pk_bf16_f32 v144, v48, v49
v_fma_f32 v50, v50, v82, v114
s_waitcnt lgkmcnt(6)
v_mfma_f32_32x32x16_bf16 v[64:79], v[176:179], a[184:187], v[64:79]
ds_read_b128 v[204:207], v11 offset:25600
v_fma_f32 v51, v51, v83, v115
v_cvt_pk_bf16_f32 v145, v50, v51
v_fma_f32 v52, v52, v84, v116
v_fma_f32 v53, v53, v85, v117
s_waitcnt lgkmcnt(6)
v_mfma_f32_32x32x16_bf16 v[64:79], v[180:183], a[188:191], v[64:79]
ds_read_b128 v[176:179], v11 offset:26624
v_cvt_pk_bf16_f32 v146, v52, v53
v_fma_f32 v54, v54, v86, v118
v_fma_f32 v55, v55, v87, v119
v_cvt_pk_bf16_f32 v147, v54, v55
s_waitcnt lgkmcnt(6)
v_mfma_f32_32x32x16_bf16 v[64:79], v[184:187], a[192:195], v[64:79]
ds_read_b128 v[180:183], v11 offset:27648
buffer_store_dwordx4 v[144:147], v10, s[8:11], s29 offen offset:0 sc1
v_fma_f32 v56, v56, v88, v120
v_fma_f32 v57, v57, v89, v121
v_cvt_pk_bf16_f32 v148, v56, v57
s_waitcnt lgkmcnt(6)
v_mfma_f32_32x32x16_bf16 v[64:79], v[188:191], a[196:199], v[64:79]
v_fma_f32 v58, v58, v90, v122
v_fma_f32 v59, v59, v91, v123
v_cvt_pk_bf16_f32 v149, v58, v59
v_fma_f32 v60, v60, v92, v124
v_fma_f32 v61, v61, v93, v125
s_waitcnt lgkmcnt(5)
v_mfma_f32_32x32x16_bf16 v[64:79], v[192:195], a[200:203], v[64:79]
v_cvt_pk_bf16_f32 v150, v60, v61
v_fma_f32 v62, v62, v94, v126
v_fma_f32 v63, v63, v95, v127
v_cvt_pk_bf16_f32 v151, v62, v63
buffer_store_dwordx4 v[148:151], v10, s[8:11], s29 offen offset:1024 sc1
s_waitcnt lgkmcnt(4)
v_mfma_f32_32x32x16_bf16 v[64:79], v[196:199], a[204:207], v[64:79]
s_add_u32 s29, s29, 28672
s_waitcnt lgkmcnt(3)
v_mfma_f32_32x32x16_bf16 v[64:79], v[200:203], a[208:211], v[64:79]
s_waitcnt lgkmcnt(2)
v_mfma_f32_32x32x16_bf16 v[64:79], v[204:207], a[212:215], v[64:79]
s_waitcnt lgkmcnt(1)
v_mfma_f32_32x32x16_bf16 v[64:79], v[176:179], a[216:219], v[64:79]
s_waitcnt lgkmcnt(0)
v_mfma_f32_32x32x16_bf16 v[64:79], v[180:183], a[220:223], v[64:79]
s_nop 11
v_pk_fma_f32 v[64:65], v[64:65], v[80:81], v[128:129]
v_cvt_pk_bf16_f32 v152, v64, v65
v_pk_fma_f32 v[66:67], v[66:67], v[82:83], v[130:131]
v_cvt_pk_bf16_f32 v153, v66, v67
v_pk_fma_f32 v[68:69], v[68:69], v[84:85], v[132:133]
v_cvt_pk_bf16_f32 v154, v68, v69
v_pk_fma_f32 v[70:71], v[70:71], v[86:87], v[134:135]
v_cvt_pk_bf16_f32 v155, v70, v71
buffer_store_dwordx4 v[152:155], v10, s[8:11], s29 offen offset:0 sc1
v_pk_fma_f32 v[72:73], v[72:73], v[88:89], v[136:137]
v_cvt_pk_bf16_f32 v156, v72, v73
v_pk_fma_f32 v[74:75], v[74:75], v[90:91], v[138:139]
v_cvt_pk_bf16_f32 v157, v74, v75
v_pk_fma_f32 v[76:77], v[76:77], v[92:93], v[140:141]
v_cvt_pk_bf16_f32 v158, v76, v77
v_pk_fma_f32 v[78:79], v[78:79], v[94:95], v[142:143]
v_cvt_pk_bf16_f32 v159, v78, v79
buffer_store_dwordx4 v[156:159], v10, s[8:11], s29 offen offset:1024 sc1
s_mov_b32 s35, s30
buffer_load_dword v12, v7, s[8:11], s42 offen sc1
s_waitcnt vmcnt(1)
s_mov_b64 exec, 1
buffer_store_dword v5, v4, s[8:11], s30 offen sc1
s_mov_b64 exec, -1
s_cmp_ge_u32 s24, 64
s_cbranch_scc1 U_END_281
s_waitcnt vmcnt(1)
v_cmp_eq_u32 vcc, 0, v12
s_cbranch_vccz U_COLD_279
s_nop 2
s_branch U_CW_282
U_END_281:
s_endpgm
M_FILL:
s_mov_b32 s51, 1
s_add_u32 s13, s13, 4
s_cmp_lt_u32 s13, 35
s_cbranch_scc1 M_PUB
s_mov_b32 s21, s14
v_lshlrev_b32 v2, 4, v1
v_mov_b32 v4, -1
v_mov_b32 v5, -1
v_mov_b32 v6, -1
v_mov_b32 v7, -1
v_mov_b32 v8, 1
s_mul_i32 s22, s12, 28672
s_add_u32 s22, s22, 60817408
s_lshl_b32 s23, s12, 2
s_add_u32 s23, s23, 38274816
FILL_314:
s_lshr_b32 s27, s21, 1
s_and_b32 s28, s21, 1
s_lshl_b32 s28, s28, 6
s_add_u32 s28, s28, s27
s_mul_i32 s24, s28, 114688
s_add_u32 s24, s24, s22
buffer_store_dwordx4 v[4:7], v2, s[8:11], s24 offen offset:0 sc1
buffer_store_dwordx4 v[4:7], v2, s[8:11], s24 offen offset:1024 sc1
buffer_store_dwordx4 v[4:7], v2, s[8:11], s24 offen offset:2048 sc1
buffer_store_dwordx4 v[4:7], v2, s[8:11], s24 offen offset:3072 sc1
s_add_u32 s24, s24, 4096
buffer_store_dwordx4 v[4:7], v2, s[8:11], s24 offen offset:0 sc1
buffer_store_dwordx4 v[4:7], v2, s[8:11], s24 offen offset:1024 sc1
buffer_store_dwordx4 v[4:7], v2, s[8:11], s24 offen offset:2048 sc1
buffer_store_dwordx4 v[4:7], v2, s[8:11], s24 offen offset:3072 sc1
s_add_u32 s24, s24, 4096
buffer_store_dwordx4 v[4:7], v2, s[8:11], s24 offen offset:0 sc1
buffer_store_dwordx4 v[4:7], v2, s[8:11], s24 offen offset:1024 sc1
buffer_store_dwordx4 v[4:7], v2, s[8:11], s24 offen offset:2048 sc1
buffer_store_dwordx4 v[4:7], v2, s[8:11], s24 offen offset:3072 sc1
s_add_u32 s24, s24, 4096
buffer_store_dwordx4 v[4:7], v2, s[8:11], s24 offen offset:0 sc1
buffer_store_dwordx4 v[4:7], v2, s[8:11], s24 offen offset:1024 sc1
buffer_store_dwordx4 v[4:7], v2, s[8:11], s24 offen offset:2048 sc1
buffer_store_dwordx4 v[4:7], v2, s[8:11], s24 offen offset:3072 sc1
s_add_u32 s24, s24, 4096
buffer_store_dwordx4 v[4:7], v2, s[8:11], s24 offen offset:0 sc1
buffer_store_dwordx4 v[4:7], v2, s[8:11], s24 offen offset:1024 sc1
buffer_store_dwordx4 v[4:7], v2, s[8:11], s24 offen offset:2048 sc1
buffer_store_dwordx4 v[4:7], v2, s[8:11], s24 offen offset:3072 sc1
s_add_u32 s24, s24, 4096
buffer_store_dwordx4 v[4:7], v2, s[8:11], s24 offen offset:0 sc1
buffer_store_dwordx4 v[4:7], v2, s[8:11], s24 offen offset:1024 sc1
buffer_store_dwordx4 v[4:7], v2, s[8:11], s24 offen offset:2048 sc1
buffer_store_dwordx4 v[4:7], v2, s[8:11], s24 offen offset:3072 sc1
s_add_u32 s24, s24, 4096
buffer_store_dwordx4 v[4:7], v2, s[8:11], s24 offen offset:0 sc1
buffer_store_dwordx4 v[4:7], v2, s[8:11], s24 offen offset:1024 sc1
buffer_store_dwordx4 v[4:7], v2, s[8:11], s24 offen offset:2048 sc1
buffer_store_dwordx4 v[4:7], v2, s[8:11], s24 offen offset:3072 sc1
s_add_u32 s24, s24, 4096
s_lshl_b32 s24, s28, 11
s_add_u32 s24, s24, s23
s_sub_u32 s25, s24, 2032
s_cmp_eq_u32 s27, 0
s_cselect_b32 s26, 131072, 0
s_add_u32 s25, s25, s26
s_waitcnt vmcnt(0)
s_mov_b64 exec, 1
buffer_store_dword v8, off, s[8:11], s24 sc1
buffer_store_dword v8, off, s[8:11], s25 sc1
s_mov_b64 exec, -1
s_add_u32 s21, s21, 2
s_cmp_lt_u32 s21, 128
s_cbranch_scc1 FILL_314
s_endpgm
M_PFF:
s_mov_b32 s50, s14
s_mov_b32 s51, 0
s_cmp_ge_u32 s13, 28
s_cbranch_scc1 M_PUB
s_cmp_ge_u32 s13, 21
s_cbranch_scc1 M_F2
s_cmp_ge_u32 s13, 14
s_cbranch_scc1 M_PU
s_lshl_b32 s17, s13, 2
s_add_u32 s17, s17, s12
s_load_dwordx4 s[48:51], s[0:1], 64
v_lshlrev_b32 v2, 4, v1
v_lshrrev_b32 v18, 2, v1
v_mul_u32_u24 v112, 3584, v18
v_and_b32 v18, 3, v1
v_lshl_add_u32 v112, v18, 4, v112
s_lshl_b32 s19, s17, 6
s_waitcnt lgkmcnt(0)
s_mov_b32 s40, s48
s_and_b32 s41, s49, 0xffff
s_mov_b32 s42, 1605632
s_mov_b32 s43, 0x00020000
s_mov_b32 s44, s50
s_and_b32 s45, s51, 0xffff
s_mov_b32 s46, 1605632
s_mov_b32 s47, 0x00020000
s_mul_i32 s38, s12, 40960
v_lshrrev_b32 v18, 5, v1
v_bfe_u32 v19, v1, 2, 2
v_lshl_add_u32 v113, v18, 3, v19
v_lshlrev_b32 v113, 6, v113
v_bfe_u32 v18, v1, 4, 1
v_lshl_add_u32 v113, v18, 10, v113
v_and_b32 v18, 1, v1
v_lshl_add_u32 v113, v18, 4, v113
v_bfe_u32 v18, v1, 1, 1
v_lshl_add_u32 v113, v18, 3, v113
v_add_u32 v113, s38, v113
s_add_u32 m0, s38, 0
s_nop 0
buffer_load_dwordx4 v112, s[40:43], s19 offen lds
s_add_u32 m0, s38, 1024
s_nop 0
buffer_load_dwordx4 v112, s[44:47], s19 offen lds
s_add_u32 s19, s19, 57344
s_add_u32 m0, s38, 2048
s_nop 0
buffer_load_dwordx4 v112, s[40:43], s19 offen lds
s_add_u32 m0, s38, 3072
s_nop 0
buffer_load_dwordx4 v112, s[44:47], s19 offen lds
s_add_u32 s19, s19, 57344
s_add_u32 m0, s38, 4096
s_nop 0
buffer_load_dwordx4 v112, s[40:43], s19 offen lds
s_add_u32 m0, s38, 5120
s_nop 0
buffer_load_dwordx4 v112, s[44:47], s19 offen lds
s_add_u32 s19, s19, 57344
s_add_u32 m0, s38, 6144
s_nop 0
buffer_load_dwordx4 v112, s[40:43], s19 offen lds
s_add_u32 m0, s38, 7168
s_nop 0
buffer_load_dwordx4 v112, s[44:47], s19 offen lds
s_add_u32 s19, s19, 57344
s_add_u32 m0, s38, 8192
s_nop 0
buffer_load_dwordx4 v112, s[40:43], s19 offen lds
s_add_u32 m0, s38, 9216
s_nop 0
buffer_load_dwordx4 v112, s[44:47], s19 offen lds
s_add_u32 s19, s19, 57344
s_add_u32 m0, s38, 10240
s_nop 0
buffer_load_dwordx4 v112, s[40:43], s19 offen lds
s_add_u32 m0, s38, 11264
s_nop 0
buffer_load_dwordx4 v112, s[44:47], s19 offen lds
s_add_u32 s19, s19, 57344
s_add_u32 m0, s38, 12288
s_nop 0
buffer_load_dwordx4 v112, s[40:43], s19 offen lds
s_add_u32 m0, s38, 13312
s_nop 0
buffer_load_dwordx4 v112, s[44:47], s19 offen lds
s_add_u32 s19, s19, 57344
s_add_u32 m0, s38, 14336
s_nop 0
buffer_load_dwordx4 v112, s[40:43], s19 offen lds
s_add_u32 m0, s38, 15360
s_nop 0
buffer_load_dwordx4 v112, s[44:47], s19 offen lds
s_add_u32 s19, s19, 57344
s_add_u32 m0, s38, 16384
s_nop 0
buffer_load_dwordx4 v112, s[40:43], s19 offen lds
s_add_u32 m0, s38, 17408
s_nop 0
buffer_load_dwordx4 v112, s[44:47], s19 offen lds
s_add_u32 s19, s19, 57344
s_add_u32 m0, s38, 18432
s_nop 0
buffer_load_dwordx4 v112, s[40:43], s19 offen lds
s_add_u32 m0, s38, 19456
s_nop 0
buffer_load_dwordx4 v112, s[44:47], s19 offen lds
s_add_u32 s19, s19, 57344
s_add_u32 m0, s38, 20480
s_nop 0
buffer_load_dwordx4 v112, s[40:43], s19 offen lds
s_add_u32 m0, s38, 21504
s_nop 0
buffer_load_dwordx4 v112, s[44:47], s19 offen lds
s_add_u32 s19, s19, 57344
s_add_u32 m0, s38, 22528
s_nop 0
buffer_load_dwordx4 v112, s[40:43], s19 offen lds
s_add_u32 m0, s38, 23552
s_nop 0
buffer_load_dwordx4 v112, s[44:47], s19 offen lds
s_add_u32 s19, s19, 57344
s_add_u32 m0, s38, 24576
s_nop 0
buffer_load_dwordx4 v112, s[40:43], s19 offen lds
s_add_u32 m0, s38, 25600
s_nop 0
buffer_load_dwordx4 v112, s[44:47], s19 offen lds
s_add_u32 s19, s19, 57344
s_add_u32 m0, s38, 26624
s_nop 0
buffer_load_dwordx4 v112, s[40:43], s19 offen lds
s_add_u32 m0, s38, 27648
s_nop 0
buffer_load_dwordx4 v112, s[44:47], s19 offen lds
s_add_u32 s19, s19, 57344
s_add_u32 m0, s38, 28672
s_nop 0
buffer_load_dwordx4 v112, s[40:43], s19 offen lds
s_add_u32 m0, s38, 29696
s_nop 0
buffer_load_dwordx4 v112, s[44:47], s19 offen lds
s_add_u32 s19, s19, 57344
s_add_u32 m0, s38, 30720
s_nop 0
buffer_load_dwordx4 v112, s[40:43], s19 offen lds
s_add_u32 m0, s38, 31744
s_nop 0
buffer_load_dwordx4 v112, s[44:47], s19 offen lds
s_add_u32 s19, s19, 57344
s_add_u32 m0, s38, 32768
s_nop 0
buffer_load_dwordx4 v112, s[40:43], s19 offen lds
s_add_u32 m0, s38, 33792
s_nop 0
buffer_load_dwordx4 v112, s[44:47], s19 offen lds
s_add_u32 s19, s19, 57344
s_add_u32 m0, s38, 34816
s_nop 0
buffer_load_dwordx4 v112, s[40:43], s19 offen lds
s_add_u32 m0, s38, 35840
s_nop 0
buffer_load_dwordx4 v112, s[44:47], s19 offen lds
s_add_u32 s19, s19, 57344
s_add_u32 m0, s38, 36864
s_nop 0
buffer_load_dwordx4 v112, s[40:43], s19 offen lds
s_add_u32 m0, s38, 37888
s_nop 0
buffer_load_dwordx4 v112, s[44:47], s19 offen lds
s_add_u32 s19, s19, 57344
s_add_u32 m0, s38, 38912
s_nop 0
buffer_load_dwordx4 v112, s[40:43], s19 offen lds
s_add_u32 m0, s38, 39936
s_nop 0
buffer_load_dwordx4 v112, s[44:47], s19 offen lds
s_add_u32 s19, s19, 57344
s_waitcnt vmcnt(20)
ds_read_b64_tr_b16 a[0:1], v113 offset:0
ds_read_b64_tr_b16 a[2:3], v113 offset:256
ds_read_b64_tr_b16 a[112:113], v113 offset:32
ds_read_b64_tr_b16 a[114:115], v113 offset:288
ds_read_b64_tr_b16 a[4:5], v113 offset:2048
ds_read_b64_tr_b16 a[6:7], v113 offset:2304
ds_read_b64_tr_b16 a[116:117], v113 offset:2080
ds_read_b64_tr_b16 a[118:119], v113 offset:2336
ds_read_b64_tr_b16 a[8:9], v113 offset:4096
ds_read_b64_tr_b16 a[10:11], v113 offset:4352
ds_read_b64_tr_b16 a[120:121], v113 offset:4128
ds_read_b64_tr_b16 a[122:123], v113 offset:4384
ds_read_b64_tr_b16 a[12:13], v113 offset:6144
ds_read_b64_tr_b16 a[14:15], v113 offset:6400
ds_read_b64_tr_b16 a[124:125], v113 offset:6176
ds_read_b64_tr_b16 a[126:127], v113 offset:6432
ds_read_b64_tr_b16 a[16:17], v113 offset:8192
ds_read_b64_tr_b16 a[18:19], v113 offset:8448
ds_read_b64_tr_b16 a[128:129], v113 offset:8224
ds_read_b64_tr_b16 a[130:131], v113 offset:8480
ds_read_b64_tr_b16 a[20:21], v113 offset:10240
ds_read_b64_tr_b16 a[22:23], v113 offset:10496
ds_read_b64_tr_b16 a[132:133], v113 offset:10272
ds_read_b64_tr_b16 a[134:135], v113 offset:10528
ds_read_b64_tr_b16 a[24:25], v113 offset:12288
ds_read_b64_tr_b16 a[26:27], v113 offset:12544
ds_read_b64_tr_b16 a[136:137], v113 offset:12320
ds_read_b64_tr_b16 a[138:139], v113 offset:12576
ds_read_b64_tr_b16 a[28:29], v113 offset:14336
ds_read_b64_tr_b16 a[30:31], v113 offset:14592
ds_read_b64_tr_b16 a[140:141], v113 offset:14368
ds_read_b64_tr_b16 a[142:143], v113 offset:14624
ds_read_b64_tr_b16 a[32:33], v113 offset:16384
ds_read_b64_tr_b16 a[34:35], v113 offset:16640
ds_read_b64_tr_b16 a[144:145], v113 offset:16416
ds_read_b64_tr_b16 a[146:147], v113 offset:16672
ds_read_b64_tr_b16 a[36:37], v113 offset:18432
ds_read_b64_tr_b16 a[38:39], v113 offset:18688
ds_read_b64_tr_b16 a[148:149], v113 offset:18464
ds_read_b64_tr_b16 a[150:151], v113 offset:18720
s_waitcnt lgkmcnt(0)
s_add_u32 m0, s38, 0
s_nop 0
buffer_load_dwordx4 v112, s[40:43], s19 offen lds
s_add_u32 m0, s38, 1024
s_nop 0
buffer_load_dwordx4 v112, s[44:47], s19 offen lds
s_add_u32 s19, s19, 57344
s_add_u32 m0, s38, 2048
s_nop 0
buffer_load_dwordx4 v112, s[40:43], s19 offen lds
s_add_u32 m0, s38, 3072
s_nop 0
buffer_load_dwordx4 v112, s[44:47], s19 offen lds
s_add_u32 s19, s19, 57344
s_add_u32 m0, s38, 4096
s_nop 0
buffer_load_dwordx4 v112, s[40:43], s19 offen lds
s_add_u32 m0, s38, 5120
s_nop 0
buffer_load_dwordx4 v112, s[44:47], s19 offen lds
s_add_u32 s19, s19, 57344
s_add_u32 m0, s38, 6144
s_nop 0
buffer_load_dwordx4 v112, s[40:43], s19 offen lds
s_add_u32 m0, s38, 7168
s_nop 0
buffer_load_dwordx4 v112, s[44:47], s19 offen lds
s_add_u32 s19, s19, 57344
s_add_u32 m0, s38, 8192
s_nop 0
buffer_load_dwordx4 v112, s[40:43], s19 offen lds
s_add_u32 m0, s38, 9216
s_nop 0
buffer_load_dwordx4 v112, s[44:47], s19 offen lds
s_add_u32 s19, s19, 57344
s_add_u32 m0, s38, 10240
s_nop 0
buffer_load_dwordx4 v112, s[40:43], s19 offen lds
s_add_u32 m0, s38, 11264
s_nop 0
buffer_load_dwordx4 v112, s[44:47], s19 offen lds
s_add_u32 s19, s19, 57344
s_add_u32 m0, s38, 12288
s_nop 0
buffer_load_dwordx4 v112, s[40:43], s19 offen lds
s_add_u32 m0, s38, 13312
s_nop 0
buffer_load_dwordx4 v112, s[44:47], s19 offen lds
s_add_u32 s19, s19, 57344
s_add_u32 m0, s38, 14336
s_nop 0
buffer_load_dwordx4 v112, s[40:43], s19 offen lds
s_add_u32 m0, s38, 15360
s_nop 0
buffer_load_dwordx4 v112, s[44:47], s19 offen lds
s_add_u32 s19, s19, 57344
s_waitcnt vmcnt(16)
ds_read_b64_tr_b16 a[40:41], v113 offset:20480
ds_read_b64_tr_b16 a[42:43], v113 offset:20736
ds_read_b64_tr_b16 a[152:153], v113 offset:20512
ds_read_b64_tr_b16 a[154:155], v113 offset:20768
ds_read_b64_tr_b16 a[44:45], v113 offset:22528
ds_read_b64_tr_b16 a[46:47], v113 offset:22784
ds_read_b64_tr_b16 a[156:157], v113 offset:22560
ds_read_b64_tr_b16 a[158:159], v113 offset:22816
ds_read_b64_tr_b16 a[48:49], v113 offset:24576
ds_read_b64_tr_b16 a[50:51], v113 offset:24832
ds_read_b64_tr_b16 a[160:161], v113 offset:24608
ds_read_b64_tr_b16 a[162:163], v113 offset:24864
ds_read_b64_tr_b16 a[52:53], v113 offset:26624
ds_read_b64_tr_b16 a[54:55], v113 offset:26880
ds_read_b64_tr_b16 a[164:165], v113 offset:26656
ds_read_b64_tr_b16 a[166:167], v113 offset:26912
ds_read_b64_tr_b16 a[56:57], v113 offset:28672
ds_read_b64_tr_b16 a[58:59], v113 offset:28928
ds_read_b64_tr_b16 a[168:169], v113 offset:28704
ds_read_b64_tr_b16 a[170:171], v113 offset:28960
ds_read_b64_tr_b16 a[60:61], v113 offset:30720
ds_read_b64_tr_b16 a[62:63], v113 offset:30976
ds_read_b64_tr_b16 a[172:173], v113 offset:30752
ds_read_b64_tr_b16 a[174:175], v113 offset:31008
ds_read_b64_tr_b16 a[64:65], v113 offset:32768
ds_read_b64_tr_b16 a[66:67], v113 offset:33024
ds_read_b64_tr_b16 a[176:177], v113 offset:32800
ds_read_b64_tr_b16 a[178:179], v113 offset:33056
ds_read_b64_tr_b16 a[68:69], v113 offset:34816
ds_read_b64_tr_b16 a[70:71], v113 offset:35072
ds_read_b64_tr_b16 a[180:181], v113 offset:34848
ds_read_b64_tr_b16 a[182:183], v113 offset:35104
ds_read_b64_tr_b16 a[72:73], v113 offset:36864
ds_read_b64_tr_b16 a[74:75], v113 offset:37120
ds_read_b64_tr_b16 a[184:185], v113 offset:36896
ds_read_b64_tr_b16 a[186:187], v113 offset:37152
ds_read_b64_tr_b16 a[76:77], v113 offset:38912
ds_read_b64_tr_b16 a[78:79], v113 offset:39168
ds_read_b64_tr_b16 a[188:189], v113 offset:38944
ds_read_b64_tr_b16 a[190:191], v113 offset:39200
s_waitcnt lgkmcnt(0)
s_getpc_b64 s[54:55]
WCODE_315:
s_sub_u32 s54, s54, WCODE_315-K_START
s_subb_u32 s55, s55, 0
v_mbcnt_lo_u32_b32 v18, -1, 0
v_mbcnt_hi_u32_b32 v18, -1, v18
v_lshl_add_u32 v18, v18, 5, s91
v_lshlrev_b32 v18, 6, v18
v_min_u32 v18, K_END-K_START-4, v18
global_load_dword v18, v18, s[54:55]
s_waitcnt vmcnt(0)
ds_read_b64_tr_b16 a[80:81], v113 offset:0
ds_read_b64_tr_b16 a[82:83], v113 offset:256
ds_read_b64_tr_b16 a[192:193], v113 offset:32
ds_read_b64_tr_b16 a[194:195], v113 offset:288
ds_read_b64_tr_b16 a[84:85], v113 offset:2048
ds_read_b64_tr_b16 a[86:87], v113 offset:2304
ds_read_b64_tr_b16 a[196:197], v113 offset:2080
ds_read_b64_tr_b16 a[198:199], v113 offset:2336
ds_read_b64_tr_b16 a[88:89], v113 offset:4096
ds_read_b64_tr_b16 a[90:91], v113 offset:4352
ds_read_b64_tr_b16 a[200:201], v113 offset:4128
ds_read_b64_tr_b16 a[202:203], v113 offset:4384
ds_read_b64_tr_b16 a[92:93], v113 offset:6144
ds_read_b64_tr_b16 a[94:95], v113 offset:6400
ds_read_b64_tr_b16 a[204:205], v113 offset:6176
ds_read_b64_tr_b16 a[206:207], v113 offset:6432
ds_read_b64_tr_b16 a[96:97], v113 offset:8192
ds_read_b64_tr_b16 a[98:99], v113 offset:8448
ds_read_b64_tr_b16 a[208:209], v113 offset:8224
ds_read_b64_tr_b16 a[210:211], v113 offset:8480
ds_read_b64_tr_b16 a[100:101], v113 offset:10240
ds_read_b64_tr_b16 a[102:103], v113 offset:10496
ds_read_b64_tr_b16 a[212:213], v113 offset:10272
ds_read_b64_tr_b16 a[214:215], v113 offset:10528
ds_read_b64_tr_b16 a[104:105], v113 offset:12288
ds_read_b64_tr_b16 a[106:107], v113 offset:12544
ds_read_b64_tr_b16 a[216:217], v113 offset:12320
ds_read_b64_tr_b16 a[218:219], v113 offset:12576
ds_read_b64_tr_b16 a[108:109], v113 offset:14336
ds_read_b64_tr_b16 a[110:111], v113 offset:14592
ds_read_b64_tr_b16 a[220:221], v113 offset:14368
ds_read_b64_tr_b16 a[222:223], v113 offset:14624
s_waitcnt lgkmcnt(0)
s_barrier
s_mul_i32 s28, s14, 7340032
s_lshl_b32 s18, s17, 11
s_add_u32 s28, s28, s18
s_add_u32 s28, s28, 77594624
s_lshl_b32 s18, s14, 15
s_add_u32 s29, s18, 37945344
s_lshl_b32 s30, s17, 2
s_add_u32 s30, s30, s18
s_add_u32 s30, s30, 38010880
s_mul_i32 s26, s14, 3670016
s_add_u32 s26, s26, 45875200
s_lshl_b32 s27, s14, 18
s_add_u32 s27, s27, 39452672
v_mov_b32 v4, 0
v_mov_b32 v5, 1
v_lshrrev_b32 v18, 5, v1
v_and_b32 v19, 31, v1
v_mov_b32 v6, v2
v_min_u32 v7, 27, v1
v_lshrrev_b32 v4, 3, v7
v_mul_u32_u24 v4, 24, v4
v_add_lshl_u32 v7, v7, v4, 2
v_mov_b32 v4, 0
v_mov_b32 v28, 0x3f803f80
v_mov_b32 v29, 0x3f803f80
v_mov_b32 v30, 0x3f803f80
v_mov_b32 v31, 0x3f803f80
s_mov_b32 s25, 0
s_mov_b32 s15, 0
s_waitcnt vmcnt(0)
v_mfma_f32_32x32x16_bf16 v[80:95], a[0:3], v[28:31], 0
v_mfma_f32_32x32x16_bf16 v[96:111], a[112:115], v[28:31], 0
v_mfma_f32_32x32x16_bf16 v[80:95], a[4:7], v[28:31], v[80:95]
v_mfma_f32_32x32x16_bf16 v[96:111], a[116:119], v[28:31], v[96:111]
v_mfma_f32_32x32x16_bf16 v[80:95], a[8:11], v[28:31], v[80:95]
v_mfma_f32_32x32x16_bf16 v[96:111], a[120:123], v[28:31], v[96:111]
v_mfma_f32_32x32x16_bf16 v[80:95], a[12:15], v[28:31], v[80:95]
v_mfma_f32_32x32x16_bf16 v[96:111], a[124:127], v[28:31], v[96:111]
v_mfma_f32_32x32x16_bf16 v[80:95], a[16:19], v[28:31], v[80:95]
v_mfma_f32_32x32x16_bf16 v[96:111], a[128:131], v[28:31], v[96:111]
v_mfma_f32_32x32x16_bf16 v[80:95], a[20:23], v[28:31], v[80:95]
v_mfma_f32_32x32x16_bf16 v[96:111], a[132:135], v[28:31], v[96:111]
v_mfma_f32_32x32x16_bf16 v[80:95], a[24:27], v[28:31], v[80:95]
v_mfma_f32_32x32x16_bf16 v[96:111], a[136:139], v[28:31], v[96:111]
v_mfma_f32_32x32x16_bf16 v[80:95], a[28:31], v[28:31], v[80:95]
v_mfma_f32_32x32x16_bf16 v[96:111], a[140:143], v[28:31], v[96:111]
v_mfma_f32_32x32x16_bf16 v[80:95], a[32:35], v[28:31], v[80:95]
v_mfma_f32_32x32x16_bf16 v[96:111], a[144:147], v[28:31], v[96:111]
v_mfma_f32_32x32x16_bf16 v[80:95], a[36:39], v[28:31], v[80:95]
v_mfma_f32_32x32x16_bf16 v[96:111], a[148:151], v[28:31], v[96:111]
v_mfma_f32_32x32x16_bf16 v[80:95], a[40:43], v[28:31], v[80:95]
v_mfma_f32_32x32x16_bf16 v[96:111], a[152:155], v[28:31], v[96:111]
v_mfma_f32_32x32x16_bf16 v[80:95], a[44:47], v[28:31], v[80:95]
v_mfma_f32_32x32x16_bf16 v[96:111], a[156:159], v[28:31], v[96:111]
v_mfma_f32_32x32x16_bf16 v[80:95], a[48:51], v[28:31], v[80:95]
v_mfma_f32_32x32x16_bf16 v[96:111], a[160:163], v[28:31], v[96:111]
v_mfma_f32_32x32x16_bf16 v[80:95], a[52:55], v[28:31], v[80:95]
v_mfma_f32_32x32x16_bf16 v[96:111], a[164:167], v[28:31], v[96:111]
v_mfma_f32_32x32x16_bf16 v[80:95], a[56:59], v[28:31], v[80:95]
v_mfma_f32_32x32x16_bf16 v[96:111], a[168:171], v[28:31], v[96:111]
v_mfma_f32_32x32x16_bf16 v[80:95], a[60:63], v[28:31], v[80:95]
v_mfma_f32_32x32x16_bf16 v[96:111], a[172:175], v[28:31], v[96:111]
v_mfma_f32_32x32x16_bf16 v[80:95], a[64:67], v[28:31], v[80:95]
v_mfma_f32_32x32x16_bf16 v[96:111], a[176:179], v[28:31], v[96:111]
v_mfma_f32_32x32x16_bf16 v[80:95], a[68:71], v[28:31], v[80:95]
v_mfma_f32_32x32x16_bf16 v[96:111], a[180:183], v[28:31], v[96:111]
v_mfma_f32_32x32x16_bf16 v[80:95], a[72:75], v[28:31], v[80:95]
v_mfma_f32_32x32x16_bf16 v[96:111], a[184:187], v[28:31], v[96:111]
v_mfma_f32_32x32x16_bf16 v[80:95], a[76:79], v[28:31], v[80:95]
v_mfma_f32_32x32x16_bf16 v[96:111], a[188:191], v[28:31], v[96:111]
v_mfma_f32_32x32x16_bf16 v[80:95], a[80:83], v[28:31], v[80:95]
v_mfma_f32_32x32x16_bf16 v[96:111], a[192:195], v[28:31], v[96:111]
v_mfma_f32_32x32x16_bf16 v[80:95], a[84:87], v[28:31], v[80:95]
v_mfma_f32_32x32x16_bf16 v[96:111], a[196:199], v[28:31], v[96:111]
v_mfma_f32_32x32x16_bf16 v[80:95], a[88:91], v[28:31], v[80:95]
v_mfma_f32_32x32x16_bf16 v[96:111], a[200:203], v[28:31], v[96:111]
v_mfma_f32_32x32x16_bf16 v[80:95], a[92:95], v[28:31], v[80:95]
v_mfma_f32_32x32x16_bf16 v[96:111], a[204:207], v[28:31], v[96:111]
v_mfma_f32_32x32x16_bf16 v[80:95], a[96:99], v[28:31], v[80:95]
v_mfma_f32_32x32x16_bf16 v[96:111], a[208:211], v[28:31], v[96:111]
v_mfma_f32_32x32x16_bf16 v[80:95], a[100:103], v[28:31], v[80:95]
v_mfma_f32_32x32x16_bf16 v[96:111], a[212:215], v[28:31], v[96:111]
v_mfma_f32_32x32x16_bf16 v[80:95], a[104:107], v[28:31], v[80:95]
v_mfma_f32_32x32x16_bf16 v[96:111], a[216:219], v[28:31], v[96:111]
v_mfma_f32_32x32x16_bf16 v[80:95], a[108:111], v[28:31], v[80:95]
v_mfma_f32_32x32x16_bf16 v[96:111], a[220:223], v[28:31], v[96:111]
s_lshl_b32 s36, s12, 10
s_add_u32 s26, s26, s36
s_mov_b64 vcc, 0
s_mov_b32 s42, 0
v_mov_b32 v12, 0
s_lshl_b32 s17, s13, 2
s_add_u32 s17, s17, s12
v_lshlrev_b32 v13, 7, v1
s_mul_i32 s39, s14, 29360128
s_lshl_b32 s18, s17, 13
s_add_u32 s39, s39, s18
s_add_u32 s39, s39, 102039552
s_lshl_b32 s44, s14, 15
s_add_u32 s44, s44, 38142208
v_add_u32 v14, s28, v13
v_mov_b32 v15, 114688
s_mul_i32 s18, s14, 3670016
s_lshl_b32 s19, s17, 9
s_add_u32 s18, s18, s19
s_add_u32 s18, s18, 45873152
v_add_u32 v18, s18, v13
v_mov_b32 v19, 28672
v_cmp_gt_u32 vcc, 16, v1
s_nop 1
v_cndmask_b32 v14, v18, v14, vcc
v_cndmask_b32 v15, v19, v15, vcc
s_and_b32 s19, s17, 15
s_lshl_b32 s19, s19, 7
s_add_u32 s19, s19, s27
v_mov_b32 v18, s19
v_mov_b32 v19, 2048
v_cmp_gt_u32 vcc, 20, v1
s_nop 1
v_cndmask_b32 v14, v18, v14, vcc
v_cndmask_b32 v15, v19, v15, vcc
s_cmp_lt_u32 s17, 32
s_cselect_b32 s46, 0xf0000, 0
s_bitcmp0_b32 s17, 3
s_cselect_b32 s47, 0x100000, 0
s_or_b32 s46, s46, s47
s_or_b32 s46, s46, 0xffff
s_mov_b32 s47, 0
s_mov_b64 vcc, 0
MS_316:
buffer_load_dword v18, off, s[92:95], s56 sc1
s_sub_u32 s16, s16, 1
s_cbranch_scc1 MS_316_ab
s_waitcnt vmcnt(0)
v_readfirstlane_b32 s58, v18
s_nop 0
s_and_b32 s17, s58, 0xffff
s_cmp_ge_u32 s17, s57
s_nop 0
s_cbranch_scc0 MS_316
s_lshr_b32 s17, s58, 16
s_cbranch_scc1 MS_316_slow
s_mov_b64 exec, s[46:47]
buffer_load_dword v16, v14, s[8:11], 0 offen sc1
s_mov_b64 exec, -1
v_add_u32 v14, v14, v15
s_mov_b64 exec, s[46:47]
buffer_load_dword v16, v14, s[8:11], 0 offen sc1
s_mov_b64 exec, -1
v_add_u32 v14, v14, v15
s_nop 1
F1_LOOP_317:
s_add_u32 s37, s25, s36
s_cbranch_vccnz F1_ND_318
v_cmp_eq_u32 vcc, 0, v12
s_cbranch_vccz OPT_319
s_nop 2
s_branch WF_320_in
WF_320:
s_sleep 1
WF_320_in:
buffer_load_dword v18, v7, s[8:11], s29 offen sc1
s_sub_u32 s16, s16, 1
s_cbranch_scc1 WFD_321_abort
s_waitcnt vmcnt(0)
v_cmp_eq_u32 vcc, 0, v18
s_cbranch_vccnz WF_320
WFD_321:
OPT_319:
s_mov_b32 m0, s37
s_nop 0
buffer_load_dwordx4 v2, s[8:11], s26 offen sc1 lds
s_add_u32 m0, m0, 4096
s_add_u32 s26, s26, 4096
buffer_load_dwordx4 v2, s[8:11], s26 offen sc1 lds
s_add_u32 m0, m0, 4096
s_add_u32 s26, s26, 4096
buffer_load_dwordx4 v2, s[8:11], s26 offen sc1 lds
s_add_u32 m0, m0, 4096
s_add_u32 s26, s26, 4096
buffer_load_dwordx4 v2, s[8:11], s26 offen sc1 lds
s_add_u32 m0, m0, 4096
s_add_u32 s26, s26, 4096
buffer_load_dwordx4 v2, s[8:11], s26 offen sc1 lds
s_add_u32 m0, m0, 4096
s_add_u32 s26, s26, 4096
buffer_load_dwordx4 v2, s[8:11], s26 offen sc1 lds
s_add_u32 m0, m0, 4096
s_add_u32 s26, s26, 4096
buffer_load_dwordx4 v2, s[8:11], s26 offen sc1 lds
s_add_u32 m0, m0, 4096
s_add_u32 s26, s26, 4096
F1_ND_318:
buffer_load_dwordx4 v[20:23], v6, s[8:11], s27 offen sc1
buffer_load_dwordx4 v[24:27], v6, s[8:11], s27 offen offset:1024 sc1
v_add_u32 v11, s25, v2
s_xor_b32 s25, s25, 28672
s_add_u32 s37, s25, s36
s_add_u32 s27, s27, 2048
s_add_u32 s29, s29, 512
s_waitcnt vmcnt(8)
s_barrier
ds_read_b128 v[176:179], v11 offset:0
ds_read_b128 v[180:183], v11 offset:1024
ds_read_b128 v[184:187], v11 offset:2048
s_waitcnt lgkmcnt(2)
v_mfma_f32_32x32x16_bf16 v[48:63], a[0:3], v[176:179], 0
ds_read_b128 v[188:191], v11 offset:3072
v_mfma_f32_32x32x16_bf16 v[64:79], a[112:115], v[176:179], 0
s_waitcnt vmcnt(7)
s_barrier
ds_read_b128 v[192:195], v11 offset:4096
s_waitcnt lgkmcnt(3)
v_mfma_f32_32x32x16_bf16 v[48:63], a[4:7], v[180:183], v[48:63]
ds_read_b128 v[196:199], v11 offset:5120
v_mfma_f32_32x32x16_bf16 v[64:79], a[116:119], v[180:183], v[64:79]
ds_read_b128 v[200:203], v11 offset:6144
s_waitcnt lgkmcnt(4)
v_mfma_f32_32x32x16_bf16 v[48:63], a[8:11], v[184:187], v[48:63]
ds_read_b128 v[204:207], v11 offset:7168
v_mfma_f32_32x32x16_bf16 v[64:79], a[120:123], v[184:187], v[64:79]
s_waitcnt vmcnt(5)
s_barrier
ds_read_b128 v[176:179], v11 offset:8192
s_waitcnt lgkmcnt(5)
v_mfma_f32_32x32x16_bf16 v[48:63], a[12:15], v[188:191], v[48:63]
ds_read_b128 v[180:183], v11 offset:9216
v_mfma_f32_32x32x16_bf16 v[64:79], a[124:127], v[188:191], v[64:79]
ds_read_b128 v[184:187], v11 offset:10240
s_waitcnt lgkmcnt(6)
v_mfma_f32_32x32x16_bf16 v[48:63], a[16:19], v[192:195], v[48:63]
ds_read_b128 v[188:191], v11 offset:11264
s_waitcnt lgkmcnt(6)
v_mfma_f32_32x32x16_bf16 v[48:63], a[20:23], v[196:199], v[48:63]
ds_read_b128 v[192:195], v11 offset:12288
s_waitcnt lgkmcnt(6)
v_mfma_f32_32x32x16_bf16 v[48:63], a[24:27], v[200:203], v[48:63]
ds_read_b128 v[196:199], v11 offset:13312
s_waitcnt lgkmcnt(6)
v_mfma_f32_32x32x16_bf16 v[48:63], a[28:31], v[204:207], v[48:63]
ds_read_b128 v[200:203], v11 offset:14336
s_waitcnt lgkmcnt(6)
v_mfma_f32_32x32x16_bf16 v[48:63], a[32:35], v[176:179], v[48:63]
ds_read_b128 v[204:207], v11 offset:15360
s_waitcnt lgkmcnt(6)
v_mfma_f32_32x32x16_bf16 v[48:63], a[36:39], v[180:183], v[48:63]
s_waitcnt vmcnt(2)
s_barrier
ds_read_b128 v[176:179], v11 offset:16384
s_waitcnt lgkmcnt(6)
v_mfma_f32_32x32x16_bf16 v[48:63], a[40:43], v[184:187], v[48:63]
ds_read_b128 v[180:183], v11 offset:17408
s_waitcnt vmcnt(0)
s_cmp_eq_u32 s42, 1
s_cbranch_scc0 OPT_322
s_mov_b64 exec, 1
buffer_store_dword v5, v4, s[8:11], s43 offen
s_mov_b64 exec, -1
OPT_322:
s_waitcnt lgkmcnt(6)
v_mfma_f32_32x32x16_bf16 v[48:63], a[44:47], v[188:191], v[48:63]
ds_read_b128 v[184:187], v11 offset:18432
s_add_u32 s17, s15, s14
s_bitcmp0_b32 s17, 0
s_cselect_b64 exec, -1, s[46:47]
buffer_load_dword v16, v14, s[8:11], 0 offen sc1
s_mov_b64 exec, -1
v_add_u32 v14, v14, v15
s_waitcnt lgkmcnt(6)
v_mfma_f32_32x32x16_bf16 v[48:63], a[48:51], v[192:195], v[48:63]
ds_read_b128 v[188:191], v11 offset:19456
v_add_f32 v20, v20, v22
v_add_f32 v21, v21, v23
v_add_f32 v24, v24, v26
v_add_f32 v25, v25, v27
s_waitcnt lgkmcnt(6)
v_mfma_f32_32x32x16_bf16 v[48:63], a[52:55], v[196:199], v[48:63]
ds_read_b128 v[192:195], v11 offset:20480
v_add_f32 v20, v20, v24
v_add_f32 v21, v21, v25
v_mov_b32 v18, v20
v_mov_b32 v19, v21
s_waitcnt lgkmcnt(6)
v_mfma_f32_32x32x16_bf16 v[48:63], a[56:59], v[200:203], v[48:63]
ds_read_b128 v[196:199], v11 offset:21504
v_permlane32_swap_b32 v18, v20
v_permlane32_swap_b32 v19, v21
v_add_f32 v20, v20, v18
v_add_f32 v21, v21, v19
s_waitcnt lgkmcnt(6)
v_mfma_f32_32x32x16_bf16 v[48:63], a[60:63], v[204:207], v[48:63]
ds_read_b128 v[200:203], v11 offset:22528
v_mul_f32 v18, 0x3b124925, v20
v_mul_f32 v19, 0x3b124925, v21
v_fma_f32 v19, -v18, v18, v19
v_max_f32 v19, 0, v19
s_waitcnt lgkmcnt(6)
v_mfma_f32_32x32x16_bf16 v[48:63], a[64:67], v[176:179], v[48:63]
ds_read_b128 v[204:207], v11 offset:23552
v_add_f32 v19, 0x3727c5ac, v19
v_rsq_f32 v20, v19
v_mov_b32 v21, v18
s_waitcnt lgkmcnt(6)
v_mfma_f32_32x32x16_bf16 v[48:63], a[68:71], v[180:183], v[48:63]
ds_read_b128 v[176:179], v11 offset:24576
v_sub_f32 v22, 0, v21
v_mul_f32 v24, 0xbfb8aa3b, v20
v_mov_b32 v26, v19
s_waitcnt lgkmcnt(6)
v_mfma_f32_32x32x16_bf16 v[48:63], a[72:75], v[184:187], v[48:63]
ds_read_b128 v[180:183], v11 offset:25600
s_waitcnt lgkmcnt(6)
v_mfma_f32_32x32x16_bf16 v[48:63], a[76:79], v[188:191], v[48:63]
ds_read_b128 v[184:187], v11 offset:26624
s_waitcnt lgkmcnt(6)
v_mfma_f32_32x32x16_bf16 v[48:63], a[80:83], v[192:195], v[48:63]
ds_read_b128 v[188:191], v11 offset:27648
s_waitcnt lgkmcnt(6)
v_mfma_f32_32x32x16_bf16 v[48:63], a[84:87], v[196:199], v[48:63]
ds_read_b128 v[192:195], v11 offset:4096
s_waitcnt lgkmcnt(6)
v_mfma_f32_32x32x16_bf16 v[48:63], a[88:91], v[200:203], v[48:63]
ds_read_b128 v[196:199], v11 offset:5120
s_waitcnt lgkmcnt(6)
v_mfma_f32_32x32x16_bf16 v[48:63], a[92:95], v[204:207], v[48:63]
ds_read_b128 v[200:203], v11 offset:6144
s_waitcnt lgkmcnt(6)
v_mfma_f32_32x32x16_bf16 v[48:63], a[96:99], v[176:179], v[48:63]
ds_read_b128 v[204:207], v11 offset:7168
s_waitcnt lgkmcnt(6)
v_mfma_f32_32x32x16_bf16 v[48:63], a[100:103], v[180:183], v[48:63]
ds_read_b128 v[176:179], v11 offset:8192
s_waitcnt lgkmcnt(6)
v_mfma_f32_32x32x16_bf16 v[48:63], a[104:107], v[184:187], v[48:63]
ds_read_b128 v[180:183], v11 offset:9216
s_waitcnt lgkmcnt(6)
v_mfma_f32_32x32x16_bf16 v[48:63], a[108:111], v[188:191], v[48:63]
ds_read_b128 v[184:187], v11 offset:10240
s_waitcnt lgkmcnt(6)
v_mfma_f32_32x32x16_bf16 v[64:79], a[128:131], v[192:195], v[64:79]
ds_read_b128 v[188:191], v11 offset:11264
s_waitcnt lgkmcnt(6)
v_mfma_f32_32x32x16_bf16 v[64:79], a[132:135], v[196:199], v[64:79]
ds_read_b128 v[192:195], v11 offset:12288
s_waitcnt lgkmcnt(6)
v_mfma_f32_32x32x16_bf16 v[64:79], a[136:139], v[200:203], v[64:79]
ds_read_b128 v[196:199], v11 offset:13312
s_nop 1
v_fma_f32 v48, v80, v22, v48
v_fma_f32 v49, v81, v22, v49
s_waitcnt lgkmcnt(6)
v_mfma_f32_32x32x16_bf16 v[64:79], a[140:143], v[204:207], v[64:79]
ds_read_b128 v[200:203], v11 offset:14336
v_fma_f32 v50, v82, v22, v50
v_fma_f32 v51, v83, v22, v51
v_fma_f32 v52, v84, v22, v52
v_fma_f32 v53, v85, v22, v53
s_waitcnt lgkmcnt(6)
v_mfma_f32_32x32x16_bf16 v[64:79], a[144:147], v[176:179], v[64:79]
buffer_load_dword v12, v7, s[8:11], s29 offen sc1
ds_read_b128 v[204:207], v11 offset:15360
v_fma_f32 v54, v86, v22, v54
v_fma_f32 v55, v87, v22, v55
v_fma_f32 v56, v88, v22, v56
s_waitcnt lgkmcnt(6)
v_mfma_f32_32x32x16_bf16 v[64:79], a[148:151], v[180:183], v[64:79]
ds_read_b128 v[176:179], v11 offset:16384
v_fma_f32 v57, v89, v22, v57
v_fma_f32 v58, v90, v22, v58
v_fma_f32 v59, v91, v22, v59
v_fma_f32 v60, v92, v22, v60
s_waitcnt lgkmcnt(6)
v_mfma_f32_32x32x16_bf16 v[64:79], a[152:155], v[184:187], v[64:79]
ds_read_b128 v[180:183], v11 offset:17408
v_fma_f32 v61, v93, v22, v61
v_fma_f32 v62, v94, v22, v62
v_fma_f32 v63, v95, v22, v63
v_mul_f32 v112, v48, v24
s_waitcnt lgkmcnt(6)
v_mfma_f32_32x32x16_bf16 v[64:79], a[156:159], v[188:191], v[64:79]
ds_read_b128 v[184:187], v11 offset:18432
v_mul_f32 v113, v49, v24
v_mul_f32 v114, v50, v24
v_mul_f32 v115, v51, v24
v_mul_f32 v116, v52, v24
s_waitcnt lgkmcnt(6)
v_mfma_f32_32x32x16_bf16 v[64:79], a[160:163], v[192:195], v[64:79]
ds_read_b128 v[188:191], v11 offset:19456
v_mul_f32 v117, v53, v24
v_mul_f32 v118, v54, v24
v_mul_f32 v119, v55, v24
s_waitcnt lgkmcnt(6)
v_mfma_f32_32x32x16_bf16 v[64:79], a[164:167], v[196:199], v[64:79]
ds_read_b128 v[192:195], v11 offset:20480
v_exp_f32 v112, v112
v_exp_f32 v113, v113
s_waitcnt lgkmcnt(6)
v_mfma_f32_32x32x16_bf16 v[64:79], a[168:171], v[200:203], v[64:79]
ds_read_b128 v[196:199], v11 offset:21504
v_exp_f32 v114, v114
v_exp_f32 v115, v115
s_waitcnt lgkmcnt(6)
v_mfma_f32_32x32x16_bf16 v[64:79], a[172:175], v[204:207], v[64:79]
ds_read_b128 v[200:203], v11 offset:22528
v_exp_f32 v116, v116
v_exp_f32 v117, v117
s_waitcnt lgkmcnt(6)
v_mfma_f32_32x32x16_bf16 v[64:79], a[176:179], v[176:179], v[64:79]
ds_read_b128 v[204:207], v11 offset:23552
v_exp_f32 v118, v118
v_exp_f32 v119, v119
s_waitcnt lgkmcnt(6)
v_mfma_f32_32x32x16_bf16 v[64:79], a[180:183], v[180:183], v[64:79]
ds_read_b128 v[176:179], v11 offset:24576
v_mul_f32 v48, v48, v56
v_mul_f32 v49, v49, v57
v_mul_f32 v50, v50, v58
v_mul_f32 v51, v51, v59
s_waitcnt lgkmcnt(6)
v_mfma_f32_32x32x16_bf16 v[64:79], a[184:187], v[184:187], v[64:79]
s_waitcnt vmcnt(0)
v_cmp_eq_u32 vcc, 0, v12
s_nop 0
s_cmp_eq_u64 vcc, 0
s_cselect_b64 vcc, -1, 0
ds_read_b128 v[180:183], v11 offset:25600
s_waitcnt lgkmcnt(6)
v_mfma_f32_32x32x16_bf16 v[64:79], a[188:191], v[188:191], v[64:79]
s_cbranch_vccz OPT_323
s_mov_b32 m0, s37
s_nop 0
buffer_load_dwordx4 v2, s[8:11], s26 offen sc1 lds
s_add_u32 m0, m0, 4096
s_add_u32 s26, s26, 4096
OPT_323:
ds_read_b128 v[184:187], v11 offset:26624
s_waitcnt lgkmcnt(6)
v_mfma_f32_32x32x16_bf16 v[64:79], a[192:195], v[192:195], v[64:79]
ds_read_b128 v[188:191], v11 offset:27648
v_mul_f32 v52, v52, v60
v_mul_f32 v53, v53, v61
v_mul_f32 v54, v54, v62
v_mul_f32 v55, v55, v63
s_waitcnt lgkmcnt(6)
v_mfma_f32_32x32x16_bf16 v[64:79], a[196:199], v[196:199], v[64:79]
s_cbranch_vccz OPT_324
buffer_load_dwordx4 v2, s[8:11], s26 offen sc1 lds
s_add_u32 m0, m0, 4096
s_add_u32 s26, s26, 4096
OPT_324:
v_fma_f32 v112, v112, v26, v26
s_waitcnt lgkmcnt(5)
v_mfma_f32_32x32x16_bf16 v[64:79], a[200:203], v[200:203], v[64:79]
v_fma_f32 v113, v113, v26, v26
v_fma_f32 v114, v114, v26, v26
v_fma_f32 v115, v115, v26, v26
v_fma_f32 v116, v116, v26, v26
v_fma_f32 v117, v117, v26, v26
s_waitcnt lgkmcnt(4)
v_mfma_f32_32x32x16_bf16 v[64:79], a[204:207], v[204:207], v[64:79]
s_cbranch_vccz OPT_325
buffer_load_dwordx4 v2, s[8:11], s26 offen sc1 lds
s_add_u32 m0, m0, 4096
s_add_u32 s26, s26, 4096
OPT_325:
v_fma_f32 v118, v118, v26, v26
s_waitcnt lgkmcnt(3)
v_mfma_f32_32x32x16_bf16 v[64:79], a[208:211], v[176:179], v[64:79]
v_fma_f32 v119, v119, v26, v26
v_rcp_f32 v112, v112
v_rcp_f32 v113, v113
s_waitcnt lgkmcnt(2)
v_mfma_f32_32x32x16_bf16 v[64:79], a[212:215], v[180:183], v[64:79]
s_cbranch_vccz OPT_326
buffer_load_dwordx4 v2, s[8:11], s26 offen sc1 lds
s_add_u32 m0, m0, 4096
s_add_u32 s26, s26, 4096
OPT_326:
s_waitcnt lgkmcnt(1)
v_mfma_f32_32x32x16_bf16 v[64:79], a[216:219], v[184:187], v[64:79]
v_rcp_f32 v114, v114
v_rcp_f32 v115, v115
s_waitcnt lgkmcnt(0)
v_mfma_f32_32x32x16_bf16 v[64:79], a[220:223], v[188:191], v[64:79]
s_cbranch_vccz OPT_327
buffer_load_dwordx4 v2, s[8:11], s26 offen sc1 lds
s_add_u32 m0, m0, 4096
s_add_u32 s26, s26, 4096
OPT_327:
v_rcp_f32 v116, v116
v_rcp_f32 v117, v117
v_rcp_f32 v118, v118
v_rcp_f32 v119, v119
v_mul_f32 v48, v48, v112
v_mul_f32 v49, v49, v113
v_mul_f32 v50, v50, v114
v_mul_f32 v51, v51, v115
v_mul_f32 v52, v52, v116
v_mul_f32 v53, v53, v117
v_mul_f32 v54, v54, v118
v_mul_f32 v55, v55, v119
v_cvt_pk_bf16_f32 v120, v48, v49
v_cvt_pk_bf16_f32 v121, v50, v51
v_cvt_pk_bf16_f32 v122, v52, v53
v_cvt_pk_bf16_f32 v123, v54, v55
buffer_store_dwordx4 v[120:123], v2, s[8:11], s28 offen offset:0
v_pk_fma_f32 v[64:65], v[96:97], v[22:23], v[64:65] op_sel_hi:[1,0,1]
v_pk_fma_f32 v[66:67], v[98:99], v[22:23], v[66:67] op_sel_hi:[1,0,1]
v_pk_fma_f32 v[68:69], v[100:101], v[22:23], v[68:69] op_sel_hi:[1,0,1]
v_pk_fma_f32 v[70:71], v[102:103], v[22:23], v[70:71] op_sel_hi:[1,0,1]
v_pk_fma_f32 v[72:73], v[104:105], v[22:23], v[72:73] op_sel_hi:[1,0,1]
v_pk_fma_f32 v[74:75], v[106:107], v[22:23], v[74:75] op_sel_hi:[1,0,1]
v_pk_fma_f32 v[76:77], v[108:109], v[22:23], v[76:77] op_sel_hi:[1,0,1]
v_pk_fma_f32 v[78:79], v[110:111], v[22:23], v[78:79] op_sel_hi:[1,0,1]
v_pk_mul_f32 v[112:113], v[64:65], v[24:25] op_sel_hi:[1,0]
v_pk_mul_f32 v[114:115], v[66:67], v[24:25] op_sel_hi:[1,0]
v_pk_mul_f32 v[116:117], v[68:69], v[24:25] op_sel_hi:[1,0]
v_pk_mul_f32 v[118:119], v[70:71], v[24:25] op_sel_hi:[1,0]
s_cbranch_vccz OPT_328
buffer_load_dwordx4 v2, s[8:11], s26 offen sc1 lds
s_add_u32 m0, m0, 4096
s_add_u32 s26, s26, 4096
OPT_328:
v_exp_f32 v112, v112
v_exp_f32 v113, v113
v_exp_f32 v114, v114
v_exp_f32 v115, v115
v_exp_f32 v116, v116
v_exp_f32 v117, v117
v_exp_f32 v118, v118
v_exp_f32 v119, v119
v_pk_mul_f32 v[64:65], v[64:65], v[72:73]
v_pk_mul_f32 v[66:67], v[66:67], v[74:75]
v_pk_mul_f32 v[68:69], v[68:69], v[76:77]
v_pk_mul_f32 v[70:71], v[70:71], v[78:79]
s_cbranch_vccz OPT_329
buffer_load_dwordx4 v2, s[8:11], s26 offen sc1 lds
s_add_u32 m0, m0, 4096
s_add_u32 s26, s26, 4096
OPT_329:
v_pk_fma_f32 v[112:113], v[112:113], v[26:27], v[26:27] op_sel_hi:[1,0,0]
v_pk_fma_f32 v[114:115], v[114:115], v[26:27], v[26:27] op_sel_hi:[1,0,0]
v_pk_fma_f32 v[116:117], v[116:117], v[26:27], v[26:27] op_sel_hi:[1,0,0]
v_pk_fma_f32 v[118:119], v[118:119], v[26:27], v[26:27] op_sel_hi:[1,0,0]
v_rcp_f32 v112, v112
v_rcp_f32 v113, v113
v_rcp_f32 v114, v114
v_rcp_f32 v115, v115
v_rcp_f32 v116, v116
v_rcp_f32 v117, v117
v_rcp_f32 v118, v118
v_rcp_f32 v119, v119
v_pk_mul_f32 v[64:65], v[64:65], v[112:113]
v_pk_mul_f32 v[66:67], v[66:67], v[114:115]
v_pk_mul_f32 v[68:69], v[68:69], v[116:117]
v_pk_mul_f32 v[70:71], v[70:71], v[118:119]
v_cvt_pk_bf16_f32 v124, v64, v65
v_cvt_pk_bf16_f32 v125, v66, v67
v_cvt_pk_bf16_f32 v126, v68, v69
v_cvt_pk_bf16_f32 v127, v70, v71
buffer_load_dword v12, v7, s[8:11], s29 offen sc1
buffer_store_dwordx4 v[124:127], v2, s[8:11], s28 offen offset:1024
s_mov_b32 s43, s30
s_cmp_eq_u32 s15, 63
s_cselect_b64 vcc, 0, vcc
s_mov_b32 s42, 1
s_cbranch_vccnz OPT_330
s_mov_b32 s42, 0
s_waitcnt vmcnt(0)
s_mov_b64 exec, 1
buffer_store_dword v5, v4, s[8:11], s30 offen
s_mov_b64 exec, -1
OPT_330:
s_add_u32 s28, s28, 114688
s_add_u32 s30, s30, 512
s_add_u32 s15, s15, 1
s_cmp_lt_u32 s15, 64
s_cbranch_scc1 F1_LOOP_317
s_endpgm
MS_316_ab:
s_mov_b32 s16, 0
s_waitcnt vmcnt(0)
MS_316_slow:
F1_LOOP_331:
s_add_u32 s37, s25, s36
s_cbranch_vccnz F1_ND_332
v_cmp_eq_u32 vcc, 0, v12
s_cbranch_vccz OPT_333
s_nop 2
s_branch WF_334_in
WF_334:
s_sleep 1
WF_334_in:
buffer_load_dword v18, v7, s[8:11], s29 offen sc1
s_sub_u32 s16, s16, 1
s_cbranch_scc1 WFD_335_abort
s_waitcnt vmcnt(0)
v_cmp_eq_u32 vcc, 0, v18
s_cbranch_vccnz WF_334
WFD_335:
OPT_333:
s_mov_b32 m0, s37
s_nop 0
buffer_load_dwordx4 v2, s[8:11], s26 offen sc1 lds
s_add_u32 m0, m0, 4096
s_add_u32 s26, s26, 4096
buffer_load_dwordx4 v2, s[8:11], s26 offen sc1 lds
s_add_u32 m0, m0, 4096
s_add_u32 s26, s26, 4096
buffer_load_dwordx4 v2, s[8:11], s26 offen sc1 lds
s_add_u32 m0, m0, 4096
s_add_u32 s26, s26, 4096
buffer_load_dwordx4 v2, s[8:11], s26 offen sc1 lds
s_add_u32 m0, m0, 4096
s_add_u32 s26, s26, 4096
buffer_load_dwordx4 v2, s[8:11], s26 offen sc1 lds
s_add_u32 m0, m0, 4096
s_add_u32 s26, s26, 4096
buffer_load_dwordx4 v2, s[8:11], s26 offen sc1 lds
s_add_u32 m0, m0, 4096
s_add_u32 s26, s26, 4096
buffer_load_dwordx4 v2, s[8:11], s26 offen sc1 lds
s_add_u32 m0, m0, 4096
s_add_u32 s26, s26, 4096
F1_ND_332:
buffer_load_dwordx4 v[20:23], v6, s[8:11], s27 offen sc1
buffer_load_dwordx4 v[24:27], v6, s[8:11], s27 offen offset:1024 sc1
v_add_u32 v11, s25, v2
s_xor_b32 s25, s25, 28672
s_add_u32 s37, s25, s36
s_add_u32 s27, s27, 2048
s_add_u32 s29, s29, 512
s_waitcnt vmcnt(8)
s_barrier
ds_read_b128 v[176:179], v11 offset:0
ds_read_b128 v[180:183], v11 offset:1024
ds_read_b128 v[184:187], v11 offset:2048
s_waitcnt lgkmcnt(2)
v_mfma_f32_32x32x16_bf16 v[48:63], a[0:3], v[176:179], 0
ds_read_b128 v[188:191], v11 offset:3072
v_mfma_f32_32x32x16_bf16 v[64:79], a[112:115], v[176:179], 0
s_waitcnt vmcnt(7)
s_barrier
ds_read_b128 v[192:195], v11 offset:4096
s_waitcnt lgkmcnt(3)
v_mfma_f32_32x32x16_bf16 v[48:63], a[4:7], v[180:183], v[48:63]
ds_read_b128 v[196:199], v11 offset:5120
v_mfma_f32_32x32x16_bf16 v[64:79], a[116:119], v[180:183], v[64:79]
ds_read_b128 v[200:203], v11 offset:6144
s_waitcnt lgkmcnt(4)
v_mfma_f32_32x32x16_bf16 v[48:63], a[8:11], v[184:187], v[48:63]
ds_read_b128 v[204:207], v11 offset:7168
v_mfma_f32_32x32x16_bf16 v[64:79], a[120:123], v[184:187], v[64:79]
s_waitcnt vmcnt(5)
s_barrier
ds_read_b128 v[176:179], v11 offset:8192
s_waitcnt lgkmcnt(5)
v_mfma_f32_32x32x16_bf16 v[48:63], a[12:15], v[188:191], v[48:63]
ds_read_b128 v[180:183], v11 offset:9216
v_mfma_f32_32x32x16_bf16 v[64:79], a[124:127], v[188:191], v[64:79]
ds_read_b128 v[184:187], v11 offset:10240
s_waitcnt lgkmcnt(6)
v_mfma_f32_32x32x16_bf16 v[48:63], a[16:19], v[192:195], v[48:63]
ds_read_b128 v[188:191], v11 offset:11264
s_waitcnt lgkmcnt(6)
v_mfma_f32_32x32x16_bf16 v[48:63], a[20:23], v[196:199], v[48:63]
ds_read_b128 v[192:195], v11 offset:12288
s_waitcnt lgkmcnt(6)
v_mfma_f32_32x32x16_bf16 v[48:63], a[24:27], v[200:203], v[48:63]
ds_read_b128 v[196:199], v11 offset:13312
s_waitcnt lgkmcnt(6)
v_mfma_f32_32x32x16_bf16 v[48:63], a[28:31], v[204:207], v[48:63]
ds_read_b128 v[200:203], v11 offset:14336
s_waitcnt lgkmcnt(6)
v_mfma_f32_32x32x16_bf16 v[48:63], a[32:35], v[176:179], v[48:63]
ds_read_b128 v[204:207], v11 offset:15360
s_waitcnt lgkmcnt(6)
v_mfma_f32_32x32x16_bf16 v[48:63], a[36:39], v[180:183], v[48:63]
s_waitcnt vmcnt(2)
s_barrier
ds_read_b128 v[176:179], v11 offset:16384
s_waitcnt lgkmcnt(6)
v_mfma_f32_32x32x16_bf16 v[48:63], a[40:43], v[184:187], v[48:63]
ds_read_b128 v[180:183], v11 offset:17408
s_waitcnt vmcnt(0)
s_cmp_eq_u32 s42, 1
s_cbranch_scc0 OPT_336
s_mov_b64 exec, 1
buffer_store_dword v5, v4, s[8:11], s43 offen sc1
s_mov_b64 exec, -1
OPT_336:
s_waitcnt lgkmcnt(6)
v_mfma_f32_32x32x16_bf16 v[48:63], a[44:47], v[188:191], v[48:63]
ds_read_b128 v[184:187], v11 offset:18432
s_waitcnt lgkmcnt(6)
v_mfma_f32_32x32x16_bf16 v[48:63], a[48:51], v[192:195], v[48:63]
ds_read_b128 v[188:191], v11 offset:19456
v_add_f32 v20, v20, v22
v_add_f32 v21, v21, v23
v_add_f32 v24, v24, v26
v_add_f32 v25, v25, v27
s_waitcnt lgkmcnt(6)
v_mfma_f32_32x32x16_bf16 v[48:63], a[52:55], v[196:199], v[48:63]
ds_read_b128 v[192:195], v11 offset:20480
v_add_f32 v20, v20, v24
v_add_f32 v21, v21, v25
v_mov_b32 v18, v20
v_mov_b32 v19, v21
s_waitcnt lgkmcnt(6)
v_mfma_f32_32x32x16_bf16 v[48:63], a[56:59], v[200:203], v[48:63]
ds_read_b128 v[196:199], v11 offset:21504
v_permlane32_swap_b32 v18, v20
v_permlane32_swap_b32 v19, v21
v_add_f32 v20, v20, v18
v_add_f32 v21, v21, v19
s_waitcnt lgkmcnt(6)
v_mfma_f32_32x32x16_bf16 v[48:63], a[60:63], v[204:207], v[48:63]
ds_read_b128 v[200:203], v11 offset:22528
v_mul_f32 v18, 0x3b124925, v20
v_mul_f32 v19, 0x3b124925, v21
v_fma_f32 v19, -v18, v18, v19
v_max_f32 v19, 0, v19
s_waitcnt lgkmcnt(6)
v_mfma_f32_32x32x16_bf16 v[48:63], a[64:67], v[176:179], v[48:63]
ds_read_b128 v[204:207], v11 offset:23552
v_add_f32 v19, 0x3727c5ac, v19
v_rsq_f32 v20, v19
v_mov_b32 v21, v18
s_waitcnt lgkmcnt(6)
v_mfma_f32_32x32x16_bf16 v[48:63], a[68:71], v[180:183], v[48:63]
ds_read_b128 v[176:179], v11 offset:24576
v_sub_f32 v22, 0, v21
v_mul_f32 v24, 0xbfb8aa3b, v20
v_mov_b32 v26, v19
s_waitcnt lgkmcnt(6)
v_mfma_f32_32x32x16_bf16 v[48:63], a[72:75], v[184:187], v[48:63]
ds_read_b128 v[180:183], v11 offset:25600
s_waitcnt lgkmcnt(6)
v_mfma_f32_32x32x16_bf16 v[48:63], a[76:79], v[188:191], v[48:63]
ds_read_b128 v[184:187], v11 offset:26624
s_waitcnt lgkmcnt(6)
v_mfma_f32_32x32x16_bf16 v[48:63], a[80:83], v[192:195], v[48:63]
ds_read_b128 v[188:191], v11 offset:27648
s_waitcnt lgkmcnt(6)
v_mfma_f32_32x32x16_bf16 v[48:63], a[84:87], v[196:199], v[48:63]
ds_read_b128 v[192:195], v11 offset:4096
s_waitcnt lgkmcnt(6)
v_mfma_f32_32x32x16_bf16 v[48:63], a[88:91], v[200:203], v[48:63]
ds_read_b128 v[196:199], v11 offset:5120
s_waitcnt lgkmcnt(6)
v_mfma_f32_32x32x16_bf16 v[48:63], a[92:95], v[204:207], v[48:63]
ds_read_b128 v[200:203], v11 offset:6144
s_waitcnt lgkmcnt(6)
v_mfma_f32_32x32x16_bf16 v[48:63], a[96:99], v[176:179], v[48:63]
ds_read_b128 v[204:207], v11 offset:7168
s_waitcnt lgkmcnt(6)
v_mfma_f32_32x32x16_bf16 v[48:63], a[100:103], v[180:183], v[48:63]
ds_read_b128 v[176:179], v11 offset:8192
s_waitcnt lgkmcnt(6)
v_mfma_f32_32x32x16_bf16 v[48:63], a[104:107], v[184:187], v[48:63]
ds_read_b128 v[180:183], v11 offset:9216
s_waitcnt lgkmcnt(6)
v_mfma_f32_32x32x16_bf16 v[48:63], a[108:111], v[188:191], v[48:63]
ds_read_b128 v[184:187], v11 offset:10240
s_waitcnt lgkmcnt(6)
v_mfma_f32_32x32x16_bf16 v[64:79], a[128:131], v[192:195], v[64:79]
ds_read_b128 v[188:191], v11 offset:11264
s_waitcnt lgkmcnt(6)
v_mfma_f32_32x32x16_bf16 v[64:79], a[132:135], v[196:199], v[64:79]
ds_read_b128 v[192:195], v11 offset:12288
s_waitcnt lgkmcnt(6)
v_mfma_f32_32x32x16_bf16 v[64:79], a[136:139], v[200:203], v[64:79]
ds_read_b128 v[196:199], v11 offset:13312
s_nop 1
v_fma_f32 v48, v80, v22, v48
v_fma_f32 v49, v81, v22, v49
s_waitcnt lgkmcnt(6)
v_mfma_f32_32x32x16_bf16 v[64:79], a[140:143], v[204:207], v[64:79]
ds_read_b128 v[200:203], v11 offset:14336
v_fma_f32 v50, v82, v22, v50
v_fma_f32 v51, v83, v22, v51
v_fma_f32 v52, v84, v22, v52
v_fma_f32 v53, v85, v22, v53
s_waitcnt lgkmcnt(6)
v_mfma_f32_32x32x16_bf16 v[64:79], a[144:147], v[176:179], v[64:79]
buffer_load_dword v12, v7, s[8:11], s29 offen sc1
ds_read_b128 v[204:207], v11 offset:15360
v_fma_f32 v54, v86, v22, v54
v_fma_f32 v55, v87, v22, v55
v_fma_f32 v56, v88, v22, v56
s_waitcnt lgkmcnt(6)
v_mfma_f32_32x32x16_bf16 v[64:79], a[148:151], v[180:183], v[64:79]
ds_read_b128 v[176:179], v11 offset:16384
v_fma_f32 v57, v89, v22, v57
v_fma_f32 v58, v90, v22, v58
v_fma_f32 v59, v91, v22, v59
v_fma_f32 v60, v92, v22, v60
s_waitcnt lgkmcnt(6)
v_mfma_f32_32x32x16_bf16 v[64:79], a[152:155], v[184:187], v[64:79]
ds_read_b128 v[180:183], v11 offset:17408
v_fma_f32 v61, v93, v22, v61
v_fma_f32 v62, v94, v22, v62
v_fma_f32 v63, v95, v22, v63
v_mul_f32 v112, v48, v24
s_waitcnt lgkmcnt(6)
v_mfma_f32_32x32x16_bf16 v[64:79], a[156:159], v[188:191], v[64:79]
ds_read_b128 v[184:187], v11 offset:18432
v_mul_f32 v113, v49, v24
v_mul_f32 v114, v50, v24
v_mul_f32 v115, v51, v24
v_mul_f32 v116, v52, v24
s_waitcnt lgkmcnt(6)
v_mfma_f32_32x32x16_bf16 v[64:79], a[160:163], v[192:195], v[64:79]
ds_read_b128 v[188:191], v11 offset:19456
v_mul_f32 v117, v53, v24
v_mul_f32 v118, v54, v24
v_mul_f32 v119, v55, v24
s_waitcnt lgkmcnt(6)
v_mfma_f32_32x32x16_bf16 v[64:79], a[164:167], v[196:199], v[64:79]
ds_read_b128 v[192:195], v11 offset:20480
v_exp_f32 v112, v112
v_exp_f32 v113, v113
s_waitcnt lgkmcnt(6)
v_mfma_f32_32x32x16_bf16 v[64:79], a[168:171], v[200:203], v[64:79]
ds_read_b128 v[196:199], v11 offset:21504
v_exp_f32 v114, v114
v_exp_f32 v115, v115
s_waitcnt lgkmcnt(6)
v_mfma_f32_32x32x16_bf16 v[64:79], a[172:175], v[204:207], v[64:79]
ds_read_b128 v[200:203], v11 offset:22528
v_exp_f32 v116, v116
v_exp_f32 v117, v117
s_waitcnt lgkmcnt(6)
v_mfma_f32_32x32x16_bf16 v[64:79], a[176:179], v[176:179], v[64:79]
ds_read_b128 v[204:207], v11 offset:23552
v_exp_f32 v118, v118
v_exp_f32 v119, v119
s_waitcnt lgkmcnt(6)
v_mfma_f32_32x32x16_bf16 v[64:79], a[180:183], v[180:183], v[64:79]
ds_read_b128 v[176:179], v11 offset:24576
v_mul_f32 v48, v48, v56
v_mul_f32 v49, v49, v57
v_mul_f32 v50, v50, v58
v_mul_f32 v51, v51, v59
s_waitcnt lgkmcnt(6)
v_mfma_f32_32x32x16_bf16 v[64:79], a[184:187], v[184:187], v[64:79]
s_waitcnt vmcnt(0)
v_cmp_eq_u32 vcc, 0, v12
s_nop 0
s_cmp_eq_u64 vcc, 0
s_cselect_b64 vcc, -1, 0
ds_read_b128 v[180:183], v11 offset:25600
s_waitcnt lgkmcnt(6)
v_mfma_f32_32x32x16_bf16 v[64:79], a[188:191], v[188:191], v[64:79]
s_cbranch_vccz OPT_337
s_mov_b32 m0, s37
s_nop 0
buffer_load_dwordx4 v2, s[8:11], s26 offen sc1 lds
s_add_u32 m0, m0, 4096
s_add_u32 s26, s26, 4096
OPT_337:
ds_read_b128 v[184:187], v11 offset:26624
s_waitcnt lgkmcnt(6)
v_mfma_f32_32x32x16_bf16 v[64:79], a[192:195], v[192:195], v[64:79]
ds_read_b128 v[188:191], v11 offset:27648
v_mul_f32 v52, v52, v60
v_mul_f32 v53, v53, v61
v_mul_f32 v54, v54, v62
v_mul_f32 v55, v55, v63
s_waitcnt lgkmcnt(6)
v_mfma_f32_32x32x16_bf16 v[64:79], a[196:199], v[196:199], v[64:79]
s_cbranch_vccz OPT_338
buffer_load_dwordx4 v2, s[8:11], s26 offen sc1 lds
s_add_u32 m0, m0, 4096
s_add_u32 s26, s26, 4096
OPT_338:
v_fma_f32 v112, v112, v26, v26
s_waitcnt lgkmcnt(5)
v_mfma_f32_32x32x16_bf16 v[64:79], a[200:203], v[200:203], v[64:79]
v_fma_f32 v113, v113, v26, v26
v_fma_f32 v114, v114, v26, v26
v_fma_f32 v115, v115, v26, v26
v_fma_f32 v116, v116, v26, v26
v_fma_f32 v117, v117, v26, v26
s_waitcnt lgkmcnt(4)
v_mfma_f32_32x32x16_bf16 v[64:79], a[204:207], v[204:207], v[64:79]
s_cbranch_vccz OPT_339
buffer_load_dwordx4 v2, s[8:11], s26 offen sc1 lds
s_add_u32 m0, m0, 4096
s_add_u32 s26, s26, 4096
OPT_339:
v_fma_f32 v118, v118, v26, v26
s_waitcnt lgkmcnt(3)
v_mfma_f32_32x32x16_bf16 v[64:79], a[208:211], v[176:179], v[64:79]
v_fma_f32 v119, v119, v26, v26
v_rcp_f32 v112, v112
v_rcp_f32 v113, v113
s_waitcnt lgkmcnt(2)
v_mfma_f32_32x32x16_bf16 v[64:79], a[212:215], v[180:183], v[64:79]
s_cbranch_vccz OPT_340
buffer_load_dwordx4 v2, s[8:11], s26 offen sc1 lds
s_add_u32 m0, m0, 4096
s_add_u32 s26, s26, 4096
OPT_340:
s_waitcnt lgkmcnt(1)
v_mfma_f32_32x32x16_bf16 v[64:79], a[216:219], v[184:187], v[64:79]
v_rcp_f32 v114, v114
v_rcp_f32 v115, v115
s_waitcnt lgkmcnt(0)
v_mfma_f32_32x32x16_bf16 v[64:79], a[220:223], v[188:191], v[64:79]
s_cbranch_vccz OPT_341
buffer_load_dwordx4 v2, s[8:11], s26 offen sc1 lds
s_add_u32 m0, m0, 4096
s_add_u32 s26, s26, 4096
OPT_341:
v_rcp_f32 v116, v116
v_rcp_f32 v117, v117
v_rcp_f32 v118, v118
v_rcp_f32 v119, v119
v_mul_f32 v48, v48, v112
v_mul_f32 v49, v49, v113
v_mul_f32 v50, v50, v114
v_mul_f32 v51, v51, v115
v_mul_f32 v52, v52, v116
v_mul_f32 v53, v53, v117
v_mul_f32 v54, v54, v118
v_mul_f32 v55, v55, v119
v_cvt_pk_bf16_f32 v120, v48, v49
v_cvt_pk_bf16_f32 v121, v50, v51
v_cvt_pk_bf16_f32 v122, v52, v53
v_cvt_pk_bf16_f32 v123, v54, v55
buffer_store_dwordx4 v[120:123], v2, s[8:11], s28 offen offset:0 sc1
v_pk_fma_f32 v[64:65], v[96:97], v[22:23], v[64:65] op_sel_hi:[1,0,1]
v_pk_fma_f32 v[66:67], v[98:99], v[22:23], v[66:67] op_sel_hi:[1,0,1]
v_pk_fma_f32 v[68:69], v[100:101], v[22:23], v[68:69] op_sel_hi:[1,0,1]
v_pk_fma_f32 v[70:71], v[102:103], v[22:23], v[70:71] op_sel_hi:[1,0,1]
v_pk_fma_f32 v[72:73], v[104:105], v[22:23], v[72:73] op_sel_hi:[1,0,1]
v_pk_fma_f32 v[74:75], v[106:107], v[22:23], v[74:75] op_sel_hi:[1,0,1]
v_pk_fma_f32 v[76:77], v[108:109], v[22:23], v[76:77] op_sel_hi:[1,0,1]
v_pk_fma_f32 v[78:79], v[110:111], v[22:23], v[78:79] op_sel_hi:[1,0,1]
v_pk_mul_f32 v[112:113], v[64:65], v[24:25] op_sel_hi:[1,0]
v_pk_mul_f32 v[114:115], v[66:67], v[24:25] op_sel_hi:[1,0]
v_pk_mul_f32 v[116:117], v[68:69], v[24:25] op_sel_hi:[1,0]
v_pk_mul_f32 v[118:119], v[70:71], v[24:25] op_sel_hi:[1,0]
s_cbranch_vccz OPT_342
buffer_load_dwordx4 v2, s[8:11], s26 offen sc1 lds
s_add_u32 m0, m0, 4096
s_add_u32 s26, s26, 4096
OPT_342:
v_exp_f32 v112, v112
v_exp_f32 v113, v113
v_exp_f32 v114, v114
v_exp_f32 v115, v115
v_exp_f32 v116, v116
v_exp_f32 v117, v117
v_exp_f32 v118, v118
v_exp_f32 v119, v119
v_pk_mul_f32 v[64:65], v[64:65], v[72:73]
v_pk_mul_f32 v[66:67], v[66:67], v[74:75]
v_pk_mul_f32 v[68:69], v[68:69], v[76:77]
v_pk_mul_f32 v[70:71], v[70:71], v[78:79]
s_cbranch_vccz OPT_343
buffer_load_dwordx4 v2, s[8:11], s26 offen sc1 lds
s_add_u32 m0, m0, 4096
s_add_u32 s26, s26, 4096
OPT_343:
v_pk_fma_f32 v[112:113], v[112:113], v[26:27], v[26:27] op_sel_hi:[1,0,0]
v_pk_fma_f32 v[114:115], v[114:115], v[26:27], v[26:27] op_sel_hi:[1,0,0]
v_pk_fma_f32 v[116:117], v[116:117], v[26:27], v[26:27] op_sel_hi:[1,0,0]
v_pk_fma_f32 v[118:119], v[118:119], v[26:27], v[26:27] op_sel_hi:[1,0,0]
v_rcp_f32 v112, v112
v_rcp_f32 v113, v113
v_rcp_f32 v114, v114
v_rcp_f32 v115, v115
v_rcp_f32 v116, v116
v_rcp_f32 v117, v117
v_rcp_f32 v118, v118
v_rcp_f32 v119, v119
v_pk_mul_f32 v[64:65], v[64:65], v[112:113]
v_pk_mul_f32 v[66:67], v[66:67], v[114:115]
v_pk_mul_f32 v[68:69], v[68:69], v[116:117]
v_pk_mul_f32 v[70:71], v[70:71], v[118:119]
v_cvt_pk_bf16_f32 v124, v64, v65
v_cvt_pk_bf16_f32 v125, v66, v67
v_cvt_pk_bf16_f32 v126, v68, v69
v_cvt_pk_bf16_f32 v127, v70, v71
buffer_load_dword v12, v7, s[8:11], s29 offen sc1
buffer_store_dwordx4 v[124:127], v2, s[8:11], s28 offen offset:1024 sc1
s_mov_b32 s43, s30
s_cmp_eq_u32 s15, 63
s_cselect_b64 vcc, 0, vcc
s_mov_b32 s42, 1
s_cbranch_vccnz OPT_344
s_mov_b32 s42, 0
s_waitcnt vmcnt(0)
s_mov_b64 exec, 1
buffer_store_dword v5, v4, s[8:11], s30 offen sc1
s_mov_b64 exec, -1
OPT_344:
s_add_u32 s28, s28, 114688
s_add_u32 s30, s30, 512
s_add_u32 s15, s15, 1
s_cmp_lt_u32 s15, 64
s_cbranch_scc1 F1_LOOP_331
s_endpgm
M_PUB:
s_xor_b32 s50, s14, 1
s_sub_u32 s13, s13, 14
M_PU:
s_sub_u32 s13, s13, 14
v_lshlrev_b32 v2, 4, v1
v_mov_b32 v4, 0
v_mov_b32 v5, 1
v_lshrrev_b32 v18, 5, v1
v_mul_u32_u24 v8, 640, v18
v_and_b32 v18, 31, v1
v_lshl_add_u32 v8, v18, 4, v8
s_mul_i32 s17, s12, 10240
s_add_u32 s17, s17, 0
v_add_u32 v8, s17, v8
v_bfe_u32 v18, v1, 3, 1
v_mul_u32_u24 v9, 640, v18
v_bfe_u32 v18, v1, 4, 1
v_mul_u32_u24 v18, 2560, v18
v_add_u32 v9, v9, v18
v_bfe_u32 v18, v1, 5, 1
v_mul_u32_u24 v18, 5120, v18
v_add_u32 v9, v9, v18
v_and_b32 v18, 7, v1
s_lshl_b32 s17, s12, 3
v_add_u32 v18, s17, v18
v_lshl_add_u32 v9, v18, 4, v9
v_add_u32 v9, 0, v9
v_lshrrev_b32 v10, 3, v1
s_lshl_b32 s17, s13, 3
v_add_u32 v10, s17, v10
v_lshlrev_b32 v10, 9, v10
v_lshl_add_u32 v10, v18, 4, v10
s_lshr_b32 s18, s13, 1
s_lshl_b32 s18, s18, 9
s_and_b32 s19, s17, 8
s_add_u32 s18, s18, s19
v_lshlrev_b32 v11, 4, v18
v_add_u32 v11, s18, v11
s_mov_b32 s36, 0xff
s_mov_b32 s37, 0
v_mov_b32 v12, v2
v_and_b32 v13, 15, v1
v_lshlrev_b32 v13, 4, v13
v_bfe_u32 v18, v1, 4, 1
v_lshl_add_u32 v13, v18, 10, v13
v_lshrrev_b32 v18, 5, v1
v_lshl_add_u32 v13, v18, 8, v13
v_and_b32 v7, 1, v1
v_mul_u32_u24 v7, 14, v7
v_bfe_u32 v18, v1, 1, 1
v_add_u32 v7, v7, v18
s_mul_i32 s17, s12, 28
s_lshl_b32 s18, s13, 1
s_add_u32 s17, s17, s18
v_add_u32 v7, s17, v7
v_lshrrev_b32 v18, 3, v7
v_mul_u32_u24 v18, 24, v18
v_add_lshl_u32 v7, v7, v18, 2
v_add_u32 v7, 38273024, v7
v_and_b32 v14, 15, v1
s_lshl_b32 s17, s12, 5
v_add_u32 v14, s17, v14
v_lshlrev_b32 v14, 2, v14
v_add_u32 v14, 37814272, v14
v_and_b32 v15, 1, v1
v_add_u32 v15, s18, v15
v_lshlrev_b32 v15, 2, v15
v_add_u32 v15, s12, v15
v_lshlrev_b32 v15, 2, v15
v_add_u32 v15, 37879808, v15
s_lshl_b32 s27, s14, 15
s_lshl_b32 s17, s13, 2
s_add_u32 s17, s17, s12
s_lshl_b32 s28, s17, 2
s_add_u32 s28, s28, s27
s_add_u32 s28, s28, 37945344
s_lshr_b32 s18, s13, 1
s_mul_i32 s18, s18, 96
s_add_u32 s28, s28, s18
s_mul_i32 s21, s14, 29360128
s_mul_i32 s17, s12, 114688
s_add_u32 s21, s21, s17
s_lshl_b32 s17, s13, 12
s_add_u32 s21, s21, s17
s_add_u32 s21, s21, 100663296
s_mul_i32 s22, s14, 7340032
s_lshl_b32 s17, s13, 14
s_add_u32 s22, s22, s17
s_lshl_b32 s17, s12, 11
s_add_u32 s22, s22, s17
s_add_u32 s22, s22, 60817408
s_mul_i32 s23, s14, 2621440
s_mul_i32 s17, s12, 10240
s_add_u32 s23, s23, s17
s_add_u32 s23, s23, 54525952
s_mul_i32 s24, s14, 3670016
s_add_u32 s24, s24, 44040192
s_add_u32 s25, s24, 1835008
s_lshl_b32 s26, s14, 18
s_add_u32 s26, s26, 39452672
s_mov_b32 s15, s50
s_mul_i32 s17, s50, 458752
s_add_u32 s21, s21, s17
s_mul_i32 s17, s50, 114688
s_add_u32 s22, s22, s17
s_mul_i32 s17, s50, 40960
s_add_u32 s23, s23, s17
s_mul_i32 s17, s50, 28672
s_add_u32 s24, s24, s17
s_add_u32 s25, s25, s17
s_mul_i32 s17, s50, 2048
s_add_u32 s26, s26, s17
s_lshl_b32 s17, s50, 9
s_add_u32 s27, s27, s17
s_add_u32 s28, s28, s17
v_add_u32 v32, 40960, v8
v_add_u32 v33, 40960, v9
v_cmp_gt_u32 vcc, 32, v1
v_and_b32 v15, 3, v1
v_lshlrev_b32 v15, 2, v15
v_add_u32 v15, 38274816, v15
v_cndmask_b32 v15, v15, v7, vcc
s_add_u32 s29, s22, 8192
s_mov_b32 s33, 0
s_cmp_lg_u32 s51, 0
s_cbranch_scc1 MS_345_slow
MS_345:
buffer_load_dword v18, off, s[92:95], s56 sc1
s_sub_u32 s16, s16, 1
s_cbranch_scc1 MS_345_ab
s_waitcnt vmcnt(0)
v_readfirstlane_b32 s58, v18
s_nop 0
s_and_b32 s17, s58, 0xffff
s_cmp_ge_u32 s17, s57
s_nop 0
s_cbranch_scc0 MS_345
s_lshr_b32 s17, s58, 16
s_cbranch_scc1 MS_345_slow
PU_LOOP_346:
s_lshr_b32 s17, s15, 1
s_lshl_b32 s18, s14, 2
s_add_u32 s17, s17, s18
s_cmp_lg_u32 s17, 4
s_cbranch_scc1 PXG_347
s_mov_b64 s[54:55], vcc
s_cmp_lg_u32 s12, 0
s_cbranch_scc1 WC_348_d
s_branch WC_348_in
WC_348:
s_sleep 16
WC_348_in:
s_mov_b32 s58, 38207488
buffer_load_dword v18, off, s[8:11], s58 sc1
s_sub_u32 s16, s16, 1
s_cbranch_scc1 WC_348_ab
s_waitcnt vmcnt(0)
v_cmp_gt_u32 vcc, 96, v18
s_cbranch_vccnz WC_348
WC_348_d:
s_barrier
s_mov_b64 vcc, s[54:55]
PXG_347:
s_cmp_eq_u32 s33, 1
s_cbranch_scc1 PU_HAVE_349
s_lshl_b32 s30, s27, 2
s_branch WF_350_in
WF_350:
s_sleep 2
WF_350_in:
buffer_load_dword v18, v15, s[8:11], s30 offen sc1
s_sub_u32 s16, s16, 1
s_cbranch_scc1 WFD_351_abort
s_waitcnt vmcnt(0)
v_cmp_eq_u32 vcc, 0, v18
s_cbranch_vccnz WF_350
WFD_351:
buffer_load_dwordx4 a[0:3], v12, s[8:11], s21 offen offset:0 sc1
buffer_load_dwordx4 a[4:7], v12, s[8:11], s21 offen offset:1024 sc1
buffer_load_dwordx4 a[32:35], v12, s[8:11], s21 offen offset:2048 sc1
buffer_load_dwordx4 a[36:39], v12, s[8:11], s21 offen offset:3072 sc1
s_add_u32 s21, s21, 28672
buffer_load_dwordx4 a[8:11], v12, s[8:11], s21 offen offset:0 sc1
buffer_load_dwordx4 a[12:15], v12, s[8:11], s21 offen offset:1024 sc1
buffer_load_dwordx4 a[40:43], v12, s[8:11], s21 offen offset:2048 sc1
buffer_load_dwordx4 a[44:47], v12, s[8:11], s21 offen offset:3072 sc1
s_add_u32 s21, s21, 28672
buffer_load_dwordx4 a[16:19], v12, s[8:11], s21 offen offset:0 sc1
buffer_load_dwordx4 a[20:23], v12, s[8:11], s21 offen offset:1024 sc1
buffer_load_dwordx4 a[48:51], v12, s[8:11], s21 offen offset:2048 sc1
buffer_load_dwordx4 a[52:55], v12, s[8:11], s21 offen offset:3072 sc1
s_add_u32 s21, s21, 28672
buffer_load_dwordx4 a[24:27], v12, s[8:11], s21 offen offset:0 sc1
buffer_load_dwordx4 a[28:31], v12, s[8:11], s21 offen offset:1024 sc1
buffer_load_dwordx4 a[56:59], v12, s[8:11], s21 offen offset:2048 sc1
buffer_load_dwordx4 a[60:63], v12, s[8:11], s21 offen offset:3072 sc1
s_add_u32 s21, s21, 831488
buffer_load_dwordx4 v[20:23], v10, s[8:11], s24 offen sc1
s_add_u32 s24, s24, 57344
PU_HAVE_349:
s_lshl_b32 s30, s27, 2
s_add_u32 s30, s30, 4096
s_add_u32 s31, s23, 4096
s_add_u32 s32, s23, 8192
s_branch POLL_352_in
POLL_352:
s_sleep 1
POLL_352_in:
buffer_load_dwordx4 v[224:227], v2, s[8:11], s32 offen offset:0 sc1
buffer_load_dwordx4 v[228:231], v2, s[8:11], s32 offen offset:1024 sc1
s_sub_u32 s16, s16, 1
s_cbranch_scc1 POLLD_353_abort
s_waitcnt vmcnt(0)
v_max3_u32 v18, v224, v225, v226
v_max3_u32 v18, v18, v227, v228
v_max3_u32 v18, v18, v229, v230
v_max_u32 v18, v18, v231
v_cmp_eq_u32 vcc, -1, v18
s_cbranch_vccnz POLL_352
POLLD_353:
PU_REDO_354:
buffer_load_dwordx4 v[192:195], v2, s[8:11], s23 offen offset:0 sc1
buffer_load_dwordx4 v[196:199], v2, s[8:11], s23 offen offset:1024 sc1
buffer_load_dwordx4 v[200:203], v2, s[8:11], s23 offen offset:2048 sc1
buffer_load_dwordx4 v[204:207], v2, s[8:11], s23 offen offset:3072 sc1
buffer_load_dwordx4 v[208:211], v2, s[8:11], s31 offen offset:0 sc1
buffer_load_dwordx4 v[212:215], v2, s[8:11], s31 offen offset:1024 sc1
buffer_load_dwordx4 v[216:219], v2, s[8:11], s31 offen offset:2048 sc1
buffer_load_dwordx4 v[220:223], v2, s[8:11], s31 offen offset:3072 sc1
buffer_load_dword v16, v15, s[8:11], s30 offen sc1
buffer_load_dwordx4 v[112:115], v13, s[8:11], s22 offen offset:0 sc1
buffer_load_dwordx4 v[120:123], v13, s[8:11], s29 offen offset:0 sc1
buffer_load_dwordx4 v[116:119], v13, s[8:11], s22 offen offset:512 sc1
buffer_load_dwordx4 v[124:127], v13, s[8:11], s29 offen offset:512 sc1
s_waitcnt vmcnt(12)
v_mfma_f32_32x32x16_bf16 v[48:63], a[0:3], v[192:195], 0
v_max3_u32 v19, v192, v193, 0
v_mfma_f32_32x32x16_bf16 v[64:79], a[32:35], v[192:195], 0
v_max3_u32 v19, v194, v195, v19
s_waitcnt vmcnt(11)
v_mfma_f32_32x32x16_bf16 v[48:63], a[4:7], v[196:199], v[48:63]
v_max3_u32 v19, v196, v197, v19
v_mfma_f32_32x32x16_bf16 v[64:79], a[36:39], v[196:199], v[64:79]
v_max3_u32 v19, v198, v199, v19
s_waitcnt vmcnt(10)
v_mfma_f32_32x32x16_bf16 v[48:63], a[8:11], v[200:203], v[48:63]
v_max3_u32 v19, v200, v201, v19
v_mfma_f32_32x32x16_bf16 v[64:79], a[40:43], v[200:203], v[64:79]
v_max3_u32 v19, v202, v203, v19
s_waitcnt vmcnt(9)
v_mfma_f32_32x32x16_bf16 v[48:63], a[12:15], v[204:207], v[48:63]
v_max3_u32 v19, v204, v205, v19
v_mfma_f32_32x32x16_bf16 v[64:79], a[44:47], v[204:207], v[64:79]
v_max3_u32 v19, v206, v207, v19
s_waitcnt vmcnt(8)
v_mfma_f32_32x32x16_bf16 v[48:63], a[16:19], v[208:211], v[48:63]
v_max3_u32 v19, v208, v209, v19
v_mfma_f32_32x32x16_bf16 v[64:79], a[48:51], v[208:211], v[64:79]
v_max3_u32 v19, v210, v211, v19
s_waitcnt vmcnt(7)
v_mfma_f32_32x32x16_bf16 v[48:63], a[20:23], v[212:215], v[48:63]
v_max3_u32 v19, v212, v213, v19
v_mfma_f32_32x32x16_bf16 v[64:79], a[52:55], v[212:215], v[64:79]
v_max3_u32 v19, v214, v215, v19
s_waitcnt vmcnt(6)
v_mfma_f32_32x32x16_bf16 v[48:63], a[24:27], v[216:219], v[48:63]
v_max3_u32 v19, v216, v217, v19
v_mfma_f32_32x32x16_bf16 v[64:79], a[56:59], v[216:219], v[64:79]
v_max3_u32 v19, v218, v219, v19
s_waitcnt vmcnt(5)
v_mfma_f32_32x32x16_bf16 v[48:63], a[28:31], v[220:223], v[48:63]
v_max3_u32 v19, v220, v221, v19
v_mfma_f32_32x32x16_bf16 v[64:79], a[60:63], v[220:223], v[64:79]
v_max3_u32 v19, v222, v223, v19
v_cmp_eq_u32 vcc, -1, v19
s_sub_u32 s17, s16, 1
s_cselect_b64 vcc, 0, vcc
s_max_i32 s16, s17, 0
s_nop 5
s_cbranch_vccnz PU_REDO_354
s_add_u32 s23, s23, 81920
s_add_u32 s27, s27, 1024
s_waitcnt vmcnt(0)
v_max3_u32 v18, v112, v113, v114
v_max3_u32 v18, v18, v115, v116
v_max3_u32 v18, v18, v117, v118
v_max3_u32 v18, v18, v119, v120
v_max3_u32 v18, v18, v121, v122
v_max3_u32 v18, v18, v123, v124
v_max3_u32 v18, v18, v125, v126
v_max_u32 v18, v18, v127
v_cmp_eq_u32 vcc, -1, v18
s_cbranch_vccz OPT_355
s_nop 2
s_branch POLL_356_in
POLL_356:
s_sleep 1
POLL_356_in:
buffer_load_dwordx4 v[112:115], v13, s[8:11], s22 offen offset:0 sc1
buffer_load_dwordx4 v[120:123], v13, s[8:11], s29 offen offset:0 sc1
buffer_load_dwordx4 v[116:119], v13, s[8:11], s22 offen offset:512 sc1
buffer_load_dwordx4 v[124:127], v13, s[8:11], s29 offen offset:512 sc1
s_sub_u32 s16, s16, 1
s_cbranch_scc1 POLLD_357_abort
s_waitcnt vmcnt(0)
v_max3_u32 v18, v112, v113, v114
v_max3_u32 v18, v18, v115, v116
v_max3_u32 v18, v18, v117, v118
v_max3_u32 v18, v18, v119, v120
v_max3_u32 v18, v18, v121, v122
v_max3_u32 v18, v18, v123, v124
v_max3_u32 v18, v18, v125, v126
v_max_u32 v18, v18, v127
v_cmp_eq_u32 vcc, -1, v18
s_cbranch_vccnz POLL_356
POLLD_357:
OPT_355:
s_add_u32 s22, s22, 229376
s_add_u32 s29, s29, 229376
v_mfma_f32_32x32x16_bf16 v[48:63], v[112:115], v[224:227], v[48:63]
v_mfma_f32_32x32x16_bf16 v[64:79], v[120:123], v[224:227], v[64:79]
v_mfma_f32_32x32x16_bf16 v[48:63], v[116:119], v[228:231], v[48:63]
v_mfma_f32_32x32x16_bf16 v[64:79], v[124:127], v[228:231], v[64:79]
s_nop 10
ds_write_b128 v8, v[48:51] offset:0
ds_write_b128 v8, v[52:55] offset:2560
ds_write_b128 v8, v[56:59] offset:1280
ds_write_b128 v8, v[60:63] offset:3840
ds_write_b128 v8, v[64:67] offset:5120
ds_write_b128 v8, v[68:71] offset:7680
ds_write_b128 v8, v[72:75] offset:6400
ds_write_b128 v8, v[76:79] offset:8960
s_waitcnt lgkmcnt(0)
s_barrier
ds_read_b128 v[80:83], v9 offset:0
ds_read_b128 v[84:87], v9 offset:1280
ds_read_b128 v[88:91], v9 offset:10240
ds_read_b128 v[92:95], v9 offset:11520
ds_read_b128 v[96:99], v9 offset:20480
ds_read_b128 v[100:103], v9 offset:21760
ds_read_b128 v[104:107], v9 offset:30720
ds_read_b128 v[108:111], v9 offset:32000
v_lshlrev_b32 v48, 16, v20
v_and_b32 v52, 0xffff0000, v20
v_lshlrev_b32 v49, 16, v21
v_and_b32 v53, 0xffff0000, v21
v_lshlrev_b32 v50, 16, v22
v_and_b32 v54, 0xffff0000, v22
v_lshlrev_b32 v51, 16, v23
v_and_b32 v55, 0xffff0000, v23
s_waitcnt lgkmcnt(6)
v_pk_add_f32 v[48:49], v[48:49], v[80:81]
v_pk_add_f32 v[50:51], v[50:51], v[82:83]
v_pk_add_f32 v[52:53], v[52:53], v[84:85]
v_pk_add_f32 v[54:55], v[54:55], v[86:87]
s_waitcnt lgkmcnt(4)
v_pk_add_f32 v[48:49], v[48:49], v[88:89]
v_pk_add_f32 v[50:51], v[50:51], v[90:91]
v_pk_add_f32 v[52:53], v[52:53], v[92:93]
v_pk_add_f32 v[54:55], v[54:55], v[94:95]
s_waitcnt lgkmcnt(2)
v_pk_add_f32 v[48:49], v[48:49], v[96:97]
v_pk_add_f32 v[50:51], v[50:51], v[98:99]
v_pk_add_f32 v[52:53], v[52:53], v[100:101]
v_pk_add_f32 v[54:55], v[54:55], v[102:103]
s_waitcnt lgkmcnt(0)
v_pk_add_f32 v[48:49], v[48:49], v[104:105]
v_pk_add_f32 v[50:51], v[50:51], v[106:107]
v_pk_add_f32 v[52:53], v[52:53], v[108:109]
v_pk_add_f32 v[54:55], v[54:55], v[110:111]
v_cvt_pk_bf16_f32 v20, v48, v52
v_cvt_pk_bf16_f32 v21, v49, v53
v_cvt_pk_bf16_f32 v22, v50, v54
v_cvt_pk_bf16_f32 v23, v51, v55
buffer_store_dwordx4 v[20:23], v10, s[8:11], s25 offen
v_lshlrev_b32 v48, 16, v20
v_and_b32 v49, 0xffff0000, v20
v_lshlrev_b32 v50, 16, v21
v_and_b32 v51, 0xffff0000, v21
v_lshlrev_b32 v52, 16, v22
v_and_b32 v53, 0xffff0000, v22
v_lshlrev_b32 v54, 16, v23
v_and_b32 v55, 0xffff0000, v23
v_pk_add_f32 v[80:81], v[48:49], v[50:51]
v_pk_mul_f32 v[82:83], v[48:49], v[48:49]
v_pk_add_f32 v[84:85], v[52:53], v[54:55]
v_pk_fma_f32 v[82:83], v[50:51], v[50:51], v[82:83]
v_pk_fma_f32 v[82:83], v[52:53], v[52:53], v[82:83]
v_pk_fma_f32 v[82:83], v[54:55], v[54:55], v[82:83]
v_pk_add_f32 v[80:81], v[80:81], v[84:85]
v_add_f32 v80, v80, v81
v_add_f32 v81, v82, v83
s_nop 0
v_add_f32_dpp v80, v80, v80 row_ror:8 row_mask:0xf bank_mask:0xf
v_add_f32_dpp v81, v81, v81 row_ror:8 row_mask:0xf bank_mask:0xf
v_mov_b32 v82, v80
v_mov_b32 v83, v81
s_nop 0
v_permlane16_swap_b32 v80, v82
v_permlane16_swap_b32 v81, v83
v_pk_add_f32 v[80:81], v[80:81], v[82:83]
v_mov_b32 v82, v80
v_mov_b32 v83, v81
s_nop 0
v_permlane32_swap_b32 v80, v82
v_permlane32_swap_b32 v81, v83
v_pk_add_f32 v[80:81], v[80:81], v[82:83]
s_mov_b64 exec, s[36:37]
buffer_store_dwordx2 v[80:81], v11, s[8:11], s26 offen
s_mov_b64 exec, -1
v_cmp_eq_u32 vcc, 0, v16
s_mov_b32 s33, 0
s_cmp_ge_u32 s15, 62
s_cselect_b64 vcc, -1, vcc
s_cbranch_vccnz PU_NR_358
s_mov_b32 s33, 1
buffer_load_dwordx4 a[0:3], v12, s[8:11], s21 offen offset:0 sc1
buffer_load_dwordx4 a[4:7], v12, s[8:11], s21 offen offset:1024 sc1
buffer_load_dwordx4 a[32:35], v12, s[8:11], s21 offen offset:2048 sc1
buffer_load_dwordx4 a[36:39], v12, s[8:11], s21 offen offset:3072 sc1
s_add_u32 s21, s21, 28672
s_waitcnt vmcnt(4)
s_mov_b64 exec, 1
buffer_store_dword v5, v4, s[8:11], s28 offen
s_mov_b64 exec, -1
buffer_load_dwordx4 a[8:11], v12, s[8:11], s21 offen offset:0 sc1
buffer_load_dwordx4 a[12:15], v12, s[8:11], s21 offen offset:1024 sc1
buffer_load_dwordx4 a[40:43], v12, s[8:11], s21 offen offset:2048 sc1
buffer_load_dwordx4 a[44:47], v12, s[8:11], s21 offen offset:3072 sc1
s_add_u32 s21, s21, 28672
buffer_load_dwordx4 a[16:19], v12, s[8:11], s21 offen offset:0 sc1
buffer_load_dwordx4 a[20:23], v12, s[8:11], s21 offen offset:1024 sc1
buffer_load_dwordx4 a[48:51], v12, s[8:11], s21 offen offset:2048 sc1
buffer_load_dwordx4 a[52:55], v12, s[8:11], s21 offen offset:3072 sc1
s_add_u32 s21, s21, 28672
buffer_load_dwordx4 a[24:27], v12, s[8:11], s21 offen offset:0 sc1
buffer_load_dwordx4 a[28:31], v12, s[8:11], s21 offen offset:1024 sc1
buffer_load_dwordx4 a[56:59], v12, s[8:11], s21 offen offset:2048 sc1
buffer_load_dwordx4 a[60:63], v12, s[8:11], s21 offen offset:3072 sc1
s_add_u32 s21, s21, 831488
buffer_load_dwordx4 v[24:27], v10, s[8:11], s24 offen sc1
s_add_u32 s24, s24, 57344
s_branch PU_JN_359
PU_NR_358:
s_waitcnt vmcnt(0)
s_mov_b64 exec, 1
buffer_store_dword v5, v4, s[8:11], s28 offen
s_mov_b64 exec, -1
PU_JN_359:
s_add_u32 s25, s25, 57344
s_add_u32 s26, s26, 4096
s_add_u32 s28, s28, 1024
s_add_u32 s15, s15, 2
s_cmp_eq_u32 s33, 1
s_cbranch_scc1 PU_HAVE_360
s_lshl_b32 s30, s27, 2
s_branch WF_361_in
WF_361:
s_sleep 2
WF_361_in:
buffer_load_dword v18, v15, s[8:11], s30 offen sc1
s_sub_u32 s16, s16, 1
s_cbranch_scc1 WFD_362_abort
s_waitcnt vmcnt(0)
v_cmp_eq_u32 vcc, 0, v18
s_cbranch_vccnz WF_361
WFD_362:
buffer_load_dwordx4 a[0:3], v12, s[8:11], s21 offen offset:0 sc1
buffer_load_dwordx4 a[4:7], v12, s[8:11], s21 offen offset:1024 sc1
buffer_load_dwordx4 a[32:35], v12, s[8:11], s21 offen offset:2048 sc1
buffer_load_dwordx4 a[36:39], v12, s[8:11], s21 offen offset:3072 sc1
s_add_u32 s21, s21, 28672
buffer_load_dwordx4 a[8:11], v12, s[8:11], s21 offen offset:0 sc1
buffer_load_dwordx4 a[12:15], v12, s[8:11], s21 offen offset:1024 sc1
buffer_load_dwordx4 a[40:43], v12, s[8:11], s21 offen offset:2048 sc1
buffer_load_dwordx4 a[44:47], v12, s[8:11], s21 offen offset:3072 sc1
s_add_u32 s21, s21, 28672
buffer_load_dwordx4 a[16:19], v12, s[8:11], s21 offen offset:0 sc1
buffer_load_dwordx4 a[20:23], v12, s[8:11], s21 offen offset:1024 sc1
buffer_load_dwordx4 a[48:51], v12, s[8:11], s21 offen offset:2048 sc1
buffer_load_dwordx4 a[52:55], v12, s[8:11], s21 offen offset:3072 sc1
s_add_u32 s21, s21, 28672
buffer_load_dwordx4 a[24:27], v12, s[8:11], s21 offen offset:0 sc1
buffer_load_dwordx4 a[28:31], v12, s[8:11], s21 offen offset:1024 sc1
buffer_load_dwordx4 a[56:59], v12, s[8:11], s21 offen offset:2048 sc1
buffer_load_dwordx4 a[60:63], v12, s[8:11], s21 offen offset:3072 sc1
s_add_u32 s21, s21, 831488
buffer_load_dwordx4 v[24:27], v10, s[8:11], s24 offen sc1
s_add_u32 s24, s24, 57344
PU_HAVE_360:
s_lshl_b32 s30, s27, 2
s_add_u32 s30, s30, 4096
s_add_u32 s31, s23, 4096
s_add_u32 s32, s23, 8192
s_branch POLL_363_in
POLL_363:
s_sleep 1
POLL_363_in:
buffer_load_dwordx4 v[224:227], v2, s[8:11], s32 offen offset:0 sc1
buffer_load_dwordx4 v[228:231], v2, s[8:11], s32 offen offset:1024 sc1
s_sub_u32 s16, s16, 1
s_cbranch_scc1 POLLD_364_abort
s_waitcnt vmcnt(0)
v_max3_u32 v18, v224, v225, v226
v_max3_u32 v18, v18, v227, v228
v_max3_u32 v18, v18, v229, v230
v_max_u32 v18, v18, v231
v_cmp_eq_u32 vcc, -1, v18
s_cbranch_vccnz POLL_363
POLLD_364:
PU_REDO_365:
buffer_load_dwordx4 v[192:195], v2, s[8:11], s23 offen offset:0 sc1
buffer_load_dwordx4 v[196:199], v2, s[8:11], s23 offen offset:1024 sc1
buffer_load_dwordx4 v[200:203], v2, s[8:11], s23 offen offset:2048 sc1
buffer_load_dwordx4 v[204:207], v2, s[8:11], s23 offen offset:3072 sc1
buffer_load_dwordx4 v[208:211], v2, s[8:11], s31 offen offset:0 sc1
buffer_load_dwordx4 v[212:215], v2, s[8:11], s31 offen offset:1024 sc1
buffer_load_dwordx4 v[216:219], v2, s[8:11], s31 offen offset:2048 sc1
buffer_load_dwordx4 v[220:223], v2, s[8:11], s31 offen offset:3072 sc1
buffer_load_dword v16, v15, s[8:11], s30 offen sc1
buffer_load_dwordx4 v[112:115], v13, s[8:11], s22 offen offset:0 sc1
buffer_load_dwordx4 v[120:123], v13, s[8:11], s29 offen offset:0 sc1
buffer_load_dwordx4 v[116:119], v13, s[8:11], s22 offen offset:512 sc1
buffer_load_dwordx4 v[124:127], v13, s[8:11], s29 offen offset:512 sc1
s_waitcnt vmcnt(12)
v_mfma_f32_32x32x16_bf16 v[48:63], a[0:3], v[192:195], 0
v_max3_u32 v19, v192, v193, 0
v_mfma_f32_32x32x16_bf16 v[64:79], a[32:35], v[192:195], 0
v_max3_u32 v19, v194, v195, v19
s_waitcnt vmcnt(11)
v_mfma_f32_32x32x16_bf16 v[48:63], a[4:7], v[196:199], v[48:63]
v_max3_u32 v19, v196, v197, v19
v_mfma_f32_32x32x16_bf16 v[64:79], a[36:39], v[196:199], v[64:79]
v_max3_u32 v19, v198, v199, v19
s_waitcnt vmcnt(10)
v_mfma_f32_32x32x16_bf16 v[48:63], a[8:11], v[200:203], v[48:63]
v_max3_u32 v19, v200, v201, v19
v_mfma_f32_32x32x16_bf16 v[64:79], a[40:43], v[200:203], v[64:79]
v_max3_u32 v19, v202, v203, v19
s_waitcnt vmcnt(9)
v_mfma_f32_32x32x16_bf16 v[48:63], a[12:15], v[204:207], v[48:63]
v_max3_u32 v19, v204, v205, v19
v_mfma_f32_32x32x16_bf16 v[64:79], a[44:47], v[204:207], v[64:79]
v_max3_u32 v19, v206, v207, v19
s_waitcnt vmcnt(8)
v_mfma_f32_32x32x16_bf16 v[48:63], a[16:19], v[208:211], v[48:63]
v_max3_u32 v19, v208, v209, v19
v_mfma_f32_32x32x16_bf16 v[64:79], a[48:51], v[208:211], v[64:79]
v_max3_u32 v19, v210, v211, v19
s_waitcnt vmcnt(7)
v_mfma_f32_32x32x16_bf16 v[48:63], a[20:23], v[212:215], v[48:63]
v_max3_u32 v19, v212, v213, v19
v_mfma_f32_32x32x16_bf16 v[64:79], a[52:55], v[212:215], v[64:79]
v_max3_u32 v19, v214, v215, v19
s_waitcnt vmcnt(6)
v_mfma_f32_32x32x16_bf16 v[48:63], a[24:27], v[216:219], v[48:63]
v_max3_u32 v19, v216, v217, v19
v_mfma_f32_32x32x16_bf16 v[64:79], a[56:59], v[216:219], v[64:79]
v_max3_u32 v19, v218, v219, v19
s_waitcnt vmcnt(5)
v_mfma_f32_32x32x16_bf16 v[48:63], a[28:31], v[220:223], v[48:63]
v_max3_u32 v19, v220, v221, v19
v_mfma_f32_32x32x16_bf16 v[64:79], a[60:63], v[220:223], v[64:79]
v_max3_u32 v19, v222, v223, v19
v_cmp_eq_u32 vcc, -1, v19
s_sub_u32 s17, s16, 1
s_cselect_b64 vcc, 0, vcc
s_max_i32 s16, s17, 0
s_nop 5
s_cbranch_vccnz PU_REDO_365
s_add_u32 s23, s23, 81920
s_add_u32 s27, s27, 1024
s_waitcnt vmcnt(0)
v_max3_u32 v18, v112, v113, v114
v_max3_u32 v18, v18, v115, v116
v_max3_u32 v18, v18, v117, v118
v_max3_u32 v18, v18, v119, v120
v_max3_u32 v18, v18, v121, v122
v_max3_u32 v18, v18, v123, v124
v_max3_u32 v18, v18, v125, v126
v_max_u32 v18, v18, v127
v_cmp_eq_u32 vcc, -1, v18
s_cbranch_vccz OPT_366
s_nop 2
s_branch POLL_367_in
POLL_367:
s_sleep 1
POLL_367_in:
buffer_load_dwordx4 v[112:115], v13, s[8:11], s22 offen offset:0 sc1
buffer_load_dwordx4 v[120:123], v13, s[8:11], s29 offen offset:0 sc1
buffer_load_dwordx4 v[116:119], v13, s[8:11], s22 offen offset:512 sc1
buffer_load_dwordx4 v[124:127], v13, s[8:11], s29 offen offset:512 sc1
s_sub_u32 s16, s16, 1
s_cbranch_scc1 POLLD_368_abort
s_waitcnt vmcnt(0)
v_max3_u32 v18, v112, v113, v114
v_max3_u32 v18, v18, v115, v116
v_max3_u32 v18, v18, v117, v118
v_max3_u32 v18, v18, v119, v120
v_max3_u32 v18, v18, v121, v122
v_max3_u32 v18, v18, v123, v124
v_max3_u32 v18, v18, v125, v126
v_max_u32 v18, v18, v127
v_cmp_eq_u32 vcc, -1, v18
s_cbranch_vccnz POLL_367
POLLD_368:
OPT_366:
s_add_u32 s22, s22, 229376
s_add_u32 s29, s29, 229376
v_mfma_f32_32x32x16_bf16 v[48:63], v[112:115], v[224:227], v[48:63]
v_mfma_f32_32x32x16_bf16 v[64:79], v[120:123], v[224:227], v[64:79]
v_mfma_f32_32x32x16_bf16 v[48:63], v[116:119], v[228:231], v[48:63]
v_mfma_f32_32x32x16_bf16 v[64:79], v[124:127], v[228:231], v[64:79]
s_nop 10
ds_write_b128 v32, v[48:51] offset:0
ds_write_b128 v32, v[52:55] offset:2560
ds_write_b128 v32, v[56:59] offset:1280
ds_write_b128 v32, v[60:63] offset:3840
ds_write_b128 v32, v[64:67] offset:5120
ds_write_b128 v32, v[68:71] offset:7680
ds_write_b128 v32, v[72:75] offset:6400
ds_write_b128 v32, v[76:79] offset:8960
s_waitcnt lgkmcnt(0)
s_barrier
ds_read_b128 v[80:83], v33 offset:0
ds_read_b128 v[84:87], v33 offset:1280
ds_read_b128 v[88:91], v33 offset:10240
ds_read_b128 v[92:95], v33 offset:11520
ds_read_b128 v[96:99], v33 offset:20480
ds_read_b128 v[100:103], v33 offset:21760
ds_read_b128 v[104:107], v33 offset:30720
ds_read_b128 v[108:111], v33 offset:32000
v_lshlrev_b32 v48, 16, v24
v_and_b32 v52, 0xffff0000, v24
v_lshlrev_b32 v49, 16, v25
v_and_b32 v53, 0xffff0000, v25
v_lshlrev_b32 v50, 16, v26
v_and_b32 v54, 0xffff0000, v26
v_lshlrev_b32 v51, 16, v27
v_and_b32 v55, 0xffff0000, v27
s_waitcnt lgkmcnt(6)
v_pk_add_f32 v[48:49], v[48:49], v[80:81]
v_pk_add_f32 v[50:51], v[50:51], v[82:83]
v_pk_add_f32 v[52:53], v[52:53], v[84:85]
v_pk_add_f32 v[54:55], v[54:55], v[86:87]
s_waitcnt lgkmcnt(4)
v_pk_add_f32 v[48:49], v[48:49], v[88:89]
v_pk_add_f32 v[50:51], v[50:51], v[90:91]
v_pk_add_f32 v[52:53], v[52:53], v[92:93]
v_pk_add_f32 v[54:55], v[54:55], v[94:95]
s_waitcnt lgkmcnt(2)
v_pk_add_f32 v[48:49], v[48:49], v[96:97]
v_pk_add_f32 v[50:51], v[50:51], v[98:99]
v_pk_add_f32 v[52:53], v[52:53], v[100:101]
v_pk_add_f32 v[54:55], v[54:55], v[102:103]
s_waitcnt lgkmcnt(0)
v_pk_add_f32 v[48:49], v[48:49], v[104:105]
v_pk_add_f32 v[50:51], v[50:51], v[106:107]
v_pk_add_f32 v[52:53], v[52:53], v[108:109]
v_pk_add_f32 v[54:55], v[54:55], v[110:111]
v_cvt_pk_bf16_f32 v24, v48, v52
v_cvt_pk_bf16_f32 v25, v49, v53
v_cvt_pk_bf16_f32 v26, v50, v54
v_cvt_pk_bf16_f32 v27, v51, v55
buffer_store_dwordx4 v[24:27], v10, s[8:11], s25 offen
v_lshlrev_b32 v48, 16, v24
v_and_b32 v49, 0xffff0000, v24
v_lshlrev_b32 v50, 16, v25
v_and_b32 v51, 0xffff0000, v25
v_lshlrev_b32 v52, 16, v26
v_and_b32 v53, 0xffff0000, v26
v_lshlrev_b32 v54, 16, v27
v_and_b32 v55, 0xffff0000, v27
v_pk_add_f32 v[80:81], v[48:49], v[50:51]
v_pk_mul_f32 v[82:83], v[48:49], v[48:49]
v_pk_add_f32 v[84:85], v[52:53], v[54:55]
v_pk_fma_f32 v[82:83], v[50:51], v[50:51], v[82:83]
v_pk_fma_f32 v[82:83], v[52:53], v[52:53], v[82:83]
v_pk_fma_f32 v[82:83], v[54:55], v[54:55], v[82:83]
v_pk_add_f32 v[80:81], v[80:81], v[84:85]
v_add_f32 v80, v80, v81
v_add_f32 v81, v82, v83
s_nop 0
v_add_f32_dpp v80, v80, v80 row_ror:8 row_mask:0xf bank_mask:0xf
v_add_f32_dpp v81, v81, v81 row_ror:8 row_mask:0xf bank_mask:0xf
v_mov_b32 v82, v80
v_mov_b32 v83, v81
s_nop 0
v_permlane16_swap_b32 v80, v82
v_permlane16_swap_b32 v81, v83
v_pk_add_f32 v[80:81], v[80:81], v[82:83]
v_mov_b32 v82, v80
v_mov_b32 v83, v81
s_nop 0
v_permlane32_swap_b32 v80, v82
v_permlane32_swap_b32 v81, v83
v_pk_add_f32 v[80:81], v[80:81], v[82:83]
s_mov_b64 exec, s[36:37]
buffer_store_dwordx2 v[80:81], v11, s[8:11], s26 offen
s_mov_b64 exec, -1
v_cmp_eq_u32 vcc, 0, v16
s_mov_b32 s33, 0
s_cmp_ge_u32 s15, 62
s_cselect_b64 vcc, -1, vcc
s_cbranch_vccnz PU_NR_369
s_mov_b32 s33, 1
buffer_load_dwordx4 a[0:3], v12, s[8:11], s21 offen offset:0 sc1
buffer_load_dwordx4 a[4:7], v12, s[8:11], s21 offen offset:1024 sc1
buffer_load_dwordx4 a[32:35], v12, s[8:11], s21 offen offset:2048 sc1
buffer_load_dwordx4 a[36:39], v12, s[8:11], s21 offen offset:3072 sc1
s_add_u32 s21, s21, 28672
s_waitcnt vmcnt(4)
s_mov_b64 exec, 1
buffer_store_dword v5, v4, s[8:11], s28 offen
s_mov_b64 exec, -1
buffer_load_dwordx4 a[8:11], v12, s[8:11], s21 offen offset:0 sc1
buffer_load_dwordx4 a[12:15], v12, s[8:11], s21 offen offset:1024 sc1
buffer_load_dwordx4 a[40:43], v12, s[8:11], s21 offen offset:2048 sc1
buffer_load_dwordx4 a[44:47], v12, s[8:11], s21 offen offset:3072 sc1
s_add_u32 s21, s21, 28672
buffer_load_dwordx4 a[16:19], v12, s[8:11], s21 offen offset:0 sc1
buffer_load_dwordx4 a[20:23], v12, s[8:11], s21 offen offset:1024 sc1
buffer_load_dwordx4 a[48:51], v12, s[8:11], s21 offen offset:2048 sc1
buffer_load_dwordx4 a[52:55], v12, s[8:11], s21 offen offset:3072 sc1
s_add_u32 s21, s21, 28672
buffer_load_dwordx4 a[24:27], v12, s[8:11], s21 offen offset:0 sc1
buffer_load_dwordx4 a[28:31], v12, s[8:11], s21 offen offset:1024 sc1
buffer_load_dwordx4 a[56:59], v12, s[8:11], s21 offen offset:2048 sc1
buffer_load_dwordx4 a[60:63], v12, s[8:11], s21 offen offset:3072 sc1
s_add_u32 s21, s21, 831488
buffer_load_dwordx4 v[20:23], v10, s[8:11], s24 offen sc1
s_add_u32 s24, s24, 57344
s_branch PU_JN_370
PU_NR_369:
s_waitcnt vmcnt(0)
s_mov_b64 exec, 1
buffer_store_dword v5, v4, s[8:11], s28 offen
s_mov_b64 exec, -1
PU_JN_370:
s_add_u32 s25, s25, 57344
s_add_u32 s26, s26, 4096
s_add_u32 s28, s28, 1024
s_add_u32 s15, s15, 2
s_cmp_lt_u32 s15, 64
s_cbranch_scc1 PU_LOOP_346
s_endpgm
MS_345_ab:
s_mov_b32 s16, 0
s_waitcnt vmcnt(0)
MS_345_slow:
PU_LOOP_371:
s_lshr_b32 s17, s15, 1
s_lshl_b32 s18, s14, 2
s_add_u32 s17, s17, s18
s_cmp_lg_u32 s17, 4
s_cbranch_scc1 PXG_372
s_mov_b64 s[54:55], vcc
s_cmp_lg_u32 s12, 0
s_cbranch_scc1 WC_373_d
s_branch WC_373_in
WC_373:
s_sleep 16
WC_373_in:
s_mov_b32 s58, 38207488
buffer_load_dword v18, off, s[8:11], s58 sc1
s_sub_u32 s16, s16, 1
s_cbranch_scc1 WC_373_ab
s_waitcnt vmcnt(0)
v_cmp_gt_u32 vcc, 96, v18
s_cbranch_vccnz WC_373
WC_373_d:
s_barrier
s_mov_b64 vcc, s[54:55]
PXG_372:
s_cmp_eq_u32 s33, 1
s_cbranch_scc1 PU_HAVE_374
s_lshl_b32 s30, s27, 2
s_branch WF_375_in
WF_375:
s_sleep 2
WF_375_in:
buffer_load_dword v18, v15, s[8:11], s30 offen sc1
s_sub_u32 s16, s16, 1
s_cbranch_scc1 WFD_376_abort
s_waitcnt vmcnt(0)
v_cmp_eq_u32 vcc, 0, v18
s_cbranch_vccnz WF_375
WFD_376:
buffer_load_dwordx4 a[0:3], v12, s[8:11], s21 offen offset:0 sc1
buffer_load_dwordx4 a[4:7], v12, s[8:11], s21 offen offset:1024 sc1
buffer_load_dwordx4 a[32:35], v12, s[8:11], s21 offen offset:2048 sc1
buffer_load_dwordx4 a[36:39], v12, s[8:11], s21 offen offset:3072 sc1
s_add_u32 s21, s21, 28672
buffer_load_dwordx4 a[8:11], v12, s[8:11], s21 offen offset:0 sc1
buffer_load_dwordx4 a[12:15], v12, s[8:11], s21 offen offset:1024 sc1
buffer_load_dwordx4 a[40:43], v12, s[8:11], s21 offen offset:2048 sc1
buffer_load_dwordx4 a[44:47], v12, s[8:11], s21 offen offset:3072 sc1
s_add_u32 s21, s21, 28672
buffer_load_dwordx4 a[16:19], v12, s[8:11], s21 offen offset:0 sc1
buffer_load_dwordx4 a[20:23], v12, s[8:11], s21 offen offset:1024 sc1
buffer_load_dwordx4 a[48:51], v12, s[8:11], s21 offen offset:2048 sc1
buffer_load_dwordx4 a[52:55], v12, s[8:11], s21 offen offset:3072 sc1
s_add_u32 s21, s21, 28672
buffer_load_dwordx4 a[24:27], v12, s[8:11], s21 offen offset:0 sc1
buffer_load_dwordx4 a[28:31], v12, s[8:11], s21 offen offset:1024 sc1
buffer_load_dwordx4 a[56:59], v12, s[8:11], s21 offen offset:2048 sc1
buffer_load_dwordx4 a[60:63], v12, s[8:11], s21 offen offset:3072 sc1
s_add_u32 s21, s21, 831488
buffer_load_dwordx4 v[20:23], v10, s[8:11], s24 offen sc1
s_add_u32 s24, s24, 57344
PU_HAVE_374:
s_lshl_b32 s30, s27, 2
s_add_u32 s30, s30, 4096
s_add_u32 s31, s23, 4096
s_add_u32 s32, s23, 8192
s_branch POLL_377_in
POLL_377:
s_sleep 1
POLL_377_in:
buffer_load_dwordx4 v[224:227], v2, s[8:11], s32 offen offset:0 sc1
buffer_load_dwordx4 v[228:231], v2, s[8:11], s32 offen offset:1024 sc1
s_sub_u32 s16, s16, 1
s_cbranch_scc1 POLLD_378_abort
s_waitcnt vmcnt(0)
v_max3_u32 v18, v224, v225, v226
v_max3_u32 v18, v18, v227, v228
v_max3_u32 v18, v18, v229, v230
v_max_u32 v18, v18, v231
v_cmp_eq_u32 vcc, -1, v18
s_cbranch_vccnz POLL_377
POLLD_378:
PU_REDO_379:
buffer_load_dwordx4 v[192:195], v2, s[8:11], s23 offen offset:0 sc1
buffer_load_dwordx4 v[196:199], v2, s[8:11], s23 offen offset:1024 sc1
buffer_load_dwordx4 v[200:203], v2, s[8:11], s23 offen offset:2048 sc1
buffer_load_dwordx4 v[204:207], v2, s[8:11], s23 offen offset:3072 sc1
buffer_load_dwordx4 v[208:211], v2, s[8:11], s31 offen offset:0 sc1
buffer_load_dwordx4 v[212:215], v2, s[8:11], s31 offen offset:1024 sc1
buffer_load_dwordx4 v[216:219], v2, s[8:11], s31 offen offset:2048 sc1
buffer_load_dwordx4 v[220:223], v2, s[8:11], s31 offen offset:3072 sc1
buffer_load_dword v16, v15, s[8:11], s30 offen sc1
buffer_load_dwordx4 v[112:115], v13, s[8:11], s22 offen offset:0 sc1
buffer_load_dwordx4 v[120:123], v13, s[8:11], s29 offen offset:0 sc1
buffer_load_dwordx4 v[116:119], v13, s[8:11], s22 offen offset:512 sc1
buffer_load_dwordx4 v[124:127], v13, s[8:11], s29 offen offset:512 sc1
s_waitcnt vmcnt(12)
v_mfma_f32_32x32x16_bf16 v[48:63], a[0:3], v[192:195], 0
v_max3_u32 v19, v192, v193, 0
v_mfma_f32_32x32x16_bf16 v[64:79], a[32:35], v[192:195], 0
v_max3_u32 v19, v194, v195, v19
s_waitcnt vmcnt(11)
v_mfma_f32_32x32x16_bf16 v[48:63], a[4:7], v[196:199], v[48:63]
v_max3_u32 v19, v196, v197, v19
v_mfma_f32_32x32x16_bf16 v[64:79], a[36:39], v[196:199], v[64:79]
v_max3_u32 v19, v198, v199, v19
s_waitcnt vmcnt(10)
v_mfma_f32_32x32x16_bf16 v[48:63], a[8:11], v[200:203], v[48:63]
v_max3_u32 v19, v200, v201, v19
v_mfma_f32_32x32x16_bf16 v[64:79], a[40:43], v[200:203], v[64:79]
v_max3_u32 v19, v202, v203, v19
s_waitcnt vmcnt(9)
v_mfma_f32_32x32x16_bf16 v[48:63], a[12:15], v[204:207], v[48:63]
v_max3_u32 v19, v204, v205, v19
v_mfma_f32_32x32x16_bf16 v[64:79], a[44:47], v[204:207], v[64:79]
v_max3_u32 v19, v206, v207, v19
s_waitcnt vmcnt(8)
v_mfma_f32_32x32x16_bf16 v[48:63], a[16:19], v[208:211], v[48:63]
v_max3_u32 v19, v208, v209, v19
v_mfma_f32_32x32x16_bf16 v[64:79], a[48:51], v[208:211], v[64:79]
v_max3_u32 v19, v210, v211, v19
s_waitcnt vmcnt(7)
v_mfma_f32_32x32x16_bf16 v[48:63], a[20:23], v[212:215], v[48:63]
v_max3_u32 v19, v212, v213, v19
v_mfma_f32_32x32x16_bf16 v[64:79], a[52:55], v[212:215], v[64:79]
v_max3_u32 v19, v214, v215, v19
s_waitcnt vmcnt(6)
v_mfma_f32_32x32x16_bf16 v[48:63], a[24:27], v[216:219], v[48:63]
v_max3_u32 v19, v216, v217, v19
v_mfma_f32_32x32x16_bf16 v[64:79], a[56:59], v[216:219], v[64:79]
v_max3_u32 v19, v218, v219, v19
s_waitcnt vmcnt(5)
v_mfma_f32_32x32x16_bf16 v[48:63], a[28:31], v[220:223], v[48:63]
v_max3_u32 v19, v220, v221, v19
v_mfma_f32_32x32x16_bf16 v[64:79], a[60:63], v[220:223], v[64:79]
v_max3_u32 v19, v222, v223, v19
v_cmp_eq_u32 vcc, -1, v19
s_sub_u32 s17, s16, 1
s_cselect_b64 vcc, 0, vcc
s_max_i32 s16, s17, 0
s_nop 5
s_cbranch_vccnz PU_REDO_379
s_add_u32 s23, s23, 81920
s_add_u32 s27, s27, 1024
s_waitcnt vmcnt(0)
v_max3_u32 v18, v112, v113, v114
v_max3_u32 v18, v18, v115, v116
v_max3_u32 v18, v18, v117, v118
v_max3_u32 v18, v18, v119, v120
v_max3_u32 v18, v18, v121, v122
v_max3_u32 v18, v18, v123, v124
v_max3_u32 v18, v18, v125, v126
v_max_u32 v18, v18, v127
v_cmp_eq_u32 vcc, -1, v18
s_cbranch_vccz OPT_380
s_nop 2
s_branch POLL_381_in
POLL_381:
s_sleep 1
POLL_381_in:
buffer_load_dwordx4 v[112:115], v13, s[8:11], s22 offen offset:0 sc1
buffer_load_dwordx4 v[120:123], v13, s[8:11], s29 offen offset:0 sc1
buffer_load_dwordx4 v[116:119], v13, s[8:11], s22 offen offset:512 sc1
buffer_load_dwordx4 v[124:127], v13, s[8:11], s29 offen offset:512 sc1
s_sub_u32 s16, s16, 1
s_cbranch_scc1 POLLD_382_abort
s_waitcnt vmcnt(0)
v_max3_u32 v18, v112, v113, v114
v_max3_u32 v18, v18, v115, v116
v_max3_u32 v18, v18, v117, v118
v_max3_u32 v18, v18, v119, v120
v_max3_u32 v18, v18, v121, v122
v_max3_u32 v18, v18, v123, v124
v_max3_u32 v18, v18, v125, v126
v_max_u32 v18, v18, v127
v_cmp_eq_u32 vcc, -1, v18
s_cbranch_vccnz POLL_381
POLLD_382:
OPT_380:
s_add_u32 s22, s22, 229376
s_add_u32 s29, s29, 229376
v_mfma_f32_32x32x16_bf16 v[48:63], v[112:115], v[224:227], v[48:63]
v_mfma_f32_32x32x16_bf16 v[64:79], v[120:123], v[224:227], v[64:79]
v_mfma_f32_32x32x16_bf16 v[48:63], v[116:119], v[228:231], v[48:63]
v_mfma_f32_32x32x16_bf16 v[64:79], v[124:127], v[228:231], v[64:79]
s_nop 10
ds_write_b128 v8, v[48:51] offset:0
ds_write_b128 v8, v[52:55] offset:2560
ds_write_b128 v8, v[56:59] offset:1280
ds_write_b128 v8, v[60:63] offset:3840
ds_write_b128 v8, v[64:67] offset:5120
ds_write_b128 v8, v[68:71] offset:7680
ds_write_b128 v8, v[72:75] offset:6400
ds_write_b128 v8, v[76:79] offset:8960
s_waitcnt lgkmcnt(0)
s_barrier
ds_read_b128 v[80:83], v9 offset:0
ds_read_b128 v[84:87], v9 offset:1280
ds_read_b128 v[88:91], v9 offset:10240
ds_read_b128 v[92:95], v9 offset:11520
ds_read_b128 v[96:99], v9 offset:20480
ds_read_b128 v[100:103], v9 offset:21760
ds_read_b128 v[104:107], v9 offset:30720
ds_read_b128 v[108:111], v9 offset:32000
v_lshlrev_b32 v48, 16, v20
v_and_b32 v52, 0xffff0000, v20
v_lshlrev_b32 v49, 16, v21
v_and_b32 v53, 0xffff0000, v21
v_lshlrev_b32 v50, 16, v22
v_and_b32 v54, 0xffff0000, v22
v_lshlrev_b32 v51, 16, v23
v_and_b32 v55, 0xffff0000, v23
s_waitcnt lgkmcnt(6)
v_pk_add_f32 v[48:49], v[48:49], v[80:81]
v_pk_add_f32 v[50:51], v[50:51], v[82:83]
v_pk_add_f32 v[52:53], v[52:53], v[84:85]
v_pk_add_f32 v[54:55], v[54:55], v[86:87]
s_waitcnt lgkmcnt(4)
v_pk_add_f32 v[48:49], v[48:49], v[88:89]
v_pk_add_f32 v[50:51], v[50:51], v[90:91]
v_pk_add_f32 v[52:53], v[52:53], v[92:93]
v_pk_add_f32 v[54:55], v[54:55], v[94:95]
s_waitcnt lgkmcnt(2)
v_pk_add_f32 v[48:49], v[48:49], v[96:97]
v_pk_add_f32 v[50:51], v[50:51], v[98:99]
v_pk_add_f32 v[52:53], v[52:53], v[100:101]
v_pk_add_f32 v[54:55], v[54:55], v[102:103]
s_waitcnt lgkmcnt(0)
v_pk_add_f32 v[48:49], v[48:49], v[104:105]
v_pk_add_f32 v[50:51], v[50:51], v[106:107]
v_pk_add_f32 v[52:53], v[52:53], v[108:109]
v_pk_add_f32 v[54:55], v[54:55], v[110:111]
v_cvt_pk_bf16_f32 v20, v48, v52
v_cvt_pk_bf16_f32 v21, v49, v53
v_cvt_pk_bf16_f32 v22, v50, v54
v_cvt_pk_bf16_f32 v23, v51, v55
buffer_store_dwordx4 v[20:23], v10, s[8:11], s25 offen sc1
v_lshlrev_b32 v48, 16, v20
v_and_b32 v49, 0xffff0000, v20
v_lshlrev_b32 v50, 16, v21
v_and_b32 v51, 0xffff0000, v21
v_lshlrev_b32 v52, 16, v22
v_and_b32 v53, 0xffff0000, v22
v_lshlrev_b32 v54, 16, v23
v_and_b32 v55, 0xffff0000, v23
v_pk_add_f32 v[80:81], v[48:49], v[50:51]
v_pk_mul_f32 v[82:83], v[48:49], v[48:49]
v_pk_add_f32 v[84:85], v[52:53], v[54:55]
v_pk_fma_f32 v[82:83], v[50:51], v[50:51], v[82:83]
v_pk_fma_f32 v[82:83], v[52:53], v[52:53], v[82:83]
v_pk_fma_f32 v[82:83], v[54:55], v[54:55], v[82:83]
v_pk_add_f32 v[80:81], v[80:81], v[84:85]
v_add_f32 v80, v80, v81
v_add_f32 v81, v82, v83
s_nop 0
v_add_f32_dpp v80, v80, v80 row_ror:8 row_mask:0xf bank_mask:0xf
v_add_f32_dpp v81, v81, v81 row_ror:8 row_mask:0xf bank_mask:0xf
v_mov_b32 v82, v80
v_mov_b32 v83, v81
s_nop 0
v_permlane16_swap_b32 v80, v82
v_permlane16_swap_b32 v81, v83
v_pk_add_f32 v[80:81], v[80:81], v[82:83]
v_mov_b32 v82, v80
v_mov_b32 v83, v81
s_nop 0
v_permlane32_swap_b32 v80, v82
v_permlane32_swap_b32 v81, v83
v_pk_add_f32 v[80:81], v[80:81], v[82:83]
s_mov_b64 exec, s[36:37]
buffer_store_dwordx2 v[80:81], v11, s[8:11], s26 offen sc1
s_mov_b64 exec, -1
v_cmp_eq_u32 vcc, 0, v16
s_mov_b32 s33, 0
s_cmp_ge_u32 s15, 62
s_cselect_b64 vcc, -1, vcc
s_cbranch_vccnz PU_NR_383
s_mov_b32 s33, 1
buffer_load_dwordx4 a[0:3], v12, s[8:11], s21 offen offset:0 sc1
buffer_load_dwordx4 a[4:7], v12, s[8:11], s21 offen offset:1024 sc1
buffer_load_dwordx4 a[32:35], v12, s[8:11], s21 offen offset:2048 sc1
buffer_load_dwordx4 a[36:39], v12, s[8:11], s21 offen offset:3072 sc1
s_add_u32 s21, s21, 28672
buffer_load_dwordx4 a[8:11], v12, s[8:11], s21 offen offset:0 sc1
buffer_load_dwordx4 a[12:15], v12, s[8:11], s21 offen offset:1024 sc1
buffer_load_dwordx4 a[40:43], v12, s[8:11], s21 offen offset:2048 sc1
buffer_load_dwordx4 a[44:47], v12, s[8:11], s21 offen offset:3072 sc1
s_add_u32 s21, s21, 28672
buffer_load_dwordx4 a[16:19], v12, s[8:11], s21 offen offset:0 sc1
buffer_load_dwordx4 a[20:23], v12, s[8:11], s21 offen offset:1024 sc1
s_waitcnt vmcnt(10)
s_mov_b64 exec, 1
buffer_store_dword v5, v4, s[8:11], s28 offen sc1
s_mov_b64 exec, -1
buffer_load_dwordx4 a[48:51], v12, s[8:11], s21 offen offset:2048 sc1
buffer_load_dwordx4 a[52:55], v12, s[8:11], s21 offen offset:3072 sc1
s_add_u32 s21, s21, 28672
buffer_load_dwordx4 a[24:27], v12, s[8:11], s21 offen offset:0 sc1
buffer_load_dwordx4 a[28:31], v12, s[8:11], s21 offen offset:1024 sc1
buffer_load_dwordx4 a[56:59], v12, s[8:11], s21 offen offset:2048 sc1
buffer_load_dwordx4 a[60:63], v12, s[8:11], s21 offen offset:3072 sc1
s_add_u32 s21, s21, 831488
buffer_load_dwordx4 v[24:27], v10, s[8:11], s24 offen sc1
s_add_u32 s24, s24, 57344
s_branch PU_JN_384
PU_NR_383:
s_waitcnt vmcnt(0)
s_mov_b64 exec, 1
buffer_store_dword v5, v4, s[8:11], s28 offen sc1
s_mov_b64 exec, -1
PU_JN_384:
s_add_u32 s25, s25, 57344
s_add_u32 s26, s26, 4096
s_add_u32 s28, s28, 1024
s_add_u32 s15, s15, 2
s_cmp_eq_u32 s33, 1
s_cbranch_scc1 PU_HAVE_385
s_lshl_b32 s30, s27, 2
s_branch WF_386_in
WF_386:
s_sleep 2
WF_386_in:
buffer_load_dword v18, v15, s[8:11], s30 offen sc1
s_sub_u32 s16, s16, 1
s_cbranch_scc1 WFD_387_abort
s_waitcnt vmcnt(0)
v_cmp_eq_u32 vcc, 0, v18
s_cbranch_vccnz WF_386
WFD_387:
buffer_load_dwordx4 a[0:3], v12, s[8:11], s21 offen offset:0 sc1
buffer_load_dwordx4 a[4:7], v12, s[8:11], s21 offen offset:1024 sc1
buffer_load_dwordx4 a[32:35], v12, s[8:11], s21 offen offset:2048 sc1
buffer_load_dwordx4 a[36:39], v12, s[8:11], s21 offen offset:3072 sc1
s_add_u32 s21, s21, 28672
buffer_load_dwordx4 a[8:11], v12, s[8:11], s21 offen offset:0 sc1
buffer_load_dwordx4 a[12:15], v12, s[8:11], s21 offen offset:1024 sc1
buffer_load_dwordx4 a[40:43], v12, s[8:11], s21 offen offset:2048 sc1
buffer_load_dwordx4 a[44:47], v12, s[8:11], s21 offen offset:3072 sc1
s_add_u32 s21, s21, 28672
buffer_load_dwordx4 a[16:19], v12, s[8:11], s21 offen offset:0 sc1
buffer_load_dwordx4 a[20:23], v12, s[8:11], s21 offen offset:1024 sc1
buffer_load_dwordx4 a[48:51], v12, s[8:11], s21 offen offset:2048 sc1
buffer_load_dwordx4 a[52:55], v12, s[8:11], s21 offen offset:3072 sc1
s_add_u32 s21, s21, 28672
buffer_load_dwordx4 a[24:27], v12, s[8:11], s21 offen offset:0 sc1
buffer_load_dwordx4 a[28:31], v12, s[8:11], s21 offen offset:1024 sc1
buffer_load_dwordx4 a[56:59], v12, s[8:11], s21 offen offset:2048 sc1
buffer_load_dwordx4 a[60:63], v12, s[8:11], s21 offen offset:3072 sc1
s_add_u32 s21, s21, 831488
buffer_load_dwordx4 v[24:27], v10, s[8:11], s24 offen sc1
s_add_u32 s24, s24, 57344
PU_HAVE_385:
s_lshl_b32 s30, s27, 2
s_add_u32 s30, s30, 4096
s_add_u32 s31, s23, 4096
s_add_u32 s32, s23, 8192
s_branch POLL_388_in
POLL_388:
s_sleep 1
POLL_388_in:
buffer_load_dwordx4 v[224:227], v2, s[8:11], s32 offen offset:0 sc1
buffer_load_dwordx4 v[228:231], v2, s[8:11], s32 offen offset:1024 sc1
s_sub_u32 s16, s16, 1
s_cbranch_scc1 POLLD_389_abort
s_waitcnt vmcnt(0)
v_max3_u32 v18, v224, v225, v226
v_max3_u32 v18, v18, v227, v228
v_max3_u32 v18, v18, v229, v230
v_max_u32 v18, v18, v231
v_cmp_eq_u32 vcc, -1, v18
s_cbranch_vccnz POLL_388
POLLD_389:
PU_REDO_390:
buffer_load_dwordx4 v[192:195], v2, s[8:11], s23 offen offset:0 sc1
buffer_load_dwordx4 v[196:199], v2, s[8:11], s23 offen offset:1024 sc1
buffer_load_dwordx4 v[200:203], v2, s[8:11], s23 offen offset:2048 sc1
buffer_load_dwordx4 v[204:207], v2, s[8:11], s23 offen offset:3072 sc1
buffer_load_dwordx4 v[208:211], v2, s[8:11], s31 offen offset:0 sc1
buffer_load_dwordx4 v[212:215], v2, s[8:11], s31 offen offset:1024 sc1
buffer_load_dwordx4 v[216:219], v2, s[8:11], s31 offen offset:2048 sc1
buffer_load_dwordx4 v[220:223], v2, s[8:11], s31 offen offset:3072 sc1
buffer_load_dword v16, v15, s[8:11], s30 offen sc1
buffer_load_dwordx4 v[112:115], v13, s[8:11], s22 offen offset:0 sc1
buffer_load_dwordx4 v[120:123], v13, s[8:11], s29 offen offset:0 sc1
buffer_load_dwordx4 v[116:119], v13, s[8:11], s22 offen offset:512 sc1
buffer_load_dwordx4 v[124:127], v13, s[8:11], s29 offen offset:512 sc1
s_waitcnt vmcnt(12)
v_mfma_f32_32x32x16_bf16 v[48:63], a[0:3], v[192:195], 0
v_max3_u32 v19, v192, v193, 0
v_mfma_f32_32x32x16_bf16 v[64:79], a[32:35], v[192:195], 0
v_max3_u32 v19, v194, v195, v19
s_waitcnt vmcnt(11)
v_mfma_f32_32x32x16_bf16 v[48:63], a[4:7], v[196:199], v[48:63]
v_max3_u32 v19, v196, v197, v19
v_mfma_f32_32x32x16_bf16 v[64:79], a[36:39], v[196:199], v[64:79]
v_max3_u32 v19, v198, v199, v19
s_waitcnt vmcnt(10)
v_mfma_f32_32x32x16_bf16 v[48:63], a[8:11], v[200:203], v[48:63]
v_max3_u32 v19, v200, v201, v19
v_mfma_f32_32x32x16_bf16 v[64:79], a[40:43], v[200:203], v[64:79]
v_max3_u32 v19, v202, v203, v19
s_waitcnt vmcnt(9)
v_mfma_f32_32x32x16_bf16 v[48:63], a[12:15], v[204:207], v[48:63]
v_max3_u32 v19, v204, v205, v19
v_mfma_f32_32x32x16_bf16 v[64:79], a[44:47], v[204:207], v[64:79]
v_max3_u32 v19, v206, v207, v19
s_waitcnt vmcnt(8)
v_mfma_f32_32x32x16_bf16 v[48:63], a[16:19], v[208:211], v[48:63]
v_max3_u32 v19, v208, v209, v19
v_mfma_f32_32x32x16_bf16 v[64:79], a[48:51], v[208:211], v[64:79]
v_max3_u32 v19, v210, v211, v19
s_waitcnt vmcnt(7)
v_mfma_f32_32x32x16_bf16 v[48:63], a[20:23], v[212:215], v[48:63]
v_max3_u32 v19, v212, v213, v19
v_mfma_f32_32x32x16_bf16 v[64:79], a[52:55], v[212:215], v[64:79]
v_max3_u32 v19, v214, v215, v19
s_waitcnt vmcnt(6)
v_mfma_f32_32x32x16_bf16 v[48:63], a[24:27], v[216:219], v[48:63]
v_max3_u32 v19, v216, v217, v19
v_mfma_f32_32x32x16_bf16 v[64:79], a[56:59], v[216:219], v[64:79]
v_max3_u32 v19, v218, v219, v19
s_waitcnt vmcnt(5)
v_mfma_f32_32x32x16_bf16 v[48:63], a[28:31], v[220:223], v[48:63]
v_max3_u32 v19, v220, v221, v19
v_mfma_f32_32x32x16_bf16 v[64:79], a[60:63], v[220:223], v[64:79]
v_max3_u32 v19, v222, v223, v19
v_cmp_eq_u32 vcc, -1, v19
s_sub_u32 s17, s16, 1
s_cselect_b64 vcc, 0, vcc
s_max_i32 s16, s17, 0
s_nop 5
s_cbranch_vccnz PU_REDO_390
s_add_u32 s23, s23, 81920
s_add_u32 s27, s27, 1024
s_waitcnt vmcnt(0)
v_max3_u32 v18, v112, v113, v114
v_max3_u32 v18, v18, v115, v116
v_max3_u32 v18, v18, v117, v118
v_max3_u32 v18, v18, v119, v120
v_max3_u32 v18, v18, v121, v122
v_max3_u32 v18, v18, v123, v124
v_max3_u32 v18, v18, v125, v126
v_max_u32 v18, v18, v127
v_cmp_eq_u32 vcc, -1, v18
s_cbranch_vccz OPT_391
s_nop 2
s_branch POLL_392_in
POLL_392:
s_sleep 1
POLL_392_in:
buffer_load_dwordx4 v[112:115], v13, s[8:11], s22 offen offset:0 sc1
buffer_load_dwordx4 v[120:123], v13, s[8:11], s29 offen offset:0 sc1
buffer_load_dwordx4 v[116:119], v13, s[8:11], s22 offen offset:512 sc1
buffer_load_dwordx4 v[124:127], v13, s[8:11], s29 offen offset:512 sc1
s_sub_u32 s16, s16, 1
s_cbranch_scc1 POLLD_393_abort
s_waitcnt vmcnt(0)
v_max3_u32 v18, v112, v113, v114
v_max3_u32 v18, v18, v115, v116
v_max3_u32 v18, v18, v117, v118
v_max3_u32 v18, v18, v119, v120
v_max3_u32 v18, v18, v121, v122
v_max3_u32 v18, v18, v123, v124
v_max3_u32 v18, v18, v125, v126
v_max_u32 v18, v18, v127
v_cmp_eq_u32 vcc, -1, v18
s_cbranch_vccnz POLL_392
POLLD_393:
OPT_391:
s_add_u32 s22, s22, 229376
s_add_u32 s29, s29, 229376
v_mfma_f32_32x32x16_bf16 v[48:63], v[112:115], v[224:227], v[48:63]
v_mfma_f32_32x32x16_bf16 v[64:79], v[120:123], v[224:227], v[64:79]
v_mfma_f32_32x32x16_bf16 v[48:63], v[116:119], v[228:231], v[48:63]
v_mfma_f32_32x32x16_bf16 v[64:79], v[124:127], v[228:231], v[64:79]
s_nop 10
ds_write_b128 v32, v[48:51] offset:0
ds_write_b128 v32, v[52:55] offset:2560
ds_write_b128 v32, v[56:59] offset:1280
ds_write_b128 v32, v[60:63] offset:3840
ds_write_b128 v32, v[64:67] offset:5120
ds_write_b128 v32, v[68:71] offset:7680
ds_write_b128 v32, v[72:75] offset:6400
ds_write_b128 v32, v[76:79] offset:8960
s_waitcnt lgkmcnt(0)
s_barrier
ds_read_b128 v[80:83], v33 offset:0
ds_read_b128 v[84:87], v33 offset:1280
ds_read_b128 v[88:91], v33 offset:10240
ds_read_b128 v[92:95], v33 offset:11520
ds_read_b128 v[96:99], v33 offset:20480
ds_read_b128 v[100:103], v33 offset:21760
ds_read_b128 v[104:107], v33 offset:30720
ds_read_b128 v[108:111], v33 offset:32000
v_lshlrev_b32 v48, 16, v24
v_and_b32 v52, 0xffff0000, v24
v_lshlrev_b32 v49, 16, v25
v_and_b32 v53, 0xffff0000, v25
v_lshlrev_b32 v50, 16, v26
v_and_b32 v54, 0xffff0000, v26
v_lshlrev_b32 v51, 16, v27
v_and_b32 v55, 0xffff0000, v27
s_waitcnt lgkmcnt(6)
v_pk_add_f32 v[48:49], v[48:49], v[80:81]
v_pk_add_f32 v[50:51], v[50:51], v[82:83]
v_pk_add_f32 v[52:53], v[52:53], v[84:85]
v_pk_add_f32 v[54:55], v[54:55], v[86:87]
s_waitcnt lgkmcnt(4)
v_pk_add_f32 v[48:49], v[48:49], v[88:89]
v_pk_add_f32 v[50:51], v[50:51], v[90:91]
v_pk_add_f32 v[52:53], v[52:53], v[92:93]
v_pk_add_f32 v[54:55], v[54:55], v[94:95]
s_waitcnt lgkmcnt(2)
v_pk_add_f32 v[48:49], v[48:49], v[96:97]
v_pk_add_f32 v[50:51], v[50:51], v[98:99]
v_pk_add_f32 v[52:53], v[52:53], v[100:101]
v_pk_add_f32 v[54:55], v[54:55], v[102:103]
s_waitcnt lgkmcnt(0)
v_pk_add_f32 v[48:49], v[48:49], v[104:105]
v_pk_add_f32 v[50:51], v[50:51], v[106:107]
v_pk_add_f32 v[52:53], v[52:53], v[108:109]
v_pk_add_f32 v[54:55], v[54:55], v[110:111]
v_cvt_pk_bf16_f32 v24, v48, v52
v_cvt_pk_bf16_f32 v25, v49, v53
v_cvt_pk_bf16_f32 v26, v50, v54
v_cvt_pk_bf16_f32 v27, v51, v55
buffer_store_dwordx4 v[24:27], v10, s[8:11], s25 offen sc1
v_lshlrev_b32 v48, 16, v24
v_and_b32 v49, 0xffff0000, v24
v_lshlrev_b32 v50, 16, v25
v_and_b32 v51, 0xffff0000, v25
v_lshlrev_b32 v52, 16, v26
v_and_b32 v53, 0xffff0000, v26
v_lshlrev_b32 v54, 16, v27
v_and_b32 v55, 0xffff0000, v27
v_pk_add_f32 v[80:81], v[48:49], v[50:51]
v_pk_mul_f32 v[82:83], v[48:49], v[48:49]
v_pk_add_f32 v[84:85], v[52:53], v[54:55]
v_pk_fma_f32 v[82:83], v[50:51], v[50:51], v[82:83]
v_pk_fma_f32 v[82:83], v[52:53], v[52:53], v[82:83]
v_pk_fma_f32 v[82:83], v[54:55], v[54:55], v[82:83]
v_pk_add_f32 v[80:81], v[80:81], v[84:85]
v_add_f32 v80, v80, v81
v_add_f32 v81, v82, v83
s_nop 0
v_add_f32_dpp v80, v80, v80 row_ror:8 row_mask:0xf bank_mask:0xf
v_add_f32_dpp v81, v81, v81 row_ror:8 row_mask:0xf bank_mask:0xf
v_mov_b32 v82, v80
v_mov_b32 v83, v81
s_nop 0
v_permlane16_swap_b32 v80, v82
v_permlane16_swap_b32 v81, v83
v_pk_add_f32 v[80:81], v[80:81], v[82:83]
v_mov_b32 v82, v80
v_mov_b32 v83, v81
s_nop 0
v_permlane32_swap_b32 v80, v82
v_permlane32_swap_b32 v81, v83
v_pk_add_f32 v[80:81], v[80:81], v[82:83]
s_mov_b64 exec, s[36:37]
buffer_store_dwordx2 v[80:81], v11, s[8:11], s26 offen sc1
s_mov_b64 exec, -1
v_cmp_eq_u32 vcc, 0, v16
s_mov_b32 s33, 0
s_cmp_ge_u32 s15, 62
s_cselect_b64 vcc, -1, vcc
s_cbranch_vccnz PU_NR_394
s_mov_b32 s33, 1
buffer_load_dwordx4 a[0:3], v12, s[8:11], s21 offen offset:0 sc1
buffer_load_dwordx4 a[4:7], v12, s[8:11], s21 offen offset:1024 sc1
buffer_load_dwordx4 a[32:35], v12, s[8:11], s21 offen offset:2048 sc1
buffer_load_dwordx4 a[36:39], v12, s[8:11], s21 offen offset:3072 sc1
s_add_u32 s21, s21, 28672
buffer_load_dwordx4 a[8:11], v12, s[8:11], s21 offen offset:0 sc1
buffer_load_dwordx4 a[12:15], v12, s[8:11], s21 offen offset:1024 sc1
buffer_load_dwordx4 a[40:43], v12, s[8:11], s21 offen offset:2048 sc1
buffer_load_dwordx4 a[44:47], v12, s[8:11], s21 offen offset:3072 sc1
s_add_u32 s21, s21, 28672
buffer_load_dwordx4 a[16:19], v12, s[8:11], s21 offen offset:0 sc1
buffer_load_dwordx4 a[20:23], v12, s[8:11], s21 offen offset:1024 sc1
s_waitcnt vmcnt(10)
s_mov_b64 exec, 1
buffer_store_dword v5, v4, s[8:11], s28 offen sc1
s_mov_b64 exec, -1
buffer_load_dwordx4 a[48:51], v12, s[8:11], s21 offen offset:2048 sc1
buffer_load_dwordx4 a[52:55], v12, s[8:11], s21 offen offset:3072 sc1
s_add_u32 s21, s21, 28672
buffer_load_dwordx4 a[24:27], v12, s[8:11], s21 offen offset:0 sc1
buffer_load_dwordx4 a[28:31], v12, s[8:11], s21 offen offset:1024 sc1
buffer_load_dwordx4 a[56:59], v12, s[8:11], s21 offen offset:2048 sc1
buffer_load_dwordx4 a[60:63], v12, s[8:11], s21 offen offset:3072 sc1
s_add_u32 s21, s21, 831488
buffer_load_dwordx4 v[20:23], v10, s[8:11], s24 offen sc1
s_add_u32 s24, s24, 57344
s_branch PU_JN_395
PU_NR_394:
s_waitcnt vmcnt(0)
s_mov_b64 exec, 1
buffer_store_dword v5, v4, s[8:11], s28 offen sc1
s_mov_b64 exec, -1
PU_JN_395:
s_add_u32 s25, s25, 57344
s_add_u32 s26, s26, 4096
s_add_u32 s28, s28, 1024
s_add_u32 s15, s15, 2
s_cmp_lt_u32 s15, 64
s_cbranch_scc1 PU_LOOP_371
s_endpgm
M_F2:
s_sub_u32 s13, s13, 21
s_load_dwordx4 s[48:51], s[0:1], 80
s_lshl_b32 s17, s13, 2
s_add_u32 s17, s17, s12
v_lshlrev_b32 v2, 4, v1
v_lshrrev_b32 v18, 3, v1
v_mul_u32_u24 v112, 896, v18
v_and_b32 v18, 7, v1
v_lshl_add_u32 v112, v18, 4, v112
s_mul_i32 s19, s12, 401408
s_lshl_b32 s18, s13, 7
s_add_u32 s19, s19, s18
s_waitcnt lgkmcnt(0)
s_mov_b32 s44, s48
s_and_b32 s45, s49, 0xffff
s_mov_b32 s46, 1605632
s_mov_b32 s47, 0x00020000
s_mov_b32 s40, s50
s_and_b32 s41, s51, 0xffff
s_mov_b32 s42, 1835008
s_mov_b32 s43, 0x00020000
s_mul_i32 s38, s12, 40960
v_lshrrev_b32 v18, 5, v1
v_bfe_u32 v19, v1, 2, 2
v_lshl_add_u32 v113, v18, 3, v19
v_lshlrev_b32 v113, 7, v113
v_bfe_u32 v18, v1, 4, 1
v_lshl_add_u32 v113, v18, 5, v113
v_and_b32 v18, 1, v1
v_lshl_add_u32 v113, v18, 4, v113
v_bfe_u32 v18, v1, 1, 1
v_lshl_add_u32 v113, v18, 3, v113
v_add_u32 v113, s38, v113
s_add_u32 m0, s38, 0
s_nop 0
buffer_load_dwordx4 v112, s[44:47], s19 offen lds
s_add_u32 s19, s19, 7168
s_add_u32 m0, s38, 1024
s_nop 0
buffer_load_dwordx4 v112, s[44:47], s19 offen lds
s_add_u32 s19, s19, 7168
s_add_u32 m0, s38, 2048
s_nop 0
buffer_load_dwordx4 v112, s[44:47], s19 offen lds
s_add_u32 s19, s19, 7168
s_add_u32 m0, s38, 3072
s_nop 0
buffer_load_dwordx4 v112, s[44:47], s19 offen lds
s_add_u32 s19, s19, 7168
s_add_u32 m0, s38, 4096
s_nop 0
buffer_load_dwordx4 v112, s[44:47], s19 offen lds
s_add_u32 s19, s19, 7168
s_add_u32 m0, s38, 5120
s_nop 0
buffer_load_dwordx4 v112, s[44:47], s19 offen lds
s_add_u32 s19, s19, 7168
s_add_u32 m0, s38, 6144
s_nop 0
buffer_load_dwordx4 v112, s[44:47], s19 offen lds
s_add_u32 s19, s19, 7168
s_add_u32 m0, s38, 7168
s_nop 0
buffer_load_dwordx4 v112, s[44:47], s19 offen lds
s_add_u32 s19, s19, 7168
s_add_u32 m0, s38, 8192
s_nop 0
buffer_load_dwordx4 v112, s[44:47], s19 offen lds
s_add_u32 s19, s19, 7168
s_add_u32 m0, s38, 9216
s_nop 0
buffer_load_dwordx4 v112, s[44:47], s19 offen lds
s_add_u32 s19, s19, 7168
s_add_u32 m0, s38, 10240
s_nop 0
buffer_load_dwordx4 v112, s[44:47], s19 offen lds
s_add_u32 s19, s19, 7168
s_add_u32 m0, s38, 11264
s_nop 0
buffer_load_dwordx4 v112, s[44:47], s19 offen lds
s_add_u32 s19, s19, 7168
s_add_u32 m0, s38, 12288
s_nop 0
buffer_load_dwordx4 v112, s[44:47], s19 offen lds
s_add_u32 s19, s19, 7168
s_add_u32 m0, s38, 13312
s_nop 0
buffer_load_dwordx4 v112, s[44:47], s19 offen lds
s_add_u32 s19, s19, 7168
s_add_u32 m0, s38, 14336
s_nop 0
buffer_load_dwordx4 v112, s[44:47], s19 offen lds
s_add_u32 s19, s19, 7168
s_add_u32 m0, s38, 15360
s_nop 0
buffer_load_dwordx4 v112, s[44:47], s19 offen lds
s_add_u32 s19, s19, 7168
s_add_u32 m0, s38, 16384
s_nop 0
buffer_load_dwordx4 v112, s[44:47], s19 offen lds
s_add_u32 s19, s19, 7168
s_add_u32 m0, s38, 17408
s_nop 0
buffer_load_dwordx4 v112, s[44:47], s19 offen lds
s_add_u32 s19, s19, 7168
s_add_u32 m0, s38, 18432
s_nop 0
buffer_load_dwordx4 v112, s[44:47], s19 offen lds
s_add_u32 s19, s19, 7168
s_add_u32 m0, s38, 19456
s_nop 0
buffer_load_dwordx4 v112, s[44:47], s19 offen lds
s_add_u32 s19, s19, 7168
s_add_u32 m0, s38, 20480
s_nop 0
buffer_load_dwordx4 v112, s[44:47], s19 offen lds
s_add_u32 s19, s19, 7168
s_add_u32 m0, s38, 21504
s_nop 0
buffer_load_dwordx4 v112, s[44:47], s19 offen lds
s_add_u32 s19, s19, 7168
s_add_u32 m0, s38, 22528
s_nop 0
buffer_load_dwordx4 v112, s[44:47], s19 offen lds
s_add_u32 s19, s19, 7168
s_add_u32 m0, s38, 23552
s_nop 0
buffer_load_dwordx4 v112, s[44:47], s19 offen lds
s_add_u32 s19, s19, 7168
s_add_u32 m0, s38, 24576
s_nop 0
buffer_load_dwordx4 v112, s[44:47], s19 offen lds
s_add_u32 s19, s19, 7168
s_add_u32 m0, s38, 25600
s_nop 0
buffer_load_dwordx4 v112, s[44:47], s19 offen lds
s_add_u32 s19, s19, 7168
s_add_u32 m0, s38, 26624
s_nop 0
buffer_load_dwordx4 v112, s[44:47], s19 offen lds
s_add_u32 s19, s19, 7168
s_add_u32 m0, s38, 27648
s_nop 0
buffer_load_dwordx4 v112, s[44:47], s19 offen lds
s_add_u32 s19, s19, 7168
s_add_u32 m0, s38, 28672
s_nop 0
buffer_load_dwordx4 v112, s[44:47], s19 offen lds
s_add_u32 s19, s19, 7168
s_add_u32 m0, s38, 29696
s_nop 0
buffer_load_dwordx4 v112, s[44:47], s19 offen lds
s_add_u32 s19, s19, 7168
s_add_u32 m0, s38, 30720
s_nop 0
buffer_load_dwordx4 v112, s[44:47], s19 offen lds
s_add_u32 s19, s19, 7168
s_add_u32 m0, s38, 31744
s_nop 0
buffer_load_dwordx4 v112, s[44:47], s19 offen lds
s_add_u32 s19, s19, 7168
s_add_u32 m0, s38, 32768
s_nop 0
buffer_load_dwordx4 v112, s[44:47], s19 offen lds
s_add_u32 s19, s19, 7168
s_add_u32 m0, s38, 33792
s_nop 0
buffer_load_dwordx4 v112, s[44:47], s19 offen lds
s_add_u32 s19, s19, 7168
s_add_u32 m0, s38, 34816
s_nop 0
buffer_load_dwordx4 v112, s[44:47], s19 offen lds
s_add_u32 s19, s19, 7168
s_add_u32 m0, s38, 35840
s_nop 0
buffer_load_dwordx4 v112, s[44:47], s19 offen lds
s_add_u32 s19, s19, 7168
s_add_u32 m0, s38, 36864
s_nop 0
buffer_load_dwordx4 v112, s[44:47], s19 offen lds
s_add_u32 s19, s19, 7168
s_add_u32 m0, s38, 37888
s_nop 0
buffer_load_dwordx4 v112, s[44:47], s19 offen lds
s_add_u32 s19, s19, 7168
s_add_u32 m0, s38, 38912
s_nop 0
buffer_load_dwordx4 v112, s[44:47], s19 offen lds
s_add_u32 s19, s19, 7168
s_add_u32 m0, s38, 39936
s_nop 0
buffer_load_dwordx4 v112, s[44:47], s19 offen lds
s_add_u32 s19, s19, 7168
s_waitcnt vmcnt(20)
ds_read_b64_tr_b16 a[0:1], v113 offset:0
ds_read_b64_tr_b16 a[2:3], v113 offset:512
ds_read_b64_tr_b16 a[112:113], v113 offset:64
ds_read_b64_tr_b16 a[114:115], v113 offset:576
ds_read_b64_tr_b16 a[4:5], v113 offset:2048
ds_read_b64_tr_b16 a[6:7], v113 offset:2560
ds_read_b64_tr_b16 a[116:117], v113 offset:2112
ds_read_b64_tr_b16 a[118:119], v113 offset:2624
ds_read_b64_tr_b16 a[8:9], v113 offset:4096
ds_read_b64_tr_b16 a[10:11], v113 offset:4608
ds_read_b64_tr_b16 a[120:121], v113 offset:4160
ds_read_b64_tr_b16 a[122:123], v113 offset:4672
ds_read_b64_tr_b16 a[12:13], v113 offset:6144
ds_read_b64_tr_b16 a[14:15], v113 offset:6656
ds_read_b64_tr_b16 a[124:125], v113 offset:6208
ds_read_b64_tr_b16 a[126:127], v113 offset:6720
ds_read_b64_tr_b16 a[16:17], v113 offset:8192
ds_read_b64_tr_b16 a[18:19], v113 offset:8704
ds_read_b64_tr_b16 a[128:129], v113 offset:8256
ds_read_b64_tr_b16 a[130:131], v113 offset:8768
ds_read_b64_tr_b16 a[20:21], v113 offset:10240
ds_read_b64_tr_b16 a[22:23], v113 offset:10752
ds_read_b64_tr_b16 a[132:133], v113 offset:10304
ds_read_b64_tr_b16 a[134:135], v113 offset:10816
ds_read_b64_tr_b16 a[24:25], v113 offset:12288
ds_read_b64_tr_b16 a[26:27], v113 offset:12800
ds_read_b64_tr_b16 a[136:137], v113 offset:12352
ds_read_b64_tr_b16 a[138:139], v113 offset:12864
ds_read_b64_tr_b16 a[28:29], v113 offset:14336
ds_read_b64_tr_b16 a[30:31], v113 offset:14848
ds_read_b64_tr_b16 a[140:141], v113 offset:14400
ds_read_b64_tr_b16 a[142:143], v113 offset:14912
ds_read_b64_tr_b16 a[32:33], v113 offset:16384
ds_read_b64_tr_b16 a[34:35], v113 offset:16896
ds_read_b64_tr_b16 a[144:145], v113 offset:16448
ds_read_b64_tr_b16 a[146:147], v113 offset:16960
ds_read_b64_tr_b16 a[36:37], v113 offset:18432
ds_read_b64_tr_b16 a[38:39], v113 offset:18944
ds_read_b64_tr_b16 a[148:149], v113 offset:18496
ds_read_b64_tr_b16 a[150:151], v113 offset:19008
s_waitcnt lgkmcnt(0)
s_add_u32 m0, s38, 0
s_nop 0
buffer_load_dwordx4 v112, s[44:47], s19 offen lds
s_add_u32 s19, s19, 7168
s_add_u32 m0, s38, 1024
s_nop 0
buffer_load_dwordx4 v112, s[44:47], s19 offen lds
s_add_u32 s19, s19, 7168
s_add_u32 m0, s38, 2048
s_nop 0
buffer_load_dwordx4 v112, s[44:47], s19 offen lds
s_add_u32 s19, s19, 7168
s_add_u32 m0, s38, 3072
s_nop 0
buffer_load_dwordx4 v112, s[44:47], s19 offen lds
s_add_u32 s19, s19, 7168
s_add_u32 m0, s38, 4096
s_nop 0
buffer_load_dwordx4 v112, s[44:47], s19 offen lds
s_add_u32 s19, s19, 7168
s_add_u32 m0, s38, 5120
s_nop 0
buffer_load_dwordx4 v112, s[44:47], s19 offen lds
s_add_u32 s19, s19, 7168
s_add_u32 m0, s38, 6144
s_nop 0
buffer_load_dwordx4 v112, s[44:47], s19 offen lds
s_add_u32 s19, s19, 7168
s_add_u32 m0, s38, 7168
s_nop 0
buffer_load_dwordx4 v112, s[44:47], s19 offen lds
s_add_u32 s19, s19, 7168
s_add_u32 m0, s38, 8192
s_nop 0
buffer_load_dwordx4 v112, s[44:47], s19 offen lds
s_add_u32 s19, s19, 7168
s_add_u32 m0, s38, 9216
s_nop 0
buffer_load_dwordx4 v112, s[44:47], s19 offen lds
s_add_u32 s19, s19, 7168
s_add_u32 m0, s38, 10240
s_nop 0
buffer_load_dwordx4 v112, s[44:47], s19 offen lds
s_add_u32 s19, s19, 7168
s_add_u32 m0, s38, 11264
s_nop 0
buffer_load_dwordx4 v112, s[44:47], s19 offen lds
s_add_u32 s19, s19, 7168
s_add_u32 m0, s38, 12288
s_nop 0
buffer_load_dwordx4 v112, s[44:47], s19 offen lds
s_add_u32 s19, s19, 7168
s_add_u32 m0, s38, 13312
s_nop 0
buffer_load_dwordx4 v112, s[44:47], s19 offen lds
s_add_u32 s19, s19, 7168
s_add_u32 m0, s38, 14336
s_nop 0
buffer_load_dwordx4 v112, s[44:47], s19 offen lds
s_add_u32 s19, s19, 7168
s_add_u32 m0, s38, 15360
s_nop 0
buffer_load_dwordx4 v112, s[44:47], s19 offen lds
s_add_u32 s19, s19, 7168
s_waitcnt vmcnt(16)
ds_read_b64_tr_b16 a[40:41], v113 offset:20480
ds_read_b64_tr_b16 a[42:43], v113 offset:20992
ds_read_b64_tr_b16 a[152:153], v113 offset:20544
ds_read_b64_tr_b16 a[154:155], v113 offset:21056
ds_read_b64_tr_b16 a[44:45], v113 offset:22528
ds_read_b64_tr_b16 a[46:47], v113 offset:23040
ds_read_b64_tr_b16 a[156:157], v113 offset:22592
ds_read_b64_tr_b16 a[158:159], v113 offset:23104
ds_read_b64_tr_b16 a[48:49], v113 offset:24576
ds_read_b64_tr_b16 a[50:51], v113 offset:25088
ds_read_b64_tr_b16 a[160:161], v113 offset:24640
ds_read_b64_tr_b16 a[162:163], v113 offset:25152
ds_read_b64_tr_b16 a[52:53], v113 offset:26624
ds_read_b64_tr_b16 a[54:55], v113 offset:27136
ds_read_b64_tr_b16 a[164:165], v113 offset:26688
ds_read_b64_tr_b16 a[166:167], v113 offset:27200
ds_read_b64_tr_b16 a[56:57], v113 offset:28672
ds_read_b64_tr_b16 a[58:59], v113 offset:29184
ds_read_b64_tr_b16 a[168:169], v113 offset:28736
ds_read_b64_tr_b16 a[170:171], v113 offset:29248
ds_read_b64_tr_b16 a[60:61], v113 offset:30720
ds_read_b64_tr_b16 a[62:63], v113 offset:31232
ds_read_b64_tr_b16 a[172:173], v113 offset:30784
ds_read_b64_tr_b16 a[174:175], v113 offset:31296
ds_read_b64_tr_b16 a[64:65], v113 offset:32768
ds_read_b64_tr_b16 a[66:67], v113 offset:33280
ds_read_b64_tr_b16 a[176:177], v113 offset:32832
ds_read_b64_tr_b16 a[178:179], v113 offset:33344
ds_read_b64_tr_b16 a[68:69], v113 offset:34816
ds_read_b64_tr_b16 a[70:71], v113 offset:35328
ds_read_b64_tr_b16 a[180:181], v113 offset:34880
ds_read_b64_tr_b16 a[182:183], v113 offset:35392
ds_read_b64_tr_b16 a[72:73], v113 offset:36864
ds_read_b64_tr_b16 a[74:75], v113 offset:37376
ds_read_b64_tr_b16 a[184:185], v113 offset:36928
ds_read_b64_tr_b16 a[186:187], v113 offset:37440
ds_read_b64_tr_b16 a[76:77], v113 offset:38912
ds_read_b64_tr_b16 a[78:79], v113 offset:39424
ds_read_b64_tr_b16 a[188:189], v113 offset:38976
ds_read_b64_tr_b16 a[190:191], v113 offset:39488
s_waitcnt lgkmcnt(0)
s_getpc_b64 s[54:55]
WCODE_396:
s_sub_u32 s54, s54, WCODE_396-K_START
s_subb_u32 s55, s55, 0
v_mbcnt_lo_u32_b32 v18, -1, 0
v_mbcnt_hi_u32_b32 v18, -1, v18
v_lshl_add_u32 v18, v18, 5, s91
v_lshlrev_b32 v18, 6, v18
v_min_u32 v18, K_END-K_START-4, v18
global_load_dword v18, v18, s[54:55]
s_waitcnt vmcnt(0)
ds_read_b64_tr_b16 a[80:81], v113 offset:0
ds_read_b64_tr_b16 a[82:83], v113 offset:512
ds_read_b64_tr_b16 a[192:193], v113 offset:64
ds_read_b64_tr_b16 a[194:195], v113 offset:576
ds_read_b64_tr_b16 a[84:85], v113 offset:2048
ds_read_b64_tr_b16 a[86:87], v113 offset:2560
ds_read_b64_tr_b16 a[196:197], v113 offset:2112
ds_read_b64_tr_b16 a[198:199], v113 offset:2624
ds_read_b64_tr_b16 a[88:89], v113 offset:4096
ds_read_b64_tr_b16 a[90:91], v113 offset:4608
ds_read_b64_tr_b16 a[200:201], v113 offset:4160
ds_read_b64_tr_b16 a[202:203], v113 offset:4672
ds_read_b64_tr_b16 a[92:93], v113 offset:6144
ds_read_b64_tr_b16 a[94:95], v113 offset:6656
ds_read_b64_tr_b16 a[204:205], v113 offset:6208
ds_read_b64_tr_b16 a[206:207], v113 offset:6720
ds_read_b64_tr_b16 a[96:97], v113 offset:8192
ds_read_b64_tr_b16 a[98:99], v113 offset:8704
ds_read_b64_tr_b16 a[208:209], v113 offset:8256
ds_read_b64_tr_b16 a[210:211], v113 offset:8768
ds_read_b64_tr_b16 a[100:101], v113 offset:10240
ds_read_b64_tr_b16 a[102:103], v113 offset:10752
ds_read_b64_tr_b16 a[212:213], v113 offset:10304
ds_read_b64_tr_b16 a[214:215], v113 offset:10816
ds_read_b64_tr_b16 a[104:105], v113 offset:12288
ds_read_b64_tr_b16 a[106:107], v113 offset:12800
ds_read_b64_tr_b16 a[216:217], v113 offset:12352
ds_read_b64_tr_b16 a[218:219], v113 offset:12864
ds_read_b64_tr_b16 a[108:109], v113 offset:14336
ds_read_b64_tr_b16 a[110:111], v113 offset:14848
ds_read_b64_tr_b16 a[220:221], v113 offset:14400
ds_read_b64_tr_b16 a[222:223], v113 offset:14912
s_waitcnt lgkmcnt(0)
s_barrier
s_mul_i32 s25, s14, 7340032
s_mul_i32 s18, s12, 28672
s_add_u32 s25, s25, s18
s_add_u32 s25, s25, 77594624
s_lshl_b32 s18, s14, 15
s_mul_i32 s29, s12, 56
s_add_u32 s29, s29, s18
s_add_u32 s29, s29, 38010880
s_lshl_b32 s30, s17, 2
s_add_u32 s30, s30, s18
s_add_u32 s30, s30, 38076416
s_lshr_b32 s18, s13, 1
s_mul_i32 s18, s18, 96
s_add_u32 s30, s30, s18
s_mul_i32 s26, s14, 3670016
s_add_u32 s26, s26, 45875200
s_mov_b32 s27, 47710208
s_mov_b32 s28, 39583744
v_mov_b32 v4, 0
v_mov_b32 v5, 1
v_min_u32 v7, 13, v1
v_lshlrev_b32 v7, 2, v7
s_mov_b32 s15, 0
s_mov_b32 s35, 0
v_lshrrev_b32 v18, 5, v1
v_mul_u32_u24 v8, 640, v18
v_and_b32 v18, 31, v1
v_lshl_add_u32 v8, v18, 4, v8
s_mul_i32 s17, s12, 10240
s_add_u32 s17, s17, 0
v_add_u32 v8, s17, v8
v_bfe_u32 v18, v1, 3, 1
v_mul_u32_u24 v9, 640, v18
v_bfe_u32 v18, v1, 4, 1
v_mul_u32_u24 v18, 2560, v18
v_add_u32 v9, v9, v18
v_bfe_u32 v18, v1, 5, 1
v_mul_u32_u24 v18, 5120, v18
v_add_u32 v9, v9, v18
v_and_b32 v18, 7, v1
s_lshl_b32 s17, s12, 3
v_add_u32 v18, s17, v18
v_lshl_add_u32 v9, v18, 4, v9
v_add_u32 v9, 0, v9
v_lshrrev_b32 v10, 3, v1
s_lshl_b32 s17, s13, 3
v_add_u32 v10, s17, v10
v_lshlrev_b32 v10, 9, v10
v_lshl_add_u32 v10, v18, 4, v10
s_lshr_b32 s18, s13, 1
s_lshl_b32 s18, s18, 9
s_and_b32 s19, s17, 8
s_add_u32 s18, s18, s19
v_lshlrev_b32 v11, 4, v18
v_add_u32 v11, s18, v11
s_mov_b32 s36, 0xff
s_mov_b32 s37, 0
v_mul_u32_u24 v12, 896, v18
v_lshrrev_b32 v18, 3, v1
v_add_u32 v18, s17, v18
v_lshl_add_u32 v12, v18, 4, v12
v_add_u32 v14, 40960, v8
v_add_u32 v15, 40960, v9
s_cmp_eq_u32 s14, 1
s_cbranch_scc1 F2_L1_397
v_mov_b32 v13, 0
s_nop 1
F2_C0_398:
v_cmp_eq_u32 vcc, 0, v13
s_cbranch_vccz OPT_404
s_nop 2
s_branch WF_405_in
WF_405:
s_sleep 1
WF_405_in:
buffer_load_dword v18, v7, s[8:11], s29 offen sc1
s_sub_u32 s16, s16, 1
s_cbranch_scc1 WFD_406_abort
s_waitcnt vmcnt(0)
v_cmp_eq_u32 vcc, 0, v18
s_cbranch_vccnz WF_405
WFD_406:
OPT_404:
buffer_load_dwordx4 v[112:115], v2, s[8:11], s25 offen offset:0 sc1
buffer_load_dwordx4 v[116:119], v2, s[8:11], s25 offen offset:1024 sc1
buffer_load_dwordx4 v[120:123], v2, s[8:11], s25 offen offset:2048 sc1
buffer_load_dwordx4 v[124:127], v2, s[8:11], s25 offen offset:3072 sc1
s_add_u32 s25, s25, 4096
buffer_load_dwordx4 v[128:131], v2, s[8:11], s25 offen offset:0 sc1
buffer_load_dwordx4 v[132:135], v2, s[8:11], s25 offen offset:1024 sc1
buffer_load_dwordx4 v[136:139], v2, s[8:11], s25 offen offset:2048 sc1
buffer_load_dwordx4 v[140:143], v2, s[8:11], s25 offen offset:3072 sc1
s_add_u32 s25, s25, 4096
buffer_load_dwordx4 v[144:147], v2, s[8:11], s25 offen offset:0 sc1
buffer_load_dwordx4 v[148:151], v2, s[8:11], s25 offen offset:1024 sc1
buffer_load_dwordx4 v[152:155], v2, s[8:11], s25 offen offset:2048 sc1
buffer_load_dwordx4 v[156:159], v2, s[8:11], s25 offen offset:3072 sc1
s_add_u32 s25, s25, 4096
s_add_u32 s29, s29, 512
s_mov_b32 s32, 1
s_waitcnt vmcnt(11)
v_mfma_f32_32x32x16_bf16 v[48:63], a[0:3], v[112:115], 0
buffer_load_dwordx4 v[160:163], v2, s[8:11], s25 offen offset:0 sc1
v_mfma_f32_32x32x16_bf16 v[64:79], a[112:115], v[112:115], 0
s_waitcnt vmcnt(11)
v_mfma_f32_32x32x16_bf16 v[48:63], a[4:7], v[116:119], v[48:63]
buffer_load_dwordx4 v[164:167], v2, s[8:11], s25 offen offset:1024 sc1
v_mfma_f32_32x32x16_bf16 v[64:79], a[116:119], v[116:119], v[64:79]
s_waitcnt vmcnt(11)
v_mfma_f32_32x32x16_bf16 v[48:63], a[8:11], v[120:123], v[48:63]
buffer_load_dwordx4 v[168:171], v2, s[8:11], s25 offen offset:2048 sc1
v_mfma_f32_32x32x16_bf16 v[64:79], a[120:123], v[120:123], v[64:79]
s_waitcnt vmcnt(11)
v_mfma_f32_32x32x16_bf16 v[48:63], a[12:15], v[124:127], v[48:63]
buffer_load_dword v13, v7, s[8:11], s29 offen sc1
buffer_load_dwordx4 v[172:175], v2, s[8:11], s25 offen offset:3072 sc1
s_add_u32 s25, s25, 4096
v_mfma_f32_32x32x16_bf16 v[64:79], a[124:127], v[124:127], v[64:79]
s_waitcnt vmcnt(12)
v_mfma_f32_32x32x16_bf16 v[48:63], a[16:19], v[128:131], v[48:63]
buffer_load_dwordx4 v[176:179], v2, s[8:11], s25 offen offset:0 sc1
v_mfma_f32_32x32x16_bf16 v[64:79], a[128:131], v[128:131], v[64:79]
s_waitcnt vmcnt(12)
v_mfma_f32_32x32x16_bf16 v[48:63], a[20:23], v[132:135], v[48:63]
buffer_load_dwordx4 v[180:183], v2, s[8:11], s25 offen offset:1024 sc1
v_mfma_f32_32x32x16_bf16 v[64:79], a[132:135], v[132:135], v[64:79]
s_waitcnt vmcnt(12)
v_mfma_f32_32x32x16_bf16 v[48:63], a[24:27], v[136:139], v[48:63]
buffer_load_dwordx4 v[184:187], v2, s[8:11], s25 offen offset:2048 sc1
v_mfma_f32_32x32x16_bf16 v[64:79], a[136:139], v[136:139], v[64:79]
s_waitcnt vmcnt(12)
v_mfma_f32_32x32x16_bf16 v[48:63], a[28:31], v[140:143], v[48:63]
buffer_load_dwordx4 v[188:191], v2, s[8:11], s25 offen offset:3072 sc1
s_add_u32 s25, s25, 4096
v_mfma_f32_32x32x16_bf16 v[64:79], a[140:143], v[140:143], v[64:79]
s_waitcnt vmcnt(12)
v_mfma_f32_32x32x16_bf16 v[48:63], a[32:35], v[144:147], v[48:63]
buffer_load_dwordx4 v[192:195], v2, s[8:11], s25 offen offset:0 sc1
v_mfma_f32_32x32x16_bf16 v[64:79], a[144:147], v[144:147], v[64:79]
s_waitcnt vmcnt(12)
v_mfma_f32_32x32x16_bf16 v[48:63], a[36:39], v[148:151], v[48:63]
buffer_load_dwordx4 v[196:199], v2, s[8:11], s25 offen offset:1024 sc1
v_mfma_f32_32x32x16_bf16 v[64:79], a[148:151], v[148:151], v[64:79]
s_waitcnt vmcnt(12)
v_mfma_f32_32x32x16_bf16 v[48:63], a[40:43], v[152:155], v[48:63]
buffer_load_dwordx4 v[200:203], v2, s[8:11], s25 offen offset:2048 sc1
v_mfma_f32_32x32x16_bf16 v[64:79], a[152:155], v[152:155], v[64:79]
s_waitcnt vmcnt(12)
v_mfma_f32_32x32x16_bf16 v[48:63], a[44:47], v[156:159], v[48:63]
buffer_load_dwordx4 v[204:207], v2, s[8:11], s25 offen offset:3072 sc1
s_add_u32 s25, s25, 4096
v_mfma_f32_32x32x16_bf16 v[64:79], a[156:159], v[156:159], v[64:79]
s_waitcnt vmcnt(12)
v_mfma_f32_32x32x16_bf16 v[48:63], a[48:51], v[160:163], v[48:63]
buffer_load_dwordx4 v[208:211], v2, s[8:11], s25 offen offset:0 sc1
v_mfma_f32_32x32x16_bf16 v[64:79], a[160:163], v[160:163], v[64:79]
s_waitcnt vmcnt(12)
v_mfma_f32_32x32x16_bf16 v[48:63], a[52:55], v[164:167], v[48:63]
buffer_load_dwordx4 v[212:215], v2, s[8:11], s25 offen offset:1024 sc1
v_mfma_f32_32x32x16_bf16 v[64:79], a[164:167], v[164:167], v[64:79]
s_waitcnt vmcnt(12)
v_mfma_f32_32x32x16_bf16 v[48:63], a[56:59], v[168:171], v[48:63]
buffer_load_dwordx4 v[216:219], v2, s[8:11], s25 offen offset:2048 sc1
v_mfma_f32_32x32x16_bf16 v[64:79], a[168:171], v[168:171], v[64:79]
s_waitcnt vmcnt(11)
v_mfma_f32_32x32x16_bf16 v[48:63], a[60:63], v[172:175], v[48:63]
buffer_load_dwordx4 v[20:23], v10, s[8:11], s26 offen sc1
s_add_u32 s26, s26, 28672
buffer_load_dwordx4 v[220:223], v2, s[8:11], s25 offen offset:3072 sc1
s_add_u32 s25, s25, 90112
v_mfma_f32_32x32x16_bf16 v[64:79], a[172:175], v[172:175], v[64:79]
s_add_u32 s15, s15, 1
v_cmp_eq_u32 vcc, 0, v13
s_cmp_eq_u32 s15, 64
s_cselect_b64 vcc, -1, vcc
s_cbranch_vccnz F2_NP_407
s_waitcnt vmcnt(12)
v_mfma_f32_32x32x16_bf16 v[48:63], a[64:67], v[176:179], v[48:63]
buffer_load_dwordx4 v[112:115], v2, s[8:11], s25 offen offset:0 sc1
v_mfma_f32_32x32x16_bf16 v[64:79], a[176:179], v[176:179], v[64:79]
s_waitcnt vmcnt(12)
v_mfma_f32_32x32x16_bf16 v[48:63], a[68:71], v[180:183], v[48:63]
buffer_load_dwordx4 v[116:119], v2, s[8:11], s25 offen offset:1024 sc1
v_mfma_f32_32x32x16_bf16 v[64:79], a[180:183], v[180:183], v[64:79]
s_waitcnt vmcnt(12)
v_mfma_f32_32x32x16_bf16 v[48:63], a[72:75], v[184:187], v[48:63]
buffer_load_dwordx4 v[120:123], v2, s[8:11], s25 offen offset:2048 sc1
v_mfma_f32_32x32x16_bf16 v[64:79], a[184:187], v[184:187], v[64:79]
s_waitcnt vmcnt(12)
v_mfma_f32_32x32x16_bf16 v[48:63], a[76:79], v[188:191], v[48:63]
buffer_load_dwordx4 v[124:127], v2, s[8:11], s25 offen offset:3072 sc1
s_add_u32 s25, s25, 4096
v_mfma_f32_32x32x16_bf16 v[64:79], a[188:191], v[188:191], v[64:79]
s_waitcnt vmcnt(12)
v_mfma_f32_32x32x16_bf16 v[48:63], a[80:83], v[192:195], v[48:63]
buffer_load_dwordx4 v[128:131], v2, s[8:11], s25 offen offset:0 sc1
v_mfma_f32_32x32x16_bf16 v[64:79], a[192:195], v[192:195], v[64:79]
s_waitcnt vmcnt(12)
v_mfma_f32_32x32x16_bf16 v[48:63], a[84:87], v[196:199], v[48:63]
buffer_load_dwordx4 v[132:135], v2, s[8:11], s25 offen offset:1024 sc1
v_mfma_f32_32x32x16_bf16 v[64:79], a[196:199], v[196:199], v[64:79]
s_waitcnt vmcnt(12)
v_mfma_f32_32x32x16_bf16 v[48:63], a[88:91], v[200:203], v[48:63]
buffer_load_dwordx4 v[136:139], v2, s[8:11], s25 offen offset:2048 sc1
v_mfma_f32_32x32x16_bf16 v[64:79], a[200:203], v[200:203], v[64:79]
s_waitcnt vmcnt(12)
v_mfma_f32_32x32x16_bf16 v[48:63], a[92:95], v[204:207], v[48:63]
buffer_load_dwordx4 v[140:143], v2, s[8:11], s25 offen offset:3072 sc1
s_add_u32 s25, s25, 4096
v_mfma_f32_32x32x16_bf16 v[64:79], a[204:207], v[204:207], v[64:79]
s_waitcnt vmcnt(12)
v_mfma_f32_32x32x16_bf16 v[48:63], a[96:99], v[208:211], v[48:63]
buffer_load_dwordx4 v[144:147], v2, s[8:11], s25 offen offset:0 sc1
v_mfma_f32_32x32x16_bf16 v[64:79], a[208:211], v[208:211], v[64:79]
s_waitcnt vmcnt(12)
v_mfma_f32_32x32x16_bf16 v[48:63], a[100:103], v[212:215], v[48:63]
buffer_load_dwordx4 v[148:151], v2, s[8:11], s25 offen offset:1024 sc1
v_mfma_f32_32x32x16_bf16 v[64:79], a[212:215], v[212:215], v[64:79]
s_waitcnt vmcnt(12)
v_mfma_f32_32x32x16_bf16 v[48:63], a[104:107], v[216:219], v[48:63]
buffer_load_dwordx4 v[152:155], v2, s[8:11], s25 offen offset:2048 sc1
v_mfma_f32_32x32x16_bf16 v[64:79], a[216:219], v[216:219], v[64:79]
s_waitcnt vmcnt(11)
v_mfma_f32_32x32x16_bf16 v[48:63], a[108:111], v[220:223], v[48:63]
buffer_load_dwordx4 v[156:159], v2, s[8:11], s25 offen offset:3072 sc1
s_add_u32 s25, s25, 4096
v_mfma_f32_32x32x16_bf16 v[64:79], a[220:223], v[220:223], v[64:79]
s_nop 10
s_branch F2_W1_401
F2_NP_407:
s_waitcnt vmcnt(12)
v_mfma_f32_32x32x16_bf16 v[48:63], a[64:67], v[176:179], v[48:63]
v_mfma_f32_32x32x16_bf16 v[64:79], a[176:179], v[176:179], v[64:79]
s_waitcnt vmcnt(11)
v_mfma_f32_32x32x16_bf16 v[48:63], a[68:71], v[180:183], v[48:63]
v_mfma_f32_32x32x16_bf16 v[64:79], a[180:183], v[180:183], v[64:79]
s_waitcnt vmcnt(10)
v_mfma_f32_32x32x16_bf16 v[48:63], a[72:75], v[184:187], v[48:63]
v_mfma_f32_32x32x16_bf16 v[64:79], a[184:187], v[184:187], v[64:79]
s_waitcnt vmcnt(9)
v_mfma_f32_32x32x16_bf16 v[48:63], a[76:79], v[188:191], v[48:63]
v_mfma_f32_32x32x16_bf16 v[64:79], a[188:191], v[188:191], v[64:79]
s_waitcnt vmcnt(8)
v_mfma_f32_32x32x16_bf16 v[48:63], a[80:83], v[192:195], v[48:63]
v_mfma_f32_32x32x16_bf16 v[64:79], a[192:195], v[192:195], v[64:79]
s_waitcnt vmcnt(7)
v_mfma_f32_32x32x16_bf16 v[48:63], a[84:87], v[196:199], v[48:63]
buffer_load_dword v13, v7, s[8:11], s29 offen sc1
v_mfma_f32_32x32x16_bf16 v[64:79], a[196:199], v[196:199], v[64:79]
s_waitcnt vmcnt(7)
v_mfma_f32_32x32x16_bf16 v[48:63], a[88:91], v[200:203], v[48:63]
s_waitcnt vmcnt(6)
v_mfma_f32_32x32x16_bf16 v[48:63], a[92:95], v[204:207], v[48:63]
s_waitcnt vmcnt(5)
v_mfma_f32_32x32x16_bf16 v[48:63], a[96:99], v[208:211], v[48:63]
s_waitcnt vmcnt(4)
v_mfma_f32_32x32x16_bf16 v[48:63], a[100:103], v[212:215], v[48:63]
s_waitcnt vmcnt(3)
v_mfma_f32_32x32x16_bf16 v[48:63], a[104:107], v[216:219], v[48:63]
s_waitcnt vmcnt(1)
v_mfma_f32_32x32x16_bf16 v[48:63], a[108:111], v[220:223], v[48:63]
v_mfma_f32_32x32x16_bf16 v[64:79], a[200:203], v[200:203], v[64:79]
s_nop 4
v_mfma_f32_32x32x16_bf16 v[64:79], a[204:207], v[204:207], v[64:79]
s_nop 4
v_mfma_f32_32x32x16_bf16 v[64:79], a[208:211], v[208:211], v[64:79]
ds_write_b128 v8, v[48:51] offset:0
v_mfma_f32_32x32x16_bf16 v[64:79], a[212:215], v[212:215], v[64:79]
ds_write_b128 v8, v[52:55] offset:1280
v_mfma_f32_32x32x16_bf16 v[64:79], a[216:219], v[216:219], v[64:79]
ds_write_b128 v8, v[56:59] offset:2560
v_mfma_f32_32x32x16_bf16 v[64:79], a[220:223], v[220:223], v[64:79]
ds_write_b128 v8, v[60:63] offset:3840
s_waitcnt vmcnt(0)
v_cmp_eq_u32 vcc, 0, v13
s_cmp_eq_u32 s15, 64
s_cselect_b64 vcc, -1, vcc
s_cbranch_vccnz F2_CE_408
buffer_load_dwordx4 v[112:115], v2, s[8:11], s25 offen offset:0 sc1
buffer_load_dwordx4 v[116:119], v2, s[8:11], s25 offen offset:1024 sc1
s_nop 3
ds_write_b128 v8, v[64:67] offset:5120
buffer_load_dwordx4 v[120:123], v2, s[8:11], s25 offen offset:2048 sc1
ds_write_b128 v8, v[68:71] offset:6400
buffer_load_dwordx4 v[124:127], v2, s[8:11], s25 offen offset:3072 sc1
s_add_u32 s25, s25, 4096
ds_write_b128 v8, v[72:75] offset:7680
buffer_load_dwordx4 v[128:131], v2, s[8:11], s25 offen offset:0 sc1
ds_write_b128 v8, v[76:79] offset:8960
buffer_load_dwordx4 v[132:135], v2, s[8:11], s25 offen offset:1024 sc1
buffer_load_dwordx4 v[136:139], v2, s[8:11], s25 offen offset:2048 sc1
buffer_load_dwordx4 v[140:143], v2, s[8:11], s25 offen offset:3072 sc1
s_add_u32 s25, s25, 4096
buffer_load_dwordx4 v[144:147], v2, s[8:11], s25 offen offset:0 sc1
buffer_load_dwordx4 v[148:151], v2, s[8:11], s25 offen offset:1024 sc1
buffer_load_dwordx4 v[152:155], v2, s[8:11], s25 offen offset:2048 sc1
buffer_load_dwordx4 v[156:159], v2, s[8:11], s25 offen offset:3072 sc1
s_add_u32 s25, s25, 4096
s_waitcnt lgkmcnt(0)
s_barrier
ds_read_b128 v[80:83], v9 offset:0
ds_read_b128 v[84:87], v9 offset:1280
ds_read_b128 v[88:91], v9 offset:10240
ds_read_b128 v[92:95], v9 offset:11520
ds_read_b128 v[96:99], v9 offset:20480
ds_read_b128 v[100:103], v9 offset:21760
ds_read_b128 v[104:107], v9 offset:30720
ds_read_b128 v[108:111], v9 offset:32000
v_lshlrev_b32 v48, 16, v20
v_and_b32 v49, 0xffff0000, v20
v_lshlrev_b32 v50, 16, v21
v_and_b32 v51, 0xffff0000, v21
v_lshlrev_b32 v52, 16, v22
v_and_b32 v53, 0xffff0000, v22
v_lshlrev_b32 v54, 16, v23
v_and_b32 v55, 0xffff0000, v23
s_waitcnt lgkmcnt(6)
v_pk_add_f32 v[48:49], v[48:49], v[80:81]
v_pk_add_f32 v[50:51], v[50:51], v[82:83]
v_pk_add_f32 v[52:53], v[52:53], v[84:85]
v_pk_add_f32 v[54:55], v[54:55], v[86:87]
s_waitcnt lgkmcnt(4)
v_pk_add_f32 v[48:49], v[48:49], v[88:89]
v_pk_add_f32 v[50:51], v[50:51], v[90:91]
v_pk_add_f32 v[52:53], v[52:53], v[92:93]
v_pk_add_f32 v[54:55], v[54:55], v[94:95]
s_waitcnt lgkmcnt(2)
v_pk_add_f32 v[48:49], v[48:49], v[96:97]
v_pk_add_f32 v[50:51], v[50:51], v[98:99]
v_pk_add_f32 v[52:53], v[52:53], v[100:101]
v_pk_add_f32 v[54:55], v[54:55], v[102:103]
s_waitcnt lgkmcnt(0)
v_pk_add_f32 v[48:49], v[48:49], v[104:105]
v_pk_add_f32 v[50:51], v[50:51], v[106:107]
v_pk_add_f32 v[52:53], v[52:53], v[108:109]
v_pk_add_f32 v[54:55], v[54:55], v[110:111]
v_cvt_pk_bf16_f32 v20, v48, v49
v_cvt_pk_bf16_f32 v21, v50, v51
v_cvt_pk_bf16_f32 v22, v52, v53
v_cvt_pk_bf16_f32 v23, v54, v55
buffer_store_dwordx4 v[20:23], v10, s[8:11], s27 offen sc1
s_add_u32 s27, s27, 28672
v_lshlrev_b32 v48, 16, v20
v_and_b32 v49, 0xffff0000, v20
v_lshlrev_b32 v50, 16, v21
v_and_b32 v51, 0xffff0000, v21
v_lshlrev_b32 v52, 16, v22
v_and_b32 v53, 0xffff0000, v22
v_lshlrev_b32 v54, 16, v23
v_and_b32 v55, 0xffff0000, v23
v_pk_add_f32 v[80:81], v[48:49], v[50:51]
v_pk_mul_f32 v[82:83], v[48:49], v[48:49]
v_pk_add_f32 v[84:85], v[52:53], v[54:55]
v_pk_fma_f32 v[82:83], v[50:51], v[50:51], v[82:83]
v_pk_fma_f32 v[82:83], v[52:53], v[52:53], v[82:83]
v_pk_fma_f32 v[82:83], v[54:55], v[54:55], v[82:83]
v_pk_add_f32 v[80:81], v[80:81], v[84:85]
v_add_f32 v80, v80, v81
v_add_f32 v81, v82, v83
s_nop 0
v_add_f32_dpp v80, v80, v80 row_ror:8 row_mask:0xf bank_mask:0xf
v_add_f32_dpp v81, v81, v81 row_ror:8 row_mask:0xf bank_mask:0xf
v_mov_b32 v82, v80
v_mov_b32 v83, v81
s_nop 0
v_permlane16_swap_b32 v80, v82
v_permlane16_swap_b32 v81, v83
v_pk_add_f32 v[80:81], v[80:81], v[82:83]
v_mov_b32 v82, v80
v_mov_b32 v83, v81
s_nop 0
v_permlane32_swap_b32 v80, v82
v_permlane32_swap_b32 v81, v83
v_pk_add_f32 v[80:81], v[80:81], v[82:83]
s_mov_b64 exec, s[36:37]
buffer_store_dwordx2 v[80:81], v11, s[8:11], s28 offen sc1
s_mov_b64 exec, -1
s_add_u32 s28, s28, 2048
s_branch F2_P1_403
F2_CE_408:
s_nop 5
ds_write_b128 v8, v[64:67] offset:5120
ds_write_b128 v8, v[68:71] offset:6400
ds_write_b128 v8, v[72:75] offset:7680
ds_write_b128 v8, v[76:79] offset:8960
s_waitcnt lgkmcnt(0)
s_barrier
ds_read_b128 v[80:83], v9 offset:0
ds_read_b128 v[84:87], v9 offset:1280
ds_read_b128 v[88:91], v9 offset:10240
ds_read_b128 v[92:95], v9 offset:11520
ds_read_b128 v[96:99], v9 offset:20480
ds_read_b128 v[100:103], v9 offset:21760
ds_read_b128 v[104:107], v9 offset:30720
ds_read_b128 v[108:111], v9 offset:32000
v_lshlrev_b32 v48, 16, v20
v_and_b32 v49, 0xffff0000, v20
v_lshlrev_b32 v50, 16, v21
v_and_b32 v51, 0xffff0000, v21
v_lshlrev_b32 v52, 16, v22
v_and_b32 v53, 0xffff0000, v22
v_lshlrev_b32 v54, 16, v23
v_and_b32 v55, 0xffff0000, v23
s_waitcnt lgkmcnt(6)
v_pk_add_f32 v[48:49], v[48:49], v[80:81]
v_pk_add_f32 v[50:51], v[50:51], v[82:83]
v_pk_add_f32 v[52:53], v[52:53], v[84:85]
v_pk_add_f32 v[54:55], v[54:55], v[86:87]
s_waitcnt lgkmcnt(4)
v_pk_add_f32 v[48:49], v[48:49], v[88:89]
v_pk_add_f32 v[50:51], v[50:51], v[90:91]
v_pk_add_f32 v[52:53], v[52:53], v[92:93]
v_pk_add_f32 v[54:55], v[54:55], v[94:95]
s_waitcnt lgkmcnt(2)
v_pk_add_f32 v[48:49], v[48:49], v[96:97]
v_pk_add_f32 v[50:51], v[50:51], v[98:99]
v_pk_add_f32 v[52:53], v[52:53], v[100:101]
v_pk_add_f32 v[54:55], v[54:55], v[102:103]
s_waitcnt lgkmcnt(0)
v_pk_add_f32 v[48:49], v[48:49], v[104:105]
v_pk_add_f32 v[50:51], v[50:51], v[106:107]
v_pk_add_f32 v[52:53], v[52:53], v[108:109]
v_pk_add_f32 v[54:55], v[54:55], v[110:111]
v_cvt_pk_bf16_f32 v20, v48, v49
v_cvt_pk_bf16_f32 v21, v50, v51
v_cvt_pk_bf16_f32 v22, v52, v53
v_cvt_pk_bf16_f32 v23, v54, v55
buffer_store_dwordx4 v[20:23], v10, s[8:11], s27 offen sc1
s_add_u32 s27, s27, 28672
v_lshlrev_b32 v48, 16, v20
v_and_b32 v49, 0xffff0000, v20
v_lshlrev_b32 v50, 16, v21
v_and_b32 v51, 0xffff0000, v21
v_lshlrev_b32 v52, 16, v22
v_and_b32 v53, 0xffff0000, v22
v_lshlrev_b32 v54, 16, v23
v_and_b32 v55, 0xffff0000, v23
v_pk_add_f32 v[80:81], v[48:49], v[50:51]
v_pk_mul_f32 v[82:83], v[48:49], v[48:49]
v_pk_add_f32 v[84:85], v[52:53], v[54:55]
v_pk_fma_f32 v[82:83], v[50:51], v[50:51], v[82:83]
v_pk_fma_f32 v[82:83], v[52:53], v[52:53], v[82:83]
v_pk_fma_f32 v[82:83], v[54:55], v[54:55], v[82:83]
v_pk_add_f32 v[80:81], v[80:81], v[84:85]
v_add_f32 v80, v80, v81
v_add_f32 v81, v82, v83
s_nop 0
v_add_f32_dpp v80, v80, v80 row_ror:8 row_mask:0xf bank_mask:0xf
v_add_f32_dpp v81, v81, v81 row_ror:8 row_mask:0xf bank_mask:0xf
v_mov_b32 v82, v80
v_mov_b32 v83, v81
s_nop 0
v_permlane16_swap_b32 v80, v82
v_permlane16_swap_b32 v81, v83
v_pk_add_f32 v[80:81], v[80:81], v[82:83]
v_mov_b32 v82, v80
v_mov_b32 v83, v81
s_nop 0
v_permlane32_swap_b32 v80, v82
v_permlane32_swap_b32 v81, v83
v_pk_add_f32 v[80:81], v[80:81], v[82:83]
s_mov_b64 exec, s[36:37]
buffer_store_dwordx2 v[80:81], v11, s[8:11], s28 offen sc1
s_mov_b64 exec, -1
s_add_u32 s28, s28, 2048
buffer_load_dword v13, v7, s[8:11], s29 offen sc1
s_waitcnt vmcnt(1)
s_mov_b64 exec, 1
buffer_store_dword v5, v4, s[8:11], s30 offen sc1
s_mov_b64 exec, -1
s_add_u32 s30, s30, 512
s_cmp_ge_u32 s15, 64
s_cbranch_scc0 OPT_409
s_endpgm
OPT_409:
s_waitcnt vmcnt(1)
s_branch F2_C1_399
F2_W0_400:
s_add_u32 s29, s29, 512
s_mov_b32 s32, 1
s_waitcnt vmcnt(11)
v_mfma_f32_32x32x16_bf16 v[48:63], a[0:3], v[112:115], 0
buffer_load_dwordx4 v[160:163], v2, s[8:11], s25 offen offset:0 sc1
v_mfma_f32_32x32x16_bf16 v[64:79], a[112:115], v[112:115], 0
s_waitcnt vmcnt(11)
v_mfma_f32_32x32x16_bf16 v[48:63], a[4:7], v[116:119], v[48:63]
buffer_load_dwordx4 v[164:167], v2, s[8:11], s25 offen offset:1024 sc1
ds_write_b128 v14, v[224:227] offset:0
v_mfma_f32_32x32x16_bf16 v[64:79], a[116:119], v[116:119], v[64:79]
ds_write_b128 v14, v[228:231] offset:1280
s_waitcnt vmcnt(11)
v_mfma_f32_32x32x16_bf16 v[48:63], a[8:11], v[120:123], v[48:63]
buffer_load_dwordx4 v[168:171], v2, s[8:11], s25 offen offset:2048 sc1
ds_write_b128 v14, v[232:235] offset:2560
v_mfma_f32_32x32x16_bf16 v[64:79], a[120:123], v[120:123], v[64:79]
ds_write_b128 v14, v[236:239] offset:3840
s_waitcnt vmcnt(11)
v_mfma_f32_32x32x16_bf16 v[48:63], a[12:15], v[124:127], v[48:63]
buffer_load_dword v13, v7, s[8:11], s29 offen sc1
buffer_load_dwordx4 v[172:175], v2, s[8:11], s25 offen offset:3072 sc1
s_add_u32 s25, s25, 4096
ds_write_b128 v14, v[240:243] offset:5120
v_mfma_f32_32x32x16_bf16 v[64:79], a[124:127], v[124:127], v[64:79]
ds_write_b128 v14, v[244:247] offset:6400
s_waitcnt vmcnt(12)
v_mfma_f32_32x32x16_bf16 v[48:63], a[16:19], v[128:131], v[48:63]
buffer_load_dwordx4 v[176:179], v2, s[8:11], s25 offen offset:0 sc1
ds_write_b128 v14, v[248:251] offset:7680
v_mfma_f32_32x32x16_bf16 v[64:79], a[128:131], v[128:131], v[64:79]
ds_write_b128 v14, v[252:255] offset:8960
s_waitcnt vmcnt(12)
v_mfma_f32_32x32x16_bf16 v[48:63], a[20:23], v[132:135], v[48:63]
buffer_load_dwordx4 v[180:183], v2, s[8:11], s25 offen offset:1024 sc1
v_mfma_f32_32x32x16_bf16 v[64:79], a[132:135], v[132:135], v[64:79]
s_waitcnt vmcnt(12)
v_mfma_f32_32x32x16_bf16 v[48:63], a[24:27], v[136:139], v[48:63]
buffer_load_dwordx4 v[184:187], v2, s[8:11], s25 offen offset:2048 sc1
v_mfma_f32_32x32x16_bf16 v[64:79], a[136:139], v[136:139], v[64:79]
s_waitcnt lgkmcnt(0)
s_barrier
ds_read_b128 v[80:83], v15 offset:0
ds_read_b128 v[84:87], v15 offset:1280
ds_read_b128 v[88:91], v15 offset:10240
s_waitcnt vmcnt(12)
v_mfma_f32_32x32x16_bf16 v[48:63], a[28:31], v[140:143], v[48:63]
buffer_load_dwordx4 v[188:191], v2, s[8:11], s25 offen offset:3072 sc1
s_add_u32 s25, s25, 4096
ds_read_b128 v[92:95], v15 offset:11520
ds_read_b128 v[96:99], v15 offset:20480
ds_read_b128 v[100:103], v15 offset:21760
ds_read_b128 v[104:107], v15 offset:30720
v_mfma_f32_32x32x16_bf16 v[64:79], a[140:143], v[140:143], v[64:79]
ds_read_b128 v[108:111], v15 offset:32000
v_lshlrev_b32 v224, 16, v24
v_and_b32 v225, 0xffff0000, v24
v_lshlrev_b32 v226, 16, v25
v_and_b32 v227, 0xffff0000, v25
s_waitcnt vmcnt(12)
v_mfma_f32_32x32x16_bf16 v[48:63], a[32:35], v[144:147], v[48:63]
buffer_load_dwordx4 v[192:195], v2, s[8:11], s25 offen offset:0 sc1
v_lshlrev_b32 v228, 16, v26
v_and_b32 v229, 0xffff0000, v26
v_lshlrev_b32 v230, 16, v27
v_and_b32 v231, 0xffff0000, v27
s_waitcnt lgkmcnt(6)
v_mfma_f32_32x32x16_bf16 v[64:79], a[144:147], v[144:147], v[64:79]
v_add_f32 v224, v224, v80
v_add_f32 v225, v225, v81
v_add_f32 v226, v226, v82
v_add_f32 v227, v227, v83
v_add_f32 v228, v228, v84
s_waitcnt vmcnt(12)
v_mfma_f32_32x32x16_bf16 v[48:63], a[36:39], v[148:151], v[48:63]
buffer_load_dwordx4 v[196:199], v2, s[8:11], s25 offen offset:1024 sc1
v_add_f32 v229, v229, v85
v_add_f32 v230, v230, v86
v_add_f32 v231, v231, v87
s_waitcnt lgkmcnt(4)
v_add_f32 v224, v224, v88
v_mfma_f32_32x32x16_bf16 v[64:79], a[148:151], v[148:151], v[64:79]
v_add_f32 v225, v225, v89
v_add_f32 v226, v226, v90
v_add_f32 v227, v227, v91
v_add_f32 v228, v228, v92
v_add_f32 v229, v229, v93
s_waitcnt vmcnt(12)
v_mfma_f32_32x32x16_bf16 v[48:63], a[40:43], v[152:155], v[48:63]
buffer_load_dwordx4 v[200:203], v2, s[8:11], s25 offen offset:2048 sc1
v_add_f32 v230, v230, v94
v_add_f32 v231, v231, v95
s_waitcnt lgkmcnt(2)
v_add_f32 v224, v224, v96
v_add_f32 v225, v225, v97
v_mfma_f32_32x32x16_bf16 v[64:79], a[152:155], v[152:155], v[64:79]
v_add_f32 v226, v226, v98
v_add_f32 v227, v227, v99
v_add_f32 v228, v228, v100
v_add_f32 v229, v229, v101
v_add_f32 v230, v230, v102
s_waitcnt vmcnt(12)
v_mfma_f32_32x32x16_bf16 v[48:63], a[44:47], v[156:159], v[48:63]
buffer_load_dwordx4 v[204:207], v2, s[8:11], s25 offen offset:3072 sc1
s_add_u32 s25, s25, 4096
v_add_f32 v231, v231, v103
s_waitcnt lgkmcnt(0)
v_add_f32 v224, v224, v104
v_add_f32 v225, v225, v105
v_mfma_f32_32x32x16_bf16 v[64:79], a[156:159], v[156:159], v[64:79]
v_add_f32 v226, v226, v106
v_add_f32 v227, v227, v107
v_add_f32 v228, v228, v108
v_add_f32 v229, v229, v109
v_add_f32 v230, v230, v110
s_waitcnt vmcnt(12)
v_mfma_f32_32x32x16_bf16 v[48:63], a[48:51], v[160:163], v[48:63]
buffer_load_dwordx4 v[208:211], v2, s[8:11], s25 offen offset:0 sc1
v_add_f32 v231, v231, v111
v_cvt_pk_bf16_f32 v24, v224, v225
v_cvt_pk_bf16_f32 v25, v226, v227
v_cvt_pk_bf16_f32 v26, v228, v229
v_cvt_pk_bf16_f32 v27, v230, v231
v_mfma_f32_32x32x16_bf16 v[64:79], a[160:163], v[160:163], v[64:79]
buffer_store_dwordx4 v[24:27], v10, s[8:11], s27 offen sc1
s_add_u32 s27, s27, 28672
v_lshlrev_b32 v224, 16, v24
v_and_b32 v225, 0xffff0000, v24
v_lshlrev_b32 v226, 16, v25
s_waitcnt vmcnt(13)
v_mfma_f32_32x32x16_bf16 v[48:63], a[52:55], v[164:167], v[48:63]
buffer_load_dwordx4 v[212:215], v2, s[8:11], s25 offen offset:1024 sc1
v_and_b32 v227, 0xffff0000, v25
v_lshlrev_b32 v228, 16, v26
v_and_b32 v229, 0xffff0000, v26
v_lshlrev_b32 v230, 16, v27
v_and_b32 v231, 0xffff0000, v27
v_mfma_f32_32x32x16_bf16 v[64:79], a[164:167], v[164:167], v[64:79]
v_add_f32 v80, v224, v226
v_add_f32 v81, v225, v227
v_mul_f32 v82, v224, v224
v_mul_f32 v83, v225, v225
v_add_f32 v84, v228, v230
s_waitcnt vmcnt(13)
v_mfma_f32_32x32x16_bf16 v[48:63], a[56:59], v[168:171], v[48:63]
buffer_load_dwordx4 v[216:219], v2, s[8:11], s25 offen offset:2048 sc1
v_add_f32 v85, v229, v231
v_fma_f32 v82, v226, v226, v82
v_fma_f32 v83, v227, v227, v83
v_fma_f32 v82, v228, v228, v82
v_fma_f32 v83, v229, v229, v83
v_mfma_f32_32x32x16_bf16 v[64:79], a[168:171], v[168:171], v[64:79]
v_fma_f32 v82, v230, v230, v82
v_fma_f32 v83, v231, v231, v83
v_add_f32 v80, v80, v84
v_add_f32 v81, v81, v85
v_add_f32 v80, v80, v81
s_waitcnt vmcnt(12)
v_mfma_f32_32x32x16_bf16 v[48:63], a[60:63], v[172:175], v[48:63]
buffer_load_dwordx4 v[20:23], v10, s[8:11], s26 offen sc1
s_add_u32 s26, s26, 28672
buffer_load_dwordx4 v[220:223], v2, s[8:11], s25 offen offset:3072 sc1
s_add_u32 s25, s25, 90112
v_add_f32 v81, v82, v83
v_add_f32_dpp v80, v80, v80 row_ror:8 row_mask:0xf bank_mask:0xf
v_mfma_f32_32x32x16_bf16 v[64:79], a[172:175], v[172:175], v[64:79]
v_add_f32_dpp v81, v81, v81 row_ror:8 row_mask:0xf bank_mask:0xf
v_mov_b32 v82, v80
v_mov_b32 v83, v81
s_nop 0
v_permlane16_swap_b32 v80, v82
s_add_u32 s15, s15, 1
v_cmp_eq_u32 vcc, 0, v13
s_cmp_eq_u32 s15, 64
s_cselect_b64 vcc, -1, vcc
s_cbranch_vccnz F2_NP_410
s_waitcnt vmcnt(13)
v_mfma_f32_32x32x16_bf16 v[48:63], a[64:67], v[176:179], v[48:63]
buffer_load_dwordx4 v[112:115], v2, s[8:11], s25 offen offset:0 sc1
v_permlane16_swap_b32 v81, v83
v_add_f32 v80, v80, v82
v_add_f32 v81, v81, v83
v_mov_b32 v82, v80
v_mov_b32 v83, v81
v_mfma_f32_32x32x16_bf16 v[64:79], a[176:179], v[176:179], v[64:79]
v_permlane32_swap_b32 v80, v82
v_permlane32_swap_b32 v81, v83
v_add_f32 v80, v80, v82
v_add_f32 v81, v81, v83
s_waitcnt vmcnt(13)
v_mfma_f32_32x32x16_bf16 v[48:63], a[68:71], v[180:183], v[48:63]
buffer_load_dwordx4 v[116:119], v2, s[8:11], s25 offen offset:1024 sc1
s_mov_b64 exec, s[36:37]
buffer_store_dwordx2 v[80:81], v11, s[8:11], s28 offen sc1
s_mov_b64 exec, -1
s_add_u32 s28, s28, 2048
v_mfma_f32_32x32x16_bf16 v[64:79], a[180:183], v[180:183], v[64:79]
s_waitcnt vmcnt(14)
v_mfma_f32_32x32x16_bf16 v[48:63], a[72:75], v[184:187], v[48:63]
buffer_load_dwordx4 v[120:123], v2, s[8:11], s25 offen offset:2048 sc1
v_mfma_f32_32x32x16_bf16 v[64:79], a[184:187], v[184:187], v[64:79]
s_waitcnt vmcnt(14)
v_mfma_f32_32x32x16_bf16 v[48:63], a[76:79], v[188:191], v[48:63]
buffer_load_dwordx4 v[124:127], v2, s[8:11], s25 offen offset:3072 sc1
s_add_u32 s25, s25, 4096
v_mfma_f32_32x32x16_bf16 v[64:79], a[188:191], v[188:191], v[64:79]
s_waitcnt vmcnt(14)
s_cmp_eq_u32 s32, 0
s_cbranch_scc1 OPT_412
s_getreg_b32 s20, hwreg(HW_REG_IB_STS)
s_and_b32 s20, s20, 0xc0000f
s_cmp_gt_u32 s20, 2
s_cbranch_scc1 OPT_412
s_waitcnt vmcnt(2)
s_mov_b64 exec, 1
buffer_store_dword v5, v4, s[8:11], s30 offen sc1
s_mov_b64 exec, -1
s_add_u32 s30, s30, 512
s_mov_b32 s32, 0
OPT_412:
v_mfma_f32_32x32x16_bf16 v[48:63], a[80:83], v[192:195], v[48:63]
buffer_load_dwordx4 v[128:131], v2, s[8:11], s25 offen offset:0 sc1
v_mfma_f32_32x32x16_bf16 v[64:79], a[192:195], v[192:195], v[64:79]
s_waitcnt vmcnt(14)
v_mfma_f32_32x32x16_bf16 v[48:63], a[84:87], v[196:199], v[48:63]
buffer_load_dwordx4 v[132:135], v2, s[8:11], s25 offen offset:1024 sc1
v_mfma_f32_32x32x16_bf16 v[64:79], a[196:199], v[196:199], v[64:79]
s_waitcnt vmcnt(14)
v_mfma_f32_32x32x16_bf16 v[48:63], a[88:91], v[200:203], v[48:63]
buffer_load_dwordx4 v[136:139], v2, s[8:11], s25 offen offset:2048 sc1
v_mfma_f32_32x32x16_bf16 v[64:79], a[200:203], v[200:203], v[64:79]
s_waitcnt vmcnt(14)
s_cmp_eq_u32 s32, 0
s_cbranch_scc1 OPT_414
s_getreg_b32 s20, hwreg(HW_REG_IB_STS)
s_and_b32 s20, s20, 0xc0000f
s_cmp_gt_u32 s20, 5
s_cbranch_scc1 OPT_414
s_waitcnt vmcnt(5)
s_mov_b64 exec, 1
buffer_store_dword v5, v4, s[8:11], s30 offen sc1
s_mov_b64 exec, -1
s_add_u32 s30, s30, 512
s_mov_b32 s32, 0
OPT_414:
v_mfma_f32_32x32x16_bf16 v[48:63], a[92:95], v[204:207], v[48:63]
buffer_load_dwordx4 v[140:143], v2, s[8:11], s25 offen offset:3072 sc1
s_add_u32 s25, s25, 4096
v_mfma_f32_32x32x16_bf16 v[64:79], a[204:207], v[204:207], v[64:79]
s_waitcnt vmcnt(14)
v_mfma_f32_32x32x16_bf16 v[48:63], a[96:99], v[208:211], v[48:63]
buffer_load_dwordx4 v[144:147], v2, s[8:11], s25 offen offset:0 sc1
v_mfma_f32_32x32x16_bf16 v[64:79], a[208:211], v[208:211], v[64:79]
s_waitcnt vmcnt(13)
v_mfma_f32_32x32x16_bf16 v[48:63], a[100:103], v[212:215], v[48:63]
buffer_load_dwordx4 v[148:151], v2, s[8:11], s25 offen offset:1024 sc1
v_mfma_f32_32x32x16_bf16 v[64:79], a[212:215], v[212:215], v[64:79]
s_waitcnt vmcnt(13)
s_cmp_eq_u32 s32, 0
s_cbranch_scc1 OPT_416
s_getreg_b32 s20, hwreg(HW_REG_IB_STS)
s_and_b32 s20, s20, 0xc0000f
s_cmp_gt_u32 s20, 8
s_cbranch_scc1 OPT_416
s_waitcnt vmcnt(8)
s_mov_b64 exec, 1
buffer_store_dword v5, v4, s[8:11], s30 offen sc1
s_mov_b64 exec, -1
s_add_u32 s30, s30, 512
s_mov_b32 s32, 0
OPT_416:
v_mfma_f32_32x32x16_bf16 v[48:63], a[104:107], v[216:219], v[48:63]
buffer_load_dwordx4 v[152:155], v2, s[8:11], s25 offen offset:2048 sc1
v_mfma_f32_32x32x16_bf16 v[64:79], a[216:219], v[216:219], v[64:79]
s_waitcnt vmcnt(12)
v_mfma_f32_32x32x16_bf16 v[48:63], a[108:111], v[220:223], v[48:63]
buffer_load_dwordx4 v[156:159], v2, s[8:11], s25 offen offset:3072 sc1
s_add_u32 s25, s25, 4096
v_mfma_f32_32x32x16_bf16 v[64:79], a[220:223], v[220:223], v[64:79]
s_cmp_eq_u32 s32, 0
s_cbranch_scc1 OPT_418
s_waitcnt vmcnt(10)
s_mov_b64 exec, 1
buffer_store_dword v5, v4, s[8:11], s30 offen sc1
s_mov_b64 exec, -1
s_add_u32 s30, s30, 512
s_mov_b32 s32, 0
OPT_418:
s_nop 8
s_branch F2_W1_401
F2_NP_410:
s_waitcnt vmcnt(13)
v_mfma_f32_32x32x16_bf16 v[48:63], a[64:67], v[176:179], v[48:63]
v_permlane16_swap_b32 v81, v83
v_add_f32 v80, v80, v82
v_add_f32 v81, v81, v83
v_mov_b32 v82, v80
v_mov_b32 v83, v81
v_mfma_f32_32x32x16_bf16 v[64:79], a[176:179], v[176:179], v[64:79]
v_permlane32_swap_b32 v80, v82
v_permlane32_swap_b32 v81, v83
v_add_f32 v80, v80, v82
v_add_f32 v81, v81, v83
s_waitcnt vmcnt(12)
v_mfma_f32_32x32x16_bf16 v[48:63], a[68:71], v[180:183], v[48:63]
s_mov_b64 exec, s[36:37]
buffer_store_dwordx2 v[80:81], v11, s[8:11], s28 offen sc1
s_mov_b64 exec, -1
s_add_u32 s28, s28, 2048
v_mfma_f32_32x32x16_bf16 v[64:79], a[180:183], v[180:183], v[64:79]
s_waitcnt vmcnt(12)
v_mfma_f32_32x32x16_bf16 v[48:63], a[72:75], v[184:187], v[48:63]
v_mfma_f32_32x32x16_bf16 v[64:79], a[184:187], v[184:187], v[64:79]
s_waitcnt vmcnt(11)
v_mfma_f32_32x32x16_bf16 v[48:63], a[76:79], v[188:191], v[48:63]
v_mfma_f32_32x32x16_bf16 v[64:79], a[188:191], v[188:191], v[64:79]
s_waitcnt vmcnt(10)
s_cmp_eq_u32 s32, 0
s_cbranch_scc1 OPT_420
s_getreg_b32 s20, hwreg(HW_REG_IB_STS)
s_and_b32 s20, s20, 0xc0000f
s_cmp_gt_u32 s20, 0
s_cbranch_scc1 OPT_420
s_waitcnt vmcnt(0)
s_mov_b64 exec, 1
buffer_store_dword v5, v4, s[8:11], s30 offen sc1
s_mov_b64 exec, -1
s_add_u32 s30, s30, 512
s_mov_b32 s32, 0
OPT_420:
v_mfma_f32_32x32x16_bf16 v[48:63], a[80:83], v[192:195], v[48:63]
v_mfma_f32_32x32x16_bf16 v[64:79], a[192:195], v[192:195], v[64:79]
s_waitcnt vmcnt(9)
v_mfma_f32_32x32x16_bf16 v[48:63], a[84:87], v[196:199], v[48:63]
buffer_load_dword v13, v7, s[8:11], s29 offen sc1
v_mfma_f32_32x32x16_bf16 v[64:79], a[196:199], v[196:199], v[64:79]
s_waitcnt vmcnt(9)
v_mfma_f32_32x32x16_bf16 v[48:63], a[88:91], v[200:203], v[48:63]
s_waitcnt vmcnt(8)
v_mfma_f32_32x32x16_bf16 v[48:63], a[92:95], v[204:207], v[48:63]
s_waitcnt vmcnt(7)
v_mfma_f32_32x32x16_bf16 v[48:63], a[96:99], v[208:211], v[48:63]
s_waitcnt vmcnt(5)
v_mfma_f32_32x32x16_bf16 v[48:63], a[100:103], v[212:215], v[48:63]
s_waitcnt vmcnt(4)
v_mfma_f32_32x32x16_bf16 v[48:63], a[104:107], v[216:219], v[48:63]
s_waitcnt vmcnt(2)
v_mfma_f32_32x32x16_bf16 v[48:63], a[108:111], v[220:223], v[48:63]
v_mfma_f32_32x32x16_bf16 v[64:79], a[200:203], v[200:203], v[64:79]
s_nop 4
v_mfma_f32_32x32x16_bf16 v[64:79], a[204:207], v[204:207], v[64:79]
s_nop 4
v_mfma_f32_32x32x16_bf16 v[64:79], a[208:211], v[208:211], v[64:79]
ds_write_b128 v8, v[48:51] offset:0
v_mfma_f32_32x32x16_bf16 v[64:79], a[212:215], v[212:215], v[64:79]
ds_write_b128 v8, v[52:55] offset:1280
v_mfma_f32_32x32x16_bf16 v[64:79], a[216:219], v[216:219], v[64:79]
ds_write_b128 v8, v[56:59] offset:2560
v_mfma_f32_32x32x16_bf16 v[64:79], a[220:223], v[220:223], v[64:79]
ds_write_b128 v8, v[60:63] offset:3840
s_cmp_eq_u32 s32, 0
s_cbranch_scc1 OPT_422
s_waitcnt vmcnt(1)
s_mov_b64 exec, 1
buffer_store_dword v5, v4, s[8:11], s30 offen sc1
s_mov_b64 exec, -1
s_add_u32 s30, s30, 512
s_mov_b32 s32, 0
OPT_422:
s_waitcnt vmcnt(0)
v_cmp_eq_u32 vcc, 0, v13
s_cmp_eq_u32 s15, 64
s_cselect_b64 vcc, -1, vcc
s_cbranch_vccnz F2_CE_423
buffer_load_dwordx4 v[112:115], v2, s[8:11], s25 offen offset:0 sc1
buffer_load_dwordx4 v[116:119], v2, s[8:11], s25 offen offset:1024 sc1
s_nop 1
ds_write_b128 v8, v[64:67] offset:5120
buffer_load_dwordx4 v[120:123], v2, s[8:11], s25 offen offset:2048 sc1
ds_write_b128 v8, v[68:71] offset:6400
buffer_load_dwordx4 v[124:127], v2, s[8:11], s25 offen offset:3072 sc1
s_add_u32 s25, s25, 4096
ds_write_b128 v8, v[72:75] offset:7680
buffer_load_dwordx4 v[128:131], v2, s[8:11], s25 offen offset:0 sc1
ds_write_b128 v8, v[76:79] offset:8960
buffer_load_dwordx4 v[132:135], v2, s[8:11], s25 offen offset:1024 sc1
buffer_load_dwordx4 v[136:139], v2, s[8:11], s25 offen offset:2048 sc1
buffer_load_dwordx4 v[140:143], v2, s[8:11], s25 offen offset:3072 sc1
s_add_u32 s25, s25, 4096
buffer_load_dwordx4 v[144:147], v2, s[8:11], s25 offen offset:0 sc1
buffer_load_dwordx4 v[148:151], v2, s[8:11], s25 offen offset:1024 sc1
buffer_load_dwordx4 v[152:155], v2, s[8:11], s25 offen offset:2048 sc1
buffer_load_dwordx4 v[156:159], v2, s[8:11], s25 offen offset:3072 sc1
s_add_u32 s25, s25, 4096
s_waitcnt lgkmcnt(0)
s_barrier
ds_read_b128 v[80:83], v9 offset:0
ds_read_b128 v[84:87], v9 offset:1280
ds_read_b128 v[88:91], v9 offset:10240
ds_read_b128 v[92:95], v9 offset:11520
ds_read_b128 v[96:99], v9 offset:20480
ds_read_b128 v[100:103], v9 offset:21760
ds_read_b128 v[104:107], v9 offset:30720
ds_read_b128 v[108:111], v9 offset:32000
v_lshlrev_b32 v48, 16, v20
v_and_b32 v49, 0xffff0000, v20
v_lshlrev_b32 v50, 16, v21
v_and_b32 v51, 0xffff0000, v21
v_lshlrev_b32 v52, 16, v22
v_and_b32 v53, 0xffff0000, v22
v_lshlrev_b32 v54, 16, v23
v_and_b32 v55, 0xffff0000, v23
s_waitcnt lgkmcnt(6)
v_pk_add_f32 v[48:49], v[48:49], v[80:81]
v_pk_add_f32 v[50:51], v[50:51], v[82:83]
v_pk_add_f32 v[52:53], v[52:53], v[84:85]
v_pk_add_f32 v[54:55], v[54:55], v[86:87]
s_waitcnt lgkmcnt(4)
v_pk_add_f32 v[48:49], v[48:49], v[88:89]
v_pk_add_f32 v[50:51], v[50:51], v[90:91]
v_pk_add_f32 v[52:53], v[52:53], v[92:93]
v_pk_add_f32 v[54:55], v[54:55], v[94:95]
s_waitcnt lgkmcnt(2)
v_pk_add_f32 v[48:49], v[48:49], v[96:97]
v_pk_add_f32 v[50:51], v[50:51], v[98:99]
v_pk_add_f32 v[52:53], v[52:53], v[100:101]
v_pk_add_f32 v[54:55], v[54:55], v[102:103]
s_waitcnt lgkmcnt(0)
v_pk_add_f32 v[48:49], v[48:49], v[104:105]
v_pk_add_f32 v[50:51], v[50:51], v[106:107]
v_pk_add_f32 v[52:53], v[52:53], v[108:109]
v_pk_add_f32 v[54:55], v[54:55], v[110:111]
v_cvt_pk_bf16_f32 v20, v48, v49
v_cvt_pk_bf16_f32 v21, v50, v51
v_cvt_pk_bf16_f32 v22, v52, v53
v_cvt_pk_bf16_f32 v23, v54, v55
buffer_store_dwordx4 v[20:23], v10, s[8:11], s27 offen sc1
s_add_u32 s27, s27, 28672
v_lshlrev_b32 v48, 16, v20
v_and_b32 v49, 0xffff0000, v20
v_lshlrev_b32 v50, 16, v21
v_and_b32 v51, 0xffff0000, v21
v_lshlrev_b32 v52, 16, v22
v_and_b32 v53, 0xffff0000, v22
v_lshlrev_b32 v54, 16, v23
v_and_b32 v55, 0xffff0000, v23
v_pk_add_f32 v[80:81], v[48:49], v[50:51]
v_pk_mul_f32 v[82:83], v[48:49], v[48:49]
v_pk_add_f32 v[84:85], v[52:53], v[54:55]
v_pk_fma_f32 v[82:83], v[50:51], v[50:51], v[82:83]
v_pk_fma_f32 v[82:83], v[52:53], v[52:53], v[82:83]
v_pk_fma_f32 v[82:83], v[54:55], v[54:55], v[82:83]
v_pk_add_f32 v[80:81], v[80:81], v[84:85]
v_add_f32 v80, v80, v81
v_add_f32 v81, v82, v83
s_nop 0
v_add_f32_dpp v80, v80, v80 row_ror:8 row_mask:0xf bank_mask:0xf
v_add_f32_dpp v81, v81, v81 row_ror:8 row_mask:0xf bank_mask:0xf
v_mov_b32 v82, v80
v_mov_b32 v83, v81
s_nop 0
v_permlane16_swap_b32 v80, v82
v_permlane16_swap_b32 v81, v83
v_pk_add_f32 v[80:81], v[80:81], v[82:83]
v_mov_b32 v82, v80
v_mov_b32 v83, v81
s_nop 0
v_permlane32_swap_b32 v80, v82
v_permlane32_swap_b32 v81, v83
v_pk_add_f32 v[80:81], v[80:81], v[82:83]
s_mov_b64 exec, s[36:37]
buffer_store_dwordx2 v[80:81], v11, s[8:11], s28 offen sc1
s_mov_b64 exec, -1
s_add_u32 s28, s28, 2048
s_branch F2_P1_403
F2_CE_423:
s_nop 3
ds_write_b128 v8, v[64:67] offset:5120
ds_write_b128 v8, v[68:71] offset:6400
ds_write_b128 v8, v[72:75] offset:7680
ds_write_b128 v8, v[76:79] offset:8960
s_waitcnt lgkmcnt(0)
s_barrier
ds_read_b128 v[80:83], v9 offset:0
ds_read_b128 v[84:87], v9 offset:1280
ds_read_b128 v[88:91], v9 offset:10240
ds_read_b128 v[92:95], v9 offset:11520
ds_read_b128 v[96:99], v9 offset:20480
ds_read_b128 v[100:103], v9 offset:21760
ds_read_b128 v[104:107], v9 offset:30720
ds_read_b128 v[108:111], v9 offset:32000
v_lshlrev_b32 v48, 16, v20
v_and_b32 v49, 0xffff0000, v20
v_lshlrev_b32 v50, 16, v21
v_and_b32 v51, 0xffff0000, v21
v_lshlrev_b32 v52, 16, v22
v_and_b32 v53, 0xffff0000, v22
v_lshlrev_b32 v54, 16, v23
v_and_b32 v55, 0xffff0000, v23
s_waitcnt lgkmcnt(6)
v_pk_add_f32 v[48:49], v[48:49], v[80:81]
v_pk_add_f32 v[50:51], v[50:51], v[82:83]
v_pk_add_f32 v[52:53], v[52:53], v[84:85]
v_pk_add_f32 v[54:55], v[54:55], v[86:87]
s_waitcnt lgkmcnt(4)
v_pk_add_f32 v[48:49], v[48:49], v[88:89]
v_pk_add_f32 v[50:51], v[50:51], v[90:91]
v_pk_add_f32 v[52:53], v[52:53], v[92:93]
v_pk_add_f32 v[54:55], v[54:55], v[94:95]
s_waitcnt lgkmcnt(2)
v_pk_add_f32 v[48:49], v[48:49], v[96:97]
v_pk_add_f32 v[50:51], v[50:51], v[98:99]
v_pk_add_f32 v[52:53], v[52:53], v[100:101]
v_pk_add_f32 v[54:55], v[54:55], v[102:103]
s_waitcnt lgkmcnt(0)
v_pk_add_f32 v[48:49], v[48:49], v[104:105]
v_pk_add_f32 v[50:51], v[50:51], v[106:107]
v_pk_add_f32 v[52:53], v[52:53], v[108:109]
v_pk_add_f32 v[54:55], v[54:55], v[110:111]
v_cvt_pk_bf16_f32 v20, v48, v49
v_cvt_pk_bf16_f32 v21, v50, v51
v_cvt_pk_bf16_f32 v22, v52, v53
v_cvt_pk_bf16_f32 v23, v54, v55
buffer_store_dwordx4 v[20:23], v10, s[8:11], s27 offen sc1
s_add_u32 s27, s27, 28672
v_lshlrev_b32 v48, 16, v20
v_and_b32 v49, 0xffff0000, v20
v_lshlrev_b32 v50, 16, v21
v_and_b32 v51, 0xffff0000, v21
v_lshlrev_b32 v52, 16, v22
v_and_b32 v53, 0xffff0000, v22
v_lshlrev_b32 v54, 16, v23
v_and_b32 v55, 0xffff0000, v23
v_pk_add_f32 v[80:81], v[48:49], v[50:51]
v_pk_mul_f32 v[82:83], v[48:49], v[48:49]
v_pk_add_f32 v[84:85], v[52:53], v[54:55]
v_pk_fma_f32 v[82:83], v[50:51], v[50:51], v[82:83]
v_pk_fma_f32 v[82:83], v[52:53], v[52:53], v[82:83]
v_pk_fma_f32 v[82:83], v[54:55], v[54:55], v[82:83]
v_pk_add_f32 v[80:81], v[80:81], v[84:85]
v_add_f32 v80, v80, v81
v_add_f32 v81, v82, v83
s_nop 0
v_add_f32_dpp v80, v80, v80 row_ror:8 row_mask:0xf bank_mask:0xf
v_add_f32_dpp v81, v81, v81 row_ror:8 row_mask:0xf bank_mask:0xf
v_mov_b32 v82, v80
v_mov_b32 v83, v81
s_nop 0
v_permlane16_swap_b32 v80, v82
v_permlane16_swap_b32 v81, v83
v_pk_add_f32 v[80:81], v[80:81], v[82:83]
v_mov_b32 v82, v80
v_mov_b32 v83, v81
s_nop 0
v_permlane32_swap_b32 v80, v82
v_permlane32_swap_b32 v81, v83
v_pk_add_f32 v[80:81], v[80:81], v[82:83]
s_mov_b64 exec, s[36:37]
buffer_store_dwordx2 v[80:81], v11, s[8:11], s28 offen sc1
s_mov_b64 exec, -1
s_add_u32 s28, s28, 2048
buffer_load_dword v13, v7, s[8:11], s29 offen sc1
s_waitcnt vmcnt(1)
s_mov_b64 exec, 1
buffer_store_dword v5, v4, s[8:11], s30 offen sc1
s_mov_b64 exec, -1
s_add_u32 s30, s30, 512
s_cmp_ge_u32 s15, 64
s_cbranch_scc0 OPT_424
s_endpgm
OPT_424:
s_waitcnt vmcnt(1)
s_branch F2_C1_399
F2_P0_402:
s_add_u32 s29, s29, 512
s_mov_b32 s32, 1
s_waitcnt vmcnt(13)
v_mfma_f32_32x32x16_bf16 v[48:63], a[0:3], v[112:115], 0
buffer_load_dwordx4 v[160:163], v2, s[8:11], s25 offen offset:0 sc1
v_mfma_f32_32x32x16_bf16 v[64:79], a[112:115], v[112:115], 0
s_waitcnt vmcnt(13)
v_mfma_f32_32x32x16_bf16 v[48:63], a[4:7], v[116:119], v[48:63]
buffer_load_dwordx4 v[164:167], v2, s[8:11], s25 offen offset:1024 sc1
v_mfma_f32_32x32x16_bf16 v[64:79], a[116:119], v[116:119], v[64:79]
s_waitcnt vmcnt(13)
v_mfma_f32_32x32x16_bf16 v[48:63], a[8:11], v[120:123], v[48:63]
buffer_load_dwordx4 v[168:171], v2, s[8:11], s25 offen offset:2048 sc1
v_mfma_f32_32x32x16_bf16 v[64:79], a[120:123], v[120:123], v[64:79]
s_waitcnt vmcnt(13)
v_mfma_f32_32x32x16_bf16 v[48:63], a[12:15], v[124:127], v[48:63]
buffer_load_dword v13, v7, s[8:11], s29 offen sc1
buffer_load_dwordx4 v[172:175], v2, s[8:11], s25 offen offset:3072 sc1
s_add_u32 s25, s25, 4096
v_mfma_f32_32x32x16_bf16 v[64:79], a[124:127], v[124:127], v[64:79]
s_waitcnt vmcnt(14)
v_mfma_f32_32x32x16_bf16 v[48:63], a[16:19], v[128:131], v[48:63]
buffer_load_dwordx4 v[176:179], v2, s[8:11], s25 offen offset:0 sc1
v_mfma_f32_32x32x16_bf16 v[64:79], a[128:131], v[128:131], v[64:79]
s_waitcnt vmcnt(14)
v_mfma_f32_32x32x16_bf16 v[48:63], a[20:23], v[132:135], v[48:63]
buffer_load_dwordx4 v[180:183], v2, s[8:11], s25 offen offset:1024 sc1
v_mfma_f32_32x32x16_bf16 v[64:79], a[132:135], v[132:135], v[64:79]
s_waitcnt vmcnt(14)
s_cmp_eq_u32 s32, 0
s_cbranch_scc1 OPT_426
s_getreg_b32 s20, hwreg(HW_REG_IB_STS)
s_and_b32 s20, s20, 0xc0000f
s_cmp_gt_u32 s20, 7
s_cbranch_scc1 OPT_426
s_waitcnt vmcnt(7)
s_mov_b64 exec, 1
buffer_store_dword v5, v4, s[8:11], s30 offen sc1
s_mov_b64 exec, -1
s_add_u32 s30, s30, 512
s_mov_b32 s32, 0
OPT_426:
v_mfma_f32_32x32x16_bf16 v[48:63], a[24:27], v[136:139], v[48:63]
buffer_load_dwordx4 v[184:187], v2, s[8:11], s25 offen offset:2048 sc1
v_mfma_f32_32x32x16_bf16 v[64:79], a[136:139], v[136:139], v[64:79]
s_waitcnt vmcnt(14)
v_mfma_f32_32x32x16_bf16 v[48:63], a[28:31], v[140:143], v[48:63]
buffer_load_dwordx4 v[188:191], v2, s[8:11], s25 offen offset:3072 sc1
s_add_u32 s25, s25, 4096
v_mfma_f32_32x32x16_bf16 v[64:79], a[140:143], v[140:143], v[64:79]
s_waitcnt vmcnt(14)
v_mfma_f32_32x32x16_bf16 v[48:63], a[32:35], v[144:147], v[48:63]
buffer_load_dwordx4 v[192:195], v2, s[8:11], s25 offen offset:0 sc1
v_mfma_f32_32x32x16_bf16 v[64:79], a[144:147], v[144:147], v[64:79]
s_waitcnt vmcnt(14)
s_cmp_eq_u32 s32, 0
s_cbranch_scc1 OPT_428
s_getreg_b32 s20, hwreg(HW_REG_IB_STS)
s_and_b32 s20, s20, 0xc0000f
s_cmp_gt_u32 s20, 10
s_cbranch_scc1 OPT_428
s_waitcnt vmcnt(10)
s_mov_b64 exec, 1
buffer_store_dword v5, v4, s[8:11], s30 offen sc1
s_mov_b64 exec, -1
s_add_u32 s30, s30, 512
s_mov_b32 s32, 0
OPT_428:
v_mfma_f32_32x32x16_bf16 v[48:63], a[36:39], v[148:151], v[48:63]
buffer_load_dwordx4 v[196:199], v2, s[8:11], s25 offen offset:1024 sc1
v_mfma_f32_32x32x16_bf16 v[64:79], a[148:151], v[148:151], v[64:79]
s_waitcnt vmcnt(14)
v_mfma_f32_32x32x16_bf16 v[48:63], a[40:43], v[152:155], v[48:63]
buffer_load_dwordx4 v[200:203], v2, s[8:11], s25 offen offset:2048 sc1
v_mfma_f32_32x32x16_bf16 v[64:79], a[152:155], v[152:155], v[64:79]
s_waitcnt vmcnt(14)
v_mfma_f32_32x32x16_bf16 v[48:63], a[44:47], v[156:159], v[48:63]
buffer_load_dwordx4 v[204:207], v2, s[8:11], s25 offen offset:3072 sc1
s_add_u32 s25, s25, 4096
v_mfma_f32_32x32x16_bf16 v[64:79], a[156:159], v[156:159], v[64:79]
s_waitcnt vmcnt(12)
v_mfma_f32_32x32x16_bf16 v[48:63], a[48:51], v[160:163], v[48:63]
buffer_load_dwordx4 v[208:211], v2, s[8:11], s25 offen offset:0 sc1
v_mfma_f32_32x32x16_bf16 v[64:79], a[160:163], v[160:163], v[64:79]
s_waitcnt vmcnt(12)
v_mfma_f32_32x32x16_bf16 v[48:63], a[52:55], v[164:167], v[48:63]
buffer_load_dwordx4 v[212:215], v2, s[8:11], s25 offen offset:1024 sc1
v_mfma_f32_32x32x16_bf16 v[64:79], a[164:167], v[164:167], v[64:79]
s_waitcnt vmcnt(12)
v_mfma_f32_32x32x16_bf16 v[48:63], a[56:59], v[168:171], v[48:63]
buffer_load_dwordx4 v[216:219], v2, s[8:11], s25 offen offset:2048 sc1
v_mfma_f32_32x32x16_bf16 v[64:79], a[168:171], v[168:171], v[64:79]
s_waitcnt vmcnt(11)
s_cmp_eq_u32 s32, 0
s_cbranch_scc1 OPT_430
s_mov_b64 exec, 1
buffer_store_dword v5, v4, s[8:11], s30 offen sc1
s_mov_b64 exec, -1
s_add_u32 s30, s30, 512
s_mov_b32 s32, 0
OPT_430:
v_mfma_f32_32x32x16_bf16 v[48:63], a[60:63], v[172:175], v[48:63]
buffer_load_dwordx4 v[20:23], v10, s[8:11], s26 offen sc1
s_add_u32 s26, s26, 28672
buffer_load_dwordx4 v[220:223], v2, s[8:11], s25 offen offset:3072 sc1
s_add_u32 s25, s25, 90112
v_mfma_f32_32x32x16_bf16 v[64:79], a[172:175], v[172:175], v[64:79]
s_add_u32 s15, s15, 1
v_cmp_eq_u32 vcc, 0, v13
s_cmp_eq_u32 s15, 64
s_cselect_b64 vcc, -1, vcc
s_cbranch_vccnz F2_NP_431
s_waitcnt vmcnt(12)
v_mfma_f32_32x32x16_bf16 v[48:63], a[64:67], v[176:179], v[48:63]
buffer_load_dwordx4 v[112:115], v2, s[8:11], s25 offen offset:0 sc1
v_mfma_f32_32x32x16_bf16 v[64:79], a[176:179], v[176:179], v[64:79]
s_waitcnt vmcnt(12)
v_mfma_f32_32x32x16_bf16 v[48:63], a[68:71], v[180:183], v[48:63]
buffer_load_dwordx4 v[116:119], v2, s[8:11], s25 offen offset:1024 sc1
v_mfma_f32_32x32x16_bf16 v[64:79], a[180:183], v[180:183], v[64:79]
s_waitcnt vmcnt(12)
v_mfma_f32_32x32x16_bf16 v[48:63], a[72:75], v[184:187], v[48:63]
buffer_load_dwordx4 v[120:123], v2, s[8:11], s25 offen offset:2048 sc1
v_mfma_f32_32x32x16_bf16 v[64:79], a[184:187], v[184:187], v[64:79]
s_waitcnt vmcnt(12)
v_mfma_f32_32x32x16_bf16 v[48:63], a[76:79], v[188:191], v[48:63]
buffer_load_dwordx4 v[124:127], v2, s[8:11], s25 offen offset:3072 sc1
s_add_u32 s25, s25, 4096
v_mfma_f32_32x32x16_bf16 v[64:79], a[188:191], v[188:191], v[64:79]
s_waitcnt vmcnt(12)
v_mfma_f32_32x32x16_bf16 v[48:63], a[80:83], v[192:195], v[48:63]
buffer_load_dwordx4 v[128:131], v2, s[8:11], s25 offen offset:0 sc1
v_mfma_f32_32x32x16_bf16 v[64:79], a[192:195], v[192:195], v[64:79]
s_waitcnt vmcnt(12)
v_mfma_f32_32x32x16_bf16 v[48:63], a[84:87], v[196:199], v[48:63]
buffer_load_dwordx4 v[132:135], v2, s[8:11], s25 offen offset:1024 sc1
v_mfma_f32_32x32x16_bf16 v[64:79], a[196:199], v[196:199], v[64:79]
s_waitcnt vmcnt(12)
v_mfma_f32_32x32x16_bf16 v[48:63], a[88:91], v[200:203], v[48:63]
buffer_load_dwordx4 v[136:139], v2, s[8:11], s25 offen offset:2048 sc1
v_mfma_f32_32x32x16_bf16 v[64:79], a[200:203], v[200:203], v[64:79]
s_waitcnt vmcnt(12)
v_mfma_f32_32x32x16_bf16 v[48:63], a[92:95], v[204:207], v[48:63]
buffer_load_dwordx4 v[140:143], v2, s[8:11], s25 offen offset:3072 sc1
s_add_u32 s25, s25, 4096
v_mfma_f32_32x32x16_bf16 v[64:79], a[204:207], v[204:207], v[64:79]
s_waitcnt vmcnt(12)
v_mfma_f32_32x32x16_bf16 v[48:63], a[96:99], v[208:211], v[48:63]
buffer_load_dwordx4 v[144:147], v2, s[8:11], s25 offen offset:0 sc1
v_mfma_f32_32x32x16_bf16 v[64:79], a[208:211], v[208:211], v[64:79]
s_waitcnt vmcnt(12)
v_mfma_f32_32x32x16_bf16 v[48:63], a[100:103], v[212:215], v[48:63]
buffer_load_dwordx4 v[148:151], v2, s[8:11], s25 offen offset:1024 sc1
v_mfma_f32_32x32x16_bf16 v[64:79], a[212:215], v[212:215], v[64:79]
s_waitcnt vmcnt(12)
v_mfma_f32_32x32x16_bf16 v[48:63], a[104:107], v[216:219], v[48:63]
buffer_load_dwordx4 v[152:155], v2, s[8:11], s25 offen offset:2048 sc1
v_mfma_f32_32x32x16_bf16 v[64:79], a[216:219], v[216:219], v[64:79]
s_waitcnt vmcnt(11)
v_mfma_f32_32x32x16_bf16 v[48:63], a[108:111], v[220:223], v[48:63]
buffer_load_dwordx4 v[156:159], v2, s[8:11], s25 offen offset:3072 sc1
s_add_u32 s25, s25, 4096
v_mfma_f32_32x32x16_bf16 v[64:79], a[220:223], v[220:223], v[64:79]
s_nop 10
s_branch F2_W1_401
F2_NP_431:
s_waitcnt vmcnt(12)
v_mfma_f32_32x32x16_bf16 v[48:63], a[64:67], v[176:179], v[48:63]
v_mfma_f32_32x32x16_bf16 v[64:79], a[176:179], v[176:179], v[64:79]
s_waitcnt vmcnt(11)
v_mfma_f32_32x32x16_bf16 v[48:63], a[68:71], v[180:183], v[48:63]
v_mfma_f32_32x32x16_bf16 v[64:79], a[180:183], v[180:183], v[64:79]
s_waitcnt vmcnt(10)
v_mfma_f32_32x32x16_bf16 v[48:63], a[72:75], v[184:187], v[48:63]
v_mfma_f32_32x32x16_bf16 v[64:79], a[184:187], v[184:187], v[64:79]
s_waitcnt vmcnt(9)
v_mfma_f32_32x32x16_bf16 v[48:63], a[76:79], v[188:191], v[48:63]
v_mfma_f32_32x32x16_bf16 v[64:79], a[188:191], v[188:191], v[64:79]
s_waitcnt vmcnt(8)
v_mfma_f32_32x32x16_bf16 v[48:63], a[80:83], v[192:195], v[48:63]
v_mfma_f32_32x32x16_bf16 v[64:79], a[192:195], v[192:195], v[64:79]
s_waitcnt vmcnt(7)
v_mfma_f32_32x32x16_bf16 v[48:63], a[84:87], v[196:199], v[48:63]
buffer_load_dword v13, v7, s[8:11], s29 offen sc1
v_mfma_f32_32x32x16_bf16 v[64:79], a[196:199], v[196:199], v[64:79]
s_waitcnt vmcnt(7)
v_mfma_f32_32x32x16_bf16 v[48:63], a[88:91], v[200:203], v[48:63]
s_waitcnt vmcnt(6)
v_mfma_f32_32x32x16_bf16 v[48:63], a[92:95], v[204:207], v[48:63]
s_waitcnt vmcnt(5)
v_mfma_f32_32x32x16_bf16 v[48:63], a[96:99], v[208:211], v[48:63]
s_waitcnt vmcnt(4)
v_mfma_f32_32x32x16_bf16 v[48:63], a[100:103], v[212:215], v[48:63]
s_waitcnt vmcnt(3)
v_mfma_f32_32x32x16_bf16 v[48:63], a[104:107], v[216:219], v[48:63]
s_waitcnt vmcnt(1)
v_mfma_f32_32x32x16_bf16 v[48:63], a[108:111], v[220:223], v[48:63]
v_mfma_f32_32x32x16_bf16 v[64:79], a[200:203], v[200:203], v[64:79]
s_nop 4
v_mfma_f32_32x32x16_bf16 v[64:79], a[204:207], v[204:207], v[64:79]
s_nop 4
v_mfma_f32_32x32x16_bf16 v[64:79], a[208:211], v[208:211], v[64:79]
ds_write_b128 v8, v[48:51] offset:0
v_mfma_f32_32x32x16_bf16 v[64:79], a[212:215], v[212:215], v[64:79]
ds_write_b128 v8, v[52:55] offset:1280
v_mfma_f32_32x32x16_bf16 v[64:79], a[216:219], v[216:219], v[64:79]
ds_write_b128 v8, v[56:59] offset:2560
v_mfma_f32_32x32x16_bf16 v[64:79], a[220:223], v[220:223], v[64:79]
ds_write_b128 v8, v[60:63] offset:3840
s_waitcnt vmcnt(0)
v_cmp_eq_u32 vcc, 0, v13
s_cmp_eq_u32 s15, 64
s_cselect_b64 vcc, -1, vcc
s_cbranch_vccnz F2_CE_432
buffer_load_dwordx4 v[112:115], v2, s[8:11], s25 offen offset:0 sc1
buffer_load_dwordx4 v[116:119], v2, s[8:11], s25 offen offset:1024 sc1
s_nop 3
ds_write_b128 v8, v[64:67] offset:5120
buffer_load_dwordx4 v[120:123], v2, s[8:11], s25 offen offset:2048 sc1
ds_write_b128 v8, v[68:71] offset:6400
buffer_load_dwordx4 v[124:127], v2, s[8:11], s25 offen offset:3072 sc1
s_add_u32 s25, s25, 4096
ds_write_b128 v8, v[72:75] offset:7680
buffer_load_dwordx4 v[128:131], v2, s[8:11], s25 offen offset:0 sc1
ds_write_b128 v8, v[76:79] offset:8960
buffer_load_dwordx4 v[132:135], v2, s[8:11], s25 offen offset:1024 sc1
buffer_load_dwordx4 v[136:139], v2, s[8:11], s25 offen offset:2048 sc1
buffer_load_dwordx4 v[140:143], v2, s[8:11], s25 offen offset:3072 sc1
s_add_u32 s25, s25, 4096
buffer_load_dwordx4 v[144:147], v2, s[8:11], s25 offen offset:0 sc1
buffer_load_dwordx4 v[148:151], v2, s[8:11], s25 offen offset:1024 sc1
buffer_load_dwordx4 v[152:155], v2, s[8:11], s25 offen offset:2048 sc1
buffer_load_dwordx4 v[156:159], v2, s[8:11], s25 offen offset:3072 sc1
s_add_u32 s25, s25, 4096
s_waitcnt lgkmcnt(0)
s_barrier
ds_read_b128 v[80:83], v9 offset:0
ds_read_b128 v[84:87], v9 offset:1280
ds_read_b128 v[88:91], v9 offset:10240
ds_read_b128 v[92:95], v9 offset:11520
ds_read_b128 v[96:99], v9 offset:20480
ds_read_b128 v[100:103], v9 offset:21760
ds_read_b128 v[104:107], v9 offset:30720
ds_read_b128 v[108:111], v9 offset:32000
v_lshlrev_b32 v48, 16, v20
v_and_b32 v49, 0xffff0000, v20
v_lshlrev_b32 v50, 16, v21
v_and_b32 v51, 0xffff0000, v21
v_lshlrev_b32 v52, 16, v22
v_and_b32 v53, 0xffff0000, v22
v_lshlrev_b32 v54, 16, v23
v_and_b32 v55, 0xffff0000, v23
s_waitcnt lgkmcnt(6)
v_pk_add_f32 v[48:49], v[48:49], v[80:81]
v_pk_add_f32 v[50:51], v[50:51], v[82:83]
v_pk_add_f32 v[52:53], v[52:53], v[84:85]
v_pk_add_f32 v[54:55], v[54:55], v[86:87]
s_waitcnt lgkmcnt(4)
v_pk_add_f32 v[48:49], v[48:49], v[88:89]
v_pk_add_f32 v[50:51], v[50:51], v[90:91]
v_pk_add_f32 v[52:53], v[52:53], v[92:93]
v_pk_add_f32 v[54:55], v[54:55], v[94:95]
s_waitcnt lgkmcnt(2)
v_pk_add_f32 v[48:49], v[48:49], v[96:97]
v_pk_add_f32 v[50:51], v[50:51], v[98:99]
v_pk_add_f32 v[52:53], v[52:53], v[100:101]
v_pk_add_f32 v[54:55], v[54:55], v[102:103]
s_waitcnt lgkmcnt(0)
v_pk_add_f32 v[48:49], v[48:49], v[104:105]
v_pk_add_f32 v[50:51], v[50:51], v[106:107]
v_pk_add_f32 v[52:53], v[52:53], v[108:109]
v_pk_add_f32 v[54:55], v[54:55], v[110:111]
v_cvt_pk_bf16_f32 v20, v48, v49
v_cvt_pk_bf16_f32 v21, v50, v51
v_cvt_pk_bf16_f32 v22, v52, v53
v_cvt_pk_bf16_f32 v23, v54, v55
buffer_store_dwordx4 v[20:23], v10, s[8:11], s27 offen sc1
s_add_u32 s27, s27, 28672
v_lshlrev_b32 v48, 16, v20
v_and_b32 v49, 0xffff0000, v20
v_lshlrev_b32 v50, 16, v21
v_and_b32 v51, 0xffff0000, v21
v_lshlrev_b32 v52, 16, v22
v_and_b32 v53, 0xffff0000, v22
v_lshlrev_b32 v54, 16, v23
v_and_b32 v55, 0xffff0000, v23
v_pk_add_f32 v[80:81], v[48:49], v[50:51]
v_pk_mul_f32 v[82:83], v[48:49], v[48:49]
v_pk_add_f32 v[84:85], v[52:53], v[54:55]
v_pk_fma_f32 v[82:83], v[50:51], v[50:51], v[82:83]
v_pk_fma_f32 v[82:83], v[52:53], v[52:53], v[82:83]
v_pk_fma_f32 v[82:83], v[54:55], v[54:55], v[82:83]
v_pk_add_f32 v[80:81], v[80:81], v[84:85]
v_add_f32 v80, v80, v81
v_add_f32 v81, v82, v83
s_nop 0
v_add_f32_dpp v80, v80, v80 row_ror:8 row_mask:0xf bank_mask:0xf
v_add_f32_dpp v81, v81, v81 row_ror:8 row_mask:0xf bank_mask:0xf
v_mov_b32 v82, v80
v_mov_b32 v83, v81
s_nop 0
v_permlane16_swap_b32 v80, v82
v_permlane16_swap_b32 v81, v83
v_pk_add_f32 v[80:81], v[80:81], v[82:83]
v_mov_b32 v82, v80
v_mov_b32 v83, v81
s_nop 0
v_permlane32_swap_b32 v80, v82
v_permlane32_swap_b32 v81, v83
v_pk_add_f32 v[80:81], v[80:81], v[82:83]
s_mov_b64 exec, s[36:37]
buffer_store_dwordx2 v[80:81], v11, s[8:11], s28 offen sc1
s_mov_b64 exec, -1
s_add_u32 s28, s28, 2048
s_branch F2_P1_403
F2_CE_432:
s_nop 5
ds_write_b128 v8, v[64:67] offset:5120
ds_write_b128 v8, v[68:71] offset:6400
ds_write_b128 v8, v[72:75] offset:7680
ds_write_b128 v8, v[76:79] offset:8960
s_waitcnt lgkmcnt(0)
s_barrier
ds_read_b128 v[80:83], v9 offset:0
ds_read_b128 v[84:87], v9 offset:1280
ds_read_b128 v[88:91], v9 offset:10240
ds_read_b128 v[92:95], v9 offset:11520
ds_read_b128 v[96:99], v9 offset:20480
ds_read_b128 v[100:103], v9 offset:21760
ds_read_b128 v[104:107], v9 offset:30720
ds_read_b128 v[108:111], v9 offset:32000
v_lshlrev_b32 v48, 16, v20
v_and_b32 v49, 0xffff0000, v20
v_lshlrev_b32 v50, 16, v21
v_and_b32 v51, 0xffff0000, v21
v_lshlrev_b32 v52, 16, v22
v_and_b32 v53, 0xffff0000, v22
v_lshlrev_b32 v54, 16, v23
v_and_b32 v55, 0xffff0000, v23
s_waitcnt lgkmcnt(6)
v_pk_add_f32 v[48:49], v[48:49], v[80:81]
v_pk_add_f32 v[50:51], v[50:51], v[82:83]
v_pk_add_f32 v[52:53], v[52:53], v[84:85]
v_pk_add_f32 v[54:55], v[54:55], v[86:87]
s_waitcnt lgkmcnt(4)
v_pk_add_f32 v[48:49], v[48:49], v[88:89]
v_pk_add_f32 v[50:51], v[50:51], v[90:91]
v_pk_add_f32 v[52:53], v[52:53], v[92:93]
v_pk_add_f32 v[54:55], v[54:55], v[94:95]
s_waitcnt lgkmcnt(2)
v_pk_add_f32 v[48:49], v[48:49], v[96:97]
v_pk_add_f32 v[50:51], v[50:51], v[98:99]
v_pk_add_f32 v[52:53], v[52:53], v[100:101]
v_pk_add_f32 v[54:55], v[54:55], v[102:103]
s_waitcnt lgkmcnt(0)
v_pk_add_f32 v[48:49], v[48:49], v[104:105]
v_pk_add_f32 v[50:51], v[50:51], v[106:107]
v_pk_add_f32 v[52:53], v[52:53], v[108:109]
v_pk_add_f32 v[54:55], v[54:55], v[110:111]
v_cvt_pk_bf16_f32 v20, v48, v49
v_cvt_pk_bf16_f32 v21, v50, v51
v_cvt_pk_bf16_f32 v22, v52, v53
v_cvt_pk_bf16_f32 v23, v54, v55
buffer_store_dwordx4 v[20:23], v10, s[8:11], s27 offen sc1
s_add_u32 s27, s27, 28672
v_lshlrev_b32 v48, 16, v20
v_and_b32 v49, 0xffff0000, v20
v_lshlrev_b32 v50, 16, v21
v_and_b32 v51, 0xffff0000, v21
v_lshlrev_b32 v52, 16, v22
v_and_b32 v53, 0xffff0000, v22
v_lshlrev_b32 v54, 16, v23
v_and_b32 v55, 0xffff0000, v23
v_pk_add_f32 v[80:81], v[48:49], v[50:51]
v_pk_mul_f32 v[82:83], v[48:49], v[48:49]
v_pk_add_f32 v[84:85], v[52:53], v[54:55]
v_pk_fma_f32 v[82:83], v[50:51], v[50:51], v[82:83]
v_pk_fma_f32 v[82:83], v[52:53], v[52:53], v[82:83]
v_pk_fma_f32 v[82:83], v[54:55], v[54:55], v[82:83]
v_pk_add_f32 v[80:81], v[80:81], v[84:85]
v_add_f32 v80, v80, v81
v_add_f32 v81, v82, v83
s_nop 0
v_add_f32_dpp v80, v80, v80 row_ror:8 row_mask:0xf bank_mask:0xf
v_add_f32_dpp v81, v81, v81 row_ror:8 row_mask:0xf bank_mask:0xf
v_mov_b32 v82, v80
v_mov_b32 v83, v81
s_nop 0
v_permlane16_swap_b32 v80, v82
v_permlane16_swap_b32 v81, v83
v_pk_add_f32 v[80:81], v[80:81], v[82:83]
v_mov_b32 v82, v80
v_mov_b32 v83, v81
s_nop 0
v_permlane32_swap_b32 v80, v82
v_permlane32_swap_b32 v81, v83
v_pk_add_f32 v[80:81], v[80:81], v[82:83]
s_mov_b64 exec, s[36:37]
buffer_store_dwordx2 v[80:81], v11, s[8:11], s28 offen sc1
s_mov_b64 exec, -1
s_add_u32 s28, s28, 2048
buffer_load_dword v13, v7, s[8:11], s29 offen sc1
s_waitcnt vmcnt(1)
s_mov_b64 exec, 1
buffer_store_dword v5, v4, s[8:11], s30 offen sc1
s_mov_b64 exec, -1
s_add_u32 s30, s30, 512
s_cmp_ge_u32 s15, 64
s_cbranch_scc0 OPT_433
s_endpgm
OPT_433:
s_waitcnt vmcnt(1)
s_branch F2_C1_399
F2_C1_399:
v_cmp_eq_u32 vcc, 0, v13
s_cbranch_vccz OPT_434
s_nop 2
s_branch WF_435_in
WF_435:
s_sleep 1
WF_435_in:
buffer_load_dword v18, v7, s[8:11], s29 offen sc1
s_sub_u32 s16, s16, 1
s_cbranch_scc1 WFD_436_abort
s_waitcnt vmcnt(0)
v_cmp_eq_u32 vcc, 0, v18
s_cbranch_vccnz WF_435
WFD_436:
OPT_434:
buffer_load_dwordx4 v[112:115], v2, s[8:11], s25 offen offset:0 sc1
buffer_load_dwordx4 v[116:119], v2, s[8:11], s25 offen offset:1024 sc1
buffer_load_dwordx4 v[120:123], v2, s[8:11], s25 offen offset:2048 sc1
buffer_load_dwordx4 v[124:127], v2, s[8:11], s25 offen offset:3072 sc1
s_add_u32 s25, s25, 4096
buffer_load_dwordx4 v[128:131], v2, s[8:11], s25 offen offset:0 sc1
buffer_load_dwordx4 v[132:135], v2, s[8:11], s25 offen offset:1024 sc1
buffer_load_dwordx4 v[136:139], v2, s[8:11], s25 offen offset:2048 sc1
buffer_load_dwordx4 v[140:143], v2, s[8:11], s25 offen offset:3072 sc1
s_add_u32 s25, s25, 4096
buffer_load_dwordx4 v[144:147], v2, s[8:11], s25 offen offset:0 sc1
buffer_load_dwordx4 v[148:151], v2, s[8:11], s25 offen offset:1024 sc1
buffer_load_dwordx4 v[152:155], v2, s[8:11], s25 offen offset:2048 sc1
buffer_load_dwordx4 v[156:159], v2, s[8:11], s25 offen offset:3072 sc1
s_add_u32 s25, s25, 4096
s_add_u32 s29, s29, 512
s_mov_b32 s32, 1
s_waitcnt vmcnt(11)
v_mfma_f32_32x32x16_bf16 v[224:239], a[0:3], v[112:115], 0
buffer_load_dwordx4 v[160:163], v2, s[8:11], s25 offen offset:0 sc1
v_mfma_f32_32x32x16_bf16 v[240:255], a[112:115], v[112:115], 0
s_waitcnt vmcnt(11)
v_mfma_f32_32x32x16_bf16 v[224:239], a[4:7], v[116:119], v[224:239]
buffer_load_dwordx4 v[164:167], v2, s[8:11], s25 offen offset:1024 sc1
v_mfma_f32_32x32x16_bf16 v[240:255], a[116:119], v[116:119], v[240:255]
s_waitcnt vmcnt(11)
v_mfma_f32_32x32x16_bf16 v[224:239], a[8:11], v[120:123], v[224:239]
buffer_load_dwordx4 v[168:171], v2, s[8:11], s25 offen offset:2048 sc1
v_mfma_f32_32x32x16_bf16 v[240:255], a[120:123], v[120:123], v[240:255]
s_waitcnt vmcnt(11)
v_mfma_f32_32x32x16_bf16 v[224:239], a[12:15], v[124:127], v[224:239]
buffer_load_dword v13, v7, s[8:11], s29 offen sc1
buffer_load_dwordx4 v[172:175], v2, s[8:11], s25 offen offset:3072 sc1
s_add_u32 s25, s25, 4096
v_mfma_f32_32x32x16_bf16 v[240:255], a[124:127], v[124:127], v[240:255]
s_waitcnt vmcnt(12)
v_mfma_f32_32x32x16_bf16 v[224:239], a[16:19], v[128:131], v[224:239]
buffer_load_dwordx4 v[176:179], v2, s[8:11], s25 offen offset:0 sc1
v_mfma_f32_32x32x16_bf16 v[240:255], a[128:131], v[128:131], v[240:255]
s_waitcnt vmcnt(12)
v_mfma_f32_32x32x16_bf16 v[224:239], a[20:23], v[132:135], v[224:239]
buffer_load_dwordx4 v[180:183], v2, s[8:11], s25 offen offset:1024 sc1
v_mfma_f32_32x32x16_bf16 v[240:255], a[132:135], v[132:135], v[240:255]
s_waitcnt vmcnt(12)
v_mfma_f32_32x32x16_bf16 v[224:239], a[24:27], v[136:139], v[224:239]
buffer_load_dwordx4 v[184:187], v2, s[8:11], s25 offen offset:2048 sc1
v_mfma_f32_32x32x16_bf16 v[240:255], a[136:139], v[136:139], v[240:255]
s_waitcnt vmcnt(12)
v_mfma_f32_32x32x16_bf16 v[224:239], a[28:31], v[140:143], v[224:239]
buffer_load_dwordx4 v[188:191], v2, s[8:11], s25 offen offset:3072 sc1
s_add_u32 s25, s25, 4096
v_mfma_f32_32x32x16_bf16 v[240:255], a[140:143], v[140:143], v[240:255]
s_waitcnt vmcnt(12)
v_mfma_f32_32x32x16_bf16 v[224:239], a[32:35], v[144:147], v[224:239]
buffer_load_dwordx4 v[192:195], v2, s[8:11], s25 offen offset:0 sc1
v_mfma_f32_32x32x16_bf16 v[240:255], a[144:147], v[144:147], v[240:255]
s_waitcnt vmcnt(12)
v_mfma_f32_32x32x16_bf16 v[224:239], a[36:39], v[148:151], v[224:239]
buffer_load_dwordx4 v[196:199], v2, s[8:11], s25 offen offset:1024 sc1
v_mfma_f32_32x32x16_bf16 v[240:255], a[148:151], v[148:151], v[240:255]
s_waitcnt vmcnt(12)
v_mfma_f32_32x32x16_bf16 v[224:239], a[40:43], v[152:155], v[224:239]
buffer_load_dwordx4 v[200:203], v2, s[8:11], s25 offen offset:2048 sc1
v_mfma_f32_32x32x16_bf16 v[240:255], a[152:155], v[152:155], v[240:255]
s_waitcnt vmcnt(12)
v_mfma_f32_32x32x16_bf16 v[224:239], a[44:47], v[156:159], v[224:239]
buffer_load_dwordx4 v[204:207], v2, s[8:11], s25 offen offset:3072 sc1
s_add_u32 s25, s25, 4096
v_mfma_f32_32x32x16_bf16 v[240:255], a[156:159], v[156:159], v[240:255]
s_waitcnt vmcnt(12)
v_mfma_f32_32x32x16_bf16 v[224:239], a[48:51], v[160:163], v[224:239]
buffer_load_dwordx4 v[208:211], v2, s[8:11], s25 offen offset:0 sc1
v_mfma_f32_32x32x16_bf16 v[240:255], a[160:163], v[160:163], v[240:255]
s_waitcnt vmcnt(12)
v_mfma_f32_32x32x16_bf16 v[224:239], a[52:55], v[164:167], v[224:239]
buffer_load_dwordx4 v[212:215], v2, s[8:11], s25 offen offset:1024 sc1
v_mfma_f32_32x32x16_bf16 v[240:255], a[164:167], v[164:167], v[240:255]
s_waitcnt vmcnt(12)
v_mfma_f32_32x32x16_bf16 v[224:239], a[56:59], v[168:171], v[224:239]
buffer_load_dwordx4 v[216:219], v2, s[8:11], s25 offen offset:2048 sc1
v_mfma_f32_32x32x16_bf16 v[240:255], a[168:171], v[168:171], v[240:255]
s_waitcnt vmcnt(11)
v_mfma_f32_32x32x16_bf16 v[224:239], a[60:63], v[172:175], v[224:239]
buffer_load_dwordx4 v[24:27], v10, s[8:11], s26 offen sc1
s_add_u32 s26, s26, 28672
buffer_load_dwordx4 v[220:223], v2, s[8:11], s25 offen offset:3072 sc1
s_add_u32 s25, s25, 90112
v_mfma_f32_32x32x16_bf16 v[240:255], a[172:175], v[172:175], v[240:255]
s_add_u32 s15, s15, 1
v_cmp_eq_u32 vcc, 0, v13
s_cmp_eq_u32 s15, 64
s_cselect_b64 vcc, -1, vcc
s_cbranch_vccnz F2_NP_437
s_waitcnt vmcnt(12)
v_mfma_f32_32x32x16_bf16 v[224:239], a[64:67], v[176:179], v[224:239]
buffer_load_dwordx4 v[112:115], v2, s[8:11], s25 offen offset:0 sc1
v_mfma_f32_32x32x16_bf16 v[240:255], a[176:179], v[176:179], v[240:255]
s_waitcnt vmcnt(12)
v_mfma_f32_32x32x16_bf16 v[224:239], a[68:71], v[180:183], v[224:239]
buffer_load_dwordx4 v[116:119], v2, s[8:11], s25 offen offset:1024 sc1
v_mfma_f32_32x32x16_bf16 v[240:255], a[180:183], v[180:183], v[240:255]
s_waitcnt vmcnt(12)
v_mfma_f32_32x32x16_bf16 v[224:239], a[72:75], v[184:187], v[224:239]
buffer_load_dwordx4 v[120:123], v2, s[8:11], s25 offen offset:2048 sc1
v_mfma_f32_32x32x16_bf16 v[240:255], a[184:187], v[184:187], v[240:255]
s_waitcnt vmcnt(12)
v_mfma_f32_32x32x16_bf16 v[224:239], a[76:79], v[188:191], v[224:239]
buffer_load_dwordx4 v[124:127], v2, s[8:11], s25 offen offset:3072 sc1
s_add_u32 s25, s25, 4096
v_mfma_f32_32x32x16_bf16 v[240:255], a[188:191], v[188:191], v[240:255]
s_waitcnt vmcnt(12)
v_mfma_f32_32x32x16_bf16 v[224:239], a[80:83], v[192:195], v[224:239]
buffer_load_dwordx4 v[128:131], v2, s[8:11], s25 offen offset:0 sc1
v_mfma_f32_32x32x16_bf16 v[240:255], a[192:195], v[192:195], v[240:255]
s_waitcnt vmcnt(12)
v_mfma_f32_32x32x16_bf16 v[224:239], a[84:87], v[196:199], v[224:239]
buffer_load_dwordx4 v[132:135], v2, s[8:11], s25 offen offset:1024 sc1
v_mfma_f32_32x32x16_bf16 v[240:255], a[196:199], v[196:199], v[240:255]
s_waitcnt vmcnt(12)
v_mfma_f32_32x32x16_bf16 v[224:239], a[88:91], v[200:203], v[224:239]
buffer_load_dwordx4 v[136:139], v2, s[8:11], s25 offen offset:2048 sc1
v_mfma_f32_32x32x16_bf16 v[240:255], a[200:203], v[200:203], v[240:255]
s_waitcnt vmcnt(12)
v_mfma_f32_32x32x16_bf16 v[224:239], a[92:95], v[204:207], v[224:239]
buffer_load_dwordx4 v[140:143], v2, s[8:11], s25 offen offset:3072 sc1
s_add_u32 s25, s25, 4096
v_mfma_f32_32x32x16_bf16 v[240:255], a[204:207], v[204:207], v[240:255]
s_waitcnt vmcnt(12)
v_mfma_f32_32x32x16_bf16 v[224:239], a[96:99], v[208:211], v[224:239]
buffer_load_dwordx4 v[144:147], v2, s[8:11], s25 offen offset:0 sc1
v_mfma_f32_32x32x16_bf16 v[240:255], a[208:211], v[208:211], v[240:255]
s_waitcnt vmcnt(12)
v_mfma_f32_32x32x16_bf16 v[224:239], a[100:103], v[212:215], v[224:239]
buffer_load_dwordx4 v[148:151], v2, s[8:11], s25 offen offset:1024 sc1
v_mfma_f32_32x32x16_bf16 v[240:255], a[212:215], v[212:215], v[240:255]
s_waitcnt vmcnt(12)
v_mfma_f32_32x32x16_bf16 v[224:239], a[104:107], v[216:219], v[224:239]
buffer_load_dwordx4 v[152:155], v2, s[8:11], s25 offen offset:2048 sc1
v_mfma_f32_32x32x16_bf16 v[240:255], a[216:219], v[216:219], v[240:255]
s_waitcnt vmcnt(11)
v_mfma_f32_32x32x16_bf16 v[224:239], a[108:111], v[220:223], v[224:239]
buffer_load_dwordx4 v[156:159], v2, s[8:11], s25 offen offset:3072 sc1
s_add_u32 s25, s25, 4096
v_mfma_f32_32x32x16_bf16 v[240:255], a[220:223], v[220:223], v[240:255]
s_nop 10
s_branch F2_W0_400
F2_NP_437:
s_waitcnt vmcnt(12)
v_mfma_f32_32x32x16_bf16 v[224:239], a[64:67], v[176:179], v[224:239]
v_mfma_f32_32x32x16_bf16 v[240:255], a[176:179], v[176:179], v[240:255]
s_waitcnt vmcnt(11)
v_mfma_f32_32x32x16_bf16 v[224:239], a[68:71], v[180:183], v[224:239]
v_mfma_f32_32x32x16_bf16 v[240:255], a[180:183], v[180:183], v[240:255]
s_waitcnt vmcnt(10)
v_mfma_f32_32x32x16_bf16 v[224:239], a[72:75], v[184:187], v[224:239]
v_mfma_f32_32x32x16_bf16 v[240:255], a[184:187], v[184:187], v[240:255]
s_waitcnt vmcnt(9)
v_mfma_f32_32x32x16_bf16 v[224:239], a[76:79], v[188:191], v[224:239]
v_mfma_f32_32x32x16_bf16 v[240:255], a[188:191], v[188:191], v[240:255]
s_waitcnt vmcnt(8)
v_mfma_f32_32x32x16_bf16 v[224:239], a[80:83], v[192:195], v[224:239]
v_mfma_f32_32x32x16_bf16 v[240:255], a[192:195], v[192:195], v[240:255]
s_waitcnt vmcnt(7)
v_mfma_f32_32x32x16_bf16 v[224:239], a[84:87], v[196:199], v[224:239]
buffer_load_dword v13, v7, s[8:11], s29 offen sc1
v_mfma_f32_32x32x16_bf16 v[240:255], a[196:199], v[196:199], v[240:255]
s_waitcnt vmcnt(7)
v_mfma_f32_32x32x16_bf16 v[224:239], a[88:91], v[200:203], v[224:239]
s_waitcnt vmcnt(6)
v_mfma_f32_32x32x16_bf16 v[224:239], a[92:95], v[204:207], v[224:239]
s_waitcnt vmcnt(5)
v_mfma_f32_32x32x16_bf16 v[224:239], a[96:99], v[208:211], v[224:239]
s_waitcnt vmcnt(4)
v_mfma_f32_32x32x16_bf16 v[224:239], a[100:103], v[212:215], v[224:239]
s_waitcnt vmcnt(3)
v_mfma_f32_32x32x16_bf16 v[224:239], a[104:107], v[216:219], v[224:239]
s_waitcnt vmcnt(1)
v_mfma_f32_32x32x16_bf16 v[224:239], a[108:111], v[220:223], v[224:239]
v_mfma_f32_32x32x16_bf16 v[240:255], a[200:203], v[200:203], v[240:255]
s_nop 4
v_mfma_f32_32x32x16_bf16 v[240:255], a[204:207], v[204:207], v[240:255]
s_nop 4
v_mfma_f32_32x32x16_bf16 v[240:255], a[208:211], v[208:211], v[240:255]
ds_write_b128 v14, v[224:227] offset:0
v_mfma_f32_32x32x16_bf16 v[240:255], a[212:215], v[212:215], v[240:255]
ds_write_b128 v14, v[228:231] offset:1280
v_mfma_f32_32x32x16_bf16 v[240:255], a[216:219], v[216:219], v[240:255]
ds_write_b128 v14, v[232:235] offset:2560
v_mfma_f32_32x32x16_bf16 v[240:255], a[220:223], v[220:223], v[240:255]
ds_write_b128 v14, v[236:239] offset:3840
s_waitcnt vmcnt(0)
v_cmp_eq_u32 vcc, 0, v13
s_cmp_eq_u32 s15, 64
s_cselect_b64 vcc, -1, vcc
s_cbranch_vccnz F2_CE_438
buffer_load_dwordx4 v[112:115], v2, s[8:11], s25 offen offset:0 sc1
buffer_load_dwordx4 v[116:119], v2, s[8:11], s25 offen offset:1024 sc1
s_nop 3
ds_write_b128 v14, v[240:243] offset:5120
buffer_load_dwordx4 v[120:123], v2, s[8:11], s25 offen offset:2048 sc1
ds_write_b128 v14, v[244:247] offset:6400
buffer_load_dwordx4 v[124:127], v2, s[8:11], s25 offen offset:3072 sc1
s_add_u32 s25, s25, 4096
ds_write_b128 v14, v[248:251] offset:7680
buffer_load_dwordx4 v[128:131], v2, s[8:11], s25 offen offset:0 sc1
ds_write_b128 v14, v[252:255] offset:8960
buffer_load_dwordx4 v[132:135], v2, s[8:11], s25 offen offset:1024 sc1
buffer_load_dwordx4 v[136:139], v2, s[8:11], s25 offen offset:2048 sc1
buffer_load_dwordx4 v[140:143], v2, s[8:11], s25 offen offset:3072 sc1
s_add_u32 s25, s25, 4096
buffer_load_dwordx4 v[144:147], v2, s[8:11], s25 offen offset:0 sc1
buffer_load_dwordx4 v[148:151], v2, s[8:11], s25 offen offset:1024 sc1
buffer_load_dwordx4 v[152:155], v2, s[8:11], s25 offen offset:2048 sc1
buffer_load_dwordx4 v[156:159], v2, s[8:11], s25 offen offset:3072 sc1
s_add_u32 s25, s25, 4096
s_waitcnt lgkmcnt(0)
s_barrier
ds_read_b128 v[80:83], v15 offset:0
ds_read_b128 v[84:87], v15 offset:1280
ds_read_b128 v[88:91], v15 offset:10240
ds_read_b128 v[92:95], v15 offset:11520
ds_read_b128 v[96:99], v15 offset:20480
ds_read_b128 v[100:103], v15 offset:21760
ds_read_b128 v[104:107], v15 offset:30720
ds_read_b128 v[108:111], v15 offset:32000
v_lshlrev_b32 v224, 16, v24
v_and_b32 v225, 0xffff0000, v24
v_lshlrev_b32 v226, 16, v25
v_and_b32 v227, 0xffff0000, v25
v_lshlrev_b32 v228, 16, v26
v_and_b32 v229, 0xffff0000, v26
v_lshlrev_b32 v230, 16, v27
v_and_b32 v231, 0xffff0000, v27
s_waitcnt lgkmcnt(6)
v_pk_add_f32 v[224:225], v[224:225], v[80:81]
v_pk_add_f32 v[226:227], v[226:227], v[82:83]
v_pk_add_f32 v[228:229], v[228:229], v[84:85]
v_pk_add_f32 v[230:231], v[230:231], v[86:87]
s_waitcnt lgkmcnt(4)
v_pk_add_f32 v[224:225], v[224:225], v[88:89]
v_pk_add_f32 v[226:227], v[226:227], v[90:91]
v_pk_add_f32 v[228:229], v[228:229], v[92:93]
v_pk_add_f32 v[230:231], v[230:231], v[94:95]
s_waitcnt lgkmcnt(2)
v_pk_add_f32 v[224:225], v[224:225], v[96:97]
v_pk_add_f32 v[226:227], v[226:227], v[98:99]
v_pk_add_f32 v[228:229], v[228:229], v[100:101]
v_pk_add_f32 v[230:231], v[230:231], v[102:103]
s_waitcnt lgkmcnt(0)
v_pk_add_f32 v[224:225], v[224:225], v[104:105]
v_pk_add_f32 v[226:227], v[226:227], v[106:107]
v_pk_add_f32 v[228:229], v[228:229], v[108:109]
v_pk_add_f32 v[230:231], v[230:231], v[110:111]
v_cvt_pk_bf16_f32 v24, v224, v225
v_cvt_pk_bf16_f32 v25, v226, v227
v_cvt_pk_bf16_f32 v26, v228, v229
v_cvt_pk_bf16_f32 v27, v230, v231
buffer_store_dwordx4 v[24:27], v10, s[8:11], s27 offen sc1
s_add_u32 s27, s27, 28672
v_lshlrev_b32 v224, 16, v24
v_and_b32 v225, 0xffff0000, v24
v_lshlrev_b32 v226, 16, v25
v_and_b32 v227, 0xffff0000, v25
v_lshlrev_b32 v228, 16, v26
v_and_b32 v229, 0xffff0000, v26
v_lshlrev_b32 v230, 16, v27
v_and_b32 v231, 0xffff0000, v27
v_pk_add_f32 v[80:81], v[224:225], v[226:227]
v_pk_mul_f32 v[82:83], v[224:225], v[224:225]
v_pk_add_f32 v[84:85], v[228:229], v[230:231]
v_pk_fma_f32 v[82:83], v[226:227], v[226:227], v[82:83]
v_pk_fma_f32 v[82:83], v[228:229], v[228:229], v[82:83]
v_pk_fma_f32 v[82:83], v[230:231], v[230:231], v[82:83]
v_pk_add_f32 v[80:81], v[80:81], v[84:85]
v_add_f32 v80, v80, v81
v_add_f32 v81, v82, v83
s_nop 0
v_add_f32_dpp v80, v80, v80 row_ror:8 row_mask:0xf bank_mask:0xf
v_add_f32_dpp v81, v81, v81 row_ror:8 row_mask:0xf bank_mask:0xf
v_mov_b32 v82, v80
v_mov_b32 v83, v81
s_nop 0
v_permlane16_swap_b32 v80, v82
v_permlane16_swap_b32 v81, v83
v_pk_add_f32 v[80:81], v[80:81], v[82:83]
v_mov_b32 v82, v80
v_mov_b32 v83, v81
s_nop 0
v_permlane32_swap_b32 v80, v82
v_permlane32_swap_b32 v81, v83
v_pk_add_f32 v[80:81], v[80:81], v[82:83]
s_mov_b64 exec, s[36:37]
buffer_store_dwordx2 v[80:81], v11, s[8:11], s28 offen sc1
s_mov_b64 exec, -1
s_add_u32 s28, s28, 2048
s_branch F2_P0_402
F2_CE_438:
s_nop 5
ds_write_b128 v14, v[240:243] offset:5120
ds_write_b128 v14, v[244:247] offset:6400
ds_write_b128 v14, v[248:251] offset:7680
ds_write_b128 v14, v[252:255] offset:8960
s_waitcnt lgkmcnt(0)
s_barrier
ds_read_b128 v[80:83], v15 offset:0
ds_read_b128 v[84:87], v15 offset:1280
ds_read_b128 v[88:91], v15 offset:10240
ds_read_b128 v[92:95], v15 offset:11520
ds_read_b128 v[96:99], v15 offset:20480
ds_read_b128 v[100:103], v15 offset:21760
ds_read_b128 v[104:107], v15 offset:30720
ds_read_b128 v[108:111], v15 offset:32000
v_lshlrev_b32 v224, 16, v24
v_and_b32 v225, 0xffff0000, v24
v_lshlrev_b32 v226, 16, v25
v_and_b32 v227, 0xffff0000, v25
v_lshlrev_b32 v228, 16, v26
v_and_b32 v229, 0xffff0000, v26
v_lshlrev_b32 v230, 16, v27
v_and_b32 v231, 0xffff0000, v27
s_waitcnt lgkmcnt(6)
v_pk_add_f32 v[224:225], v[224:225], v[80:81]
v_pk_add_f32 v[226:227], v[226:227], v[82:83]
v_pk_add_f32 v[228:229], v[228:229], v[84:85]
v_pk_add_f32 v[230:231], v[230:231], v[86:87]
s_waitcnt lgkmcnt(4)
v_pk_add_f32 v[224:225], v[224:225], v[88:89]
v_pk_add_f32 v[226:227], v[226:227], v[90:91]
v_pk_add_f32 v[228:229], v[228:229], v[92:93]
v_pk_add_f32 v[230:231], v[230:231], v[94:95]
s_waitcnt lgkmcnt(2)
v_pk_add_f32 v[224:225], v[224:225], v[96:97]
v_pk_add_f32 v[226:227], v[226:227], v[98:99]
v_pk_add_f32 v[228:229], v[228:229], v[100:101]
v_pk_add_f32 v[230:231], v[230:231], v[102:103]
s_waitcnt lgkmcnt(0)
v_pk_add_f32 v[224:225], v[224:225], v[104:105]
v_pk_add_f32 v[226:227], v[226:227], v[106:107]
v_pk_add_f32 v[228:229], v[228:229], v[108:109]
v_pk_add_f32 v[230:231], v[230:231], v[110:111]
v_cvt_pk_bf16_f32 v24, v224, v225
v_cvt_pk_bf16_f32 v25, v226, v227
v_cvt_pk_bf16_f32 v26, v228, v229
v_cvt_pk_bf16_f32 v27, v230, v231
buffer_store_dwordx4 v[24:27], v10, s[8:11], s27 offen sc1
s_add_u32 s27, s27, 28672
v_lshlrev_b32 v224, 16, v24
v_and_b32 v225, 0xffff0000, v24
v_lshlrev_b32 v226, 16, v25
v_and_b32 v227, 0xffff0000, v25
v_lshlrev_b32 v228, 16, v26
v_and_b32 v229, 0xffff0000, v26
v_lshlrev_b32 v230, 16, v27
v_and_b32 v231, 0xffff0000, v27
v_pk_add_f32 v[80:81], v[224:225], v[226:227]
v_pk_mul_f32 v[82:83], v[224:225], v[224:225]
v_pk_add_f32 v[84:85], v[228:229], v[230:231]
v_pk_fma_f32 v[82:83], v[226:227], v[226:227], v[82:83]
v_pk_fma_f32 v[82:83], v[228:229], v[228:229], v[82:83]
v_pk_fma_f32 v[82:83], v[230:231], v[230:231], v[82:83]
v_pk_add_f32 v[80:81], v[80:81], v[84:85]
v_add_f32 v80, v80, v81
v_add_f32 v81, v82, v83
s_nop 0
v_add_f32_dpp v80, v80, v80 row_ror:8 row_mask:0xf bank_mask:0xf
v_add_f32_dpp v81, v81, v81 row_ror:8 row_mask:0xf bank_mask:0xf
v_mov_b32 v82, v80
v_mov_b32 v83, v81
s_nop 0
v_permlane16_swap_b32 v80, v82
v_permlane16_swap_b32 v81, v83
v_pk_add_f32 v[80:81], v[80:81], v[82:83]
v_mov_b32 v82, v80
v_mov_b32 v83, v81
s_nop 0
v_permlane32_swap_b32 v80, v82
v_permlane32_swap_b32 v81, v83
v_pk_add_f32 v[80:81], v[80:81], v[82:83]
s_mov_b64 exec, s[36:37]
buffer_store_dwordx2 v[80:81], v11, s[8:11], s28 offen sc1
s_mov_b64 exec, -1
s_add_u32 s28, s28, 2048
buffer_load_dword v13, v7, s[8:11], s29 offen sc1
s_waitcnt vmcnt(1)
s_mov_b64 exec, 1
buffer_store_dword v5, v4, s[8:11], s30 offen sc1
s_mov_b64 exec, -1
s_add_u32 s30, s30, 512
s_cmp_ge_u32 s15, 64
s_cbranch_scc0 OPT_439
s_endpgm
OPT_439:
s_waitcnt vmcnt(1)
s_branch F2_C0_398
F2_W1_401:
s_add_u32 s29, s29, 512
s_mov_b32 s32, 1
s_waitcnt vmcnt(11)
v_mfma_f32_32x32x16_bf16 v[224:239], a[0:3], v[112:115], 0
buffer_load_dwordx4 v[160:163], v2, s[8:11], s25 offen offset:0 sc1
v_mfma_f32_32x32x16_bf16 v[240:255], a[112:115], v[112:115], 0
s_waitcnt vmcnt(11)
v_mfma_f32_32x32x16_bf16 v[224:239], a[4:7], v[116:119], v[224:239]
buffer_load_dwordx4 v[164:167], v2, s[8:11], s25 offen offset:1024 sc1
ds_write_b128 v8, v[48:51] offset:0
v_mfma_f32_32x32x16_bf16 v[240:255], a[116:119], v[116:119], v[240:255]
ds_write_b128 v8, v[52:55] offset:1280
s_waitcnt vmcnt(11)
v_mfma_f32_32x32x16_bf16 v[224:239], a[8:11], v[120:123], v[224:239]
buffer_load_dwordx4 v[168:171], v2, s[8:11], s25 offen offset:2048 sc1
ds_write_b128 v8, v[56:59] offset:2560
v_mfma_f32_32x32x16_bf16 v[240:255], a[120:123], v[120:123], v[240:255]
ds_write_b128 v8, v[60:63] offset:3840
s_waitcnt vmcnt(11)
v_mfma_f32_32x32x16_bf16 v[224:239], a[12:15], v[124:127], v[224:239]
buffer_load_dword v13, v7, s[8:11], s29 offen sc1
buffer_load_dwordx4 v[172:175], v2, s[8:11], s25 offen offset:3072 sc1
s_add_u32 s25, s25, 4096
ds_write_b128 v8, v[64:67] offset:5120
v_mfma_f32_32x32x16_bf16 v[240:255], a[124:127], v[124:127], v[240:255]
ds_write_b128 v8, v[68:71] offset:6400
s_waitcnt vmcnt(12)
v_mfma_f32_32x32x16_bf16 v[224:239], a[16:19], v[128:131], v[224:239]
buffer_load_dwordx4 v[176:179], v2, s[8:11], s25 offen offset:0 sc1
ds_write_b128 v8, v[72:75] offset:7680
v_mfma_f32_32x32x16_bf16 v[240:255], a[128:131], v[128:131], v[240:255]
ds_write_b128 v8, v[76:79] offset:8960
s_waitcnt vmcnt(12)
v_mfma_f32_32x32x16_bf16 v[224:239], a[20:23], v[132:135], v[224:239]
buffer_load_dwordx4 v[180:183], v2, s[8:11], s25 offen offset:1024 sc1
v_mfma_f32_32x32x16_bf16 v[240:255], a[132:135], v[132:135], v[240:255]
s_waitcnt vmcnt(12)
v_mfma_f32_32x32x16_bf16 v[224:239], a[24:27], v[136:139], v[224:239]
buffer_load_dwordx4 v[184:187], v2, s[8:11], s25 offen offset:2048 sc1
v_mfma_f32_32x32x16_bf16 v[240:255], a[136:139], v[136:139], v[240:255]
s_waitcnt lgkmcnt(0)
s_barrier
ds_read_b128 v[80:83], v9 offset:0
ds_read_b128 v[84:87], v9 offset:1280
ds_read_b128 v[88:91], v9 offset:10240
s_waitcnt vmcnt(12)
v_mfma_f32_32x32x16_bf16 v[224:239], a[28:31], v[140:143], v[224:239]
buffer_load_dwordx4 v[188:191], v2, s[8:11], s25 offen offset:3072 sc1
s_add_u32 s25, s25, 4096
ds_read_b128 v[92:95], v9 offset:11520
ds_read_b128 v[96:99], v9 offset:20480
ds_read_b128 v[100:103], v9 offset:21760
ds_read_b128 v[104:107], v9 offset:30720
v_mfma_f32_32x32x16_bf16 v[240:255], a[140:143], v[140:143], v[240:255]
ds_read_b128 v[108:111], v9 offset:32000
v_lshlrev_b32 v48, 16, v20
v_and_b32 v49, 0xffff0000, v20
v_lshlrev_b32 v50, 16, v21
v_and_b32 v51, 0xffff0000, v21
s_waitcnt vmcnt(12)
v_mfma_f32_32x32x16_bf16 v[224:239], a[32:35], v[144:147], v[224:239]
buffer_load_dwordx4 v[192:195], v2, s[8:11], s25 offen offset:0 sc1
v_lshlrev_b32 v52, 16, v22
v_and_b32 v53, 0xffff0000, v22
v_lshlrev_b32 v54, 16, v23
v_and_b32 v55, 0xffff0000, v23
s_waitcnt lgkmcnt(6)
v_mfma_f32_32x32x16_bf16 v[240:255], a[144:147], v[144:147], v[240:255]
v_add_f32 v48, v48, v80
v_add_f32 v49, v49, v81
v_add_f32 v50, v50, v82
v_add_f32 v51, v51, v83
v_add_f32 v52, v52, v84
s_waitcnt vmcnt(12)
v_mfma_f32_32x32x16_bf16 v[224:239], a[36:39], v[148:151], v[224:239]
buffer_load_dwordx4 v[196:199], v2, s[8:11], s25 offen offset:1024 sc1
v_add_f32 v53, v53, v85
v_add_f32 v54, v54, v86
v_add_f32 v55, v55, v87
s_waitcnt lgkmcnt(4)
v_add_f32 v48, v48, v88
v_mfma_f32_32x32x16_bf16 v[240:255], a[148:151], v[148:151], v[240:255]
v_add_f32 v49, v49, v89
v_add_f32 v50, v50, v90
v_add_f32 v51, v51, v91
v_add_f32 v52, v52, v92
v_add_f32 v53, v53, v93
s_waitcnt vmcnt(12)
v_mfma_f32_32x32x16_bf16 v[224:239], a[40:43], v[152:155], v[224:239]
buffer_load_dwordx4 v[200:203], v2, s[8:11], s25 offen offset:2048 sc1
v_add_f32 v54, v54, v94
v_add_f32 v55, v55, v95
s_waitcnt lgkmcnt(2)
v_add_f32 v48, v48, v96
v_add_f32 v49, v49, v97
v_mfma_f32_32x32x16_bf16 v[240:255], a[152:155], v[152:155], v[240:255]
v_add_f32 v50, v50, v98
v_add_f32 v51, v51, v99
v_add_f32 v52, v52, v100
v_add_f32 v53, v53, v101
v_add_f32 v54, v54, v102
s_waitcnt vmcnt(12)
v_mfma_f32_32x32x16_bf16 v[224:239], a[44:47], v[156:159], v[224:239]
buffer_load_dwordx4 v[204:207], v2, s[8:11], s25 offen offset:3072 sc1
s_add_u32 s25, s25, 4096
v_add_f32 v55, v55, v103
s_waitcnt lgkmcnt(0)
v_add_f32 v48, v48, v104
v_add_f32 v49, v49, v105
v_mfma_f32_32x32x16_bf16 v[240:255], a[156:159], v[156:159], v[240:255]
v_add_f32 v50, v50, v106
v_add_f32 v51, v51, v107
v_add_f32 v52, v52, v108
v_add_f32 v53, v53, v109
v_add_f32 v54, v54, v110
s_waitcnt vmcnt(12)
v_mfma_f32_32x32x16_bf16 v[224:239], a[48:51], v[160:163], v[224:239]
buffer_load_dwordx4 v[208:211], v2, s[8:11], s25 offen offset:0 sc1
v_add_f32 v55, v55, v111
v_cvt_pk_bf16_f32 v20, v48, v49
v_cvt_pk_bf16_f32 v21, v50, v51
v_cvt_pk_bf16_f32 v22, v52, v53
v_cvt_pk_bf16_f32 v23, v54, v55
v_mfma_f32_32x32x16_bf16 v[240:255], a[160:163], v[160:163], v[240:255]
buffer_store_dwordx4 v[20:23], v10, s[8:11], s27 offen sc1
s_add_u32 s27, s27, 28672
v_lshlrev_b32 v48, 16, v20
v_and_b32 v49, 0xffff0000, v20
v_lshlrev_b32 v50, 16, v21
s_waitcnt vmcnt(13)
v_mfma_f32_32x32x16_bf16 v[224:239], a[52:55], v[164:167], v[224:239]
buffer_load_dwordx4 v[212:215], v2, s[8:11], s25 offen offset:1024 sc1
v_and_b32 v51, 0xffff0000, v21
v_lshlrev_b32 v52, 16, v22
v_and_b32 v53, 0xffff0000, v22
v_lshlrev_b32 v54, 16, v23
v_and_b32 v55, 0xffff0000, v23
v_mfma_f32_32x32x16_bf16 v[240:255], a[164:167], v[164:167], v[240:255]
v_add_f32 v80, v48, v50
v_add_f32 v81, v49, v51
v_mul_f32 v82, v48, v48
v_mul_f32 v83, v49, v49
v_add_f32 v84, v52, v54
s_waitcnt vmcnt(13)
v_mfma_f32_32x32x16_bf16 v[224:239], a[56:59], v[168:171], v[224:239]
buffer_load_dwordx4 v[216:219], v2, s[8:11], s25 offen offset:2048 sc1
v_add_f32 v85, v53, v55
v_fma_f32 v82, v50, v50, v82
v_fma_f32 v83, v51, v51, v83
v_fma_f32 v82, v52, v52, v82
v_fma_f32 v83, v53, v53, v83
v_mfma_f32_32x32x16_bf16 v[240:255], a[168:171], v[168:171], v[240:255]
v_fma_f32 v82, v54, v54, v82
v_fma_f32 v83, v55, v55, v83
v_add_f32 v80, v80, v84
v_add_f32 v81, v81, v85
v_add_f32 v80, v80, v81
s_waitcnt vmcnt(12)
v_mfma_f32_32x32x16_bf16 v[224:239], a[60:63], v[172:175], v[224:239]
buffer_load_dwordx4 v[24:27], v10, s[8:11], s26 offen sc1
s_add_u32 s26, s26, 28672
buffer_load_dwordx4 v[220:223], v2, s[8:11], s25 offen offset:3072 sc1
s_add_u32 s25, s25, 90112
v_add_f32 v81, v82, v83
v_add_f32_dpp v80, v80, v80 row_ror:8 row_mask:0xf bank_mask:0xf
v_mfma_f32_32x32x16_bf16 v[240:255], a[172:175], v[172:175], v[240:255]
v_add_f32_dpp v81, v81, v81 row_ror:8 row_mask:0xf bank_mask:0xf
v_mov_b32 v82, v80
v_mov_b32 v83, v81
s_nop 0
v_permlane16_swap_b32 v80, v82
s_add_u32 s15, s15, 1
v_cmp_eq_u32 vcc, 0, v13
s_cmp_eq_u32 s15, 64
s_cselect_b64 vcc, -1, vcc
s_cbranch_vccnz F2_NP_440
s_waitcnt vmcnt(13)
v_mfma_f32_32x32x16_bf16 v[224:239], a[64:67], v[176:179], v[224:239]
buffer_load_dwordx4 v[112:115], v2, s[8:11], s25 offen offset:0 sc1
v_permlane16_swap_b32 v81, v83
v_add_f32 v80, v80, v82
v_add_f32 v81, v81, v83
v_mov_b32 v82, v80
v_mov_b32 v83, v81
v_mfma_f32_32x32x16_bf16 v[240:255], a[176:179], v[176:179], v[240:255]
v_permlane32_swap_b32 v80, v82
v_permlane32_swap_b32 v81, v83
v_add_f32 v80, v80, v82
v_add_f32 v81, v81, v83
s_waitcnt vmcnt(13)
v_mfma_f32_32x32x16_bf16 v[224:239], a[68:71], v[180:183], v[224:239]
buffer_load_dwordx4 v[116:119], v2, s[8:11], s25 offen offset:1024 sc1
s_mov_b64 exec, s[36:37]
buffer_store_dwordx2 v[80:81], v11, s[8:11], s28 offen sc1
s_mov_b64 exec, -1
s_add_u32 s28, s28, 2048
v_mfma_f32_32x32x16_bf16 v[240:255], a[180:183], v[180:183], v[240:255]
s_waitcnt vmcnt(14)
v_mfma_f32_32x32x16_bf16 v[224:239], a[72:75], v[184:187], v[224:239]
buffer_load_dwordx4 v[120:123], v2, s[8:11], s25 offen offset:2048 sc1
v_mfma_f32_32x32x16_bf16 v[240:255], a[184:187], v[184:187], v[240:255]
s_waitcnt vmcnt(14)
v_mfma_f32_32x32x16_bf16 v[224:239], a[76:79], v[188:191], v[224:239]
buffer_load_dwordx4 v[124:127], v2, s[8:11], s25 offen offset:3072 sc1
s_add_u32 s25, s25, 4096
v_mfma_f32_32x32x16_bf16 v[240:255], a[188:191], v[188:191], v[240:255]
s_waitcnt vmcnt(14)
s_cmp_eq_u32 s32, 0
s_cbranch_scc1 OPT_442
s_getreg_b32 s20, hwreg(HW_REG_IB_STS)
s_and_b32 s20, s20, 0xc0000f
s_cmp_gt_u32 s20, 2
s_cbranch_scc1 OPT_442
s_waitcnt vmcnt(2)
s_mov_b64 exec, 1
buffer_store_dword v5, v4, s[8:11], s30 offen sc1
s_mov_b64 exec, -1
s_add_u32 s30, s30, 512
s_mov_b32 s32, 0
OPT_442:
v_mfma_f32_32x32x16_bf16 v[224:239], a[80:83], v[192:195], v[224:239]
buffer_load_dwordx4 v[128:131], v2, s[8:11], s25 offen offset:0 sc1
v_mfma_f32_32x32x16_bf16 v[240:255], a[192:195], v[192:195], v[240:255]
s_waitcnt vmcnt(14)
v_mfma_f32_32x32x16_bf16 v[224:239], a[84:87], v[196:199], v[224:239]
buffer_load_dwordx4 v[132:135], v2, s[8:11], s25 offen offset:1024 sc1
v_mfma_f32_32x32x16_bf16 v[240:255], a[196:199], v[196:199], v[240:255]
s_waitcnt vmcnt(14)
v_mfma_f32_32x32x16_bf16 v[224:239], a[88:91], v[200:203], v[224:239]
buffer_load_dwordx4 v[136:139], v2, s[8:11], s25 offen offset:2048 sc1
v_mfma_f32_32x32x16_bf16 v[240:255], a[200:203], v[200:203], v[240:255]
s_waitcnt vmcnt(14)
s_cmp_eq_u32 s32, 0
s_cbranch_scc1 OPT_444
s_getreg_b32 s20, hwreg(HW_REG_IB_STS)
s_and_b32 s20, s20, 0xc0000f
s_cmp_gt_u32 s20, 5
s_cbranch_scc1 OPT_444
s_waitcnt vmcnt(5)
s_mov_b64 exec, 1
buffer_store_dword v5, v4, s[8:11], s30 offen sc1
s_mov_b64 exec, -1
s_add_u32 s30, s30, 512
s_mov_b32 s32, 0
OPT_444:
v_mfma_f32_32x32x16_bf16 v[224:239], a[92:95], v[204:207], v[224:239]
buffer_load_dwordx4 v[140:143], v2, s[8:11], s25 offen offset:3072 sc1
s_add_u32 s25, s25, 4096
v_mfma_f32_32x32x16_bf16 v[240:255], a[204:207], v[204:207], v[240:255]
s_waitcnt vmcnt(14)
v_mfma_f32_32x32x16_bf16 v[224:239], a[96:99], v[208:211], v[224:239]
buffer_load_dwordx4 v[144:147], v2, s[8:11], s25 offen offset:0 sc1
v_mfma_f32_32x32x16_bf16 v[240:255], a[208:211], v[208:211], v[240:255]
s_waitcnt vmcnt(13)
v_mfma_f32_32x32x16_bf16 v[224:239], a[100:103], v[212:215], v[224:239]
buffer_load_dwordx4 v[148:151], v2, s[8:11], s25 offen offset:1024 sc1
v_mfma_f32_32x32x16_bf16 v[240:255], a[212:215], v[212:215], v[240:255]
s_waitcnt vmcnt(13)
s_cmp_eq_u32 s32, 0
s_cbranch_scc1 OPT_446
s_getreg_b32 s20, hwreg(HW_REG_IB_STS)
s_and_b32 s20, s20, 0xc0000f
s_cmp_gt_u32 s20, 8
s_cbranch_scc1 OPT_446
s_waitcnt vmcnt(8)
s_mov_b64 exec, 1
buffer_store_dword v5, v4, s[8:11], s30 offen sc1
s_mov_b64 exec, -1
s_add_u32 s30, s30, 512
s_mov_b32 s32, 0
OPT_446:
v_mfma_f32_32x32x16_bf16 v[224:239], a[104:107], v[216:219], v[224:239]
buffer_load_dwordx4 v[152:155], v2, s[8:11], s25 offen offset:2048 sc1
v_mfma_f32_32x32x16_bf16 v[240:255], a[216:219], v[216:219], v[240:255]
s_waitcnt vmcnt(12)
v_mfma_f32_32x32x16_bf16 v[224:239], a[108:111], v[220:223], v[224:239]
buffer_load_dwordx4 v[156:159], v2, s[8:11], s25 offen offset:3072 sc1
s_add_u32 s25, s25, 4096
v_mfma_f32_32x32x16_bf16 v[240:255], a[220:223], v[220:223], v[240:255]
s_cmp_eq_u32 s32, 0
s_cbranch_scc1 OPT_448
s_waitcnt vmcnt(10)
s_mov_b64 exec, 1
buffer_store_dword v5, v4, s[8:11], s30 offen sc1
s_mov_b64 exec, -1
s_add_u32 s30, s30, 512
s_mov_b32 s32, 0
OPT_448:
s_nop 8
s_branch F2_W0_400
F2_NP_440:
s_waitcnt vmcnt(13)
v_mfma_f32_32x32x16_bf16 v[224:239], a[64:67], v[176:179], v[224:239]
v_permlane16_swap_b32 v81, v83
v_add_f32 v80, v80, v82
v_add_f32 v81, v81, v83
v_mov_b32 v82, v80
v_mov_b32 v83, v81
v_mfma_f32_32x32x16_bf16 v[240:255], a[176:179], v[176:179], v[240:255]
v_permlane32_swap_b32 v80, v82
v_permlane32_swap_b32 v81, v83
v_add_f32 v80, v80, v82
v_add_f32 v81, v81, v83
s_waitcnt vmcnt(12)
v_mfma_f32_32x32x16_bf16 v[224:239], a[68:71], v[180:183], v[224:239]
s_mov_b64 exec, s[36:37]
buffer_store_dwordx2 v[80:81], v11, s[8:11], s28 offen sc1
s_mov_b64 exec, -1
s_add_u32 s28, s28, 2048
v_mfma_f32_32x32x16_bf16 v[240:255], a[180:183], v[180:183], v[240:255]
s_waitcnt vmcnt(12)
v_mfma_f32_32x32x16_bf16 v[224:239], a[72:75], v[184:187], v[224:239]
v_mfma_f32_32x32x16_bf16 v[240:255], a[184:187], v[184:187], v[240:255]
s_waitcnt vmcnt(11)
v_mfma_f32_32x32x16_bf16 v[224:239], a[76:79], v[188:191], v[224:239]
v_mfma_f32_32x32x16_bf16 v[240:255], a[188:191], v[188:191], v[240:255]
s_waitcnt vmcnt(10)
s_cmp_eq_u32 s32, 0
s_cbranch_scc1 OPT_450
s_getreg_b32 s20, hwreg(HW_REG_IB_STS)
s_and_b32 s20, s20, 0xc0000f
s_cmp_gt_u32 s20, 0
s_cbranch_scc1 OPT_450
s_waitcnt vmcnt(0)
s_mov_b64 exec, 1
buffer_store_dword v5, v4, s[8:11], s30 offen sc1
s_mov_b64 exec, -1
s_add_u32 s30, s30, 512
s_mov_b32 s32, 0
OPT_450:
v_mfma_f32_32x32x16_bf16 v[224:239], a[80:83], v[192:195], v[224:239]
v_mfma_f32_32x32x16_bf16 v[240:255], a[192:195], v[192:195], v[240:255]
s_waitcnt vmcnt(9)
v_mfma_f32_32x32x16_bf16 v[224:239], a[84:87], v[196:199], v[224:239]
buffer_load_dword v13, v7, s[8:11], s29 offen sc1
v_mfma_f32_32x32x16_bf16 v[240:255], a[196:199], v[196:199], v[240:255]
s_waitcnt vmcnt(9)
v_mfma_f32_32x32x16_bf16 v[224:239], a[88:91], v[200:203], v[224:239]
s_waitcnt vmcnt(8)
v_mfma_f32_32x32x16_bf16 v[224:239], a[92:95], v[204:207], v[224:239]
s_waitcnt vmcnt(7)
v_mfma_f32_32x32x16_bf16 v[224:239], a[96:99], v[208:211], v[224:239]
s_waitcnt vmcnt(5)
v_mfma_f32_32x32x16_bf16 v[224:239], a[100:103], v[212:215], v[224:239]
s_waitcnt vmcnt(4)
v_mfma_f32_32x32x16_bf16 v[224:239], a[104:107], v[216:219], v[224:239]
s_waitcnt vmcnt(2)
v_mfma_f32_32x32x16_bf16 v[224:239], a[108:111], v[220:223], v[224:239]
v_mfma_f32_32x32x16_bf16 v[240:255], a[200:203], v[200:203], v[240:255]
s_nop 4
v_mfma_f32_32x32x16_bf16 v[240:255], a[204:207], v[204:207], v[240:255]
s_nop 4
v_mfma_f32_32x32x16_bf16 v[240:255], a[208:211], v[208:211], v[240:255]
ds_write_b128 v14, v[224:227] offset:0
v_mfma_f32_32x32x16_bf16 v[240:255], a[212:215], v[212:215], v[240:255]
ds_write_b128 v14, v[228:231] offset:1280
v_mfma_f32_32x32x16_bf16 v[240:255], a[216:219], v[216:219], v[240:255]
ds_write_b128 v14, v[232:235] offset:2560
v_mfma_f32_32x32x16_bf16 v[240:255], a[220:223], v[220:223], v[240:255]
ds_write_b128 v14, v[236:239] offset:3840
s_cmp_eq_u32 s32, 0
s_cbranch_scc1 OPT_452
s_waitcnt vmcnt(1)
s_mov_b64 exec, 1
buffer_store_dword v5, v4, s[8:11], s30 offen sc1
s_mov_b64 exec, -1
s_add_u32 s30, s30, 512
s_mov_b32 s32, 0
OPT_452:
s_waitcnt vmcnt(0)
v_cmp_eq_u32 vcc, 0, v13
s_cmp_eq_u32 s15, 64
s_cselect_b64 vcc, -1, vcc
s_cbranch_vccnz F2_CE_453
buffer_load_dwordx4 v[112:115], v2, s[8:11], s25 offen offset:0 sc1
buffer_load_dwordx4 v[116:119], v2, s[8:11], s25 offen offset:1024 sc1
s_nop 1
ds_write_b128 v14, v[240:243] offset:5120
buffer_load_dwordx4 v[120:123], v2, s[8:11], s25 offen offset:2048 sc1
ds_write_b128 v14, v[244:247] offset:6400
buffer_load_dwordx4 v[124:127], v2, s[8:11], s25 offen offset:3072 sc1
s_add_u32 s25, s25, 4096
ds_write_b128 v14, v[248:251] offset:7680
buffer_load_dwordx4 v[128:131], v2, s[8:11], s25 offen offset:0 sc1
ds_write_b128 v14, v[252:255] offset:8960
buffer_load_dwordx4 v[132:135], v2, s[8:11], s25 offen offset:1024 sc1
buffer_load_dwordx4 v[136:139], v2, s[8:11], s25 offen offset:2048 sc1
buffer_load_dwordx4 v[140:143], v2, s[8:11], s25 offen offset:3072 sc1
s_add_u32 s25, s25, 4096
buffer_load_dwordx4 v[144:147], v2, s[8:11], s25 offen offset:0 sc1
buffer_load_dwordx4 v[148:151], v2, s[8:11], s25 offen offset:1024 sc1
buffer_load_dwordx4 v[152:155], v2, s[8:11], s25 offen offset:2048 sc1
buffer_load_dwordx4 v[156:159], v2, s[8:11], s25 offen offset:3072 sc1
s_add_u32 s25, s25, 4096
s_waitcnt lgkmcnt(0)
s_barrier
ds_read_b128 v[80:83], v15 offset:0
ds_read_b128 v[84:87], v15 offset:1280
ds_read_b128 v[88:91], v15 offset:10240
ds_read_b128 v[92:95], v15 offset:11520
ds_read_b128 v[96:99], v15 offset:20480
ds_read_b128 v[100:103], v15 offset:21760
ds_read_b128 v[104:107], v15 offset:30720
ds_read_b128 v[108:111], v15 offset:32000
v_lshlrev_b32 v224, 16, v24
v_and_b32 v225, 0xffff0000, v24
v_lshlrev_b32 v226, 16, v25
v_and_b32 v227, 0xffff0000, v25
v_lshlrev_b32 v228, 16, v26
v_and_b32 v229, 0xffff0000, v26
v_lshlrev_b32 v230, 16, v27
v_and_b32 v231, 0xffff0000, v27
s_waitcnt lgkmcnt(6)
v_pk_add_f32 v[224:225], v[224:225], v[80:81]
v_pk_add_f32 v[226:227], v[226:227], v[82:83]
v_pk_add_f32 v[228:229], v[228:229], v[84:85]
v_pk_add_f32 v[230:231], v[230:231], v[86:87]
s_waitcnt lgkmcnt(4)
v_pk_add_f32 v[224:225], v[224:225], v[88:89]
v_pk_add_f32 v[226:227], v[226:227], v[90:91]
v_pk_add_f32 v[228:229], v[228:229], v[92:93]
v_pk_add_f32 v[230:231], v[230:231], v[94:95]
s_waitcnt lgkmcnt(2)
v_pk_add_f32 v[224:225], v[224:225], v[96:97]
v_pk_add_f32 v[226:227], v[226:227], v[98:99]
v_pk_add_f32 v[228:229], v[228:229], v[100:101]
v_pk_add_f32 v[230:231], v[230:231], v[102:103]
s_waitcnt lgkmcnt(0)
v_pk_add_f32 v[224:225], v[224:225], v[104:105]
v_pk_add_f32 v[226:227], v[226:227], v[106:107]
v_pk_add_f32 v[228:229], v[228:229], v[108:109]
v_pk_add_f32 v[230:231], v[230:231], v[110:111]
v_cvt_pk_bf16_f32 v24, v224, v225
v_cvt_pk_bf16_f32 v25, v226, v227
v_cvt_pk_bf16_f32 v26, v228, v229
v_cvt_pk_bf16_f32 v27, v230, v231
buffer_store_dwordx4 v[24:27], v10, s[8:11], s27 offen sc1
s_add_u32 s27, s27, 28672
v_lshlrev_b32 v224, 16, v24
v_and_b32 v225, 0xffff0000, v24
v_lshlrev_b32 v226, 16, v25
v_and_b32 v227, 0xffff0000, v25
v_lshlrev_b32 v228, 16, v26
v_and_b32 v229, 0xffff0000, v26
v_lshlrev_b32 v230, 16, v27
v_and_b32 v231, 0xffff0000, v27
v_pk_add_f32 v[80:81], v[224:225], v[226:227]
v_pk_mul_f32 v[82:83], v[224:225], v[224:225]
v_pk_add_f32 v[84:85], v[228:229], v[230:231]
v_pk_fma_f32 v[82:83], v[226:227], v[226:227], v[82:83]
v_pk_fma_f32 v[82:83], v[228:229], v[228:229], v[82:83]
v_pk_fma_f32 v[82:83], v[230:231], v[230:231], v[82:83]
v_pk_add_f32 v[80:81], v[80:81], v[84:85]
v_add_f32 v80, v80, v81
v_add_f32 v81, v82, v83
s_nop 0
v_add_f32_dpp v80, v80, v80 row_ror:8 row_mask:0xf bank_mask:0xf
v_add_f32_dpp v81, v81, v81 row_ror:8 row_mask:0xf bank_mask:0xf
v_mov_b32 v82, v80
v_mov_b32 v83, v81
s_nop 0
v_permlane16_swap_b32 v80, v82
v_permlane16_swap_b32 v81, v83
v_pk_add_f32 v[80:81], v[80:81], v[82:83]
v_mov_b32 v82, v80
v_mov_b32 v83, v81
s_nop 0
v_permlane32_swap_b32 v80, v82
v_permlane32_swap_b32 v81, v83
v_pk_add_f32 v[80:81], v[80:81], v[82:83]
s_mov_b64 exec, s[36:37]
buffer_store_dwordx2 v[80:81], v11, s[8:11], s28 offen sc1
s_mov_b64 exec, -1
s_add_u32 s28, s28, 2048
s_branch F2_P0_402
F2_CE_453:
s_nop 3
ds_write_b128 v14, v[240:243] offset:5120
ds_write_b128 v14, v[244:247] offset:6400
ds_write_b128 v14, v[248:251] offset:7680
ds_write_b128 v14, v[252:255] offset:8960
s_waitcnt lgkmcnt(0)
s_barrier
ds_read_b128 v[80:83], v15 offset:0
ds_read_b128 v[84:87], v15 offset:1280
ds_read_b128 v[88:91], v15 offset:10240
ds_read_b128 v[92:95], v15 offset:11520
ds_read_b128 v[96:99], v15 offset:20480
ds_read_b128 v[100:103], v15 offset:21760
ds_read_b128 v[104:107], v15 offset:30720
ds_read_b128 v[108:111], v15 offset:32000
v_lshlrev_b32 v224, 16, v24
v_and_b32 v225, 0xffff0000, v24
v_lshlrev_b32 v226, 16, v25
v_and_b32 v227, 0xffff0000, v25
v_lshlrev_b32 v228, 16, v26
v_and_b32 v229, 0xffff0000, v26
v_lshlrev_b32 v230, 16, v27
v_and_b32 v231, 0xffff0000, v27
s_waitcnt lgkmcnt(6)
v_pk_add_f32 v[224:225], v[224:225], v[80:81]
v_pk_add_f32 v[226:227], v[226:227], v[82:83]
v_pk_add_f32 v[228:229], v[228:229], v[84:85]
v_pk_add_f32 v[230:231], v[230:231], v[86:87]
s_waitcnt lgkmcnt(4)
v_pk_add_f32 v[224:225], v[224:225], v[88:89]
v_pk_add_f32 v[226:227], v[226:227], v[90:91]
v_pk_add_f32 v[228:229], v[228:229], v[92:93]
v_pk_add_f32 v[230:231], v[230:231], v[94:95]
s_waitcnt lgkmcnt(2)
v_pk_add_f32 v[224:225], v[224:225], v[96:97]
v_pk_add_f32 v[226:227], v[226:227], v[98:99]
v_pk_add_f32 v[228:229], v[228:229], v[100:101]
v_pk_add_f32 v[230:231], v[230:231], v[102:103]
s_waitcnt lgkmcnt(0)
v_pk_add_f32 v[224:225], v[224:225], v[104:105]
v_pk_add_f32 v[226:227], v[226:227], v[106:107]
v_pk_add_f32 v[228:229], v[228:229], v[108:109]
v_pk_add_f32 v[230:231], v[230:231], v[110:111]
v_cvt_pk_bf16_f32 v24, v224, v225
v_cvt_pk_bf16_f32 v25, v226, v227
v_cvt_pk_bf16_f32 v26, v228, v229
v_cvt_pk_bf16_f32 v27, v230, v231
buffer_store_dwordx4 v[24:27], v10, s[8:11], s27 offen sc1
s_add_u32 s27, s27, 28672
v_lshlrev_b32 v224, 16, v24
v_and_b32 v225, 0xffff0000, v24
v_lshlrev_b32 v226, 16, v25
v_and_b32 v227, 0xffff0000, v25
v_lshlrev_b32 v228, 16, v26
v_and_b32 v229, 0xffff0000, v26
v_lshlrev_b32 v230, 16, v27
v_and_b32 v231, 0xffff0000, v27
v_pk_add_f32 v[80:81], v[224:225], v[226:227]
v_pk_mul_f32 v[82:83], v[224:225], v[224:225]
v_pk_add_f32 v[84:85], v[228:229], v[230:231]
v_pk_fma_f32 v[82:83], v[226:227], v[226:227], v[82:83]
v_pk_fma_f32 v[82:83], v[228:229], v[228:229], v[82:83]
v_pk_fma_f32 v[82:83], v[230:231], v[230:231], v[82:83]
v_pk_add_f32 v[80:81], v[80:81], v[84:85]
v_add_f32 v80, v80, v81
v_add_f32 v81, v82, v83
s_nop 0
v_add_f32_dpp v80, v80, v80 row_ror:8 row_mask:0xf bank_mask:0xf
v_add_f32_dpp v81, v81, v81 row_ror:8 row_mask:0xf bank_mask:0xf
v_mov_b32 v82, v80
v_mov_b32 v83, v81
s_nop 0
v_permlane16_swap_b32 v80, v82
v_permlane16_swap_b32 v81, v83
v_pk_add_f32 v[80:81], v[80:81], v[82:83]
v_mov_b32 v82, v80
v_mov_b32 v83, v81
s_nop 0
v_permlane32_swap_b32 v80, v82
v_permlane32_swap_b32 v81, v83
v_pk_add_f32 v[80:81], v[80:81], v[82:83]
s_mov_b64 exec, s[36:37]
buffer_store_dwordx2 v[80:81], v11, s[8:11], s28 offen sc1
s_mov_b64 exec, -1
s_add_u32 s28, s28, 2048
buffer_load_dword v13, v7, s[8:11], s29 offen sc1
s_waitcnt vmcnt(1)
s_mov_b64 exec, 1
buffer_store_dword v5, v4, s[8:11], s30 offen sc1
s_mov_b64 exec, -1
s_add_u32 s30, s30, 512
s_cmp_ge_u32 s15, 64
s_cbranch_scc0 OPT_454
s_endpgm
OPT_454:
s_waitcnt vmcnt(1)
s_branch F2_C0_398
F2_P1_403:
s_add_u32 s29, s29, 512
s_mov_b32 s32, 1
s_waitcnt vmcnt(13)
v_mfma_f32_32x32x16_bf16 v[224:239], a[0:3], v[112:115], 0
buffer_load_dwordx4 v[160:163], v2, s[8:11], s25 offen offset:0 sc1
v_mfma_f32_32x32x16_bf16 v[240:255], a[112:115], v[112:115], 0
s_waitcnt vmcnt(13)
v_mfma_f32_32x32x16_bf16 v[224:239], a[4:7], v[116:119], v[224:239]
buffer_load_dwordx4 v[164:167], v2, s[8:11], s25 offen offset:1024 sc1
v_mfma_f32_32x32x16_bf16 v[240:255], a[116:119], v[116:119], v[240:255]
s_waitcnt vmcnt(13)
v_mfma_f32_32x32x16_bf16 v[224:239], a[8:11], v[120:123], v[224:239]
buffer_load_dwordx4 v[168:171], v2, s[8:11], s25 offen offset:2048 sc1
v_mfma_f32_32x32x16_bf16 v[240:255], a[120:123], v[120:123], v[240:255]
s_waitcnt vmcnt(13)
v_mfma_f32_32x32x16_bf16 v[224:239], a[12:15], v[124:127], v[224:239]
buffer_load_dword v13, v7, s[8:11], s29 offen sc1
buffer_load_dwordx4 v[172:175], v2, s[8:11], s25 offen offset:3072 sc1
s_add_u32 s25, s25, 4096
v_mfma_f32_32x32x16_bf16 v[240:255], a[124:127], v[124:127], v[240:255]
s_waitcnt vmcnt(14)
v_mfma_f32_32x32x16_bf16 v[224:239], a[16:19], v[128:131], v[224:239]
buffer_load_dwordx4 v[176:179], v2, s[8:11], s25 offen offset:0 sc1
v_mfma_f32_32x32x16_bf16 v[240:255], a[128:131], v[128:131], v[240:255]
s_waitcnt vmcnt(14)
v_mfma_f32_32x32x16_bf16 v[224:239], a[20:23], v[132:135], v[224:239]
buffer_load_dwordx4 v[180:183], v2, s[8:11], s25 offen offset:1024 sc1
v_mfma_f32_32x32x16_bf16 v[240:255], a[132:135], v[132:135], v[240:255]
s_waitcnt vmcnt(14)
s_cmp_eq_u32 s32, 0
s_cbranch_scc1 OPT_456
s_getreg_b32 s20, hwreg(HW_REG_IB_STS)
s_and_b32 s20, s20, 0xc0000f
s_cmp_gt_u32 s20, 7
s_cbranch_scc1 OPT_456
s_waitcnt vmcnt(7)
s_mov_b64 exec, 1
buffer_store_dword v5, v4, s[8:11], s30 offen sc1
s_mov_b64 exec, -1
s_add_u32 s30, s30, 512
s_mov_b32 s32, 0
OPT_456:
v_mfma_f32_32x32x16_bf16 v[224:239], a[24:27], v[136:139], v[224:239]
buffer_load_dwordx4 v[184:187], v2, s[8:11], s25 offen offset:2048 sc1
v_mfma_f32_32x32x16_bf16 v[240:255], a[136:139], v[136:139], v[240:255]
s_waitcnt vmcnt(14)
v_mfma_f32_32x32x16_bf16 v[224:239], a[28:31], v[140:143], v[224:239]
buffer_load_dwordx4 v[188:191], v2, s[8:11], s25 offen offset:3072 sc1
s_add_u32 s25, s25, 4096
v_mfma_f32_32x32x16_bf16 v[240:255], a[140:143], v[140:143], v[240:255]
s_waitcnt vmcnt(14)
v_mfma_f32_32x32x16_bf16 v[224:239], a[32:35], v[144:147], v[224:239]
buffer_load_dwordx4 v[192:195], v2, s[8:11], s25 offen offset:0 sc1
v_mfma_f32_32x32x16_bf16 v[240:255], a[144:147], v[144:147], v[240:255]
s_waitcnt vmcnt(14)
s_cmp_eq_u32 s32, 0
s_cbranch_scc1 OPT_458
s_getreg_b32 s20, hwreg(HW_REG_IB_STS)
s_and_b32 s20, s20, 0xc0000f
s_cmp_gt_u32 s20, 10
s_cbranch_scc1 OPT_458
s_waitcnt vmcnt(10)
s_mov_b64 exec, 1
buffer_store_dword v5, v4, s[8:11], s30 offen sc1
s_mov_b64 exec, -1
s_add_u32 s30, s30, 512
s_mov_b32 s32, 0
OPT_458:
v_mfma_f32_32x32x16_bf16 v[224:239], a[36:39], v[148:151], v[224:239]
buffer_load_dwordx4 v[196:199], v2, s[8:11], s25 offen offset:1024 sc1
v_mfma_f32_32x32x16_bf16 v[240:255], a[148:151], v[148:151], v[240:255]
s_waitcnt vmcnt(14)
v_mfma_f32_32x32x16_bf16 v[224:239], a[40:43], v[152:155], v[224:239]
buffer_load_dwordx4 v[200:203], v2, s[8:11], s25 offen offset:2048 sc1
v_mfma_f32_32x32x16_bf16 v[240:255], a[152:155], v[152:155], v[240:255]
s_waitcnt vmcnt(14)
v_mfma_f32_32x32x16_bf16 v[224:239], a[44:47], v[156:159], v[224:239]
buffer_load_dwordx4 v[204:207], v2, s[8:11], s25 offen offset:3072 sc1
s_add_u32 s25, s25, 4096
v_mfma_f32_32x32x16_bf16 v[240:255], a[156:159], v[156:159], v[240:255]
s_waitcnt vmcnt(12)
v_mfma_f32_32x32x16_bf16 v[224:239], a[48:51], v[160:163], v[224:239]
buffer_load_dwordx4 v[208:211], v2, s[8:11], s25 offen offset:0 sc1
v_mfma_f32_32x32x16_bf16 v[240:255], a[160:163], v[160:163], v[240:255]
s_waitcnt vmcnt(12)
v_mfma_f32_32x32x16_bf16 v[224:239], a[52:55], v[164:167], v[224:239]
buffer_load_dwordx4 v[212:215], v2, s[8:11], s25 offen offset:1024 sc1
v_mfma_f32_32x32x16_bf16 v[240:255], a[164:167], v[164:167], v[240:255]
s_waitcnt vmcnt(12)
v_mfma_f32_32x32x16_bf16 v[224:239], a[56:59], v[168:171], v[224:239]
buffer_load_dwordx4 v[216:219], v2, s[8:11], s25 offen offset:2048 sc1
v_mfma_f32_32x32x16_bf16 v[240:255], a[168:171], v[168:171], v[240:255]
s_waitcnt vmcnt(11)
s_cmp_eq_u32 s32, 0
s_cbranch_scc1 OPT_460
s_mov_b64 exec, 1
buffer_store_dword v5, v4, s[8:11], s30 offen sc1
s_mov_b64 exec, -1
s_add_u32 s30, s30, 512
s_mov_b32 s32, 0
OPT_460:
v_mfma_f32_32x32x16_bf16 v[224:239], a[60:63], v[172:175], v[224:239]
buffer_load_dwordx4 v[24:27], v10, s[8:11], s26 offen sc1
s_add_u32 s26, s26, 28672
buffer_load_dwordx4 v[220:223], v2, s[8:11], s25 offen offset:3072 sc1
s_add_u32 s25, s25, 90112
v_mfma_f32_32x32x16_bf16 v[240:255], a[172:175], v[172:175], v[240:255]
s_add_u32 s15, s15, 1
v_cmp_eq_u32 vcc, 0, v13
s_cmp_eq_u32 s15, 64
s_cselect_b64 vcc, -1, vcc
s_cbranch_vccnz F2_NP_461
s_waitcnt vmcnt(12)
v_mfma_f32_32x32x16_bf16 v[224:239], a[64:67], v[176:179], v[224:239]
buffer_load_dwordx4 v[112:115], v2, s[8:11], s25 offen offset:0 sc1
v_mfma_f32_32x32x16_bf16 v[240:255], a[176:179], v[176:179], v[240:255]
s_waitcnt vmcnt(12)
v_mfma_f32_32x32x16_bf16 v[224:239], a[68:71], v[180:183], v[224:239]
buffer_load_dwordx4 v[116:119], v2, s[8:11], s25 offen offset:1024 sc1
v_mfma_f32_32x32x16_bf16 v[240:255], a[180:183], v[180:183], v[240:255]
s_waitcnt vmcnt(12)
v_mfma_f32_32x32x16_bf16 v[224:239], a[72:75], v[184:187], v[224:239]
buffer_load_dwordx4 v[120:123], v2, s[8:11], s25 offen offset:2048 sc1
v_mfma_f32_32x32x16_bf16 v[240:255], a[184:187], v[184:187], v[240:255]
s_waitcnt vmcnt(12)
v_mfma_f32_32x32x16_bf16 v[224:239], a[76:79], v[188:191], v[224:239]
buffer_load_dwordx4 v[124:127], v2, s[8:11], s25 offen offset:3072 sc1
s_add_u32 s25, s25, 4096
v_mfma_f32_32x32x16_bf16 v[240:255], a[188:191], v[188:191], v[240:255]
s_waitcnt vmcnt(12)
v_mfma_f32_32x32x16_bf16 v[224:239], a[80:83], v[192:195], v[224:239]
buffer_load_dwordx4 v[128:131], v2, s[8:11], s25 offen offset:0 sc1
v_mfma_f32_32x32x16_bf16 v[240:255], a[192:195], v[192:195], v[240:255]
s_waitcnt vmcnt(12)
v_mfma_f32_32x32x16_bf16 v[224:239], a[84:87], v[196:199], v[224:239]
buffer_load_dwordx4 v[132:135], v2, s[8:11], s25 offen offset:1024 sc1
v_mfma_f32_32x32x16_bf16 v[240:255], a[196:199], v[196:199], v[240:255]
s_waitcnt vmcnt(12)
v_mfma_f32_32x32x16_bf16 v[224:239], a[88:91], v[200:203], v[224:239]
buffer_load_dwordx4 v[136:139], v2, s[8:11], s25 offen offset:2048 sc1
v_mfma_f32_32x32x16_bf16 v[240:255], a[200:203], v[200:203], v[240:255]
s_waitcnt vmcnt(12)
v_mfma_f32_32x32x16_bf16 v[224:239], a[92:95], v[204:207], v[224:239]
buffer_load_dwordx4 v[140:143], v2, s[8:11], s25 offen offset:3072 sc1
s_add_u32 s25, s25, 4096
v_mfma_f32_32x32x16_bf16 v[240:255], a[204:207], v[204:207], v[240:255]
s_waitcnt vmcnt(12)
v_mfma_f32_32x32x16_bf16 v[224:239], a[96:99], v[208:211], v[224:239]
buffer_load_dwordx4 v[144:147], v2, s[8:11], s25 offen offset:0 sc1
v_mfma_f32_32x32x16_bf16 v[240:255], a[208:211], v[208:211], v[240:255]
s_waitcnt vmcnt(12)
v_mfma_f32_32x32x16_bf16 v[224:239], a[100:103], v[212:215], v[224:239]
buffer_load_dwordx4 v[148:151], v2, s[8:11], s25 offen offset:1024 sc1
v_mfma_f32_32x32x16_bf16 v[240:255], a[212:215], v[212:215], v[240:255]
s_waitcnt vmcnt(12)
v_mfma_f32_32x32x16_bf16 v[224:239], a[104:107], v[216:219], v[224:239]
buffer_load_dwordx4 v[152:155], v2, s[8:11], s25 offen offset:2048 sc1
v_mfma_f32_32x32x16_bf16 v[240:255], a[216:219], v[216:219], v[240:255]
s_waitcnt vmcnt(11)
v_mfma_f32_32x32x16_bf16 v[224:239], a[108:111], v[220:223], v[224:239]
buffer_load_dwordx4 v[156:159], v2, s[8:11], s25 offen offset:3072 sc1
s_add_u32 s25, s25, 4096
v_mfma_f32_32x32x16_bf16 v[240:255], a[220:223], v[220:223], v[240:255]
s_nop 10
s_branch F2_W0_400
F2_NP_461:
s_waitcnt vmcnt(12)
v_mfma_f32_32x32x16_bf16 v[224:239], a[64:67], v[176:179], v[224:239]
v_mfma_f32_32x32x16_bf16 v[240:255], a[176:179], v[176:179], v[240:255]
s_waitcnt vmcnt(11)
v_mfma_f32_32x32x16_bf16 v[224:239], a[68:71], v[180:183], v[224:239]
v_mfma_f32_32x32x16_bf16 v[240:255], a[180:183], v[180:183], v[240:255]
s_waitcnt vmcnt(10)
v_mfma_f32_32x32x16_bf16 v[224:239], a[72:75], v[184:187], v[224:239]
v_mfma_f32_32x32x16_bf16 v[240:255], a[184:187], v[184:187], v[240:255]
s_waitcnt vmcnt(9)
v_mfma_f32_32x32x16_bf16 v[224:239], a[76:79], v[188:191], v[224:239]
v_mfma_f32_32x32x16_bf16 v[240:255], a[188:191], v[188:191], v[240:255]
s_waitcnt vmcnt(8)
v_mfma_f32_32x32x16_bf16 v[224:239], a[80:83], v[192:195], v[224:239]
v_mfma_f32_32x32x16_bf16 v[240:255], a[192:195], v[192:195], v[240:255]
s_waitcnt vmcnt(7)
v_mfma_f32_32x32x16_bf16 v[224:239], a[84:87], v[196:199], v[224:239]
buffer_load_dword v13, v7, s[8:11], s29 offen sc1
v_mfma_f32_32x32x16_bf16 v[240:255], a[196:199], v[196:199], v[240:255]
s_waitcnt vmcnt(7)
v_mfma_f32_32x32x16_bf16 v[224:239], a[88:91], v[200:203], v[224:239]
s_waitcnt vmcnt(6)
v_mfma_f32_32x32x16_bf16 v[224:239], a[92:95], v[204:207], v[224:239]
s_waitcnt vmcnt(5)
v_mfma_f32_32x32x16_bf16 v[224:239], a[96:99], v[208:211], v[224:239]
s_waitcnt vmcnt(4)
v_mfma_f32_32x32x16_bf16 v[224:239], a[100:103], v[212:215], v[224:239]
s_waitcnt vmcnt(3)
v_mfma_f32_32x32x16_bf16 v[224:239], a[104:107], v[216:219], v[224:239]
s_waitcnt vmcnt(1)
v_mfma_f32_32x32x16_bf16 v[224:239], a[108:111], v[220:223], v[224:239]
v_mfma_f32_32x32x16_bf16 v[240:255], a[200:203], v[200:203], v[240:255]
s_nop 4
v_mfma_f32_32x32x16_bf16 v[240:255], a[204:207], v[204:207], v[240:255]
s_nop 4
v_mfma_f32_32x32x16_bf16 v[240:255], a[208:211], v[208:211], v[240:255]
ds_write_b128 v14, v[224:227] offset:0
v_mfma_f32_32x32x16_bf16 v[240:255], a[212:215], v[212:215], v[240:255]
ds_write_b128 v14, v[228:231] offset:1280
v_mfma_f32_32x32x16_bf16 v[240:255], a[216:219], v[216:219], v[240:255]
ds_write_b128 v14, v[232:235] offset:2560
v_mfma_f32_32x32x16_bf16 v[240:255], a[220:223], v[220:223], v[240:255]
ds_write_b128 v14, v[236:239] offset:3840
s_waitcnt vmcnt(0)
v_cmp_eq_u32 vcc, 0, v13
s_cmp_eq_u32 s15, 64
s_cselect_b64 vcc, -1, vcc
s_cbranch_vccnz F2_CE_462
buffer_load_dwordx4 v[112:115], v2, s[8:11], s25 offen offset:0 sc1
buffer_load_dwordx4 v[116:119], v2, s[8:11], s25 offen offset:1024 sc1
s_nop 3
ds_write_b128 v14, v[240:243] offset:5120
buffer_load_dwordx4 v[120:123], v2, s[8:11], s25 offen offset:2048 sc1
ds_write_b128 v14, v[244:247] offset:6400
buffer_load_dwordx4 v[124:127], v2, s[8:11], s25 offen offset:3072 sc1
s_add_u32 s25, s25, 4096
ds_write_b128 v14, v[248:251] offset:7680
buffer_load_dwordx4 v[128:131], v2, s[8:11], s25 offen offset:0 sc1
ds_write_b128 v14, v[252:255] offset:8960
buffer_load_dwordx4 v[132:135], v2, s[8:11], s25 offen offset:1024 sc1
buffer_load_dwordx4 v[136:139], v2, s[8:11], s25 offen offset:2048 sc1
buffer_load_dwordx4 v[140:143], v2, s[8:11], s25 offen offset:3072 sc1
s_add_u32 s25, s25, 4096
buffer_load_dwordx4 v[144:147], v2, s[8:11], s25 offen offset:0 sc1
buffer_load_dwordx4 v[148:151], v2, s[8:11], s25 offen offset:1024 sc1
buffer_load_dwordx4 v[152:155], v2, s[8:11], s25 offen offset:2048 sc1
buffer_load_dwordx4 v[156:159], v2, s[8:11], s25 offen offset:3072 sc1
s_add_u32 s25, s25, 4096
s_waitcnt lgkmcnt(0)
s_barrier
ds_read_b128 v[80:83], v15 offset:0
ds_read_b128 v[84:87], v15 offset:1280
ds_read_b128 v[88:91], v15 offset:10240
ds_read_b128 v[92:95], v15 offset:11520
ds_read_b128 v[96:99], v15 offset:20480
ds_read_b128 v[100:103], v15 offset:21760
ds_read_b128 v[104:107], v15 offset:30720
ds_read_b128 v[108:111], v15 offset:32000
v_lshlrev_b32 v224, 16, v24
v_and_b32 v225, 0xffff0000, v24
v_lshlrev_b32 v226, 16, v25
v_and_b32 v227, 0xffff0000, v25
v_lshlrev_b32 v228, 16, v26
v_and_b32 v229, 0xffff0000, v26
v_lshlrev_b32 v230, 16, v27
v_and_b32 v231, 0xffff0000, v27
s_waitcnt lgkmcnt(6)
v_pk_add_f32 v[224:225], v[224:225], v[80:81]
v_pk_add_f32 v[226:227], v[226:227], v[82:83]
v_pk_add_f32 v[228:229], v[228:229], v[84:85]
v_pk_add_f32 v[230:231], v[230:231], v[86:87]
s_waitcnt lgkmcnt(4)
v_pk_add_f32 v[224:225], v[224:225], v[88:89]
v_pk_add_f32 v[226:227], v[226:227], v[90:91]
v_pk_add_f32 v[228:229], v[228:229], v[92:93]
v_pk_add_f32 v[230:231], v[230:231], v[94:95]
s_waitcnt lgkmcnt(2)
v_pk_add_f32 v[224:225], v[224:225], v[96:97]
v_pk_add_f32 v[226:227], v[226:227], v[98:99]
v_pk_add_f32 v[228:229], v[228:229], v[100:101]
v_pk_add_f32 v[230:231], v[230:231], v[102:103]
s_waitcnt lgkmcnt(0)
v_pk_add_f32 v[224:225], v[224:225], v[104:105]
v_pk_add_f32 v[226:227], v[226:227], v[106:107]
v_pk_add_f32 v[228:229], v[228:229], v[108:109]
v_pk_add_f32 v[230:231], v[230:231], v[110:111]
v_cvt_pk_bf16_f32 v24, v224, v225
v_cvt_pk_bf16_f32 v25, v226, v227
v_cvt_pk_bf16_f32 v26, v228, v229
v_cvt_pk_bf16_f32 v27, v230, v231
buffer_store_dwordx4 v[24:27], v10, s[8:11], s27 offen sc1
s_add_u32 s27, s27, 28672
v_lshlrev_b32 v224, 16, v24
v_and_b32 v225, 0xffff0000, v24
v_lshlrev_b32 v226, 16, v25
v_and_b32 v227, 0xffff0000, v25
v_lshlrev_b32 v228, 16, v26
v_and_b32 v229, 0xffff0000, v26
v_lshlrev_b32 v230, 16, v27
v_and_b32 v231, 0xffff0000, v27
v_pk_add_f32 v[80:81], v[224:225], v[226:227]
v_pk_mul_f32 v[82:83], v[224:225], v[224:225]
v_pk_add_f32 v[84:85], v[228:229], v[230:231]
v_pk_fma_f32 v[82:83], v[226:227], v[226:227], v[82:83]
v_pk_fma_f32 v[82:83], v[228:229], v[228:229], v[82:83]
v_pk_fma_f32 v[82:83], v[230:231], v[230:231], v[82:83]
v_pk_add_f32 v[80:81], v[80:81], v[84:85]
v_add_f32 v80, v80, v81
v_add_f32 v81, v82, v83
s_nop 0
v_add_f32_dpp v80, v80, v80 row_ror:8 row_mask:0xf bank_mask:0xf
v_add_f32_dpp v81, v81, v81 row_ror:8 row_mask:0xf bank_mask:0xf
v_mov_b32 v82, v80
v_mov_b32 v83, v81
s_nop 0
v_permlane16_swap_b32 v80, v82
v_permlane16_swap_b32 v81, v83
v_pk_add_f32 v[80:81], v[80:81], v[82:83]
v_mov_b32 v82, v80
v_mov_b32 v83, v81
s_nop 0
v_permlane32_swap_b32 v80, v82
v_permlane32_swap_b32 v81, v83
v_pk_add_f32 v[80:81], v[80:81], v[82:83]
s_mov_b64 exec, s[36:37]
buffer_store_dwordx2 v[80:81], v11, s[8:11], s28 offen sc1
s_mov_b64 exec, -1
s_add_u32 s28, s28, 2048
s_branch F2_P0_402
F2_CE_462:
s_nop 5
ds_write_b128 v14, v[240:243] offset:5120
ds_write_b128 v14, v[244:247] offset:6400
ds_write_b128 v14, v[248:251] offset:7680
ds_write_b128 v14, v[252:255] offset:8960
s_waitcnt lgkmcnt(0)
s_barrier
ds_read_b128 v[80:83], v15 offset:0
ds_read_b128 v[84:87], v15 offset:1280
ds_read_b128 v[88:91], v15 offset:10240
ds_read_b128 v[92:95], v15 offset:11520
ds_read_b128 v[96:99], v15 offset:20480
ds_read_b128 v[100:103], v15 offset:21760
ds_read_b128 v[104:107], v15 offset:30720
ds_read_b128 v[108:111], v15 offset:32000
v_lshlrev_b32 v224, 16, v24
v_and_b32 v225, 0xffff0000, v24
v_lshlrev_b32 v226, 16, v25
v_and_b32 v227, 0xffff0000, v25
v_lshlrev_b32 v228, 16, v26
v_and_b32 v229, 0xffff0000, v26
v_lshlrev_b32 v230, 16, v27
v_and_b32 v231, 0xffff0000, v27
s_waitcnt lgkmcnt(6)
v_pk_add_f32 v[224:225], v[224:225], v[80:81]
v_pk_add_f32 v[226:227], v[226:227], v[82:83]
v_pk_add_f32 v[228:229], v[228:229], v[84:85]
v_pk_add_f32 v[230:231], v[230:231], v[86:87]
s_waitcnt lgkmcnt(4)
v_pk_add_f32 v[224:225], v[224:225], v[88:89]
v_pk_add_f32 v[226:227], v[226:227], v[90:91]
v_pk_add_f32 v[228:229], v[228:229], v[92:93]
v_pk_add_f32 v[230:231], v[230:231], v[94:95]
s_waitcnt lgkmcnt(2)
v_pk_add_f32 v[224:225], v[224:225], v[96:97]
v_pk_add_f32 v[226:227], v[226:227], v[98:99]
v_pk_add_f32 v[228:229], v[228:229], v[100:101]
v_pk_add_f32 v[230:231], v[230:231], v[102:103]
s_waitcnt lgkmcnt(0)
v_pk_add_f32 v[224:225], v[224:225], v[104:105]
v_pk_add_f32 v[226:227], v[226:227], v[106:107]
v_pk_add_f32 v[228:229], v[228:229], v[108:109]
v_pk_add_f32 v[230:231], v[230:231], v[110:111]
v_cvt_pk_bf16_f32 v24, v224, v225
v_cvt_pk_bf16_f32 v25, v226, v227
v_cvt_pk_bf16_f32 v26, v228, v229
v_cvt_pk_bf16_f32 v27, v230, v231
buffer_store_dwordx4 v[24:27], v10, s[8:11], s27 offen sc1
s_add_u32 s27, s27, 28672
v_lshlrev_b32 v224, 16, v24
v_and_b32 v225, 0xffff0000, v24
v_lshlrev_b32 v226, 16, v25
v_and_b32 v227, 0xffff0000, v25
v_lshlrev_b32 v228, 16, v26
v_and_b32 v229, 0xffff0000, v26
v_lshlrev_b32 v230, 16, v27
v_and_b32 v231, 0xffff0000, v27
v_pk_add_f32 v[80:81], v[224:225], v[226:227]
v_pk_mul_f32 v[82:83], v[224:225], v[224:225]
v_pk_add_f32 v[84:85], v[228:229], v[230:231]
v_pk_fma_f32 v[82:83], v[226:227], v[226:227], v[82:83]
v_pk_fma_f32 v[82:83], v[228:229], v[228:229], v[82:83]
v_pk_fma_f32 v[82:83], v[230:231], v[230:231], v[82:83]
v_pk_add_f32 v[80:81], v[80:81], v[84:85]
v_add_f32 v80, v80, v81
v_add_f32 v81, v82, v83
s_nop 0
v_add_f32_dpp v80, v80, v80 row_ror:8 row_mask:0xf bank_mask:0xf
v_add_f32_dpp v81, v81, v81 row_ror:8 row_mask:0xf bank_mask:0xf
v_mov_b32 v82, v80
v_mov_b32 v83, v81
s_nop 0
v_permlane16_swap_b32 v80, v82
v_permlane16_swap_b32 v81, v83
v_pk_add_f32 v[80:81], v[80:81], v[82:83]
v_mov_b32 v82, v80
v_mov_b32 v83, v81
s_nop 0
v_permlane32_swap_b32 v80, v82
v_permlane32_swap_b32 v81, v83
v_pk_add_f32 v[80:81], v[80:81], v[82:83]
s_mov_b64 exec, s[36:37]
buffer_store_dwordx2 v[80:81], v11, s[8:11], s28 offen sc1
s_mov_b64 exec, -1
s_add_u32 s28, s28, 2048
buffer_load_dword v13, v7, s[8:11], s29 offen sc1
s_waitcnt vmcnt(1)
s_mov_b64 exec, 1
buffer_store_dword v5, v4, s[8:11], s30 offen sc1
s_mov_b64 exec, -1
s_add_u32 s30, s30, 512
s_cmp_ge_u32 s15, 64
s_cbranch_scc0 OPT_463
s_endpgm
OPT_463:
s_waitcnt vmcnt(1)
s_branch F2_C0_398
F2_L1_397:
v_mov_b32 v13, 0
s_nop 1
F2_C0_464:
v_cmp_eq_u32 vcc, 0, v13
s_cbranch_vccz OPT_470
s_nop 2
s_branch WF_471_in
WF_471:
s_sleep 1
WF_471_in:
buffer_load_dword v18, v7, s[8:11], s29 offen sc1
s_sub_u32 s16, s16, 1
s_cbranch_scc1 WFD_472_abort
s_waitcnt vmcnt(0)
v_cmp_eq_u32 vcc, 0, v18
s_cbranch_vccnz WF_471
WFD_472:
OPT_470:
buffer_load_dwordx4 v[112:115], v2, s[8:11], s25 offen offset:0 sc1
buffer_load_dwordx4 v[116:119], v2, s[8:11], s25 offen offset:1024 sc1
buffer_load_dwordx4 v[120:123], v2, s[8:11], s25 offen offset:2048 sc1
buffer_load_dwordx4 v[124:127], v2, s[8:11], s25 offen offset:3072 sc1
s_add_u32 s25, s25, 4096
buffer_load_dwordx4 v[128:131], v2, s[8:11], s25 offen offset:0 sc1
buffer_load_dwordx4 v[132:135], v2, s[8:11], s25 offen offset:1024 sc1
buffer_load_dwordx4 v[136:139], v2, s[8:11], s25 offen offset:2048 sc1
buffer_load_dwordx4 v[140:143], v2, s[8:11], s25 offen offset:3072 sc1
s_add_u32 s25, s25, 4096
buffer_load_dwordx4 v[144:147], v2, s[8:11], s25 offen offset:0 sc1
buffer_load_dwordx4 v[148:151], v2, s[8:11], s25 offen offset:1024 sc1
buffer_load_dwordx4 v[152:155], v2, s[8:11], s25 offen offset:2048 sc1
buffer_load_dwordx4 v[156:159], v2, s[8:11], s25 offen offset:3072 sc1
s_add_u32 s25, s25, 4096
s_add_u32 s29, s29, 512
s_mov_b32 s32, 1
s_waitcnt vmcnt(11)
v_mfma_f32_32x32x16_bf16 v[48:63], a[0:3], v[112:115], 0
buffer_load_dwordx4 v[160:163], v2, s[8:11], s25 offen offset:0 sc1
v_mfma_f32_32x32x16_bf16 v[64:79], a[112:115], v[112:115], 0
s_waitcnt vmcnt(11)
v_mfma_f32_32x32x16_bf16 v[48:63], a[4:7], v[116:119], v[48:63]
buffer_load_dwordx4 v[164:167], v2, s[8:11], s25 offen offset:1024 sc1
v_mfma_f32_32x32x16_bf16 v[64:79], a[116:119], v[116:119], v[64:79]
s_waitcnt vmcnt(11)
v_mfma_f32_32x32x16_bf16 v[48:63], a[8:11], v[120:123], v[48:63]
buffer_load_dwordx4 v[168:171], v2, s[8:11], s25 offen offset:2048 sc1
v_mfma_f32_32x32x16_bf16 v[64:79], a[120:123], v[120:123], v[64:79]
s_waitcnt vmcnt(11)
v_mfma_f32_32x32x16_bf16 v[48:63], a[12:15], v[124:127], v[48:63]
buffer_load_dword v13, v7, s[8:11], s29 offen sc1
buffer_load_dwordx4 v[172:175], v2, s[8:11], s25 offen offset:3072 sc1
s_add_u32 s25, s25, 4096
v_mfma_f32_32x32x16_bf16 v[64:79], a[124:127], v[124:127], v[64:79]
s_waitcnt vmcnt(12)
v_mfma_f32_32x32x16_bf16 v[48:63], a[16:19], v[128:131], v[48:63]
buffer_load_dwordx4 v[176:179], v2, s[8:11], s25 offen offset:0 sc1
v_mfma_f32_32x32x16_bf16 v[64:79], a[128:131], v[128:131], v[64:79]
s_waitcnt vmcnt(12)
v_mfma_f32_32x32x16_bf16 v[48:63], a[20:23], v[132:135], v[48:63]
buffer_load_dwordx4 v[180:183], v2, s[8:11], s25 offen offset:1024 sc1
v_mfma_f32_32x32x16_bf16 v[64:79], a[132:135], v[132:135], v[64:79]
s_waitcnt vmcnt(12)
v_mfma_f32_32x32x16_bf16 v[48:63], a[24:27], v[136:139], v[48:63]
buffer_load_dwordx4 v[184:187], v2, s[8:11], s25 offen offset:2048 sc1
v_mfma_f32_32x32x16_bf16 v[64:79], a[136:139], v[136:139], v[64:79]
s_waitcnt vmcnt(12)
v_mfma_f32_32x32x16_bf16 v[48:63], a[28:31], v[140:143], v[48:63]
buffer_load_dwordx4 v[188:191], v2, s[8:11], s25 offen offset:3072 sc1
s_add_u32 s25, s25, 4096
v_mfma_f32_32x32x16_bf16 v[64:79], a[140:143], v[140:143], v[64:79]
s_waitcnt vmcnt(12)
v_mfma_f32_32x32x16_bf16 v[48:63], a[32:35], v[144:147], v[48:63]
buffer_load_dwordx4 v[192:195], v2, s[8:11], s25 offen offset:0 sc1
v_mfma_f32_32x32x16_bf16 v[64:79], a[144:147], v[144:147], v[64:79]
s_waitcnt vmcnt(12)
v_mfma_f32_32x32x16_bf16 v[48:63], a[36:39], v[148:151], v[48:63]
buffer_load_dwordx4 v[196:199], v2, s[8:11], s25 offen offset:1024 sc1
v_mfma_f32_32x32x16_bf16 v[64:79], a[148:151], v[148:151], v[64:79]
s_waitcnt vmcnt(12)
v_mfma_f32_32x32x16_bf16 v[48:63], a[40:43], v[152:155], v[48:63]
buffer_load_dwordx4 v[200:203], v2, s[8:11], s25 offen offset:2048 sc1
v_mfma_f32_32x32x16_bf16 v[64:79], a[152:155], v[152:155], v[64:79]
s_waitcnt vmcnt(12)
v_mfma_f32_32x32x16_bf16 v[48:63], a[44:47], v[156:159], v[48:63]
buffer_load_dwordx4 v[204:207], v2, s[8:11], s25 offen offset:3072 sc1
s_add_u32 s25, s25, 4096
v_mfma_f32_32x32x16_bf16 v[64:79], a[156:159], v[156:159], v[64:79]
s_waitcnt vmcnt(12)
v_mfma_f32_32x32x16_bf16 v[48:63], a[48:51], v[160:163], v[48:63]
buffer_load_dwordx4 v[208:211], v2, s[8:11], s25 offen offset:0 sc1
v_mfma_f32_32x32x16_bf16 v[64:79], a[160:163], v[160:163], v[64:79]
s_waitcnt vmcnt(12)
v_mfma_f32_32x32x16_bf16 v[48:63], a[52:55], v[164:167], v[48:63]
buffer_load_dwordx4 v[212:215], v2, s[8:11], s25 offen offset:1024 sc1
v_mfma_f32_32x32x16_bf16 v[64:79], a[164:167], v[164:167], v[64:79]
s_waitcnt vmcnt(12)
v_mfma_f32_32x32x16_bf16 v[48:63], a[56:59], v[168:171], v[48:63]
buffer_load_dwordx4 v[216:219], v2, s[8:11], s25 offen offset:2048 sc1
v_mfma_f32_32x32x16_bf16 v[64:79], a[168:171], v[168:171], v[64:79]
s_waitcnt vmcnt(11)
v_mfma_f32_32x32x16_bf16 v[48:63], a[60:63], v[172:175], v[48:63]
buffer_load_dwordx4 v[20:23], v10, s[8:11], s26 offen sc1
s_add_u32 s26, s26, 28672
buffer_load_dwordx4 v[220:223], v2, s[8:11], s25 offen offset:3072 sc1
s_add_u32 s25, s25, 90112
v_mfma_f32_32x32x16_bf16 v[64:79], a[172:175], v[172:175], v[64:79]
s_add_u32 s15, s15, 1
v_cmp_eq_u32 vcc, 0, v13
s_cmp_eq_u32 s15, 64
s_cselect_b64 vcc, -1, vcc
s_cbranch_vccnz F2_NP_473
s_waitcnt vmcnt(12)
v_mfma_f32_32x32x16_bf16 v[48:63], a[64:67], v[176:179], v[48:63]
buffer_load_dwordx4 v[112:115], v2, s[8:11], s25 offen offset:0 sc1
v_mfma_f32_32x32x16_bf16 v[64:79], a[176:179], v[176:179], v[64:79]
s_waitcnt vmcnt(12)
v_mfma_f32_32x32x16_bf16 v[48:63], a[68:71], v[180:183], v[48:63]
buffer_load_dwordx4 v[116:119], v2, s[8:11], s25 offen offset:1024 sc1
v_mfma_f32_32x32x16_bf16 v[64:79], a[180:183], v[180:183], v[64:79]
s_waitcnt vmcnt(12)
v_mfma_f32_32x32x16_bf16 v[48:63], a[72:75], v[184:187], v[48:63]
buffer_load_dwordx4 v[120:123], v2, s[8:11], s25 offen offset:2048 sc1
v_mfma_f32_32x32x16_bf16 v[64:79], a[184:187], v[184:187], v[64:79]
s_waitcnt vmcnt(12)
v_mfma_f32_32x32x16_bf16 v[48:63], a[76:79], v[188:191], v[48:63]
buffer_load_dwordx4 v[124:127], v2, s[8:11], s25 offen offset:3072 sc1
s_add_u32 s25, s25, 4096
v_mfma_f32_32x32x16_bf16 v[64:79], a[188:191], v[188:191], v[64:79]
s_waitcnt vmcnt(12)
v_mfma_f32_32x32x16_bf16 v[48:63], a[80:83], v[192:195], v[48:63]
buffer_load_dwordx4 v[128:131], v2, s[8:11], s25 offen offset:0 sc1
v_mfma_f32_32x32x16_bf16 v[64:79], a[192:195], v[192:195], v[64:79]
s_waitcnt vmcnt(12)
v_mfma_f32_32x32x16_bf16 v[48:63], a[84:87], v[196:199], v[48:63]
buffer_load_dwordx4 v[132:135], v2, s[8:11], s25 offen offset:1024 sc1
v_mfma_f32_32x32x16_bf16 v[64:79], a[196:199], v[196:199], v[64:79]
s_waitcnt vmcnt(12)
v_mfma_f32_32x32x16_bf16 v[48:63], a[88:91], v[200:203], v[48:63]
buffer_load_dwordx4 v[136:139], v2, s[8:11], s25 offen offset:2048 sc1
v_mfma_f32_32x32x16_bf16 v[64:79], a[200:203], v[200:203], v[64:79]
s_waitcnt vmcnt(12)
v_mfma_f32_32x32x16_bf16 v[48:63], a[92:95], v[204:207], v[48:63]
buffer_load_dwordx4 v[140:143], v2, s[8:11], s25 offen offset:3072 sc1
s_add_u32 s25, s25, 4096
v_mfma_f32_32x32x16_bf16 v[64:79], a[204:207], v[204:207], v[64:79]
s_waitcnt vmcnt(12)
v_mfma_f32_32x32x16_bf16 v[48:63], a[96:99], v[208:211], v[48:63]
buffer_load_dwordx4 v[144:147], v2, s[8:11], s25 offen offset:0 sc1
v_mfma_f32_32x32x16_bf16 v[64:79], a[208:211], v[208:211], v[64:79]
s_waitcnt vmcnt(12)
v_mfma_f32_32x32x16_bf16 v[48:63], a[100:103], v[212:215], v[48:63]
buffer_load_dwordx4 v[148:151], v2, s[8:11], s25 offen offset:1024 sc1
v_mfma_f32_32x32x16_bf16 v[64:79], a[212:215], v[212:215], v[64:79]
s_waitcnt vmcnt(12)
v_mfma_f32_32x32x16_bf16 v[48:63], a[104:107], v[216:219], v[48:63]
buffer_load_dwordx4 v[152:155], v2, s[8:11], s25 offen offset:2048 sc1
v_mfma_f32_32x32x16_bf16 v[64:79], a[216:219], v[216:219], v[64:79]
s_waitcnt vmcnt(11)
v_mfma_f32_32x32x16_bf16 v[48:63], a[108:111], v[220:223], v[48:63]
buffer_load_dwordx4 v[156:159], v2, s[8:11], s25 offen offset:3072 sc1
s_add_u32 s25, s25, 4096
v_mfma_f32_32x32x16_bf16 v[64:79], a[220:223], v[220:223], v[64:79]
s_nop 10
s_branch F2_W1_467
F2_NP_473:
s_waitcnt vmcnt(12)
v_mfma_f32_32x32x16_bf16 v[48:63], a[64:67], v[176:179], v[48:63]
v_mfma_f32_32x32x16_bf16 v[64:79], a[176:179], v[176:179], v[64:79]
s_waitcnt vmcnt(11)
v_mfma_f32_32x32x16_bf16 v[48:63], a[68:71], v[180:183], v[48:63]
v_mfma_f32_32x32x16_bf16 v[64:79], a[180:183], v[180:183], v[64:79]
s_waitcnt vmcnt(10)
v_mfma_f32_32x32x16_bf16 v[48:63], a[72:75], v[184:187], v[48:63]
v_mfma_f32_32x32x16_bf16 v[64:79], a[184:187], v[184:187], v[64:79]
s_waitcnt vmcnt(9)
v_mfma_f32_32x32x16_bf16 v[48:63], a[76:79], v[188:191], v[48:63]
v_mfma_f32_32x32x16_bf16 v[64:79], a[188:191], v[188:191], v[64:79]
s_waitcnt vmcnt(8)
v_mfma_f32_32x32x16_bf16 v[48:63], a[80:83], v[192:195], v[48:63]
v_mfma_f32_32x32x16_bf16 v[64:79], a[192:195], v[192:195], v[64:79]
s_waitcnt vmcnt(7)
v_mfma_f32_32x32x16_bf16 v[48:63], a[84:87], v[196:199], v[48:63]
buffer_load_dword v13, v7, s[8:11], s29 offen sc1
v_mfma_f32_32x32x16_bf16 v[64:79], a[196:199], v[196:199], v[64:79]
s_waitcnt vmcnt(7)
v_mfma_f32_32x32x16_bf16 v[48:63], a[88:91], v[200:203], v[48:63]
s_waitcnt vmcnt(6)
v_mfma_f32_32x32x16_bf16 v[48:63], a[92:95], v[204:207], v[48:63]
s_waitcnt vmcnt(5)
v_mfma_f32_32x32x16_bf16 v[48:63], a[96:99], v[208:211], v[48:63]
s_waitcnt vmcnt(4)
v_mfma_f32_32x32x16_bf16 v[48:63], a[100:103], v[212:215], v[48:63]
s_waitcnt vmcnt(3)
v_mfma_f32_32x32x16_bf16 v[48:63], a[104:107], v[216:219], v[48:63]
s_waitcnt vmcnt(1)
v_mfma_f32_32x32x16_bf16 v[48:63], a[108:111], v[220:223], v[48:63]
v_mfma_f32_32x32x16_bf16 v[64:79], a[200:203], v[200:203], v[64:79]
s_nop 4
v_mfma_f32_32x32x16_bf16 v[64:79], a[204:207], v[204:207], v[64:79]
s_nop 4
v_mfma_f32_32x32x16_bf16 v[64:79], a[208:211], v[208:211], v[64:79]
ds_write_b128 v8, v[48:51] offset:0
v_mfma_f32_32x32x16_bf16 v[64:79], a[212:215], v[212:215], v[64:79]
ds_write_b128 v8, v[52:55] offset:1280
v_mfma_f32_32x32x16_bf16 v[64:79], a[216:219], v[216:219], v[64:79]
ds_write_b128 v8, v[56:59] offset:2560
v_mfma_f32_32x32x16_bf16 v[64:79], a[220:223], v[220:223], v[64:79]
ds_write_b128 v8, v[60:63] offset:3840
s_waitcnt vmcnt(0)
v_cmp_eq_u32 vcc, 0, v13
s_cmp_eq_u32 s15, 64
s_cselect_b64 vcc, -1, vcc
s_cbranch_vccnz F2_CE_474
buffer_load_dwordx4 v[112:115], v2, s[8:11], s25 offen offset:0 sc1
buffer_load_dwordx4 v[116:119], v2, s[8:11], s25 offen offset:1024 sc1
s_nop 3
ds_write_b128 v8, v[64:67] offset:5120
buffer_load_dwordx4 v[120:123], v2, s[8:11], s25 offen offset:2048 sc1
ds_write_b128 v8, v[68:71] offset:6400
buffer_load_dwordx4 v[124:127], v2, s[8:11], s25 offen offset:3072 sc1
s_add_u32 s25, s25, 4096
ds_write_b128 v8, v[72:75] offset:7680
buffer_load_dwordx4 v[128:131], v2, s[8:11], s25 offen offset:0 sc1
ds_write_b128 v8, v[76:79] offset:8960
buffer_load_dwordx4 v[132:135], v2, s[8:11], s25 offen offset:1024 sc1
buffer_load_dwordx4 v[136:139], v2, s[8:11], s25 offen offset:2048 sc1
buffer_load_dwordx4 v[140:143], v2, s[8:11], s25 offen offset:3072 sc1
s_add_u32 s25, s25, 4096
buffer_load_dwordx4 v[144:147], v2, s[8:11], s25 offen offset:0 sc1
buffer_load_dwordx4 v[148:151], v2, s[8:11], s25 offen offset:1024 sc1
buffer_load_dwordx4 v[152:155], v2, s[8:11], s25 offen offset:2048 sc1
buffer_load_dwordx4 v[156:159], v2, s[8:11], s25 offen offset:3072 sc1
s_add_u32 s25, s25, 4096
s_waitcnt lgkmcnt(0)
s_barrier
ds_read_b128 v[80:83], v9 offset:0
ds_read_b128 v[84:87], v9 offset:1280
ds_read_b128 v[88:91], v9 offset:10240
ds_read_b128 v[92:95], v9 offset:11520
ds_read_b128 v[96:99], v9 offset:20480
ds_read_b128 v[100:103], v9 offset:21760
ds_read_b128 v[104:107], v9 offset:30720
ds_read_b128 v[108:111], v9 offset:32000
v_lshlrev_b32 v48, 16, v20
v_and_b32 v49, 0xffff0000, v20
v_lshlrev_b32 v50, 16, v21
v_and_b32 v51, 0xffff0000, v21
v_lshlrev_b32 v52, 16, v22
v_and_b32 v53, 0xffff0000, v22
v_lshlrev_b32 v54, 16, v23
v_and_b32 v55, 0xffff0000, v23
s_waitcnt lgkmcnt(6)
v_pk_add_f32 v[48:49], v[48:49], v[80:81]
v_pk_add_f32 v[50:51], v[50:51], v[82:83]
v_pk_add_f32 v[52:53], v[52:53], v[84:85]
v_pk_add_f32 v[54:55], v[54:55], v[86:87]
s_waitcnt lgkmcnt(4)
v_pk_add_f32 v[48:49], v[48:49], v[88:89]
v_pk_add_f32 v[50:51], v[50:51], v[90:91]
v_pk_add_f32 v[52:53], v[52:53], v[92:93]
v_pk_add_f32 v[54:55], v[54:55], v[94:95]
s_waitcnt lgkmcnt(2)
v_pk_add_f32 v[48:49], v[48:49], v[96:97]
v_pk_add_f32 v[50:51], v[50:51], v[98:99]
v_pk_add_f32 v[52:53], v[52:53], v[100:101]
v_pk_add_f32 v[54:55], v[54:55], v[102:103]
s_waitcnt lgkmcnt(0)
v_pk_add_f32 v[48:49], v[48:49], v[104:105]
v_pk_add_f32 v[50:51], v[50:51], v[106:107]
v_pk_add_f32 v[52:53], v[52:53], v[108:109]
v_pk_add_f32 v[54:55], v[54:55], v[110:111]
v_cvt_pk_bf16_f32 v20, v48, v49
v_cvt_pk_bf16_f32 v21, v50, v51
v_cvt_pk_bf16_f32 v22, v52, v53
v_cvt_pk_bf16_f32 v23, v54, v55
buffer_store_dwordx4 v[20:23], v12, s[40:43], s35 offen
s_add_u32 s35, s35, 28672
s_branch F2_P1_469
F2_CE_474:
s_nop 5
ds_write_b128 v8, v[64:67] offset:5120
ds_write_b128 v8, v[68:71] offset:6400
ds_write_b128 v8, v[72:75] offset:7680
ds_write_b128 v8, v[76:79] offset:8960
s_waitcnt lgkmcnt(0)
s_barrier
ds_read_b128 v[80:83], v9 offset:0
ds_read_b128 v[84:87], v9 offset:1280
ds_read_b128 v[88:91], v9 offset:10240
ds_read_b128 v[92:95], v9 offset:11520
ds_read_b128 v[96:99], v9 offset:20480
ds_read_b128 v[100:103], v9 offset:21760
ds_read_b128 v[104:107], v9 offset:30720
ds_read_b128 v[108:111], v9 offset:32000
v_lshlrev_b32 v48, 16, v20
v_and_b32 v49, 0xffff0000, v20
v_lshlrev_b32 v50, 16, v21
v_and_b32 v51, 0xffff0000, v21
v_lshlrev_b32 v52, 16, v22
v_and_b32 v53, 0xffff0000, v22
v_lshlrev_b32 v54, 16, v23
v_and_b32 v55, 0xffff0000, v23
s_waitcnt lgkmcnt(6)
v_pk_add_f32 v[48:49], v[48:49], v[80:81]
v_pk_add_f32 v[50:51], v[50:51], v[82:83]
v_pk_add_f32 v[52:53], v[52:53], v[84:85]
v_pk_add_f32 v[54:55], v[54:55], v[86:87]
s_waitcnt lgkmcnt(4)
v_pk_add_f32 v[48:49], v[48:49], v[88:89]
v_pk_add_f32 v[50:51], v[50:51], v[90:91]
v_pk_add_f32 v[52:53], v[52:53], v[92:93]
v_pk_add_f32 v[54:55], v[54:55], v[94:95]
s_waitcnt lgkmcnt(2)
v_pk_add_f32 v[48:49], v[48:49], v[96:97]
v_pk_add_f32 v[50:51], v[50:51], v[98:99]
v_pk_add_f32 v[52:53], v[52:53], v[100:101]
v_pk_add_f32 v[54:55], v[54:55], v[102:103]
s_waitcnt lgkmcnt(0)
v_pk_add_f32 v[48:49], v[48:49], v[104:105]
v_pk_add_f32 v[50:51], v[50:51], v[106:107]
v_pk_add_f32 v[52:53], v[52:53], v[108:109]
v_pk_add_f32 v[54:55], v[54:55], v[110:111]
v_cvt_pk_bf16_f32 v20, v48, v49
v_cvt_pk_bf16_f32 v21, v50, v51
v_cvt_pk_bf16_f32 v22, v52, v53
v_cvt_pk_bf16_f32 v23, v54, v55
buffer_store_dwordx4 v[20:23], v12, s[40:43], s35 offen
s_add_u32 s35, s35, 28672
buffer_load_dword v13, v7, s[8:11], s29 offen sc1
s_cmp_ge_u32 s15, 64
s_cbranch_scc0 OPT_475
s_endpgm
OPT_475:
s_waitcnt vmcnt(0)
s_branch F2_C1_465
F2_W0_466:
s_add_u32 s29, s29, 512
s_mov_b32 s32, 1
s_waitcnt vmcnt(11)
v_mfma_f32_32x32x16_bf16 v[48:63], a[0:3], v[112:115], 0
buffer_load_dwordx4 v[160:163], v2, s[8:11], s25 offen offset:0 sc1
v_mfma_f32_32x32x16_bf16 v[64:79], a[112:115], v[112:115], 0
s_waitcnt vmcnt(11)
v_mfma_f32_32x32x16_bf16 v[48:63], a[4:7], v[116:119], v[48:63]
buffer_load_dwordx4 v[164:167], v2, s[8:11], s25 offen offset:1024 sc1
ds_write_b128 v14, v[224:227] offset:0
v_mfma_f32_32x32x16_bf16 v[64:79], a[116:119], v[116:119], v[64:79]
ds_write_b128 v14, v[228:231] offset:1280
s_waitcnt vmcnt(11)
v_mfma_f32_32x32x16_bf16 v[48:63], a[8:11], v[120:123], v[48:63]
buffer_load_dwordx4 v[168:171], v2, s[8:11], s25 offen offset:2048 sc1
ds_write_b128 v14, v[232:235] offset:2560
v_mfma_f32_32x32x16_bf16 v[64:79], a[120:123], v[120:123], v[64:79]
ds_write_b128 v14, v[236:239] offset:3840
s_waitcnt vmcnt(11)
v_mfma_f32_32x32x16_bf16 v[48:63], a[12:15], v[124:127], v[48:63]
buffer_load_dword v13, v7, s[8:11], s29 offen sc1
buffer_load_dwordx4 v[172:175], v2, s[8:11], s25 offen offset:3072 sc1
s_add_u32 s25, s25, 4096
ds_write_b128 v14, v[240:243] offset:5120
v_mfma_f32_32x32x16_bf16 v[64:79], a[124:127], v[124:127], v[64:79]
ds_write_b128 v14, v[244:247] offset:6400
s_waitcnt vmcnt(12)
v_mfma_f32_32x32x16_bf16 v[48:63], a[16:19], v[128:131], v[48:63]
buffer_load_dwordx4 v[176:179], v2, s[8:11], s25 offen offset:0 sc1
ds_write_b128 v14, v[248:251] offset:7680
v_mfma_f32_32x32x16_bf16 v[64:79], a[128:131], v[128:131], v[64:79]
ds_write_b128 v14, v[252:255] offset:8960
s_waitcnt vmcnt(12)
v_mfma_f32_32x32x16_bf16 v[48:63], a[20:23], v[132:135], v[48:63]
buffer_load_dwordx4 v[180:183], v2, s[8:11], s25 offen offset:1024 sc1
v_mfma_f32_32x32x16_bf16 v[64:79], a[132:135], v[132:135], v[64:79]
s_waitcnt vmcnt(12)
v_mfma_f32_32x32x16_bf16 v[48:63], a[24:27], v[136:139], v[48:63]
buffer_load_dwordx4 v[184:187], v2, s[8:11], s25 offen offset:2048 sc1
v_mfma_f32_32x32x16_bf16 v[64:79], a[136:139], v[136:139], v[64:79]
s_waitcnt lgkmcnt(0)
s_barrier
ds_read_b128 v[80:83], v15 offset:0
ds_read_b128 v[84:87], v15 offset:1280
ds_read_b128 v[88:91], v15 offset:10240
s_waitcnt vmcnt(12)
v_mfma_f32_32x32x16_bf16 v[48:63], a[28:31], v[140:143], v[48:63]
buffer_load_dwordx4 v[188:191], v2, s[8:11], s25 offen offset:3072 sc1
s_add_u32 s25, s25, 4096
ds_read_b128 v[92:95], v15 offset:11520
ds_read_b128 v[96:99], v15 offset:20480
ds_read_b128 v[100:103], v15 offset:21760
ds_read_b128 v[104:107], v15 offset:30720
v_mfma_f32_32x32x16_bf16 v[64:79], a[140:143], v[140:143], v[64:79]
ds_read_b128 v[108:111], v15 offset:32000
v_lshlrev_b32 v224, 16, v24
v_and_b32 v225, 0xffff0000, v24
v_lshlrev_b32 v226, 16, v25
v_and_b32 v227, 0xffff0000, v25
s_waitcnt vmcnt(12)
v_mfma_f32_32x32x16_bf16 v[48:63], a[32:35], v[144:147], v[48:63]
buffer_load_dwordx4 v[192:195], v2, s[8:11], s25 offen offset:0 sc1
v_lshlrev_b32 v228, 16, v26
v_and_b32 v229, 0xffff0000, v26
v_lshlrev_b32 v230, 16, v27
v_and_b32 v231, 0xffff0000, v27
s_waitcnt lgkmcnt(6)
v_mfma_f32_32x32x16_bf16 v[64:79], a[144:147], v[144:147], v[64:79]
v_add_f32 v224, v224, v80
v_add_f32 v225, v225, v81
v_add_f32 v226, v226, v82
v_add_f32 v227, v227, v83
v_add_f32 v228, v228, v84
s_waitcnt vmcnt(12)
v_mfma_f32_32x32x16_bf16 v[48:63], a[36:39], v[148:151], v[48:63]
buffer_load_dwordx4 v[196:199], v2, s[8:11], s25 offen offset:1024 sc1
v_add_f32 v229, v229, v85
v_add_f32 v230, v230, v86
v_add_f32 v231, v231, v87
s_waitcnt lgkmcnt(4)
v_add_f32 v224, v224, v88
v_mfma_f32_32x32x16_bf16 v[64:79], a[148:151], v[148:151], v[64:79]
v_add_f32 v225, v225, v89
v_add_f32 v226, v226, v90
v_add_f32 v227, v227, v91
v_add_f32 v228, v228, v92
v_add_f32 v229, v229, v93
s_waitcnt vmcnt(12)
v_mfma_f32_32x32x16_bf16 v[48:63], a[40:43], v[152:155], v[48:63]
buffer_load_dwordx4 v[200:203], v2, s[8:11], s25 offen offset:2048 sc1
v_add_f32 v230, v230, v94
v_add_f32 v231, v231, v95
s_waitcnt lgkmcnt(2)
v_add_f32 v224, v224, v96
v_add_f32 v225, v225, v97
v_mfma_f32_32x32x16_bf16 v[64:79], a[152:155], v[152:155], v[64:79]
v_add_f32 v226, v226, v98
v_add_f32 v227, v227, v99
v_add_f32 v228, v228, v100
v_add_f32 v229, v229, v101
v_add_f32 v230, v230, v102
s_waitcnt vmcnt(12)
v_mfma_f32_32x32x16_bf16 v[48:63], a[44:47], v[156:159], v[48:63]
buffer_load_dwordx4 v[204:207], v2, s[8:11], s25 offen offset:3072 sc1
s_add_u32 s25, s25, 4096
v_add_f32 v231, v231, v103
s_waitcnt lgkmcnt(0)
v_add_f32 v224, v224, v104
v_add_f32 v225, v225, v105
v_mfma_f32_32x32x16_bf16 v[64:79], a[156:159], v[156:159], v[64:79]
v_add_f32 v226, v226, v106
v_add_f32 v227, v227, v107
v_add_f32 v228, v228, v108
v_add_f32 v229, v229, v109
v_add_f32 v230, v230, v110
s_waitcnt vmcnt(12)
v_mfma_f32_32x32x16_bf16 v[48:63], a[48:51], v[160:163], v[48:63]
buffer_load_dwordx4 v[208:211], v2, s[8:11], s25 offen offset:0 sc1
v_add_f32 v231, v231, v111
v_cvt_pk_bf16_f32 v24, v224, v225
v_cvt_pk_bf16_f32 v25, v226, v227
v_cvt_pk_bf16_f32 v26, v228, v229
v_cvt_pk_bf16_f32 v27, v230, v231
v_mfma_f32_32x32x16_bf16 v[64:79], a[160:163], v[160:163], v[64:79]
buffer_store_dwordx4 v[24:27], v12, s[40:43], s35 offen
s_add_u32 s35, s35, 28672
s_waitcnt vmcnt(13)
v_mfma_f32_32x32x16_bf16 v[48:63], a[52:55], v[164:167], v[48:63]
buffer_load_dwordx4 v[212:215], v2, s[8:11], s25 offen offset:1024 sc1
v_mfma_f32_32x32x16_bf16 v[64:79], a[164:167], v[164:167], v[64:79]
s_waitcnt vmcnt(13)
v_mfma_f32_32x32x16_bf16 v[48:63], a[56:59], v[168:171], v[48:63]
buffer_load_dwordx4 v[216:219], v2, s[8:11], s25 offen offset:2048 sc1
v_mfma_f32_32x32x16_bf16 v[64:79], a[168:171], v[168:171], v[64:79]
s_waitcnt vmcnt(12)
v_mfma_f32_32x32x16_bf16 v[48:63], a[60:63], v[172:175], v[48:63]
buffer_load_dwordx4 v[20:23], v10, s[8:11], s26 offen sc1
s_add_u32 s26, s26, 28672
buffer_load_dwordx4 v[220:223], v2, s[8:11], s25 offen offset:3072 sc1
s_add_u32 s25, s25, 90112
v_mfma_f32_32x32x16_bf16 v[64:79], a[172:175], v[172:175], v[64:79]
s_add_u32 s15, s15, 1
v_cmp_eq_u32 vcc, 0, v13
s_cmp_eq_u32 s15, 64
s_cselect_b64 vcc, -1, vcc
s_cbranch_vccnz F2_NP_476
s_waitcnt vmcnt(13)
v_mfma_f32_32x32x16_bf16 v[48:63], a[64:67], v[176:179], v[48:63]
buffer_load_dwordx4 v[112:115], v2, s[8:11], s25 offen offset:0 sc1
v_mfma_f32_32x32x16_bf16 v[64:79], a[176:179], v[176:179], v[64:79]
s_waitcnt vmcnt(13)
v_mfma_f32_32x32x16_bf16 v[48:63], a[68:71], v[180:183], v[48:63]
buffer_load_dwordx4 v[116:119], v2, s[8:11], s25 offen offset:1024 sc1
v_mfma_f32_32x32x16_bf16 v[64:79], a[180:183], v[180:183], v[64:79]
s_waitcnt vmcnt(13)
v_mfma_f32_32x32x16_bf16 v[48:63], a[72:75], v[184:187], v[48:63]
buffer_load_dwordx4 v[120:123], v2, s[8:11], s25 offen offset:2048 sc1
v_mfma_f32_32x32x16_bf16 v[64:79], a[184:187], v[184:187], v[64:79]
s_waitcnt vmcnt(13)
v_mfma_f32_32x32x16_bf16 v[48:63], a[76:79], v[188:191], v[48:63]
buffer_load_dwordx4 v[124:127], v2, s[8:11], s25 offen offset:3072 sc1
s_add_u32 s25, s25, 4096
v_mfma_f32_32x32x16_bf16 v[64:79], a[188:191], v[188:191], v[64:79]
s_waitcnt vmcnt(13)
v_mfma_f32_32x32x16_bf16 v[48:63], a[80:83], v[192:195], v[48:63]
buffer_load_dwordx4 v[128:131], v2, s[8:11], s25 offen offset:0 sc1
v_mfma_f32_32x32x16_bf16 v[64:79], a[192:195], v[192:195], v[64:79]
s_waitcnt vmcnt(13)
v_mfma_f32_32x32x16_bf16 v[48:63], a[84:87], v[196:199], v[48:63]
buffer_load_dwordx4 v[132:135], v2, s[8:11], s25 offen offset:1024 sc1
v_mfma_f32_32x32x16_bf16 v[64:79], a[196:199], v[196:199], v[64:79]
s_waitcnt vmcnt(13)
v_mfma_f32_32x32x16_bf16 v[48:63], a[88:91], v[200:203], v[48:63]
buffer_load_dwordx4 v[136:139], v2, s[8:11], s25 offen offset:2048 sc1
v_mfma_f32_32x32x16_bf16 v[64:79], a[200:203], v[200:203], v[64:79]
s_waitcnt vmcnt(13)
v_mfma_f32_32x32x16_bf16 v[48:63], a[92:95], v[204:207], v[48:63]
buffer_load_dwordx4 v[140:143], v2, s[8:11], s25 offen offset:3072 sc1
s_add_u32 s25, s25, 4096
v_mfma_f32_32x32x16_bf16 v[64:79], a[204:207], v[204:207], v[64:79]
s_waitcnt vmcnt(13)
v_mfma_f32_32x32x16_bf16 v[48:63], a[96:99], v[208:211], v[48:63]
buffer_load_dwordx4 v[144:147], v2, s[8:11], s25 offen offset:0 sc1
v_mfma_f32_32x32x16_bf16 v[64:79], a[208:211], v[208:211], v[64:79]
s_waitcnt vmcnt(12)
v_mfma_f32_32x32x16_bf16 v[48:63], a[100:103], v[212:215], v[48:63]
buffer_load_dwordx4 v[148:151], v2, s[8:11], s25 offen offset:1024 sc1
v_mfma_f32_32x32x16_bf16 v[64:79], a[212:215], v[212:215], v[64:79]
s_waitcnt vmcnt(12)
v_mfma_f32_32x32x16_bf16 v[48:63], a[104:107], v[216:219], v[48:63]
buffer_load_dwordx4 v[152:155], v2, s[8:11], s25 offen offset:2048 sc1
v_mfma_f32_32x32x16_bf16 v[64:79], a[216:219], v[216:219], v[64:79]
s_waitcnt vmcnt(11)
v_mfma_f32_32x32x16_bf16 v[48:63], a[108:111], v[220:223], v[48:63]
buffer_load_dwordx4 v[156:159], v2, s[8:11], s25 offen offset:3072 sc1
s_add_u32 s25, s25, 4096
v_mfma_f32_32x32x16_bf16 v[64:79], a[220:223], v[220:223], v[64:79]
s_nop 10
s_branch F2_W1_467
F2_NP_476:
s_waitcnt vmcnt(13)
v_mfma_f32_32x32x16_bf16 v[48:63], a[64:67], v[176:179], v[48:63]
v_mfma_f32_32x32x16_bf16 v[64:79], a[176:179], v[176:179], v[64:79]
s_waitcnt vmcnt(12)
v_mfma_f32_32x32x16_bf16 v[48:63], a[68:71], v[180:183], v[48:63]
v_mfma_f32_32x32x16_bf16 v[64:79], a[180:183], v[180:183], v[64:79]
s_waitcnt vmcnt(11)
v_mfma_f32_32x32x16_bf16 v[48:63], a[72:75], v[184:187], v[48:63]
v_mfma_f32_32x32x16_bf16 v[64:79], a[184:187], v[184:187], v[64:79]
s_waitcnt vmcnt(10)
v_mfma_f32_32x32x16_bf16 v[48:63], a[76:79], v[188:191], v[48:63]
v_mfma_f32_32x32x16_bf16 v[64:79], a[188:191], v[188:191], v[64:79]
s_waitcnt vmcnt(9)
v_mfma_f32_32x32x16_bf16 v[48:63], a[80:83], v[192:195], v[48:63]
v_mfma_f32_32x32x16_bf16 v[64:79], a[192:195], v[192:195], v[64:79]
s_waitcnt vmcnt(8)
v_mfma_f32_32x32x16_bf16 v[48:63], a[84:87], v[196:199], v[48:63]
buffer_load_dword v13, v7, s[8:11], s29 offen sc1
v_mfma_f32_32x32x16_bf16 v[64:79], a[196:199], v[196:199], v[64:79]
s_waitcnt vmcnt(8)
v_mfma_f32_32x32x16_bf16 v[48:63], a[88:91], v[200:203], v[48:63]
s_waitcnt vmcnt(7)
v_mfma_f32_32x32x16_bf16 v[48:63], a[92:95], v[204:207], v[48:63]
s_waitcnt vmcnt(6)
v_mfma_f32_32x32x16_bf16 v[48:63], a[96:99], v[208:211], v[48:63]
s_waitcnt vmcnt(4)
v_mfma_f32_32x32x16_bf16 v[48:63], a[100:103], v[212:215], v[48:63]
s_waitcnt vmcnt(3)
v_mfma_f32_32x32x16_bf16 v[48:63], a[104:107], v[216:219], v[48:63]
s_waitcnt vmcnt(1)
v_mfma_f32_32x32x16_bf16 v[48:63], a[108:111], v[220:223], v[48:63]
v_mfma_f32_32x32x16_bf16 v[64:79], a[200:203], v[200:203], v[64:79]
s_nop 4
v_mfma_f32_32x32x16_bf16 v[64:79], a[204:207], v[204:207], v[64:79]
s_nop 4
v_mfma_f32_32x32x16_bf16 v[64:79], a[208:211], v[208:211], v[64:79]
ds_write_b128 v8, v[48:51] offset:0
v_mfma_f32_32x32x16_bf16 v[64:79], a[212:215], v[212:215], v[64:79]
ds_write_b128 v8, v[52:55] offset:1280
v_mfma_f32_32x32x16_bf16 v[64:79], a[216:219], v[216:219], v[64:79]
ds_write_b128 v8, v[56:59] offset:2560
v_mfma_f32_32x32x16_bf16 v[64:79], a[220:223], v[220:223], v[64:79]
ds_write_b128 v8, v[60:63] offset:3840
s_waitcnt vmcnt(0)
v_cmp_eq_u32 vcc, 0, v13
s_cmp_eq_u32 s15, 64
s_cselect_b64 vcc, -1, vcc
s_cbranch_vccnz F2_CE_477
buffer_load_dwordx4 v[112:115], v2, s[8:11], s25 offen offset:0 sc1
buffer_load_dwordx4 v[116:119], v2, s[8:11], s25 offen offset:1024 sc1
s_nop 3
ds_write_b128 v8, v[64:67] offset:5120
buffer_load_dwordx4 v[120:123], v2, s[8:11], s25 offen offset:2048 sc1
ds_write_b128 v8, v[68:71] offset:6400
buffer_load_dwordx4 v[124:127], v2, s[8:11], s25 offen offset:3072 sc1
s_add_u32 s25, s25, 4096
ds_write_b128 v8, v[72:75] offset:7680
buffer_load_dwordx4 v[128:131], v2, s[8:11], s25 offen offset:0 sc1
ds_write_b128 v8, v[76:79] offset:8960
buffer_load_dwordx4 v[132:135], v2, s[8:11], s25 offen offset:1024 sc1
buffer_load_dwordx4 v[136:139], v2, s[8:11], s25 offen offset:2048 sc1
buffer_load_dwordx4 v[140:143], v2, s[8:11], s25 offen offset:3072 sc1
s_add_u32 s25, s25, 4096
buffer_load_dwordx4 v[144:147], v2, s[8:11], s25 offen offset:0 sc1
buffer_load_dwordx4 v[148:151], v2, s[8:11], s25 offen offset:1024 sc1
buffer_load_dwordx4 v[152:155], v2, s[8:11], s25 offen offset:2048 sc1
buffer_load_dwordx4 v[156:159], v2, s[8:11], s25 offen offset:3072 sc1
s_add_u32 s25, s25, 4096
s_waitcnt lgkmcnt(0)
s_barrier
ds_read_b128 v[80:83], v9 offset:0
ds_read_b128 v[84:87], v9 offset:1280
ds_read_b128 v[88:91], v9 offset:10240
ds_read_b128 v[92:95], v9 offset:11520
ds_read_b128 v[96:99], v9 offset:20480
ds_read_b128 v[100:103], v9 offset:21760
ds_read_b128 v[104:107], v9 offset:30720
ds_read_b128 v[108:111], v9 offset:32000
v_lshlrev_b32 v48, 16, v20
v_and_b32 v49, 0xffff0000, v20
v_lshlrev_b32 v50, 16, v21
v_and_b32 v51, 0xffff0000, v21
v_lshlrev_b32 v52, 16, v22
v_and_b32 v53, 0xffff0000, v22
v_lshlrev_b32 v54, 16, v23
v_and_b32 v55, 0xffff0000, v23
s_waitcnt lgkmcnt(6)
v_pk_add_f32 v[48:49], v[48:49], v[80:81]
v_pk_add_f32 v[50:51], v[50:51], v[82:83]
v_pk_add_f32 v[52:53], v[52:53], v[84:85]
v_pk_add_f32 v[54:55], v[54:55], v[86:87]
s_waitcnt lgkmcnt(4)
v_pk_add_f32 v[48:49], v[48:49], v[88:89]
v_pk_add_f32 v[50:51], v[50:51], v[90:91]
v_pk_add_f32 v[52:53], v[52:53], v[92:93]
v_pk_add_f32 v[54:55], v[54:55], v[94:95]
s_waitcnt lgkmcnt(2)
v_pk_add_f32 v[48:49], v[48:49], v[96:97]
v_pk_add_f32 v[50:51], v[50:51], v[98:99]
v_pk_add_f32 v[52:53], v[52:53], v[100:101]
v_pk_add_f32 v[54:55], v[54:55], v[102:103]
s_waitcnt lgkmcnt(0)
v_pk_add_f32 v[48:49], v[48:49], v[104:105]
v_pk_add_f32 v[50:51], v[50:51], v[106:107]
v_pk_add_f32 v[52:53], v[52:53], v[108:109]
v_pk_add_f32 v[54:55], v[54:55], v[110:111]
v_cvt_pk_bf16_f32 v20, v48, v49
v_cvt_pk_bf16_f32 v21, v50, v51
v_cvt_pk_bf16_f32 v22, v52, v53
v_cvt_pk_bf16_f32 v23, v54, v55
buffer_store_dwordx4 v[20:23], v12, s[40:43], s35 offen
s_add_u32 s35, s35, 28672
s_branch F2_P1_469
F2_CE_477:
s_nop 5
ds_write_b128 v8, v[64:67] offset:5120
ds_write_b128 v8, v[68:71] offset:6400
ds_write_b128 v8, v[72:75] offset:7680
ds_write_b128 v8, v[76:79] offset:8960
s_waitcnt lgkmcnt(0)
s_barrier
ds_read_b128 v[80:83], v9 offset:0
ds_read_b128 v[84:87], v9 offset:1280
ds_read_b128 v[88:91], v9 offset:10240
ds_read_b128 v[92:95], v9 offset:11520
ds_read_b128 v[96:99], v9 offset:20480
ds_read_b128 v[100:103], v9 offset:21760
ds_read_b128 v[104:107], v9 offset:30720
ds_read_b128 v[108:111], v9 offset:32000
v_lshlrev_b32 v48, 16, v20
v_and_b32 v49, 0xffff0000, v20
v_lshlrev_b32 v50, 16, v21
v_and_b32 v51, 0xffff0000, v21
v_lshlrev_b32 v52, 16, v22
v_and_b32 v53, 0xffff0000, v22
v_lshlrev_b32 v54, 16, v23
v_and_b32 v55, 0xffff0000, v23
s_waitcnt lgkmcnt(6)
v_pk_add_f32 v[48:49], v[48:49], v[80:81]
v_pk_add_f32 v[50:51], v[50:51], v[82:83]
v_pk_add_f32 v[52:53], v[52:53], v[84:85]
v_pk_add_f32 v[54:55], v[54:55], v[86:87]
s_waitcnt lgkmcnt(4)
v_pk_add_f32 v[48:49], v[48:49], v[88:89]
v_pk_add_f32 v[50:51], v[50:51], v[90:91]
v_pk_add_f32 v[52:53], v[52:53], v[92:93]
v_pk_add_f32 v[54:55], v[54:55], v[94:95]
s_waitcnt lgkmcnt(2)
v_pk_add_f32 v[48:49], v[48:49], v[96:97]
v_pk_add_f32 v[50:51], v[50:51], v[98:99]
v_pk_add_f32 v[52:53], v[52:53], v[100:101]
v_pk_add_f32 v[54:55], v[54:55], v[102:103]
s_waitcnt lgkmcnt(0)
v_pk_add_f32 v[48:49], v[48:49], v[104:105]
v_pk_add_f32 v[50:51], v[50:51], v[106:107]
v_pk_add_f32 v[52:53], v[52:53], v[108:109]
v_pk_add_f32 v[54:55], v[54:55], v[110:111]
v_cvt_pk_bf16_f32 v20, v48, v49
v_cvt_pk_bf16_f32 v21, v50, v51
v_cvt_pk_bf16_f32 v22, v52, v53
v_cvt_pk_bf16_f32 v23, v54, v55
buffer_store_dwordx4 v[20:23], v12, s[40:43], s35 offen
s_add_u32 s35, s35, 28672
buffer_load_dword v13, v7, s[8:11], s29 offen sc1
s_cmp_ge_u32 s15, 64
s_cbranch_scc0 OPT_478
s_endpgm
OPT_478:
s_waitcnt vmcnt(0)
s_branch F2_C1_465
F2_P0_468:
s_add_u32 s29, s29, 512
s_mov_b32 s32, 1
s_waitcnt vmcnt(12)
v_mfma_f32_32x32x16_bf16 v[48:63], a[0:3], v[112:115], 0
buffer_load_dwordx4 v[160:163], v2, s[8:11], s25 offen offset:0 sc1
v_mfma_f32_32x32x16_bf16 v[64:79], a[112:115], v[112:115], 0
s_waitcnt vmcnt(12)
v_mfma_f32_32x32x16_bf16 v[48:63], a[4:7], v[116:119], v[48:63]
buffer_load_dwordx4 v[164:167], v2, s[8:11], s25 offen offset:1024 sc1
v_mfma_f32_32x32x16_bf16 v[64:79], a[116:119], v[116:119], v[64:79]
s_waitcnt vmcnt(12)
v_mfma_f32_32x32x16_bf16 v[48:63], a[8:11], v[120:123], v[48:63]
buffer_load_dwordx4 v[168:171], v2, s[8:11], s25 offen offset:2048 sc1
v_mfma_f32_32x32x16_bf16 v[64:79], a[120:123], v[120:123], v[64:79]
s_waitcnt vmcnt(12)
v_mfma_f32_32x32x16_bf16 v[48:63], a[12:15], v[124:127], v[48:63]
buffer_load_dword v13, v7, s[8:11], s29 offen sc1
buffer_load_dwordx4 v[172:175], v2, s[8:11], s25 offen offset:3072 sc1
s_add_u32 s25, s25, 4096
v_mfma_f32_32x32x16_bf16 v[64:79], a[124:127], v[124:127], v[64:79]
s_waitcnt vmcnt(13)
v_mfma_f32_32x32x16_bf16 v[48:63], a[16:19], v[128:131], v[48:63]
buffer_load_dwordx4 v[176:179], v2, s[8:11], s25 offen offset:0 sc1
v_mfma_f32_32x32x16_bf16 v[64:79], a[128:131], v[128:131], v[64:79]
s_waitcnt vmcnt(13)
v_mfma_f32_32x32x16_bf16 v[48:63], a[20:23], v[132:135], v[48:63]
buffer_load_dwordx4 v[180:183], v2, s[8:11], s25 offen offset:1024 sc1
v_mfma_f32_32x32x16_bf16 v[64:79], a[132:135], v[132:135], v[64:79]
s_waitcnt vmcnt(13)
v_mfma_f32_32x32x16_bf16 v[48:63], a[24:27], v[136:139], v[48:63]
buffer_load_dwordx4 v[184:187], v2, s[8:11], s25 offen offset:2048 sc1
v_mfma_f32_32x32x16_bf16 v[64:79], a[136:139], v[136:139], v[64:79]
s_waitcnt vmcnt(13)
v_mfma_f32_32x32x16_bf16 v[48:63], a[28:31], v[140:143], v[48:63]
buffer_load_dwordx4 v[188:191], v2, s[8:11], s25 offen offset:3072 sc1
s_add_u32 s25, s25, 4096
v_mfma_f32_32x32x16_bf16 v[64:79], a[140:143], v[140:143], v[64:79]
s_waitcnt vmcnt(13)
v_mfma_f32_32x32x16_bf16 v[48:63], a[32:35], v[144:147], v[48:63]
buffer_load_dwordx4 v[192:195], v2, s[8:11], s25 offen offset:0 sc1
v_mfma_f32_32x32x16_bf16 v[64:79], a[144:147], v[144:147], v[64:79]
s_waitcnt vmcnt(13)
v_mfma_f32_32x32x16_bf16 v[48:63], a[36:39], v[148:151], v[48:63]
buffer_load_dwordx4 v[196:199], v2, s[8:11], s25 offen offset:1024 sc1
v_mfma_f32_32x32x16_bf16 v[64:79], a[148:151], v[148:151], v[64:79]
s_waitcnt vmcnt(13)
v_mfma_f32_32x32x16_bf16 v[48:63], a[40:43], v[152:155], v[48:63]
buffer_load_dwordx4 v[200:203], v2, s[8:11], s25 offen offset:2048 sc1
v_mfma_f32_32x32x16_bf16 v[64:79], a[152:155], v[152:155], v[64:79]
s_waitcnt vmcnt(13)
v_mfma_f32_32x32x16_bf16 v[48:63], a[44:47], v[156:159], v[48:63]
buffer_load_dwordx4 v[204:207], v2, s[8:11], s25 offen offset:3072 sc1
s_add_u32 s25, s25, 4096
v_mfma_f32_32x32x16_bf16 v[64:79], a[156:159], v[156:159], v[64:79]
s_waitcnt vmcnt(12)
v_mfma_f32_32x32x16_bf16 v[48:63], a[48:51], v[160:163], v[48:63]
buffer_load_dwordx4 v[208:211], v2, s[8:11], s25 offen offset:0 sc1
v_mfma_f32_32x32x16_bf16 v[64:79], a[160:163], v[160:163], v[64:79]
s_waitcnt vmcnt(12)
v_mfma_f32_32x32x16_bf16 v[48:63], a[52:55], v[164:167], v[48:63]
buffer_load_dwordx4 v[212:215], v2, s[8:11], s25 offen offset:1024 sc1
v_mfma_f32_32x32x16_bf16 v[64:79], a[164:167], v[164:167], v[64:79]
s_waitcnt vmcnt(12)
v_mfma_f32_32x32x16_bf16 v[48:63], a[56:59], v[168:171], v[48:63]
buffer_load_dwordx4 v[216:219], v2, s[8:11], s25 offen offset:2048 sc1
v_mfma_f32_32x32x16_bf16 v[64:79], a[168:171], v[168:171], v[64:79]
s_waitcnt vmcnt(11)
v_mfma_f32_32x32x16_bf16 v[48:63], a[60:63], v[172:175], v[48:63]
buffer_load_dwordx4 v[20:23], v10, s[8:11], s26 offen sc1
s_add_u32 s26, s26, 28672
buffer_load_dwordx4 v[220:223], v2, s[8:11], s25 offen offset:3072 sc1
s_add_u32 s25, s25, 90112
v_mfma_f32_32x32x16_bf16 v[64:79], a[172:175], v[172:175], v[64:79]
s_add_u32 s15, s15, 1
v_cmp_eq_u32 vcc, 0, v13
s_cmp_eq_u32 s15, 64
s_cselect_b64 vcc, -1, vcc
s_cbranch_vccnz F2_NP_479
s_waitcnt vmcnt(12)
v_mfma_f32_32x32x16_bf16 v[48:63], a[64:67], v[176:179], v[48:63]
buffer_load_dwordx4 v[112:115], v2, s[8:11], s25 offen offset:0 sc1
v_mfma_f32_32x32x16_bf16 v[64:79], a[176:179], v[176:179], v[64:79]
s_waitcnt vmcnt(12)
v_mfma_f32_32x32x16_bf16 v[48:63], a[68:71], v[180:183], v[48:63]
buffer_load_dwordx4 v[116:119], v2, s[8:11], s25 offen offset:1024 sc1
v_mfma_f32_32x32x16_bf16 v[64:79], a[180:183], v[180:183], v[64:79]
s_waitcnt vmcnt(12)
v_mfma_f32_32x32x16_bf16 v[48:63], a[72:75], v[184:187], v[48:63]
buffer_load_dwordx4 v[120:123], v2, s[8:11], s25 offen offset:2048 sc1
v_mfma_f32_32x32x16_bf16 v[64:79], a[184:187], v[184:187], v[64:79]
s_waitcnt vmcnt(12)
v_mfma_f32_32x32x16_bf16 v[48:63], a[76:79], v[188:191], v[48:63]
buffer_load_dwordx4 v[124:127], v2, s[8:11], s25 offen offset:3072 sc1
s_add_u32 s25, s25, 4096
v_mfma_f32_32x32x16_bf16 v[64:79], a[188:191], v[188:191], v[64:79]
s_waitcnt vmcnt(12)
v_mfma_f32_32x32x16_bf16 v[48:63], a[80:83], v[192:195], v[48:63]
buffer_load_dwordx4 v[128:131], v2, s[8:11], s25 offen offset:0 sc1
v_mfma_f32_32x32x16_bf16 v[64:79], a[192:195], v[192:195], v[64:79]
s_waitcnt vmcnt(12)
v_mfma_f32_32x32x16_bf16 v[48:63], a[84:87], v[196:199], v[48:63]
buffer_load_dwordx4 v[132:135], v2, s[8:11], s25 offen offset:1024 sc1
v_mfma_f32_32x32x16_bf16 v[64:79], a[196:199], v[196:199], v[64:79]
s_waitcnt vmcnt(12)
v_mfma_f32_32x32x16_bf16 v[48:63], a[88:91], v[200:203], v[48:63]
buffer_load_dwordx4 v[136:139], v2, s[8:11], s25 offen offset:2048 sc1
v_mfma_f32_32x32x16_bf16 v[64:79], a[200:203], v[200:203], v[64:79]
s_waitcnt vmcnt(12)
v_mfma_f32_32x32x16_bf16 v[48:63], a[92:95], v[204:207], v[48:63]
buffer_load_dwordx4 v[140:143], v2, s[8:11], s25 offen offset:3072 sc1
s_add_u32 s25, s25, 4096
v_mfma_f32_32x32x16_bf16 v[64:79], a[204:207], v[204:207], v[64:79]
s_waitcnt vmcnt(12)
v_mfma_f32_32x32x16_bf16 v[48:63], a[96:99], v[208:211], v[48:63]
buffer_load_dwordx4 v[144:147], v2, s[8:11], s25 offen offset:0 sc1
v_mfma_f32_32x32x16_bf16 v[64:79], a[208:211], v[208:211], v[64:79]
s_waitcnt vmcnt(12)
v_mfma_f32_32x32x16_bf16 v[48:63], a[100:103], v[212:215], v[48:63]
buffer_load_dwordx4 v[148:151], v2, s[8:11], s25 offen offset:1024 sc1
v_mfma_f32_32x32x16_bf16 v[64:79], a[212:215], v[212:215], v[64:79]
s_waitcnt vmcnt(12)
v_mfma_f32_32x32x16_bf16 v[48:63], a[104:107], v[216:219], v[48:63]
buffer_load_dwordx4 v[152:155], v2, s[8:11], s25 offen offset:2048 sc1
v_mfma_f32_32x32x16_bf16 v[64:79], a[216:219], v[216:219], v[64:79]
s_waitcnt vmcnt(11)
v_mfma_f32_32x32x16_bf16 v[48:63], a[108:111], v[220:223], v[48:63]
buffer_load_dwordx4 v[156:159], v2, s[8:11], s25 offen offset:3072 sc1
s_add_u32 s25, s25, 4096
v_mfma_f32_32x32x16_bf16 v[64:79], a[220:223], v[220:223], v[64:79]
s_nop 10
s_branch F2_W1_467
F2_NP_479:
s_waitcnt vmcnt(12)
v_mfma_f32_32x32x16_bf16 v[48:63], a[64:67], v[176:179], v[48:63]
v_mfma_f32_32x32x16_bf16 v[64:79], a[176:179], v[176:179], v[64:79]
s_waitcnt vmcnt(11)
v_mfma_f32_32x32x16_bf16 v[48:63], a[68:71], v[180:183], v[48:63]
v_mfma_f32_32x32x16_bf16 v[64:79], a[180:183], v[180:183], v[64:79]
s_waitcnt vmcnt(10)
v_mfma_f32_32x32x16_bf16 v[48:63], a[72:75], v[184:187], v[48:63]
v_mfma_f32_32x32x16_bf16 v[64:79], a[184:187], v[184:187], v[64:79]
s_waitcnt vmcnt(9)
v_mfma_f32_32x32x16_bf16 v[48:63], a[76:79], v[188:191], v[48:63]
v_mfma_f32_32x32x16_bf16 v[64:79], a[188:191], v[188:191], v[64:79]
s_waitcnt vmcnt(8)
v_mfma_f32_32x32x16_bf16 v[48:63], a[80:83], v[192:195], v[48:63]
v_mfma_f32_32x32x16_bf16 v[64:79], a[192:195], v[192:195], v[64:79]
s_waitcnt vmcnt(7)
v_mfma_f32_32x32x16_bf16 v[48:63], a[84:87], v[196:199], v[48:63]
buffer_load_dword v13, v7, s[8:11], s29 offen sc1
v_mfma_f32_32x32x16_bf16 v[64:79], a[196:199], v[196:199], v[64:79]
s_waitcnt vmcnt(7)
v_mfma_f32_32x32x16_bf16 v[48:63], a[88:91], v[200:203], v[48:63]
s_waitcnt vmcnt(6)
v_mfma_f32_32x32x16_bf16 v[48:63], a[92:95], v[204:207], v[48:63]
s_waitcnt vmcnt(5)
v_mfma_f32_32x32x16_bf16 v[48:63], a[96:99], v[208:211], v[48:63]
s_waitcnt vmcnt(4)
v_mfma_f32_32x32x16_bf16 v[48:63], a[100:103], v[212:215], v[48:63]
s_waitcnt vmcnt(3)
v_mfma_f32_32x32x16_bf16 v[48:63], a[104:107], v[216:219], v[48:63]
s_waitcnt vmcnt(1)
v_mfma_f32_32x32x16_bf16 v[48:63], a[108:111], v[220:223], v[48:63]
v_mfma_f32_32x32x16_bf16 v[64:79], a[200:203], v[200:203], v[64:79]
s_nop 4
v_mfma_f32_32x32x16_bf16 v[64:79], a[204:207], v[204:207], v[64:79]
s_nop 4
v_mfma_f32_32x32x16_bf16 v[64:79], a[208:211], v[208:211], v[64:79]
ds_write_b128 v8, v[48:51] offset:0
v_mfma_f32_32x32x16_bf16 v[64:79], a[212:215], v[212:215], v[64:79]
ds_write_b128 v8, v[52:55] offset:1280
v_mfma_f32_32x32x16_bf16 v[64:79], a[216:219], v[216:219], v[64:79]
ds_write_b128 v8, v[56:59] offset:2560
v_mfma_f32_32x32x16_bf16 v[64:79], a[220:223], v[220:223], v[64:79]
ds_write_b128 v8, v[60:63] offset:3840
s_waitcnt vmcnt(0)
v_cmp_eq_u32 vcc, 0, v13
s_cmp_eq_u32 s15, 64
s_cselect_b64 vcc, -1, vcc
s_cbranch_vccnz F2_CE_480
buffer_load_dwordx4 v[112:115], v2, s[8:11], s25 offen offset:0 sc1
buffer_load_dwordx4 v[116:119], v2, s[8:11], s25 offen offset:1024 sc1
s_nop 3
ds_write_b128 v8, v[64:67] offset:5120
buffer_load_dwordx4 v[120:123], v2, s[8:11], s25 offen offset:2048 sc1
ds_write_b128 v8, v[68:71] offset:6400
buffer_load_dwordx4 v[124:127], v2, s[8:11], s25 offen offset:3072 sc1
s_add_u32 s25, s25, 4096
ds_write_b128 v8, v[72:75] offset:7680
buffer_load_dwordx4 v[128:131], v2, s[8:11], s25 offen offset:0 sc1
ds_write_b128 v8, v[76:79] offset:8960
buffer_load_dwordx4 v[132:135], v2, s[8:11], s25 offen offset:1024 sc1
buffer_load_dwordx4 v[136:139], v2, s[8:11], s25 offen offset:2048 sc1
buffer_load_dwordx4 v[140:143], v2, s[8:11], s25 offen offset:3072 sc1
s_add_u32 s25, s25, 4096
buffer_load_dwordx4 v[144:147], v2, s[8:11], s25 offen offset:0 sc1
buffer_load_dwordx4 v[148:151], v2, s[8:11], s25 offen offset:1024 sc1
buffer_load_dwordx4 v[152:155], v2, s[8:11], s25 offen offset:2048 sc1
buffer_load_dwordx4 v[156:159], v2, s[8:11], s25 offen offset:3072 sc1
s_add_u32 s25, s25, 4096
s_waitcnt lgkmcnt(0)
s_barrier
ds_read_b128 v[80:83], v9 offset:0
ds_read_b128 v[84:87], v9 offset:1280
ds_read_b128 v[88:91], v9 offset:10240
ds_read_b128 v[92:95], v9 offset:11520
ds_read_b128 v[96:99], v9 offset:20480
ds_read_b128 v[100:103], v9 offset:21760
ds_read_b128 v[104:107], v9 offset:30720
ds_read_b128 v[108:111], v9 offset:32000
v_lshlrev_b32 v48, 16, v20
v_and_b32 v49, 0xffff0000, v20
v_lshlrev_b32 v50, 16, v21
v_and_b32 v51, 0xffff0000, v21
v_lshlrev_b32 v52, 16, v22
v_and_b32 v53, 0xffff0000, v22
v_lshlrev_b32 v54, 16, v23
v_and_b32 v55, 0xffff0000, v23
s_waitcnt lgkmcnt(6)
v_pk_add_f32 v[48:49], v[48:49], v[80:81]
v_pk_add_f32 v[50:51], v[50:51], v[82:83]
v_pk_add_f32 v[52:53], v[52:53], v[84:85]
v_pk_add_f32 v[54:55], v[54:55], v[86:87]
s_waitcnt lgkmcnt(4)
v_pk_add_f32 v[48:49], v[48:49], v[88:89]
v_pk_add_f32 v[50:51], v[50:51], v[90:91]
v_pk_add_f32 v[52:53], v[52:53], v[92:93]
v_pk_add_f32 v[54:55], v[54:55], v[94:95]
s_waitcnt lgkmcnt(2)
v_pk_add_f32 v[48:49], v[48:49], v[96:97]
v_pk_add_f32 v[50:51], v[50:51], v[98:99]
v_pk_add_f32 v[52:53], v[52:53], v[100:101]
v_pk_add_f32 v[54:55], v[54:55], v[102:103]
s_waitcnt lgkmcnt(0)
v_pk_add_f32 v[48:49], v[48:49], v[104:105]
v_pk_add_f32 v[50:51], v[50:51], v[106:107]
v_pk_add_f32 v[52:53], v[52:53], v[108:109]
v_pk_add_f32 v[54:55], v[54:55], v[110:111]
v_cvt_pk_bf16_f32 v20, v48, v49
v_cvt_pk_bf16_f32 v21, v50, v51
v_cvt_pk_bf16_f32 v22, v52, v53
v_cvt_pk_bf16_f32 v23, v54, v55
buffer_store_dwordx4 v[20:23], v12, s[40:43], s35 offen
s_add_u32 s35, s35, 28672
s_branch F2_P1_469
F2_CE_480:
s_nop 5
ds_write_b128 v8, v[64:67] offset:5120
ds_write_b128 v8, v[68:71] offset:6400
ds_write_b128 v8, v[72:75] offset:7680
ds_write_b128 v8, v[76:79] offset:8960
s_waitcnt lgkmcnt(0)
s_barrier
ds_read_b128 v[80:83], v9 offset:0
ds_read_b128 v[84:87], v9 offset:1280
ds_read_b128 v[88:91], v9 offset:10240
ds_read_b128 v[92:95], v9 offset:11520
ds_read_b128 v[96:99], v9 offset:20480
ds_read_b128 v[100:103], v9 offset:21760
ds_read_b128 v[104:107], v9 offset:30720
ds_read_b128 v[108:111], v9 offset:32000
v_lshlrev_b32 v48, 16, v20
v_and_b32 v49, 0xffff0000, v20
v_lshlrev_b32 v50, 16, v21
v_and_b32 v51, 0xffff0000, v21
v_lshlrev_b32 v52, 16, v22
v_and_b32 v53, 0xffff0000, v22
v_lshlrev_b32 v54, 16, v23
v_and_b32 v55, 0xffff0000, v23
s_waitcnt lgkmcnt(6)
v_pk_add_f32 v[48:49], v[48:49], v[80:81]
v_pk_add_f32 v[50:51], v[50:51], v[82:83]
v_pk_add_f32 v[52:53], v[52:53], v[84:85]
v_pk_add_f32 v[54:55], v[54:55], v[86:87]
s_waitcnt lgkmcnt(4)
v_pk_add_f32 v[48:49], v[48:49], v[88:89]
v_pk_add_f32 v[50:51], v[50:51], v[90:91]
v_pk_add_f32 v[52:53], v[52:53], v[92:93]
v_pk_add_f32 v[54:55], v[54:55], v[94:95]
s_waitcnt lgkmcnt(2)
v_pk_add_f32 v[48:49], v[48:49], v[96:97]
v_pk_add_f32 v[50:51], v[50:51], v[98:99]
v_pk_add_f32 v[52:53], v[52:53], v[100:101]
v_pk_add_f32 v[54:55], v[54:55], v[102:103]
s_waitcnt lgkmcnt(0)
v_pk_add_f32 v[48:49], v[48:49], v[104:105]
v_pk_add_f32 v[50:51], v[50:51], v[106:107]
v_pk_add_f32 v[52:53], v[52:53], v[108:109]
v_pk_add_f32 v[54:55], v[54:55], v[110:111]
v_cvt_pk_bf16_f32 v20, v48, v49
v_cvt_pk_bf16_f32 v21, v50, v51
v_cvt_pk_bf16_f32 v22, v52, v53
v_cvt_pk_bf16_f32 v23, v54, v55
buffer_store_dwordx4 v[20:23], v12, s[40:43], s35 offen
s_add_u32 s35, s35, 28672
buffer_load_dword v13, v7, s[8:11], s29 offen sc1
s_cmp_ge_u32 s15, 64
s_cbranch_scc0 OPT_481
s_endpgm
OPT_481:
s_waitcnt vmcnt(0)
s_branch F2_C1_465
F2_C1_465:
v_cmp_eq_u32 vcc, 0, v13
s_cbranch_vccz OPT_482
s_nop 2
s_branch WF_483_in
WF_483:
s_sleep 1
WF_483_in:
buffer_load_dword v18, v7, s[8:11], s29 offen sc1
s_sub_u32 s16, s16, 1
s_cbranch_scc1 WFD_484_abort
s_waitcnt vmcnt(0)
v_cmp_eq_u32 vcc, 0, v18
s_cbranch_vccnz WF_483
WFD_484:
OPT_482:
buffer_load_dwordx4 v[112:115], v2, s[8:11], s25 offen offset:0 sc1
buffer_load_dwordx4 v[116:119], v2, s[8:11], s25 offen offset:1024 sc1
buffer_load_dwordx4 v[120:123], v2, s[8:11], s25 offen offset:2048 sc1
buffer_load_dwordx4 v[124:127], v2, s[8:11], s25 offen offset:3072 sc1
s_add_u32 s25, s25, 4096
buffer_load_dwordx4 v[128:131], v2, s[8:11], s25 offen offset:0 sc1
buffer_load_dwordx4 v[132:135], v2, s[8:11], s25 offen offset:1024 sc1
buffer_load_dwordx4 v[136:139], v2, s[8:11], s25 offen offset:2048 sc1
buffer_load_dwordx4 v[140:143], v2, s[8:11], s25 offen offset:3072 sc1
s_add_u32 s25, s25, 4096
buffer_load_dwordx4 v[144:147], v2, s[8:11], s25 offen offset:0 sc1
buffer_load_dwordx4 v[148:151], v2, s[8:11], s25 offen offset:1024 sc1
buffer_load_dwordx4 v[152:155], v2, s[8:11], s25 offen offset:2048 sc1
buffer_load_dwordx4 v[156:159], v2, s[8:11], s25 offen offset:3072 sc1
s_add_u32 s25, s25, 4096
s_add_u32 s29, s29, 512
s_mov_b32 s32, 1
s_waitcnt vmcnt(11)
v_mfma_f32_32x32x16_bf16 v[224:239], a[0:3], v[112:115], 0
buffer_load_dwordx4 v[160:163], v2, s[8:11], s25 offen offset:0 sc1
v_mfma_f32_32x32x16_bf16 v[240:255], a[112:115], v[112:115], 0
s_waitcnt vmcnt(11)
v_mfma_f32_32x32x16_bf16 v[224:239], a[4:7], v[116:119], v[224:239]
buffer_load_dwordx4 v[164:167], v2, s[8:11], s25 offen offset:1024 sc1
v_mfma_f32_32x32x16_bf16 v[240:255], a[116:119], v[116:119], v[240:255]
s_waitcnt vmcnt(11)
v_mfma_f32_32x32x16_bf16 v[224:239], a[8:11], v[120:123], v[224:239]
buffer_load_dwordx4 v[168:171], v2, s[8:11], s25 offen offset:2048 sc1
v_mfma_f32_32x32x16_bf16 v[240:255], a[120:123], v[120:123], v[240:255]
s_waitcnt vmcnt(11)
v_mfma_f32_32x32x16_bf16 v[224:239], a[12:15], v[124:127], v[224:239]
buffer_load_dword v13, v7, s[8:11], s29 offen sc1
buffer_load_dwordx4 v[172:175], v2, s[8:11], s25 offen offset:3072 sc1
s_add_u32 s25, s25, 4096
v_mfma_f32_32x32x16_bf16 v[240:255], a[124:127], v[124:127], v[240:255]
s_waitcnt vmcnt(12)
v_mfma_f32_32x32x16_bf16 v[224:239], a[16:19], v[128:131], v[224:239]
buffer_load_dwordx4 v[176:179], v2, s[8:11], s25 offen offset:0 sc1
v_mfma_f32_32x32x16_bf16 v[240:255], a[128:131], v[128:131], v[240:255]
s_waitcnt vmcnt(12)
v_mfma_f32_32x32x16_bf16 v[224:239], a[20:23], v[132:135], v[224:239]
buffer_load_dwordx4 v[180:183], v2, s[8:11], s25 offen offset:1024 sc1
v_mfma_f32_32x32x16_bf16 v[240:255], a[132:135], v[132:135], v[240:255]
s_waitcnt vmcnt(12)
v_mfma_f32_32x32x16_bf16 v[224:239], a[24:27], v[136:139], v[224:239]
buffer_load_dwordx4 v[184:187], v2, s[8:11], s25 offen offset:2048 sc1
v_mfma_f32_32x32x16_bf16 v[240:255], a[136:139], v[136:139], v[240:255]
s_waitcnt vmcnt(12)
v_mfma_f32_32x32x16_bf16 v[224:239], a[28:31], v[140:143], v[224:239]
buffer_load_dwordx4 v[188:191], v2, s[8:11], s25 offen offset:3072 sc1
s_add_u32 s25, s25, 4096
v_mfma_f32_32x32x16_bf16 v[240:255], a[140:143], v[140:143], v[240:255]
s_waitcnt vmcnt(12)
v_mfma_f32_32x32x16_bf16 v[224:239], a[32:35], v[144:147], v[224:239]
buffer_load_dwordx4 v[192:195], v2, s[8:11], s25 offen offset:0 sc1
v_mfma_f32_32x32x16_bf16 v[240:255], a[144:147], v[144:147], v[240:255]
s_waitcnt vmcnt(12)
v_mfma_f32_32x32x16_bf16 v[224:239], a[36:39], v[148:151], v[224:239]
buffer_load_dwordx4 v[196:199], v2, s[8:11], s25 offen offset:1024 sc1
v_mfma_f32_32x32x16_bf16 v[240:255], a[148:151], v[148:151], v[240:255]
s_waitcnt vmcnt(12)
v_mfma_f32_32x32x16_bf16 v[224:239], a[40:43], v[152:155], v[224:239]
buffer_load_dwordx4 v[200:203], v2, s[8:11], s25 offen offset:2048 sc1
v_mfma_f32_32x32x16_bf16 v[240:255], a[152:155], v[152:155], v[240:255]
s_waitcnt vmcnt(12)
v_mfma_f32_32x32x16_bf16 v[224:239], a[44:47], v[156:159], v[224:239]
buffer_load_dwordx4 v[204:207], v2, s[8:11], s25 offen offset:3072 sc1
s_add_u32 s25, s25, 4096
v_mfma_f32_32x32x16_bf16 v[240:255], a[156:159], v[156:159], v[240:255]
s_waitcnt vmcnt(12)
v_mfma_f32_32x32x16_bf16 v[224:239], a[48:51], v[160:163], v[224:239]
buffer_load_dwordx4 v[208:211], v2, s[8:11], s25 offen offset:0 sc1
v_mfma_f32_32x32x16_bf16 v[240:255], a[160:163], v[160:163], v[240:255]
s_waitcnt vmcnt(12)
v_mfma_f32_32x32x16_bf16 v[224:239], a[52:55], v[164:167], v[224:239]
buffer_load_dwordx4 v[212:215], v2, s[8:11], s25 offen offset:1024 sc1
v_mfma_f32_32x32x16_bf16 v[240:255], a[164:167], v[164:167], v[240:255]
s_waitcnt vmcnt(12)
v_mfma_f32_32x32x16_bf16 v[224:239], a[56:59], v[168:171], v[224:239]
buffer_load_dwordx4 v[216:219], v2, s[8:11], s25 offen offset:2048 sc1
v_mfma_f32_32x32x16_bf16 v[240:255], a[168:171], v[168:171], v[240:255]
s_waitcnt vmcnt(11)
v_mfma_f32_32x32x16_bf16 v[224:239], a[60:63], v[172:175], v[224:239]
buffer_load_dwordx4 v[24:27], v10, s[8:11], s26 offen sc1
s_add_u32 s26, s26, 28672
buffer_load_dwordx4 v[220:223], v2, s[8:11], s25 offen offset:3072 sc1
s_add_u32 s25, s25, 90112
v_mfma_f32_32x32x16_bf16 v[240:255], a[172:175], v[172:175], v[240:255]
s_add_u32 s15, s15, 1
v_cmp_eq_u32 vcc, 0, v13
s_cmp_eq_u32 s15, 64
s_cselect_b64 vcc, -1, vcc
s_cbranch_vccnz F2_NP_485
s_waitcnt vmcnt(12)
v_mfma_f32_32x32x16_bf16 v[224:239], a[64:67], v[176:179], v[224:239]
buffer_load_dwordx4 v[112:115], v2, s[8:11], s25 offen offset:0 sc1
v_mfma_f32_32x32x16_bf16 v[240:255], a[176:179], v[176:179], v[240:255]
s_waitcnt vmcnt(12)
v_mfma_f32_32x32x16_bf16 v[224:239], a[68:71], v[180:183], v[224:239]
buffer_load_dwordx4 v[116:119], v2, s[8:11], s25 offen offset:1024 sc1
v_mfma_f32_32x32x16_bf16 v[240:255], a[180:183], v[180:183], v[240:255]
s_waitcnt vmcnt(12)
v_mfma_f32_32x32x16_bf16 v[224:239], a[72:75], v[184:187], v[224:239]
buffer_load_dwordx4 v[120:123], v2, s[8:11], s25 offen offset:2048 sc1
v_mfma_f32_32x32x16_bf16 v[240:255], a[184:187], v[184:187], v[240:255]
s_waitcnt vmcnt(12)
v_mfma_f32_32x32x16_bf16 v[224:239], a[76:79], v[188:191], v[224:239]
buffer_load_dwordx4 v[124:127], v2, s[8:11], s25 offen offset:3072 sc1
s_add_u32 s25, s25, 4096
v_mfma_f32_32x32x16_bf16 v[240:255], a[188:191], v[188:191], v[240:255]
s_waitcnt vmcnt(12)
v_mfma_f32_32x32x16_bf16 v[224:239], a[80:83], v[192:195], v[224:239]
buffer_load_dwordx4 v[128:131], v2, s[8:11], s25 offen offset:0 sc1
v_mfma_f32_32x32x16_bf16 v[240:255], a[192:195], v[192:195], v[240:255]
s_waitcnt vmcnt(12)
v_mfma_f32_32x32x16_bf16 v[224:239], a[84:87], v[196:199], v[224:239]
buffer_load_dwordx4 v[132:135], v2, s[8:11], s25 offen offset:1024 sc1
v_mfma_f32_32x32x16_bf16 v[240:255], a[196:199], v[196:199], v[240:255]
s_waitcnt vmcnt(12)
v_mfma_f32_32x32x16_bf16 v[224:239], a[88:91], v[200:203], v[224:239]
buffer_load_dwordx4 v[136:139], v2, s[8:11], s25 offen offset:2048 sc1
v_mfma_f32_32x32x16_bf16 v[240:255], a[200:203], v[200:203], v[240:255]
s_waitcnt vmcnt(12)
v_mfma_f32_32x32x16_bf16 v[224:239], a[92:95], v[204:207], v[224:239]
buffer_load_dwordx4 v[140:143], v2, s[8:11], s25 offen offset:3072 sc1
s_add_u32 s25, s25, 4096
v_mfma_f32_32x32x16_bf16 v[240:255], a[204:207], v[204:207], v[240:255]
s_waitcnt vmcnt(12)
v_mfma_f32_32x32x16_bf16 v[224:239], a[96:99], v[208:211], v[224:239]
buffer_load_dwordx4 v[144:147], v2, s[8:11], s25 offen offset:0 sc1
v_mfma_f32_32x32x16_bf16 v[240:255], a[208:211], v[208:211], v[240:255]
s_waitcnt vmcnt(12)
v_mfma_f32_32x32x16_bf16 v[224:239], a[100:103], v[212:215], v[224:239]
buffer_load_dwordx4 v[148:151], v2, s[8:11], s25 offen offset:1024 sc1
v_mfma_f32_32x32x16_bf16 v[240:255], a[212:215], v[212:215], v[240:255]
s_waitcnt vmcnt(12)
v_mfma_f32_32x32x16_bf16 v[224:239], a[104:107], v[216:219], v[224:239]
buffer_load_dwordx4 v[152:155], v2, s[8:11], s25 offen offset:2048 sc1
v_mfma_f32_32x32x16_bf16 v[240:255], a[216:219], v[216:219], v[240:255]
s_waitcnt vmcnt(11)
v_mfma_f32_32x32x16_bf16 v[224:239], a[108:111], v[220:223], v[224:239]
buffer_load_dwordx4 v[156:159], v2, s[8:11], s25 offen offset:3072 sc1
s_add_u32 s25, s25, 4096
v_mfma_f32_32x32x16_bf16 v[240:255], a[220:223], v[220:223], v[240:255]
s_nop 10
s_branch F2_W0_466
F2_NP_485:
s_waitcnt vmcnt(12)
v_mfma_f32_32x32x16_bf16 v[224:239], a[64:67], v[176:179], v[224:239]
v_mfma_f32_32x32x16_bf16 v[240:255], a[176:179], v[176:179], v[240:255]
s_waitcnt vmcnt(11)
v_mfma_f32_32x32x16_bf16 v[224:239], a[68:71], v[180:183], v[224:239]
v_mfma_f32_32x32x16_bf16 v[240:255], a[180:183], v[180:183], v[240:255]
s_waitcnt vmcnt(10)
v_mfma_f32_32x32x16_bf16 v[224:239], a[72:75], v[184:187], v[224:239]
v_mfma_f32_32x32x16_bf16 v[240:255], a[184:187], v[184:187], v[240:255]
s_waitcnt vmcnt(9)
v_mfma_f32_32x32x16_bf16 v[224:239], a[76:79], v[188:191], v[224:239]
v_mfma_f32_32x32x16_bf16 v[240:255], a[188:191], v[188:191], v[240:255]
s_waitcnt vmcnt(8)
v_mfma_f32_32x32x16_bf16 v[224:239], a[80:83], v[192:195], v[224:239]
v_mfma_f32_32x32x16_bf16 v[240:255], a[192:195], v[192:195], v[240:255]
s_waitcnt vmcnt(7)
v_mfma_f32_32x32x16_bf16 v[224:239], a[84:87], v[196:199], v[224:239]
buffer_load_dword v13, v7, s[8:11], s29 offen sc1
v_mfma_f32_32x32x16_bf16 v[240:255], a[196:199], v[196:199], v[240:255]
s_waitcnt vmcnt(7)
v_mfma_f32_32x32x16_bf16 v[224:239], a[88:91], v[200:203], v[224:239]
s_waitcnt vmcnt(6)
v_mfma_f32_32x32x16_bf16 v[224:239], a[92:95], v[204:207], v[224:239]
s_waitcnt vmcnt(5)
v_mfma_f32_32x32x16_bf16 v[224:239], a[96:99], v[208:211], v[224:239]
s_waitcnt vmcnt(4)
v_mfma_f32_32x32x16_bf16 v[224:239], a[100:103], v[212:215], v[224:239]
s_waitcnt vmcnt(3)
v_mfma_f32_32x32x16_bf16 v[224:239], a[104:107], v[216:219], v[224:239]
s_waitcnt vmcnt(1)
v_mfma_f32_32x32x16_bf16 v[224:239], a[108:111], v[220:223], v[224:239]
v_mfma_f32_32x32x16_bf16 v[240:255], a[200:203], v[200:203], v[240:255]
s_nop 4
v_mfma_f32_32x32x16_bf16 v[240:255], a[204:207], v[204:207], v[240:255]
s_nop 4
v_mfma_f32_32x32x16_bf16 v[240:255], a[208:211], v[208:211], v[240:255]
ds_write_b128 v14, v[224:227] offset:0
v_mfma_f32_32x32x16_bf16 v[240:255], a[212:215], v[212:215], v[240:255]
ds_write_b128 v14, v[228:231] offset:1280
v_mfma_f32_32x32x16_bf16 v[240:255], a[216:219], v[216:219], v[240:255]
ds_write_b128 v14, v[232:235] offset:2560
v_mfma_f32_32x32x16_bf16 v[240:255], a[220:223], v[220:223], v[240:255]
ds_write_b128 v14, v[236:239] offset:3840
s_waitcnt vmcnt(0)
v_cmp_eq_u32 vcc, 0, v13
s_cmp_eq_u32 s15, 64
s_cselect_b64 vcc, -1, vcc
s_cbranch_vccnz F2_CE_486
buffer_load_dwordx4 v[112:115], v2, s[8:11], s25 offen offset:0 sc1
buffer_load_dwordx4 v[116:119], v2, s[8:11], s25 offen offset:1024 sc1
s_nop 3
ds_write_b128 v14, v[240:243] offset:5120
buffer_load_dwordx4 v[120:123], v2, s[8:11], s25 offen offset:2048 sc1
ds_write_b128 v14, v[244:247] offset:6400
buffer_load_dwordx4 v[124:127], v2, s[8:11], s25 offen offset:3072 sc1
s_add_u32 s25, s25, 4096
ds_write_b128 v14, v[248:251] offset:7680
buffer_load_dwordx4 v[128:131], v2, s[8:11], s25 offen offset:0 sc1
ds_write_b128 v14, v[252:255] offset:8960
buffer_load_dwordx4 v[132:135], v2, s[8:11], s25 offen offset:1024 sc1
buffer_load_dwordx4 v[136:139], v2, s[8:11], s25 offen offset:2048 sc1
buffer_load_dwordx4 v[140:143], v2, s[8:11], s25 offen offset:3072 sc1
s_add_u32 s25, s25, 4096
buffer_load_dwordx4 v[144:147], v2, s[8:11], s25 offen offset:0 sc1
buffer_load_dwordx4 v[148:151], v2, s[8:11], s25 offen offset:1024 sc1
buffer_load_dwordx4 v[152:155], v2, s[8:11], s25 offen offset:2048 sc1
buffer_load_dwordx4 v[156:159], v2, s[8:11], s25 offen offset:3072 sc1
s_add_u32 s25, s25, 4096
s_waitcnt lgkmcnt(0)
s_barrier
ds_read_b128 v[80:83], v15 offset:0
ds_read_b128 v[84:87], v15 offset:1280
ds_read_b128 v[88:91], v15 offset:10240
ds_read_b128 v[92:95], v15 offset:11520
ds_read_b128 v[96:99], v15 offset:20480
ds_read_b128 v[100:103], v15 offset:21760
ds_read_b128 v[104:107], v15 offset:30720
ds_read_b128 v[108:111], v15 offset:32000
v_lshlrev_b32 v224, 16, v24
v_and_b32 v225, 0xffff0000, v24
v_lshlrev_b32 v226, 16, v25
v_and_b32 v227, 0xffff0000, v25
v_lshlrev_b32 v228, 16, v26
v_and_b32 v229, 0xffff0000, v26
v_lshlrev_b32 v230, 16, v27
v_and_b32 v231, 0xffff0000, v27
s_waitcnt lgkmcnt(6)
v_pk_add_f32 v[224:225], v[224:225], v[80:81]
v_pk_add_f32 v[226:227], v[226:227], v[82:83]
v_pk_add_f32 v[228:229], v[228:229], v[84:85]
v_pk_add_f32 v[230:231], v[230:231], v[86:87]
s_waitcnt lgkmcnt(4)
v_pk_add_f32 v[224:225], v[224:225], v[88:89]
v_pk_add_f32 v[226:227], v[226:227], v[90:91]
v_pk_add_f32 v[228:229], v[228:229], v[92:93]
v_pk_add_f32 v[230:231], v[230:231], v[94:95]
s_waitcnt lgkmcnt(2)
v_pk_add_f32 v[224:225], v[224:225], v[96:97]
v_pk_add_f32 v[226:227], v[226:227], v[98:99]
v_pk_add_f32 v[228:229], v[228:229], v[100:101]
v_pk_add_f32 v[230:231], v[230:231], v[102:103]
s_waitcnt lgkmcnt(0)
v_pk_add_f32 v[224:225], v[224:225], v[104:105]
v_pk_add_f32 v[226:227], v[226:227], v[106:107]
v_pk_add_f32 v[228:229], v[228:229], v[108:109]
v_pk_add_f32 v[230:231], v[230:231], v[110:111]
v_cvt_pk_bf16_f32 v24, v224, v225
v_cvt_pk_bf16_f32 v25, v226, v227
v_cvt_pk_bf16_f32 v26, v228, v229
v_cvt_pk_bf16_f32 v27, v230, v231
buffer_store_dwordx4 v[24:27], v12, s[40:43], s35 offen
s_add_u32 s35, s35, 28672
s_branch F2_P0_468
F2_CE_486:
s_nop 5
ds_write_b128 v14, v[240:243] offset:5120
ds_write_b128 v14, v[244:247] offset:6400
ds_write_b128 v14, v[248:251] offset:7680
ds_write_b128 v14, v[252:255] offset:8960
s_waitcnt lgkmcnt(0)
s_barrier
ds_read_b128 v[80:83], v15 offset:0
ds_read_b128 v[84:87], v15 offset:1280
ds_read_b128 v[88:91], v15 offset:10240
ds_read_b128 v[92:95], v15 offset:11520
ds_read_b128 v[96:99], v15 offset:20480
ds_read_b128 v[100:103], v15 offset:21760
ds_read_b128 v[104:107], v15 offset:30720
ds_read_b128 v[108:111], v15 offset:32000
v_lshlrev_b32 v224, 16, v24
v_and_b32 v225, 0xffff0000, v24
v_lshlrev_b32 v226, 16, v25
v_and_b32 v227, 0xffff0000, v25
v_lshlrev_b32 v228, 16, v26
v_and_b32 v229, 0xffff0000, v26
v_lshlrev_b32 v230, 16, v27
v_and_b32 v231, 0xffff0000, v27
s_waitcnt lgkmcnt(6)
v_pk_add_f32 v[224:225], v[224:225], v[80:81]
v_pk_add_f32 v[226:227], v[226:227], v[82:83]
v_pk_add_f32 v[228:229], v[228:229], v[84:85]
v_pk_add_f32 v[230:231], v[230:231], v[86:87]
s_waitcnt lgkmcnt(4)
v_pk_add_f32 v[224:225], v[224:225], v[88:89]
v_pk_add_f32 v[226:227], v[226:227], v[90:91]
v_pk_add_f32 v[228:229], v[228:229], v[92:93]
v_pk_add_f32 v[230:231], v[230:231], v[94:95]
s_waitcnt lgkmcnt(2)
v_pk_add_f32 v[224:225], v[224:225], v[96:97]
v_pk_add_f32 v[226:227], v[226:227], v[98:99]
v_pk_add_f32 v[228:229], v[228:229], v[100:101]
v_pk_add_f32 v[230:231], v[230:231], v[102:103]
s_waitcnt lgkmcnt(0)
v_pk_add_f32 v[224:225], v[224:225], v[104:105]
v_pk_add_f32 v[226:227], v[226:227], v[106:107]
v_pk_add_f32 v[228:229], v[228:229], v[108:109]
v_pk_add_f32 v[230:231], v[230:231], v[110:111]
v_cvt_pk_bf16_f32 v24, v224, v225
v_cvt_pk_bf16_f32 v25, v226, v227
v_cvt_pk_bf16_f32 v26, v228, v229
v_cvt_pk_bf16_f32 v27, v230, v231
buffer_store_dwordx4 v[24:27], v12, s[40:43], s35 offen
s_add_u32 s35, s35, 28672
buffer_load_dword v13, v7, s[8:11], s29 offen sc1
s_cmp_ge_u32 s15, 64
s_cbranch_scc0 OPT_487
s_endpgm
OPT_487:
s_waitcnt vmcnt(0)
s_branch F2_C0_464
F2_W1_467:
s_add_u32 s29, s29, 512
s_mov_b32 s32, 1
s_waitcnt vmcnt(11)
v_mfma_f32_32x32x16_bf16 v[224:239], a[0:3], v[112:115], 0
buffer_load_dwordx4 v[160:163], v2, s[8:11], s25 offen offset:0 sc1
v_mfma_f32_32x32x16_bf16 v[240:255], a[112:115], v[112:115], 0
s_waitcnt vmcnt(11)
v_mfma_f32_32x32x16_bf16 v[224:239], a[4:7], v[116:119], v[224:239]
buffer_load_dwordx4 v[164:167], v2, s[8:11], s25 offen offset:1024 sc1
ds_write_b128 v8, v[48:51] offset:0
v_mfma_f32_32x32x16_bf16 v[240:255], a[116:119], v[116:119], v[240:255]
ds_write_b128 v8, v[52:55] offset:1280
s_waitcnt vmcnt(11)
v_mfma_f32_32x32x16_bf16 v[224:239], a[8:11], v[120:123], v[224:239]
buffer_load_dwordx4 v[168:171], v2, s[8:11], s25 offen offset:2048 sc1
ds_write_b128 v8, v[56:59] offset:2560
v_mfma_f32_32x32x16_bf16 v[240:255], a[120:123], v[120:123], v[240:255]
ds_write_b128 v8, v[60:63] offset:3840
s_waitcnt vmcnt(11)
v_mfma_f32_32x32x16_bf16 v[224:239], a[12:15], v[124:127], v[224:239]
buffer_load_dword v13, v7, s[8:11], s29 offen sc1
buffer_load_dwordx4 v[172:175], v2, s[8:11], s25 offen offset:3072 sc1
s_add_u32 s25, s25, 4096
ds_write_b128 v8, v[64:67] offset:5120
v_mfma_f32_32x32x16_bf16 v[240:255], a[124:127], v[124:127], v[240:255]
ds_write_b128 v8, v[68:71] offset:6400
s_waitcnt vmcnt(12)
v_mfma_f32_32x32x16_bf16 v[224:239], a[16:19], v[128:131], v[224:239]
buffer_load_dwordx4 v[176:179], v2, s[8:11], s25 offen offset:0 sc1
ds_write_b128 v8, v[72:75] offset:7680
v_mfma_f32_32x32x16_bf16 v[240:255], a[128:131], v[128:131], v[240:255]
ds_write_b128 v8, v[76:79] offset:8960
s_waitcnt vmcnt(12)
v_mfma_f32_32x32x16_bf16 v[224:239], a[20:23], v[132:135], v[224:239]
buffer_load_dwordx4 v[180:183], v2, s[8:11], s25 offen offset:1024 sc1
v_mfma_f32_32x32x16_bf16 v[240:255], a[132:135], v[132:135], v[240:255]
s_waitcnt vmcnt(12)
v_mfma_f32_32x32x16_bf16 v[224:239], a[24:27], v[136:139], v[224:239]
buffer_load_dwordx4 v[184:187], v2, s[8:11], s25 offen offset:2048 sc1
v_mfma_f32_32x32x16_bf16 v[240:255], a[136:139], v[136:139], v[240:255]
s_waitcnt lgkmcnt(0)
s_barrier
ds_read_b128 v[80:83], v9 offset:0
ds_read_b128 v[84:87], v9 offset:1280
ds_read_b128 v[88:91], v9 offset:10240
s_waitcnt vmcnt(12)
v_mfma_f32_32x32x16_bf16 v[224:239], a[28:31], v[140:143], v[224:239]
buffer_load_dwordx4 v[188:191], v2, s[8:11], s25 offen offset:3072 sc1
s_add_u32 s25, s25, 4096
ds_read_b128 v[92:95], v9 offset:11520
ds_read_b128 v[96:99], v9 offset:20480
ds_read_b128 v[100:103], v9 offset:21760
ds_read_b128 v[104:107], v9 offset:30720
v_mfma_f32_32x32x16_bf16 v[240:255], a[140:143], v[140:143], v[240:255]
ds_read_b128 v[108:111], v9 offset:32000
v_lshlrev_b32 v48, 16, v20
v_and_b32 v49, 0xffff0000, v20
v_lshlrev_b32 v50, 16, v21
v_and_b32 v51, 0xffff0000, v21
s_waitcnt vmcnt(12)
v_mfma_f32_32x32x16_bf16 v[224:239], a[32:35], v[144:147], v[224:239]
buffer_load_dwordx4 v[192:195], v2, s[8:11], s25 offen offset:0 sc1
v_lshlrev_b32 v52, 16, v22
v_and_b32 v53, 0xffff0000, v22
v_lshlrev_b32 v54, 16, v23
v_and_b32 v55, 0xffff0000, v23
s_waitcnt lgkmcnt(6)
v_mfma_f32_32x32x16_bf16 v[240:255], a[144:147], v[144:147], v[240:255]
v_add_f32 v48, v48, v80
v_add_f32 v49, v49, v81
v_add_f32 v50, v50, v82
v_add_f32 v51, v51, v83
v_add_f32 v52, v52, v84
s_waitcnt vmcnt(12)
v_mfma_f32_32x32x16_bf16 v[224:239], a[36:39], v[148:151], v[224:239]
buffer_load_dwordx4 v[196:199], v2, s[8:11], s25 offen offset:1024 sc1
v_add_f32 v53, v53, v85
v_add_f32 v54, v54, v86
v_add_f32 v55, v55, v87
s_waitcnt lgkmcnt(4)
v_add_f32 v48, v48, v88
v_mfma_f32_32x32x16_bf16 v[240:255], a[148:151], v[148:151], v[240:255]
v_add_f32 v49, v49, v89
v_add_f32 v50, v50, v90
v_add_f32 v51, v51, v91
v_add_f32 v52, v52, v92
v_add_f32 v53, v53, v93
s_waitcnt vmcnt(12)
v_mfma_f32_32x32x16_bf16 v[224:239], a[40:43], v[152:155], v[224:239]
buffer_load_dwordx4 v[200:203], v2, s[8:11], s25 offen offset:2048 sc1
v_add_f32 v54, v54, v94
v_add_f32 v55, v55, v95
s_waitcnt lgkmcnt(2)
v_add_f32 v48, v48, v96
v_add_f32 v49, v49, v97
v_mfma_f32_32x32x16_bf16 v[240:255], a[152:155], v[152:155], v[240:255]
v_add_f32 v50, v50, v98
v_add_f32 v51, v51, v99
v_add_f32 v52, v52, v100
v_add_f32 v53, v53, v101
v_add_f32 v54, v54, v102
s_waitcnt vmcnt(12)
v_mfma_f32_32x32x16_bf16 v[224:239], a[44:47], v[156:159], v[224:239]
buffer_load_dwordx4 v[204:207], v2, s[8:11], s25 offen offset:3072 sc1
s_add_u32 s25, s25, 4096
v_add_f32 v55, v55, v103
s_waitcnt lgkmcnt(0)
v_add_f32 v48, v48, v104
v_add_f32 v49, v49, v105
v_mfma_f32_32x32x16_bf16 v[240:255], a[156:159], v[156:159], v[240:255]
v_add_f32 v50, v50, v106
v_add_f32 v51, v51, v107
v_add_f32 v52, v52, v108
v_add_f32 v53, v53, v109
v_add_f32 v54, v54, v110
s_waitcnt vmcnt(12)
v_mfma_f32_32x32x16_bf16 v[224:239], a[48:51], v[160:163], v[224:239]
buffer_load_dwordx4 v[208:211], v2, s[8:11], s25 offen offset:0 sc1
v_add_f32 v55, v55, v111
v_cvt_pk_bf16_f32 v20, v48, v49
v_cvt_pk_bf16_f32 v21, v50, v51
v_cvt_pk_bf16_f32 v22, v52, v53
v_cvt_pk_bf16_f32 v23, v54, v55
v_mfma_f32_32x32x16_bf16 v[240:255], a[160:163], v[160:163], v[240:255]
buffer_store_dwordx4 v[20:23], v12, s[40:43], s35 offen
s_add_u32 s35, s35, 28672
s_waitcnt vmcnt(13)
v_mfma_f32_32x32x16_bf16 v[224:239], a[52:55], v[164:167], v[224:239]
buffer_load_dwordx4 v[212:215], v2, s[8:11], s25 offen offset:1024 sc1
v_mfma_f32_32x32x16_bf16 v[240:255], a[164:167], v[164:167], v[240:255]
s_waitcnt vmcnt(13)
v_mfma_f32_32x32x16_bf16 v[224:239], a[56:59], v[168:171], v[224:239]
buffer_load_dwordx4 v[216:219], v2, s[8:11], s25 offen offset:2048 sc1
v_mfma_f32_32x32x16_bf16 v[240:255], a[168:171], v[168:171], v[240:255]
s_waitcnt vmcnt(12)
v_mfma_f32_32x32x16_bf16 v[224:239], a[60:63], v[172:175], v[224:239]
buffer_load_dwordx4 v[24:27], v10, s[8:11], s26 offen sc1
s_add_u32 s26, s26, 28672
buffer_load_dwordx4 v[220:223], v2, s[8:11], s25 offen offset:3072 sc1
s_add_u32 s25, s25, 90112
v_mfma_f32_32x32x16_bf16 v[240:255], a[172:175], v[172:175], v[240:255]
s_add_u32 s15, s15, 1
v_cmp_eq_u32 vcc, 0, v13
s_cmp_eq_u32 s15, 64
s_cselect_b64 vcc, -1, vcc
s_cbranch_vccnz F2_NP_488
s_waitcnt vmcnt(13)
v_mfma_f32_32x32x16_bf16 v[224:239], a[64:67], v[176:179], v[224:239]
buffer_load_dwordx4 v[112:115], v2, s[8:11], s25 offen offset:0 sc1
v_mfma_f32_32x32x16_bf16 v[240:255], a[176:179], v[176:179], v[240:255]
s_waitcnt vmcnt(13)
v_mfma_f32_32x32x16_bf16 v[224:239], a[68:71], v[180:183], v[224:239]
buffer_load_dwordx4 v[116:119], v2, s[8:11], s25 offen offset:1024 sc1
v_mfma_f32_32x32x16_bf16 v[240:255], a[180:183], v[180:183], v[240:255]
s_waitcnt vmcnt(13)
v_mfma_f32_32x32x16_bf16 v[224:239], a[72:75], v[184:187], v[224:239]
buffer_load_dwordx4 v[120:123], v2, s[8:11], s25 offen offset:2048 sc1
v_mfma_f32_32x32x16_bf16 v[240:255], a[184:187], v[184:187], v[240:255]
s_waitcnt vmcnt(13)
v_mfma_f32_32x32x16_bf16 v[224:239], a[76:79], v[188:191], v[224:239]
buffer_load_dwordx4 v[124:127], v2, s[8:11], s25 offen offset:3072 sc1
s_add_u32 s25, s25, 4096
v_mfma_f32_32x32x16_bf16 v[240:255], a[188:191], v[188:191], v[240:255]
s_waitcnt vmcnt(13)
v_mfma_f32_32x32x16_bf16 v[224:239], a[80:83], v[192:195], v[224:239]
buffer_load_dwordx4 v[128:131], v2, s[8:11], s25 offen offset:0 sc1
v_mfma_f32_32x32x16_bf16 v[240:255], a[192:195], v[192:195], v[240:255]
s_waitcnt vmcnt(13)
v_mfma_f32_32x32x16_bf16 v[224:239], a[84:87], v[196:199], v[224:239]
buffer_load_dwordx4 v[132:135], v2, s[8:11], s25 offen offset:1024 sc1
v_mfma_f32_32x32x16_bf16 v[240:255], a[196:199], v[196:199], v[240:255]
s_waitcnt vmcnt(13)
v_mfma_f32_32x32x16_bf16 v[224:239], a[88:91], v[200:203], v[224:239]
buffer_load_dwordx4 v[136:139], v2, s[8:11], s25 offen offset:2048 sc1
v_mfma_f32_32x32x16_bf16 v[240:255], a[200:203], v[200:203], v[240:255]
s_waitcnt vmcnt(13)
v_mfma_f32_32x32x16_bf16 v[224:239], a[92:95], v[204:207], v[224:239]
buffer_load_dwordx4 v[140:143], v2, s[8:11], s25 offen offset:3072 sc1
s_add_u32 s25, s25, 4096
v_mfma_f32_32x32x16_bf16 v[240:255], a[204:207], v[204:207], v[240:255]
s_waitcnt vmcnt(13)
v_mfma_f32_32x32x16_bf16 v[224:239], a[96:99], v[208:211], v[224:239]
buffer_load_dwordx4 v[144:147], v2, s[8:11], s25 offen offset:0 sc1
v_mfma_f32_32x32x16_bf16 v[240:255], a[208:211], v[208:211], v[240:255]
s_waitcnt vmcnt(12)
v_mfma_f32_32x32x16_bf16 v[224:239], a[100:103], v[212:215], v[224:239]
buffer_load_dwordx4 v[148:151], v2, s[8:11], s25 offen offset:1024 sc1
v_mfma_f32_32x32x16_bf16 v[240:255], a[212:215], v[212:215], v[240:255]
s_waitcnt vmcnt(12)
v_mfma_f32_32x32x16_bf16 v[224:239], a[104:107], v[216:219], v[224:239]
buffer_load_dwordx4 v[152:155], v2, s[8:11], s25 offen offset:2048 sc1
v_mfma_f32_32x32x16_bf16 v[240:255], a[216:219], v[216:219], v[240:255]
s_waitcnt vmcnt(11)
v_mfma_f32_32x32x16_bf16 v[224:239], a[108:111], v[220:223], v[224:239]
buffer_load_dwordx4 v[156:159], v2, s[8:11], s25 offen offset:3072 sc1
s_add_u32 s25, s25, 4096
v_mfma_f32_32x32x16_bf16 v[240:255], a[220:223], v[220:223], v[240:255]
s_nop 10
s_branch F2_W0_466
F2_NP_488:
s_waitcnt vmcnt(13)
v_mfma_f32_32x32x16_bf16 v[224:239], a[64:67], v[176:179], v[224:239]
v_mfma_f32_32x32x16_bf16 v[240:255], a[176:179], v[176:179], v[240:255]
s_waitcnt vmcnt(12)
v_mfma_f32_32x32x16_bf16 v[224:239], a[68:71], v[180:183], v[224:239]
v_mfma_f32_32x32x16_bf16 v[240:255], a[180:183], v[180:183], v[240:255]
s_waitcnt vmcnt(11)
v_mfma_f32_32x32x16_bf16 v[224:239], a[72:75], v[184:187], v[224:239]
v_mfma_f32_32x32x16_bf16 v[240:255], a[184:187], v[184:187], v[240:255]
s_waitcnt vmcnt(10)
v_mfma_f32_32x32x16_bf16 v[224:239], a[76:79], v[188:191], v[224:239]
v_mfma_f32_32x32x16_bf16 v[240:255], a[188:191], v[188:191], v[240:255]
s_waitcnt vmcnt(9)
v_mfma_f32_32x32x16_bf16 v[224:239], a[80:83], v[192:195], v[224:239]
v_mfma_f32_32x32x16_bf16 v[240:255], a[192:195], v[192:195], v[240:255]
s_waitcnt vmcnt(8)
v_mfma_f32_32x32x16_bf16 v[224:239], a[84:87], v[196:199], v[224:239]
buffer_load_dword v13, v7, s[8:11], s29 offen sc1
v_mfma_f32_32x32x16_bf16 v[240:255], a[196:199], v[196:199], v[240:255]
s_waitcnt vmcnt(8)
v_mfma_f32_32x32x16_bf16 v[224:239], a[88:91], v[200:203], v[224:239]
s_waitcnt vmcnt(7)
v_mfma_f32_32x32x16_bf16 v[224:239], a[92:95], v[204:207], v[224:239]
s_waitcnt vmcnt(6)
v_mfma_f32_32x32x16_bf16 v[224:239], a[96:99], v[208:211], v[224:239]
s_waitcnt vmcnt(4)
v_mfma_f32_32x32x16_bf16 v[224:239], a[100:103], v[212:215], v[224:239]
s_waitcnt vmcnt(3)
v_mfma_f32_32x32x16_bf16 v[224:239], a[104:107], v[216:219], v[224:239]
s_waitcnt vmcnt(1)
v_mfma_f32_32x32x16_bf16 v[224:239], a[108:111], v[220:223], v[224:239]
v_mfma_f32_32x32x16_bf16 v[240:255], a[200:203], v[200:203], v[240:255]
s_nop 4
v_mfma_f32_32x32x16_bf16 v[240:255], a[204:207], v[204:207], v[240:255]
s_nop 4
v_mfma_f32_32x32x16_bf16 v[240:255], a[208:211], v[208:211], v[240:255]
ds_write_b128 v14, v[224:227] offset:0
v_mfma_f32_32x32x16_bf16 v[240:255], a[212:215], v[212:215], v[240:255]
ds_write_b128 v14, v[228:231] offset:1280
v_mfma_f32_32x32x16_bf16 v[240:255], a[216:219], v[216:219], v[240:255]
ds_write_b128 v14, v[232:235] offset:2560
v_mfma_f32_32x32x16_bf16 v[240:255], a[220:223], v[220:223], v[240:255]
ds_write_b128 v14, v[236:239] offset:3840
s_waitcnt vmcnt(0)
v_cmp_eq_u32 vcc, 0, v13
s_cmp_eq_u32 s15, 64
s_cselect_b64 vcc, -1, vcc
s_cbranch_vccnz F2_CE_489
buffer_load_dwordx4 v[112:115], v2, s[8:11], s25 offen offset:0 sc1
buffer_load_dwordx4 v[116:119], v2, s[8:11], s25 offen offset:1024 sc1
s_nop 3
ds_write_b128 v14, v[240:243] offset:5120
buffer_load_dwordx4 v[120:123], v2, s[8:11], s25 offen offset:2048 sc1
ds_write_b128 v14, v[244:247] offset:6400
buffer_load_dwordx4 v[124:127], v2, s[8:11], s25 offen offset:3072 sc1
s_add_u32 s25, s25, 4096
ds_write_b128 v14, v[248:251] offset:7680
buffer_load_dwordx4 v[128:131], v2, s[8:11], s25 offen offset:0 sc1
ds_write_b128 v14, v[252:255] offset:8960
buffer_load_dwordx4 v[132:135], v2, s[8:11], s25 offen offset:1024 sc1
buffer_load_dwordx4 v[136:139], v2, s[8:11], s25 offen offset:2048 sc1
buffer_load_dwordx4 v[140:143], v2, s[8:11], s25 offen offset:3072 sc1
s_add_u32 s25, s25, 4096
buffer_load_dwordx4 v[144:147], v2, s[8:11], s25 offen offset:0 sc1
buffer_load_dwordx4 v[148:151], v2, s[8:11], s25 offen offset:1024 sc1
buffer_load_dwordx4 v[152:155], v2, s[8:11], s25 offen offset:2048 sc1
buffer_load_dwordx4 v[156:159], v2, s[8:11], s25 offen offset:3072 sc1
s_add_u32 s25, s25, 4096
s_waitcnt lgkmcnt(0)
s_barrier
ds_read_b128 v[80:83], v15 offset:0
ds_read_b128 v[84:87], v15 offset:1280
ds_read_b128 v[88:91], v15 offset:10240
ds_read_b128 v[92:95], v15 offset:11520
ds_read_b128 v[96:99], v15 offset:20480
ds_read_b128 v[100:103], v15 offset:21760
ds_read_b128 v[104:107], v15 offset:30720
ds_read_b128 v[108:111], v15 offset:32000
v_lshlrev_b32 v224, 16, v24
v_and_b32 v225, 0xffff0000, v24
v_lshlrev_b32 v226, 16, v25
v_and_b32 v227, 0xffff0000, v25
v_lshlrev_b32 v228, 16, v26
v_and_b32 v229, 0xffff0000, v26
v_lshlrev_b32 v230, 16, v27
v_and_b32 v231, 0xffff0000, v27
s_waitcnt lgkmcnt(6)
v_pk_add_f32 v[224:225], v[224:225], v[80:81]
v_pk_add_f32 v[226:227], v[226:227], v[82:83]
v_pk_add_f32 v[228:229], v[228:229], v[84:85]
v_pk_add_f32 v[230:231], v[230:231], v[86:87]
s_waitcnt lgkmcnt(4)
v_pk_add_f32 v[224:225], v[224:225], v[88:89]
v_pk_add_f32 v[226:227], v[226:227], v[90:91]
v_pk_add_f32 v[228:229], v[228:229], v[92:93]
v_pk_add_f32 v[230:231], v[230:231], v[94:95]
s_waitcnt lgkmcnt(2)
v_pk_add_f32 v[224:225], v[224:225], v[96:97]
v_pk_add_f32 v[226:227], v[226:227], v[98:99]
v_pk_add_f32 v[228:229], v[228:229], v[100:101]
v_pk_add_f32 v[230:231], v[230:231], v[102:103]
s_waitcnt lgkmcnt(0)
v_pk_add_f32 v[224:225], v[224:225], v[104:105]
v_pk_add_f32 v[226:227], v[226:227], v[106:107]
v_pk_add_f32 v[228:229], v[228:229], v[108:109]
v_pk_add_f32 v[230:231], v[230:231], v[110:111]
v_cvt_pk_bf16_f32 v24, v224, v225
v_cvt_pk_bf16_f32 v25, v226, v227
v_cvt_pk_bf16_f32 v26, v228, v229
v_cvt_pk_bf16_f32 v27, v230, v231
buffer_store_dwordx4 v[24:27], v12, s[40:43], s35 offen
s_add_u32 s35, s35, 28672
s_branch F2_P0_468
F2_CE_489:
s_nop 5
ds_write_b128 v14, v[240:243] offset:5120
ds_write_b128 v14, v[244:247] offset:6400
ds_write_b128 v14, v[248:251] offset:7680
ds_write_b128 v14, v[252:255] offset:8960
s_waitcnt lgkmcnt(0)
s_barrier
ds_read_b128 v[80:83], v15 offset:0
ds_read_b128 v[84:87], v15 offset:1280
ds_read_b128 v[88:91], v15 offset:10240
ds_read_b128 v[92:95], v15 offset:11520
ds_read_b128 v[96:99], v15 offset:20480
ds_read_b128 v[100:103], v15 offset:21760
ds_read_b128 v[104:107], v15 offset:30720
ds_read_b128 v[108:111], v15 offset:32000
v_lshlrev_b32 v224, 16, v24
v_and_b32 v225, 0xffff0000, v24
v_lshlrev_b32 v226, 16, v25
v_and_b32 v227, 0xffff0000, v25
v_lshlrev_b32 v228, 16, v26
v_and_b32 v229, 0xffff0000, v26
v_lshlrev_b32 v230, 16, v27
v_and_b32 v231, 0xffff0000, v27
s_waitcnt lgkmcnt(6)
v_pk_add_f32 v[224:225], v[224:225], v[80:81]
v_pk_add_f32 v[226:227], v[226:227], v[82:83]
v_pk_add_f32 v[228:229], v[228:229], v[84:85]
v_pk_add_f32 v[230:231], v[230:231], v[86:87]
s_waitcnt lgkmcnt(4)
v_pk_add_f32 v[224:225], v[224:225], v[88:89]
v_pk_add_f32 v[226:227], v[226:227], v[90:91]
v_pk_add_f32 v[228:229], v[228:229], v[92:93]
v_pk_add_f32 v[230:231], v[230:231], v[94:95]
s_waitcnt lgkmcnt(2)
v_pk_add_f32 v[224:225], v[224:225], v[96:97]
v_pk_add_f32 v[226:227], v[226:227], v[98:99]
v_pk_add_f32 v[228:229], v[228:229], v[100:101]
v_pk_add_f32 v[230:231], v[230:231], v[102:103]
s_waitcnt lgkmcnt(0)
v_pk_add_f32 v[224:225], v[224:225], v[104:105]
v_pk_add_f32 v[226:227], v[226:227], v[106:107]
v_pk_add_f32 v[228:229], v[228:229], v[108:109]
v_pk_add_f32 v[230:231], v[230:231], v[110:111]
v_cvt_pk_bf16_f32 v24, v224, v225
v_cvt_pk_bf16_f32 v25, v226, v227
v_cvt_pk_bf16_f32 v26, v228, v229
v_cvt_pk_bf16_f32 v27, v230, v231
buffer_store_dwordx4 v[24:27], v12, s[40:43], s35 offen
s_add_u32 s35, s35, 28672
buffer_load_dword v13, v7, s[8:11], s29 offen sc1
s_cmp_ge_u32 s15, 64
s_cbranch_scc0 OPT_490
s_endpgm
OPT_490:
s_waitcnt vmcnt(0)
s_branch F2_C0_464
F2_P1_469:
s_add_u32 s29, s29, 512
s_mov_b32 s32, 1
s_waitcnt vmcnt(12)
v_mfma_f32_32x32x16_bf16 v[224:239], a[0:3], v[112:115], 0
buffer_load_dwordx4 v[160:163], v2, s[8:11], s25 offen offset:0 sc1
v_mfma_f32_32x32x16_bf16 v[240:255], a[112:115], v[112:115], 0
s_waitcnt vmcnt(12)
v_mfma_f32_32x32x16_bf16 v[224:239], a[4:7], v[116:119], v[224:239]
buffer_load_dwordx4 v[164:167], v2, s[8:11], s25 offen offset:1024 sc1
v_mfma_f32_32x32x16_bf16 v[240:255], a[116:119], v[116:119], v[240:255]
s_waitcnt vmcnt(12)
v_mfma_f32_32x32x16_bf16 v[224:239], a[8:11], v[120:123], v[224:239]
buffer_load_dwordx4 v[168:171], v2, s[8:11], s25 offen offset:2048 sc1
v_mfma_f32_32x32x16_bf16 v[240:255], a[120:123], v[120:123], v[240:255]
s_waitcnt vmcnt(12)
v_mfma_f32_32x32x16_bf16 v[224:239], a[12:15], v[124:127], v[224:239]
buffer_load_dword v13, v7, s[8:11], s29 offen sc1
buffer_load_dwordx4 v[172:175], v2, s[8:11], s25 offen offset:3072 sc1
s_add_u32 s25, s25, 4096
v_mfma_f32_32x32x16_bf16 v[240:255], a[124:127], v[124:127], v[240:255]
s_waitcnt vmcnt(13)
v_mfma_f32_32x32x16_bf16 v[224:239], a[16:19], v[128:131], v[224:239]
buffer_load_dwordx4 v[176:179], v2, s[8:11], s25 offen offset:0 sc1
v_mfma_f32_32x32x16_bf16 v[240:255], a[128:131], v[128:131], v[240:255]
s_waitcnt vmcnt(13)
v_mfma_f32_32x32x16_bf16 v[224:239], a[20:23], v[132:135], v[224:239]
buffer_load_dwordx4 v[180:183], v2, s[8:11], s25 offen offset:1024 sc1
v_mfma_f32_32x32x16_bf16 v[240:255], a[132:135], v[132:135], v[240:255]
s_waitcnt vmcnt(13)
v_mfma_f32_32x32x16_bf16 v[224:239], a[24:27], v[136:139], v[224:239]
buffer_load_dwordx4 v[184:187], v2, s[8:11], s25 offen offset:2048 sc1
v_mfma_f32_32x32x16_bf16 v[240:255], a[136:139], v[136:139], v[240:255]
s_waitcnt vmcnt(13)
v_mfma_f32_32x32x16_bf16 v[224:239], a[28:31], v[140:143], v[224:239]
buffer_load_dwordx4 v[188:191], v2, s[8:11], s25 offen offset:3072 sc1
s_add_u32 s25, s25, 4096
v_mfma_f32_32x32x16_bf16 v[240:255], a[140:143], v[140:143], v[240:255]
s_waitcnt vmcnt(13)
v_mfma_f32_32x32x16_bf16 v[224:239], a[32:35], v[144:147], v[224:239]
buffer_load_dwordx4 v[192:195], v2, s[8:11], s25 offen offset:0 sc1
v_mfma_f32_32x32x16_bf16 v[240:255], a[144:147], v[144:147], v[240:255]
s_waitcnt vmcnt(13)
v_mfma_f32_32x32x16_bf16 v[224:239], a[36:39], v[148:151], v[224:239]
buffer_load_dwordx4 v[196:199], v2, s[8:11], s25 offen offset:1024 sc1
v_mfma_f32_32x32x16_bf16 v[240:255], a[148:151], v[148:151], v[240:255]
s_waitcnt vmcnt(13)
v_mfma_f32_32x32x16_bf16 v[224:239], a[40:43], v[152:155], v[224:239]
buffer_load_dwordx4 v[200:203], v2, s[8:11], s25 offen offset:2048 sc1
v_mfma_f32_32x32x16_bf16 v[240:255], a[152:155], v[152:155], v[240:255]
s_waitcnt vmcnt(13)
v_mfma_f32_32x32x16_bf16 v[224:239], a[44:47], v[156:159], v[224:239]
buffer_load_dwordx4 v[204:207], v2, s[8:11], s25 offen offset:3072 sc1
s_add_u32 s25, s25, 4096
v_mfma_f32_32x32x16_bf16 v[240:255], a[156:159], v[156:159], v[240:255]
s_waitcnt vmcnt(12)
v_mfma_f32_32x32x16_bf16 v[224:239], a[48:51], v[160:163], v[224:239]
buffer_load_dwordx4 v[208:211], v2, s[8:11], s25 offen offset:0 sc1
v_mfma_f32_32x32x16_bf16 v[240:255], a[160:163], v[160:163], v[240:255]
s_waitcnt vmcnt(12)
v_mfma_f32_32x32x16_bf16 v[224:239], a[52:55], v[164:167], v[224:239]
buffer_load_dwordx4 v[212:215], v2, s[8:11], s25 offen offset:1024 sc1
v_mfma_f32_32x32x16_bf16 v[240:255], a[164:167], v[164:167], v[240:255]
s_waitcnt vmcnt(12)
v_mfma_f32_32x32x16_bf16 v[224:239], a[56:59], v[168:171], v[224:239]
buffer_load_dwordx4 v[216:219], v2, s[8:11], s25 offen offset:2048 sc1
v_mfma_f32_32x32x16_bf16 v[240:255], a[168:171], v[168:171], v[240:255]
s_waitcnt vmcnt(11)
v_mfma_f32_32x32x16_bf16 v[224:239], a[60:63], v[172:175], v[224:239]
buffer_load_dwordx4 v[24:27], v10, s[8:11], s26 offen sc1
s_add_u32 s26, s26, 28672
buffer_load_dwordx4 v[220:223], v2, s[8:11], s25 offen offset:3072 sc1
s_add_u32 s25, s25, 90112
v_mfma_f32_32x32x16_bf16 v[240:255], a[172:175], v[172:175], v[240:255]
s_add_u32 s15, s15, 1
v_cmp_eq_u32 vcc, 0, v13
s_cmp_eq_u32 s15, 64
s_cselect_b64 vcc, -1, vcc
s_cbranch_vccnz F2_NP_491
s_waitcnt vmcnt(12)
v_mfma_f32_32x32x16_bf16 v[224:239], a[64:67], v[176:179], v[224:239]
buffer_load_dwordx4 v[112:115], v2, s[8:11], s25 offen offset:0 sc1
v_mfma_f32_32x32x16_bf16 v[240:255], a[176:179], v[176:179], v[240:255]
s_waitcnt vmcnt(12)
v_mfma_f32_32x32x16_bf16 v[224:239], a[68:71], v[180:183], v[224:239]
buffer_load_dwordx4 v[116:119], v2, s[8:11], s25 offen offset:1024 sc1
v_mfma_f32_32x32x16_bf16 v[240:255], a[180:183], v[180:183], v[240:255]
s_waitcnt vmcnt(12)
v_mfma_f32_32x32x16_bf16 v[224:239], a[72:75], v[184:187], v[224:239]
buffer_load_dwordx4 v[120:123], v2, s[8:11], s25 offen offset:2048 sc1
v_mfma_f32_32x32x16_bf16 v[240:255], a[184:187], v[184:187], v[240:255]
s_waitcnt vmcnt(12)
v_mfma_f32_32x32x16_bf16 v[224:239], a[76:79], v[188:191], v[224:239]
buffer_load_dwordx4 v[124:127], v2, s[8:11], s25 offen offset:3072 sc1
s_add_u32 s25, s25, 4096
v_mfma_f32_32x32x16_bf16 v[240:255], a[188:191], v[188:191], v[240:255]
s_waitcnt vmcnt(12)
v_mfma_f32_32x32x16_bf16 v[224:239], a[80:83], v[192:195], v[224:239]
buffer_load_dwordx4 v[128:131], v2, s[8:11], s25 offen offset:0 sc1
v_mfma_f32_32x32x16_bf16 v[240:255], a[192:195], v[192:195], v[240:255]
s_waitcnt vmcnt(12)
v_mfma_f32_32x32x16_bf16 v[224:239], a[84:87], v[196:199], v[224:239]
buffer_load_dwordx4 v[132:135], v2, s[8:11], s25 offen offset:1024 sc1
v_mfma_f32_32x32x16_bf16 v[240:255], a[196:199], v[196:199], v[240:255]
s_waitcnt vmcnt(12)
v_mfma_f32_32x32x16_bf16 v[224:239], a[88:91], v[200:203], v[224:239]
buffer_load_dwordx4 v[136:139], v2, s[8:11], s25 offen offset:2048 sc1
v_mfma_f32_32x32x16_bf16 v[240:255], a[200:203], v[200:203], v[240:255]
s_waitcnt vmcnt(12)
v_mfma_f32_32x32x16_bf16 v[224:239], a[92:95], v[204:207], v[224:239]
buffer_load_dwordx4 v[140:143], v2, s[8:11], s25 offen offset:3072 sc1
s_add_u32 s25, s25, 4096
v_mfma_f32_32x32x16_bf16 v[240:255], a[204:207], v[204:207], v[240:255]
s_waitcnt vmcnt(12)
v_mfma_f32_32x32x16_bf16 v[224:239], a[96:99], v[208:211], v[224:239]
buffer_load_dwordx4 v[144:147], v2, s[8:11], s25 offen offset:0 sc1
v_mfma_f32_32x32x16_bf16 v[240:255], a[208:211], v[208:211], v[240:255]
s_waitcnt vmcnt(12)
v_mfma_f32_32x32x16_bf16 v[224:239], a[100:103], v[212:215], v[224:239]
buffer_load_dwordx4 v[148:151], v2, s[8:11], s25 offen offset:1024 sc1
v_mfma_f32_32x32x16_bf16 v[240:255], a[212:215], v[212:215], v[240:255]
s_waitcnt vmcnt(12)
v_mfma_f32_32x32x16_bf16 v[224:239], a[104:107], v[216:219], v[224:239]
buffer_load_dwordx4 v[152:155], v2, s[8:11], s25 offen offset:2048 sc1
v_mfma_f32_32x32x16_bf16 v[240:255], a[216:219], v[216:219], v[240:255]
s_waitcnt vmcnt(11)
v_mfma_f32_32x32x16_bf16 v[224:239], a[108:111], v[220:223], v[224:239]
buffer_load_dwordx4 v[156:159], v2, s[8:11], s25 offen offset:3072 sc1
s_add_u32 s25, s25, 4096
v_mfma_f32_32x32x16_bf16 v[240:255], a[220:223], v[220:223], v[240:255]
s_nop 10
s_branch F2_W0_466
F2_NP_491:
s_waitcnt vmcnt(12)
v_mfma_f32_32x32x16_bf16 v[224:239], a[64:67], v[176:179], v[224:239]
v_mfma_f32_32x32x16_bf16 v[240:255], a[176:179], v[176:179], v[240:255]
s_waitcnt vmcnt(11)
v_mfma_f32_32x32x16_bf16 v[224:239], a[68:71], v[180:183], v[224:239]
v_mfma_f32_32x32x16_bf16 v[240:255], a[180:183], v[180:183], v[240:255]
s_waitcnt vmcnt(10)
v_mfma_f32_32x32x16_bf16 v[224:239], a[72:75], v[184:187], v[224:239]
v_mfma_f32_32x32x16_bf16 v[240:255], a[184:187], v[184:187], v[240:255]
s_waitcnt vmcnt(9)
v_mfma_f32_32x32x16_bf16 v[224:239], a[76:79], v[188:191], v[224:239]
v_mfma_f32_32x32x16_bf16 v[240:255], a[188:191], v[188:191], v[240:255]
s_waitcnt vmcnt(8)
v_mfma_f32_32x32x16_bf16 v[224:239], a[80:83], v[192:195], v[224:239]
v_mfma_f32_32x32x16_bf16 v[240:255], a[192:195], v[192:195], v[240:255]
s_waitcnt vmcnt(7)
v_mfma_f32_32x32x16_bf16 v[224:239], a[84:87], v[196:199], v[224:239]
buffer_load_dword v13, v7, s[8:11], s29 offen sc1
v_mfma_f32_32x32x16_bf16 v[240:255], a[196:199], v[196:199], v[240:255]
s_waitcnt vmcnt(7)
v_mfma_f32_32x32x16_bf16 v[224:239], a[88:91], v[200:203], v[224:239]
s_waitcnt vmcnt(6)
v_mfma_f32_32x32x16_bf16 v[224:239], a[92:95], v[204:207], v[224:239]
s_waitcnt vmcnt(5)
v_mfma_f32_32x32x16_bf16 v[224:239], a[96:99], v[208:211], v[224:239]
s_waitcnt vmcnt(4)
v_mfma_f32_32x32x16_bf16 v[224:239], a[100:103], v[212:215], v[224:239]
s_waitcnt vmcnt(3)
v_mfma_f32_32x32x16_bf16 v[224:239], a[104:107], v[216:219], v[224:239]
s_waitcnt vmcnt(1)
v_mfma_f32_32x32x16_bf16 v[224:239], a[108:111], v[220:223], v[224:239]
v_mfma_f32_32x32x16_bf16 v[240:255], a[200:203], v[200:203], v[240:255]
s_nop 4
v_mfma_f32_32x32x16_bf16 v[240:255], a[204:207], v[204:207], v[240:255]
s_nop 4
v_mfma_f32_32x32x16_bf16 v[240:255], a[208:211], v[208:211], v[240:255]
ds_write_b128 v14, v[224:227] offset:0
v_mfma_f32_32x32x16_bf16 v[240:255], a[212:215], v[212:215], v[240:255]
ds_write_b128 v14, v[228:231] offset:1280
v_mfma_f32_32x32x16_bf16 v[240:255], a[216:219], v[216:219], v[240:255]
ds_write_b128 v14, v[232:235] offset:2560
v_mfma_f32_32x32x16_bf16 v[240:255], a[220:223], v[220:223], v[240:255]
ds_write_b128 v14, v[236:239] offset:3840
s_waitcnt vmcnt(0)
v_cmp_eq_u32 vcc, 0, v13
s_cmp_eq_u32 s15, 64
s_cselect_b64 vcc, -1, vcc
s_cbranch_vccnz F2_CE_492
buffer_load_dwordx4 v[112:115], v2, s[8:11], s25 offen offset:0 sc1
buffer_load_dwordx4 v[116:119], v2, s[8:11], s25 offen offset:1024 sc1
s_nop 3
ds_write_b128 v14, v[240:243] offset:5120
buffer_load_dwordx4 v[120:123], v2, s[8:11], s25 offen offset:2048 sc1
ds_write_b128 v14, v[244:247] offset:6400
buffer_load_dwordx4 v[124:127], v2, s[8:11], s25 offen offset:3072 sc1
s_add_u32 s25, s25, 4096
ds_write_b128 v14, v[248:251] offset:7680
buffer_load_dwordx4 v[128:131], v2, s[8:11], s25 offen offset:0 sc1
ds_write_b128 v14, v[252:255] offset:8960
buffer_load_dwordx4 v[132:135], v2, s[8:11], s25 offen offset:1024 sc1
buffer_load_dwordx4 v[136:139], v2, s[8:11], s25 offen offset:2048 sc1
buffer_load_dwordx4 v[140:143], v2, s[8:11], s25 offen offset:3072 sc1
s_add_u32 s25, s25, 4096
buffer_load_dwordx4 v[144:147], v2, s[8:11], s25 offen offset:0 sc1
buffer_load_dwordx4 v[148:151], v2, s[8:11], s25 offen offset:1024 sc1
buffer_load_dwordx4 v[152:155], v2, s[8:11], s25 offen offset:2048 sc1
buffer_load_dwordx4 v[156:159], v2, s[8:11], s25 offen offset:3072 sc1
s_add_u32 s25, s25, 4096
s_waitcnt lgkmcnt(0)
s_barrier
ds_read_b128 v[80:83], v15 offset:0
ds_read_b128 v[84:87], v15 offset:1280
ds_read_b128 v[88:91], v15 offset:10240
ds_read_b128 v[92:95], v15 offset:11520
ds_read_b128 v[96:99], v15 offset:20480
ds_read_b128 v[100:103], v15 offset:21760
ds_read_b128 v[104:107], v15 offset:30720
ds_read_b128 v[108:111], v15 offset:32000
v_lshlrev_b32 v224, 16, v24
v_and_b32 v225, 0xffff0000, v24
v_lshlrev_b32 v226, 16, v25
v_and_b32 v227, 0xffff0000, v25
v_lshlrev_b32 v228, 16, v26
v_and_b32 v229, 0xffff0000, v26
v_lshlrev_b32 v230, 16, v27
v_and_b32 v231, 0xffff0000, v27
s_waitcnt lgkmcnt(6)
v_pk_add_f32 v[224:225], v[224:225], v[80:81]
v_pk_add_f32 v[226:227], v[226:227], v[82:83]
v_pk_add_f32 v[228:229], v[228:229], v[84:85]
v_pk_add_f32 v[230:231], v[230:231], v[86:87]
s_waitcnt lgkmcnt(4)
v_pk_add_f32 v[224:225], v[224:225], v[88:89]
v_pk_add_f32 v[226:227], v[226:227], v[90:91]
v_pk_add_f32 v[228:229], v[228:229], v[92:93]
v_pk_add_f32 v[230:231], v[230:231], v[94:95]
s_waitcnt lgkmcnt(2)
v_pk_add_f32 v[224:225], v[224:225], v[96:97]
v_pk_add_f32 v[226:227], v[226:227], v[98:99]
v_pk_add_f32 v[228:229], v[228:229], v[100:101]
v_pk_add_f32 v[230:231], v[230:231], v[102:103]
s_waitcnt lgkmcnt(0)
v_pk_add_f32 v[224:225], v[224:225], v[104:105]
v_pk_add_f32 v[226:227], v[226:227], v[106:107]
v_pk_add_f32 v[228:229], v[228:229], v[108:109]
v_pk_add_f32 v[230:231], v[230:231], v[110:111]
v_cvt_pk_bf16_f32 v24, v224, v225
v_cvt_pk_bf16_f32 v25, v226, v227
v_cvt_pk_bf16_f32 v26, v228, v229
v_cvt_pk_bf16_f32 v27, v230, v231
buffer_store_dwordx4 v[24:27], v12, s[40:43], s35 offen
s_add_u32 s35, s35, 28672
s_branch F2_P0_468
F2_CE_492:
s_nop 5
ds_write_b128 v14, v[240:243] offset:5120
ds_write_b128 v14, v[244:247] offset:6400
ds_write_b128 v14, v[248:251] offset:7680
ds_write_b128 v14, v[252:255] offset:8960
s_waitcnt lgkmcnt(0)
s_barrier
ds_read_b128 v[80:83], v15 offset:0
ds_read_b128 v[84:87], v15 offset:1280
ds_read_b128 v[88:91], v15 offset:10240
ds_read_b128 v[92:95], v15 offset:11520
ds_read_b128 v[96:99], v15 offset:20480
ds_read_b128 v[100:103], v15 offset:21760
ds_read_b128 v[104:107], v15 offset:30720
ds_read_b128 v[108:111], v15 offset:32000
v_lshlrev_b32 v224, 16, v24
v_and_b32 v225, 0xffff0000, v24
v_lshlrev_b32 v226, 16, v25
v_and_b32 v227, 0xffff0000, v25
v_lshlrev_b32 v228, 16, v26
v_and_b32 v229, 0xffff0000, v26
v_lshlrev_b32 v230, 16, v27
v_and_b32 v231, 0xffff0000, v27
s_waitcnt lgkmcnt(6)
v_pk_add_f32 v[224:225], v[224:225], v[80:81]
v_pk_add_f32 v[226:227], v[226:227], v[82:83]
v_pk_add_f32 v[228:229], v[228:229], v[84:85]
v_pk_add_f32 v[230:231], v[230:231], v[86:87]
s_waitcnt lgkmcnt(4)
v_pk_add_f32 v[224:225], v[224:225], v[88:89]
v_pk_add_f32 v[226:227], v[226:227], v[90:91]
v_pk_add_f32 v[228:229], v[228:229], v[92:93]
v_pk_add_f32 v[230:231], v[230:231], v[94:95]
s_waitcnt lgkmcnt(2)
v_pk_add_f32 v[224:225], v[224:225], v[96:97]
v_pk_add_f32 v[226:227], v[226:227], v[98:99]
v_pk_add_f32 v[228:229], v[228:229], v[100:101]
v_pk_add_f32 v[230:231], v[230:231], v[102:103]
s_waitcnt lgkmcnt(0)
v_pk_add_f32 v[224:225], v[224:225], v[104:105]
v_pk_add_f32 v[226:227], v[226:227], v[106:107]
v_pk_add_f32 v[228:229], v[228:229], v[108:109]
v_pk_add_f32 v[230:231], v[230:231], v[110:111]
v_cvt_pk_bf16_f32 v24, v224, v225
v_cvt_pk_bf16_f32 v25, v226, v227
v_cvt_pk_bf16_f32 v26, v228, v229
v_cvt_pk_bf16_f32 v27, v230, v231
buffer_store_dwordx4 v[24:27], v12, s[40:43], s35 offen
s_add_u32 s35, s35, 28672
buffer_load_dword v13, v7, s[8:11], s29 offen sc1
s_cmp_ge_u32 s15, 64
s_cbranch_scc0 OPT_493
s_endpgm
OPT_493:
s_waitcnt vmcnt(0)
s_branch F2_C0_464
M_EXIT:
s_endpgm
GI_10_p:
s_sleep 4
buffer_load_dword v22, off, s[92:95], 0 offset:176 sc1
s_sub_u32 s16, s16, 1
s_waitcnt vmcnt(0)
s_cbranch_scc0 GI_10
s_mov_b32 s16, 0
s_branch GI_10_ok

GI_13_p:
s_sleep 4
buffer_load_dword v22, off, s[92:95], 0 offset:176 sc1
s_sub_u32 s16, s16, 1
s_waitcnt vmcnt(0)
s_cbranch_scc0 GI_13
s_mov_b32 s16, 0
s_branch GI_13_ok

GI_16_p:
s_sleep 4
buffer_load_dword v22, off, s[92:95], 0 offset:176 sc1
s_sub_u32 s16, s16, 1
s_waitcnt vmcnt(0)
s_cbranch_scc0 GI_16
s_mov_b32 s16, 0
s_branch GI_16_ok

GI_19_p:
s_sleep 4
buffer_load_dword v22, off, s[92:95], 0 offset:176 sc1
s_sub_u32 s16, s16, 1
s_waitcnt vmcnt(0)
s_cbranch_scc0 GI_19
s_mov_b32 s16, 0
s_branch GI_19_ok

WC_63_ab:
s_mov_b32 s16, 0
s_waitcnt vmcnt(0)
s_branch WC_63_d

WC_64_ab:
s_mov_b32 s16, 0
s_waitcnt vmcnt(0)
s_branch WC_64_d

WFD_70_abort:
s_mov_b32 s16, 0
s_waitcnt vmcnt(0)
s_branch WFD_70

WFD_73_abort:
s_mov_b32 s16, 0
s_waitcnt vmcnt(0)
s_branch WFD_73

WFD_76_abort:
s_mov_b32 s16, 0
s_waitcnt vmcnt(0)
s_branch WFD_76

WFD_79_abort:
s_mov_b32 s16, 0
s_waitcnt vmcnt(0)
s_branch WFD_79

WFD_82_abort:
s_mov_b32 s16, 0
s_waitcnt vmcnt(0)
s_branch WFD_82

WFD_85_abort:
s_mov_b32 s16, 0
s_waitcnt vmcnt(0)
s_branch WFD_85

WFD_89_abort:
s_mov_b32 s16, 0
s_waitcnt vmcnt(0)
s_branch WFD_89

PL_I_90_p:
s_sleep 8
buffer_load_dword v56, off, s[92:95], 0 offset:16 sc1
s_sub_u32 s16, s16, 1
s_waitcnt vmcnt(0)
s_cbranch_scc0 PL_I_90
s_mov_b32 s16, 0
s_branch PL_I_90_ok

PP_95_abort:
s_mov_b32 s16, 0
s_waitcnt vmcnt(0)
s_branch PP_95_d1

PP_97_abort:
s_mov_b32 s16, 0
s_waitcnt vmcnt(0)
s_branch PP_97_d1

PP_99_abort:
s_mov_b32 s16, 0
s_waitcnt vmcnt(0)
s_branch PP_99_d1

PP_101_abort:
s_mov_b32 s16, 0
s_waitcnt vmcnt(0)
s_branch PP_101_d1

WFD_103_abort:
s_mov_b32 s16, 0
s_waitcnt vmcnt(0)
s_branch WFD_103

WFD_106_abort:
s_mov_b32 s16, 0
s_waitcnt vmcnt(0)
s_branch WFD_106

WFD_109_abort:
s_mov_b32 s16, 0
s_waitcnt vmcnt(0)
s_branch WFD_109

WFD_112_abort:
s_mov_b32 s16, 0
s_waitcnt vmcnt(0)
s_branch WFD_112

WFD_115_abort:
s_mov_b32 s16, 0
s_waitcnt vmcnt(0)
s_branch WFD_115

WFD_118_abort:
s_mov_b32 s16, 0
s_waitcnt vmcnt(0)
s_branch WFD_118

WFD_122_abort:
s_mov_b32 s16, 0
s_waitcnt vmcnt(0)
s_branch WFD_122

PL_I_123_p:
s_sleep 8
buffer_load_dword v56, off, s[92:95], 0 offset:16 sc1
s_sub_u32 s16, s16, 1
s_waitcnt vmcnt(0)
s_cbranch_scc0 PL_I_123
s_mov_b32 s16, 0
s_branch PL_I_123_ok

PG_124_slow:
buffer_load_dword v129, v130, s[8:11], s35 offen sc1
s_sub_u32 s16, s16, 1
s_cbranch_scc1 PG_124_ab
s_waitcnt vmcnt(0)
s_branch PG_124
PG_124_ab:
s_mov_b32 s16, 0
s_waitcnt vmcnt(0)
s_branch PG_124_ok

PP_127_abort:
s_mov_b32 s16, 0
s_waitcnt vmcnt(0)
s_branch PP_127_d1

CA_PW_128:
ds_read_b32 v136, v60
ds_read_b64_tr_b16 v[64:65], v124 offset:0
ds_read_b64_tr_b16 v[66:67], v124 offset:128
ds_read_b128 v[80:83], v125 offset:20480
ds_read_b128 v[84:87], v125 offset:20992
ds_read_b64_tr_b16 v[68:69], v124 offset:1024
ds_read_b64_tr_b16 v[70:71], v124 offset:1152
ds_read_b128 v[88:91], v125 offset:21504
ds_read_b128 v[92:95], v125 offset:22016
ds_read_b64_tr_b16 v[72:73], v124 offset:2048
ds_read_b64_tr_b16 v[74:75], v124 offset:2176
ds_read_b128 v[96:99], v125 offset:22528
ds_read_b128 v[100:103], v125 offset:23040
s_waitcnt lgkmcnt(6)
v_cmp_lt_u32 vcc, v136, v62
s_cbranch_vccnz CA_PW_128
s_waitcnt lgkmcnt(0)
s_branch CA_PW_128_ok

CA_PW_129:
ds_read_b32 v136, v60
ds_read_b64_tr_b16 v[76:77], v124 offset:3072
ds_read_b64_tr_b16 v[78:79], v124 offset:3200
ds_read_b128 v[104:107], v125 offset:23552
ds_read_b128 v[108:111], v125 offset:24064
s_waitcnt lgkmcnt(2)
v_cmp_lt_u32 vcc, v136, v62
s_cbranch_vccnz CA_PW_129
s_waitcnt lgkmcnt(0)
s_branch CA_PW_129_ok

CA_PW_132:
ds_read_b32 v136, v60
ds_read_b64_tr_b16 v[64:65], v124 offset:4096
ds_read_b64_tr_b16 v[66:67], v124 offset:4224
s_waitcnt lgkmcnt(2)
v_cmp_lt_u32 vcc, v136, v62
s_cbranch_vccnz CA_PW_132
s_waitcnt lgkmcnt(0)
s_branch CA_PW_132_ok

CA_PW_134:
ds_read_b32 v136, v60
ds_read_b64_tr_b16 v[68:69], v124 offset:5120
ds_read_b64_tr_b16 v[70:71], v124 offset:5248
s_waitcnt lgkmcnt(2)
v_cmp_lt_u32 vcc, v136, v62
s_cbranch_vccnz CA_PW_134
s_waitcnt lgkmcnt(0)
s_branch CA_PW_134_ok

CA_PW_135:
ds_read_b32 v136, v60
ds_read_b64_tr_b16 v[72:73], v124 offset:6144
ds_read_b64_tr_b16 v[74:75], v124 offset:6272
s_waitcnt lgkmcnt(2)
v_cmp_lt_u32 vcc, v136, v62
s_cbranch_vccnz CA_PW_135
s_waitcnt lgkmcnt(0)
s_branch CA_PW_135_ok

PG_137_slow:
buffer_load_dword v129, v130, s[8:11], s35 offen sc1
s_sub_u32 s16, s16, 1
s_cbranch_scc1 PG_137_ab
s_waitcnt vmcnt(0)
s_branch PG_137
PG_137_ab:
s_mov_b32 s16, 0
s_waitcnt vmcnt(0)
s_branch PG_137_ok

PP_140_abort:
s_mov_b32 s16, 0
s_waitcnt vmcnt(0)
s_branch PP_140_d1

CA_PW_141:
ds_read_b32 v136, v60
ds_read_b64_tr_b16 v[64:65], v124 offset:0
ds_read_b64_tr_b16 v[66:67], v124 offset:128
ds_read_b128 v[80:83], v125 offset:20480
ds_read_b128 v[84:87], v125 offset:20992
ds_read_b64_tr_b16 v[68:69], v124 offset:1024
ds_read_b64_tr_b16 v[70:71], v124 offset:1152
ds_read_b128 v[88:91], v125 offset:21504
ds_read_b128 v[92:95], v125 offset:22016
ds_read_b64_tr_b16 v[72:73], v124 offset:2048
ds_read_b64_tr_b16 v[74:75], v124 offset:2176
ds_read_b128 v[96:99], v125 offset:22528
ds_read_b128 v[100:103], v125 offset:23040
s_waitcnt lgkmcnt(6)
v_cmp_lt_u32 vcc, v136, v62
s_cbranch_vccnz CA_PW_141
s_waitcnt lgkmcnt(0)
s_branch CA_PW_141_ok

CA_PW_142:
ds_read_b32 v136, v60
ds_read_b64_tr_b16 v[76:77], v124 offset:3072
ds_read_b64_tr_b16 v[78:79], v124 offset:3200
ds_read_b128 v[104:107], v125 offset:23552
ds_read_b128 v[108:111], v125 offset:24064
s_waitcnt lgkmcnt(2)
v_cmp_lt_u32 vcc, v136, v62
s_cbranch_vccnz CA_PW_142
s_waitcnt lgkmcnt(0)
s_branch CA_PW_142_ok

CA_PW_145:
ds_read_b32 v136, v60
ds_read_b64_tr_b16 v[64:65], v124 offset:4096
ds_read_b64_tr_b16 v[66:67], v124 offset:4224
s_waitcnt lgkmcnt(2)
v_cmp_lt_u32 vcc, v136, v62
s_cbranch_vccnz CA_PW_145
s_waitcnt lgkmcnt(0)
s_branch CA_PW_145_ok

CA_PW_147:
ds_read_b32 v136, v60
ds_read_b64_tr_b16 v[68:69], v124 offset:5120
ds_read_b64_tr_b16 v[70:71], v124 offset:5248
s_waitcnt lgkmcnt(2)
v_cmp_lt_u32 vcc, v136, v62
s_cbranch_vccnz CA_PW_147
s_waitcnt lgkmcnt(0)
s_branch CA_PW_147_ok

CA_PW_148:
ds_read_b32 v136, v60
ds_read_b64_tr_b16 v[72:73], v124 offset:6144
ds_read_b64_tr_b16 v[74:75], v124 offset:6272
s_waitcnt lgkmcnt(2)
v_cmp_lt_u32 vcc, v136, v62
s_cbranch_vccnz CA_PW_148
s_waitcnt lgkmcnt(0)
s_branch CA_PW_148_ok

PG_150_slow:
buffer_load_dword v129, v130, s[8:11], s35 offen sc1
s_sub_u32 s16, s16, 1
s_cbranch_scc1 PG_150_ab
s_waitcnt vmcnt(0)
s_branch PG_150
PG_150_ab:
s_mov_b32 s16, 0
s_waitcnt vmcnt(0)
s_branch PG_150_ok

WFD_153_abort:
s_mov_b32 s16, 0
s_waitcnt vmcnt(0)
s_branch WFD_153

WFD_156_abort:
s_mov_b32 s16, 0
s_waitcnt vmcnt(0)
s_branch WFD_156

WFD_159_abort:
s_mov_b32 s16, 0
s_waitcnt vmcnt(0)
s_branch WFD_159

WFD_162_abort:
s_mov_b32 s16, 0
s_waitcnt vmcnt(0)
s_branch WFD_162

WFD_165_abort:
s_mov_b32 s16, 0
s_waitcnt vmcnt(0)
s_branch WFD_165

WFD_168_abort:
s_mov_b32 s16, 0
s_waitcnt vmcnt(0)
s_branch WFD_168

WFD_172_abort:
s_mov_b32 s16, 0
s_waitcnt vmcnt(0)
s_branch WFD_172

PL_I_173_p:
s_sleep 8
buffer_load_dword v120, off, s[92:95], 0 offset:16 sc1
s_sub_u32 s16, s16, 1
s_waitcnt vmcnt(0)
s_cbranch_scc0 PL_I_173
s_mov_b32 s16, 0
s_branch PL_I_173_ok

POLLD_179_abort:
s_mov_b32 s16, 0
s_waitcnt vmcnt(0)
s_branch POLLD_179

PG_190_slow:
buffer_load_dword v3, v2, s[8:11], s35 offen sc1
s_sub_u32 s16, s16, 1
s_cbranch_scc1 PG_190_ab
s_waitcnt vmcnt(0)
s_branch PG_190
PG_190_ab:
s_mov_b32 s16, 0
s_waitcnt vmcnt(0)
s_branch PG_190_ok

PP_191_abort:
s_mov_b32 s16, 0
s_waitcnt vmcnt(0)
s_branch PP_191_d1

POLLD_196_abort:
s_mov_b32 s16, 0
s_waitcnt vmcnt(0)
s_branch POLLD_196

PG_207_slow:
buffer_load_dword v3, v2, s[8:11], s35 offen sc1
s_sub_u32 s16, s16, 1
s_cbranch_scc1 PG_207_ab
s_waitcnt vmcnt(0)
s_branch PG_207
PG_207_ab:
s_mov_b32 s16, 0
s_waitcnt vmcnt(0)
s_branch PG_207_ok

PP_208_abort:
s_mov_b32 s16, 0
s_waitcnt vmcnt(0)
s_branch PP_208_d1

WFD_212_abort:
s_mov_b32 s16, 0
s_waitcnt vmcnt(0)
s_branch WFD_212

WFD_215_abort:
s_mov_b32 s16, 0
s_waitcnt vmcnt(0)
s_branch WFD_215

WFD_218_abort:
s_mov_b32 s16, 0
s_waitcnt vmcnt(0)
s_branch WFD_218

WFD_221_abort:
s_mov_b32 s16, 0
s_waitcnt vmcnt(0)
s_branch WFD_221

WFD_224_abort:
s_mov_b32 s16, 0
s_waitcnt vmcnt(0)
s_branch WFD_224

WFD_227_abort:
s_mov_b32 s16, 0
s_waitcnt vmcnt(0)
s_branch WFD_227

WFD_230_abort:
s_mov_b32 s16, 0
s_waitcnt vmcnt(0)
s_branch WFD_230

WFD_233_abort:
s_mov_b32 s16, 0
s_waitcnt vmcnt(0)
s_branch WFD_233

WFD_237_abort:
s_mov_b32 s16, 0
s_waitcnt vmcnt(0)
s_branch WFD_237

PL_I_238_p:
s_sleep 8
buffer_load_dword v113, off, s[92:95], 0 offset:16 sc1
s_sub_u32 s16, s16, 1
s_waitcnt vmcnt(0)
s_cbranch_scc0 PL_I_238
s_mov_b32 s16, 0
s_branch PL_I_238_ok

WC_242_ab:
s_mov_b32 s16, 0
s_waitcnt vmcnt(0)
s_branch WC_242_d

WFD_244_abort:
s_mov_b32 s16, 0
s_waitcnt vmcnt(0)
s_branch WFD_244

POLLD_255_abort:
s_mov_b32 s16, 0
s_waitcnt vmcnt(0)
s_branch POLLD_255

WFD_257_abort:
s_mov_b32 s16, 0
s_waitcnt vmcnt(0)
s_branch WFD_257

WFD_260_abort:
s_mov_b32 s16, 0
s_waitcnt vmcnt(0)
s_branch WFD_260

WFD_263_abort:
s_mov_b32 s16, 0
s_waitcnt vmcnt(0)
s_branch WFD_263

WFD_266_abort:
s_mov_b32 s16, 0
s_waitcnt vmcnt(0)
s_branch WFD_266

WFD_269_abort:
s_mov_b32 s16, 0
s_waitcnt vmcnt(0)
s_branch WFD_269

WFD_272_abort:
s_mov_b32 s16, 0
s_waitcnt vmcnt(0)
s_branch WFD_272

WFD_276_abort:
s_mov_b32 s16, 0
s_waitcnt vmcnt(0)
s_branch WFD_276

PL_I_277_p:
s_sleep 8
buffer_load_dword v3, off, s[92:95], 0 offset:16 sc1
s_sub_u32 s16, s16, 1
s_waitcnt vmcnt(0)
s_cbranch_scc0 PL_I_277
s_mov_b32 s16, 0
s_branch PL_I_277_ok

U_X0_278_p:
buffer_load_dword v17, off, s[92:95], 0 offset:144 sc1
s_sub_u32 s16, s16, 1
s_waitcnt vmcnt(0)
s_cbranch_scc0 U_X0_278
s_mov_b32 s16, 0
s_branch U_X0_278_ok

WFD_285_abort:
s_mov_b32 s16, 0
s_waitcnt vmcnt(0)
s_branch WFD_285

WFD_321_abort:
s_mov_b32 s16, 0
s_waitcnt vmcnt(0)
s_branch WFD_321

WFD_335_abort:
s_mov_b32 s16, 0
s_waitcnt vmcnt(0)
s_branch WFD_335

WC_348_ab:
s_mov_b32 s16, 0
s_waitcnt vmcnt(0)
s_branch WC_348_d

WFD_351_abort:
s_mov_b32 s16, 0
s_waitcnt vmcnt(0)
s_branch WFD_351

POLLD_353_abort:
s_mov_b32 s16, 0
s_waitcnt vmcnt(0)
s_branch POLLD_353

POLLD_357_abort:
s_mov_b32 s16, 0
s_waitcnt vmcnt(0)
s_branch POLLD_357

WFD_362_abort:
s_mov_b32 s16, 0
s_waitcnt vmcnt(0)
s_branch WFD_362

POLLD_364_abort:
s_mov_b32 s16, 0
s_waitcnt vmcnt(0)
s_branch POLLD_364

POLLD_368_abort:
s_mov_b32 s16, 0
s_waitcnt vmcnt(0)
s_branch POLLD_368

WC_373_ab:
s_mov_b32 s16, 0
s_waitcnt vmcnt(0)
s_branch WC_373_d

WFD_376_abort:
s_mov_b32 s16, 0
s_waitcnt vmcnt(0)
s_branch WFD_376

POLLD_378_abort:
s_mov_b32 s16, 0
s_waitcnt vmcnt(0)
s_branch POLLD_378

POLLD_382_abort:
s_mov_b32 s16, 0
s_waitcnt vmcnt(0)
s_branch POLLD_382

WFD_387_abort:
s_mov_b32 s16, 0
s_waitcnt vmcnt(0)
s_branch WFD_387

POLLD_389_abort:
s_mov_b32 s16, 0
s_waitcnt vmcnt(0)
s_branch POLLD_389

POLLD_393_abort:
s_mov_b32 s16, 0
s_waitcnt vmcnt(0)
s_branch POLLD_393

WFD_406_abort:
s_mov_b32 s16, 0
s_waitcnt vmcnt(0)
s_branch WFD_406

WFD_436_abort:
s_mov_b32 s16, 0
s_waitcnt vmcnt(0)
s_branch WFD_436

WFD_472_abort:
s_mov_b32 s16, 0
s_waitcnt vmcnt(0)
s_branch WFD_472

WFD_484_abort:
s_mov_b32 s16, 0
s_waitcnt vmcnt(0)
s_branch WFD_484

K_END:

.section .rodata,"a"
.p2align 6
.amdhsa_kernel interleave_layers__memory_aug_recurrent_mem_tr__swiglu_ffn__prompt_kernel
  .amdhsa_next_free_vgpr 512
  .amdhsa_next_free_sgpr 102
  .amdhsa_accum_offset 256
  .amdhsa_group_segment_fixed_size 0
  .amdhsa_kernarg_size 112
  .amdhsa_user_sgpr_count 2
  .amdhsa_user_sgpr_kernarg_segment_ptr 1
  .amdhsa_system_sgpr_workgroup_id_x 1
.end_amdhsa_kernel
```
